```python
import torch

def _softmax(x, axis=-1):
    return torch.softmax(x, dim=axis)
def _gelu(x):
    return torch.nn.functional.gelu(x, approximate="tanh")
def _silu(x):
    return torch.nn.functional.silu(x)
def _sigmoid(x):
    return torch.sigmoid(x)
def _layernorm(x, axis=-1, eps=1e-5):
    m = x.mean(dim=axis, keepdim=True)
    v = x.var(dim=axis, keepdim=True, unbiased=False)
    return (x - m) / torch.sqrt(v + eps)
def _scatter_add(tgt, idx, src, axis=0):
    return tgt.clone().index_add_(axis, idx, src)
def _segment_sum(src, seg, n):
    out = torch.zeros((n,) + src.shape[1:], dtype=src.dtype)
    return out.index_add_(0, seg, src)
def _pad(x, pw):
    flat = tuple(v for pair in reversed(pw) for v in pair)
    return torch.nn.functional.pad(x, flat)

kernel_name = 'recurrent_scan__spectral_fnet__glu_gated_bilinear__prompt'

def setup_inputs():

    _w = (lambda a: (lambda t: t.to(torch.bfloat16) if t.is_floating_point() else t)(torch.as_tensor(a)))
    def _A_setup():
        B, S, D = 1, 2048, 1024
        ns = torch.arange(S)[:, None] * torch.arange(S)[None, :]
        nd = torch.arange(D)[:, None] * torch.arange(D)[None, :]
        Ws_re = torch.cos(-2.0 * torch.pi * ns / S).to(float)
        Ws_im = torch.sin(-2.0 * torch.pi * ns / S).to(float)
        Wd_re = torch.cos(-2.0 * torch.pi * nd / D).to(float)
        Wd_im = torch.sin(-2.0 * torch.pi * nd / D).to(float)
        return {
            "x": _w((lambda *s: torch.randn(*s, dtype=torch.bfloat16) * 0.05)(B, S, D)),
            "dft_seq_re": _w(Ws_re),
            "dft_seq_im": _w(Ws_im),
            "dft_hid_re": _w(Wd_re),
            "dft_hid_im": _w(Wd_im),
        }
    _A_in = _A_setup()

    def _B_setup():
        B, S, D, F = 1, 2048, 1024, 3584
        return {
            "x": _w((lambda *s: torch.randn(*s, dtype=torch.bfloat16) * 0.05)(B, S, D)),
            "w_gate": _w((lambda *s: torch.randn(*s, dtype=torch.bfloat16) * 0.05)(D, F) * (D ** -0.5)),
            "w_up": _w((lambda *s: torch.randn(*s, dtype=torch.bfloat16) * 0.05)(D, F) * (D ** -0.5)),
            "w_down": _w((lambda *s: torch.randn(*s, dtype=torch.bfloat16) * 0.05)(F, D) * (F ** -0.5)),
        }
    _B_in = _B_setup()

    return {
        "A_x": _A_in["x"],
        "A_dft_seq_re": _A_in["dft_seq_re"],
        "A_dft_seq_im": _A_in["dft_seq_im"],
        "A_dft_hid_re": _A_in["dft_hid_re"],
        "A_dft_hid_im": _A_in["dft_hid_im"],
        "B_x": _B_in["x"],
        "B_w_gate": _B_in["w_gate"],
        "B_w_up": _B_in["w_up"],
        "B_w_down": _B_in["w_down"],
    }

def reference(A_x, A_dft_seq_re, A_dft_seq_im, A_dft_hid_re, A_dft_hid_im, B_x, B_w_gate, B_w_up, B_w_down):
    def _A_ref(x, dft_seq_re, dft_seq_im, dft_hid_re, dft_hid_im):
        a = torch.einsum("bsd,ed->bse", x, dft_hid_re)
        b = torch.einsum("bsd,ed->bse", x, dft_hid_im)
        y = torch.einsum("ts,bse->bte", dft_seq_re, a) - torch.einsum("ts,bse->bte", dft_seq_im, b)
        return y

    def _B_ref(x, w_gate, w_up, w_down):
        g = torch.einsum("bsd,df->bsf", x, w_gate)
        u = torch.einsum("bsd,df->bsf", x, w_up)
        h = g * u
        return torch.einsum("bsf,fd->bsd", h, w_down)

    x = A_x
    xn = _layernorm(x, axis=-1)
    s = _A_ref(xn, A_dft_seq_re, A_dft_seq_im, A_dft_hid_re, A_dft_hid_im)
    g = _silu(_B_ref(xn, B_w_gate, B_w_up, B_w_down))
    return x + s * g
```

```asm
; @launch kernel=recurrent_scan__spectral_fnet__glu_gated_bilinear__prompt_kernel grid=(256,1,1) block=(256,1,1) lds=163840
.amdgcn_target "amdgcn-amd-amdhsa--gfx950"
.text
.globl recurrent_scan__spectral_fnet__glu_gated_bilinear__prompt_kernel
.p2align 8
.type recurrent_scan__spectral_fnet__glu_gated_bilinear__prompt_kernel,@function
recurrent_scan__spectral_fnet__glu_gated_bilinear__prompt_kernel:
    s_cmp_ge_u32 s2, 256
    s_cbranch_scc1 L_done
    s_load_dwordx2 s[6:7], s[0:1], 0
    s_load_dwordx2 s[4:5], s[0:1], 88
    s_load_dwordx8 s[84:91], s[0:1], 8
    s_load_dwordx4 s[8:11], s[0:1], 48
    s_load_dwordx2 s[44:45], s[0:1], 64
    s_load_dwordx2 s[60:61], s[0:1], 72
    s_load_dwordx2 s[92:93], s[0:1], 80
    s_memrealtime s[62:63]
    v_lshrrev_b32 v1, 6, v0
    s_and_b32 s27, s2, 7
    v_readfirstlane_b32 s24, v1
    v_and_b32 v1, 63, v0
    s_nop 2
    s_add_u32 s76, s2, 1
    s_and_b32 s76, s76, 255
    s_add_u32 s28, s76, 0
    s_sub_u32 s29, 2048, s28
    s_cmp_eq_u32 s24, 0
    s_cselect_b32 s29, s28, s29
    s_sub_u32 s30, 1024, s28
    s_cmp_eq_u32 s24, 2
    s_cselect_b32 s29, s30, s29
    s_add_u32 s30, 1024, s28
    s_cmp_eq_u32 s24, 3
    s_cselect_b32 s36, s30, s29
    s_add_u32 s28, s76, 256
    s_sub_u32 s29, 2048, s28
    s_cmp_eq_u32 s24, 0
    s_cselect_b32 s29, s28, s29
    s_sub_u32 s30, 1024, s28
    s_cmp_eq_u32 s24, 2
    s_cselect_b32 s29, s30, s29
    s_add_u32 s30, 1024, s28
    s_cmp_eq_u32 s24, 3
    s_cselect_b32 s37, s30, s29
    s_lshl_b32 s28, s24, 10
    s_lshl_b32 s29, s24, 8
    s_or_b32 s28, s28, s29
    s_and_b32 s28, s28, 1536
    s_cmp_eq_u32 s76, 0
    s_cselect_b32 s36, s28, s36
    s_lshl_b32 s36, s36, 11
    s_lshl_b32 s37, s37, 11
    v_lshlrev_b32 v44, 4, v1
    s_waitcnt lgkmcnt(0)
    s_mov_b32 s12, s6
    s_mov_b32 s13, s7
    s_mov_b32 s14, 4194304
    s_mov_b32 s15, 0x00020000
    s_add_u32 s48, s4, 35651584
    s_addc_u32 s49, s5, 0
    s_mov_b32 s50, 8192
    s_mov_b32 s51, 0x00020000
    s_mov_b32 s94, 256
    s_mov_b32 s95, 0x00020000
    v_mov_b32 v60, 0
    s_cmp_lg_u32 s2, 255
    s_cbranch_scc1 L_nogen
    s_cmp_lg_u32 s24, 0
    s_cbranch_scc1 L_nogen
    s_or_b32 s62, s62, 1
    v_mov_b32 v61, s62
    s_mov_b64 exec, 1
    buffer_store_dword v61, v60, s[92:95], 0 offen sc1
    s_mov_b64 exec, -1
L_nogen:
    buffer_load_dwordx4 v[64:67], v44, s[12:15], s36 offen
    buffer_load_dwordx4 v[68:71], v44, s[12:15], s36 offen offset:1024
    buffer_load_dwordx4 v[72:75], v44, s[12:15], s37 offen
    buffer_load_dwordx4 v[76:79], v44, s[12:15], s37 offen offset:1024
    s_getpc_b64 s[80:81]
L_pc0:
    s_mov_b32 s82, L_end-L_pc0
    s_mov_b32 s83, 0x00020000
    v_lshlrev_b32 v36, 6, v1
    s_lshl_b32 s79, s24, 12
    s_lshr_b32 s3, s2, 3
    s_cmp_ge_u32 s3, 28
    s_cbranch_scc1 L_dft
    s_lshr_b32 s25, s27, 1
    s_and_b32 s26, s27, 1
    s_cmp_ge_u32 s3, 24
    s_cbranch_scc1 L_shr
    s_mul_i32 s28, s25, 6
    s_mul_i32 s26, s26, 3
    s_add_u32 s28, s28, s26
    s_lshr_b32 s26, s3, 3
    s_add_u32 s28, s28, s26
    s_mul_i32 s26, s28, 43
    s_lshr_b32 s26, s26, 7
    s_add_u32 s26, s26, 1
    s_min_u32 s26, s26, 4
    s_add_u32 s26, s26, s28
    s_and_b32 s25, s3, 7
    s_branch L_mapd
L_shr:
    s_lshl_b32 s28, s26, 2
    s_lshl_b32 s26, s25, 2
    s_add_u32 s25, s28, s3
    s_sub_u32 s25, s25, 24
L_mapd:
    v_lshrrev_b32 v3, 4, v1
    s_and_b32 s3, s24, 1
    s_lshl_b32 s3, s3, 5
    v_add_u32 v2, s3, v3
    v_mul_u32_u24 v2, 7168, v2
    v_and_b32 v4, 15, v1
    v_lshlrev_b32 v5, 1, v3
    v_xor_b32 v4, v4, v5
    v_xor_b32 v5, 8, v4
    v_lshl_add_u32 v4, v4, 4, v2
    v_lshl_add_u32 v5, v5, 4, v2
    v_add_u32 v16, 0, v4
    v_add_u32 v17, 27648, v4
    v_add_u32 v18, 55296, v5
    v_add_u32 v19, 82944, v5
    v_add_u32 v20, 114688, v4
    v_add_u32 v21, 142336, v4
    v_add_u32 v22, 169984, v5
    v_add_u32 v23, 197632, v5
    s_lshl_b32 s31, s24, 13
    s_add_u32 s31, s31, 65536
    s_cmp_ge_u32 s24, 2
    s_cselect_b32 s16, s10, s8
    s_cselect_b32 s17, s11, s9
    s_lshl_b32 s3, s26, 8
    s_add_u32 s16, s16, s3
    s_addc_u32 s17, s17, 0
    s_sub_u32 s18, 7340032, s3
    s_mov_b32 s19, 0x00020000
    s_and_b32 s97, s25, 0
    s_mov_b32 s98, 0
    s_mov_b32 s99, 0
    s_mul_i32 s29, s97, 458752
    s_mov_b32 m0, s31
    s_nop 0
    buffer_load_dwordx4 v16, s[16:19], s29 offen offset:0 lds
    buffer_load_dwordx4 v17, s[16:19], s29 offen offset:1024 lds
    buffer_load_dwordx4 v18, s[16:19], s29 offen offset:2048 lds
    buffer_load_dwordx4 v19, s[16:19], s29 offen offset:3072 lds
    s_add_u32 m0, s31, 4096
    s_nop 0
    buffer_load_dwordx4 v20, s[16:19], s29 offen offset:0 lds
    buffer_load_dwordx4 v21, s[16:19], s29 offen offset:1024 lds
    buffer_load_dwordx4 v22, s[16:19], s29 offen offset:2048 lds
    buffer_load_dwordx4 v23, s[16:19], s29 offen offset:3072 lds
    s_add_u32 s99, s99, 1
    s_xor_b32 s29, s99, s97
    s_mul_i32 s29, s29, 458752
    s_add_u32 s31, s31, 0x8000
    s_cmp_ge_u32 s31, 163840
    s_cselect_b32 s3, 98304, 0
    s_sub_u32 s31, s31, s3
    s_mov_b32 m0, s31
    s_nop 0
    buffer_load_dwordx4 v16, s[16:19], s29 offen offset:0 lds
    buffer_load_dwordx4 v17, s[16:19], s29 offen offset:1024 lds
    buffer_load_dwordx4 v18, s[16:19], s29 offen offset:2048 lds
    buffer_load_dwordx4 v19, s[16:19], s29 offen offset:3072 lds
    s_add_u32 m0, s31, 4096
    s_nop 0
    buffer_load_dwordx4 v20, s[16:19], s29 offen offset:0 lds
    buffer_load_dwordx4 v21, s[16:19], s29 offen offset:1024 lds
    buffer_load_dwordx4 v22, s[16:19], s29 offen offset:2048 lds
    buffer_load_dwordx4 v23, s[16:19], s29 offen offset:3072 lds
    s_add_u32 s99, s99, 1
    s_xor_b32 s29, s99, s97
    s_mul_i32 s29, s29, 458752
    s_add_u32 s31, s31, 0x8000
    s_cmp_ge_u32 s31, 163840
    s_cselect_b32 s3, 98304, 0
    s_sub_u32 s31, s31, s3
    s_mov_b32 s56, s29
    s_mov_b32 s12, s4
    s_mov_b32 s13, s5
    s_mov_b32 s14, 4194304
    s_mov_b32 s15, 0x00020000
    s_add_u32 s20, s4, 27262976
    s_addc_u32 s21, s5, 0
    s_mov_b32 s22, 2506752
    s_mov_b32 s23, 0x00020000
    s_mov_b32 s63, 0xffff0000
    v_lshrrev_b32 v5, 3, v1
    v_lshlrev_b32 v5, 15, v5
    v_and_b32 v6, 7, v1
    s_lshl_b32 s28, s24, 11
    s_add_u32 s28, s28, 131072
    s_mov_b32 s34, s28
    s_waitcnt vmcnt(16)
    v_lshlrev_b32 v100, 16, v64
    v_and_b32 v101, s63, v64
    v_lshlrev_b32 v102, 16, v65
    v_and_b32 v103, s63, v65
    v_lshlrev_b32 v104, 16, v66
    v_and_b32 v105, s63, v66
    v_lshlrev_b32 v106, 16, v67
    v_and_b32 v107, s63, v67
    v_lshlrev_b32 v108, 16, v68
    v_and_b32 v109, s63, v68
    v_lshlrev_b32 v110, 16, v69
    v_and_b32 v111, s63, v69
    v_lshlrev_b32 v112, 16, v70
    v_and_b32 v113, s63, v70
    v_lshlrev_b32 v114, 16, v71
    v_and_b32 v115, s63, v71
    v_lshlrev_b32 v116, 16, v72
    v_and_b32 v117, s63, v72
    v_lshlrev_b32 v118, 16, v73
    v_and_b32 v119, s63, v73
    v_lshlrev_b32 v120, 16, v74
    v_and_b32 v121, s63, v74
    v_lshlrev_b32 v122, 16, v75
    v_and_b32 v123, s63, v75
    v_lshlrev_b32 v124, 16, v76
    v_and_b32 v125, s63, v76
    v_lshlrev_b32 v126, 16, v77
    v_and_b32 v127, s63, v77
    v_lshlrev_b32 v128, 16, v78
    v_and_b32 v129, s63, v78
    v_lshlrev_b32 v130, 16, v79
    v_and_b32 v131, s63, v79
    v_pk_add_f32 v[132:133], v[100:101], v[108:109]
    v_pk_add_f32 v[134:135], v[102:103], v[110:111]
    v_pk_add_f32 v[136:137], v[104:105], v[112:113]
    v_pk_add_f32 v[138:139], v[106:107], v[114:115]
    v_pk_add_f32 v[148:149], v[116:117], v[124:125]
    v_pk_add_f32 v[150:151], v[118:119], v[126:127]
    v_pk_add_f32 v[152:153], v[120:121], v[128:129]
    v_pk_add_f32 v[154:155], v[122:123], v[130:131]
    v_pk_add_f32 v[132:133], v[132:133], v[136:137]
    v_pk_add_f32 v[134:135], v[134:135], v[138:139]
    v_pk_add_f32 v[148:149], v[148:149], v[152:153]
    v_pk_add_f32 v[150:151], v[150:151], v[154:155]
    v_pk_add_f32 v[132:133], v[132:133], v[134:135]
    v_pk_add_f32 v[148:149], v[148:149], v[150:151]
    v_add_f32 v164, v132, v133
    v_add_f32 v165, v148, v149
    s_nop 0
    v_add_f32_dpp v164, v164, v164 row_ror:1 row_mask:0xf bank_mask:0xf
    v_add_f32_dpp v165, v165, v165 row_ror:1 row_mask:0xf bank_mask:0xf
    s_nop 0
    v_add_f32_dpp v164, v164, v164 row_ror:2 row_mask:0xf bank_mask:0xf
    v_add_f32_dpp v165, v165, v165 row_ror:2 row_mask:0xf bank_mask:0xf
    s_nop 0
    v_add_f32_dpp v164, v164, v164 row_ror:4 row_mask:0xf bank_mask:0xf
    v_add_f32_dpp v165, v165, v165 row_ror:4 row_mask:0xf bank_mask:0xf
    s_nop 0
    v_add_f32_dpp v164, v164, v164 row_ror:8 row_mask:0xf bank_mask:0xf
    v_add_f32_dpp v165, v165, v165 row_ror:8 row_mask:0xf bank_mask:0xf
    s_nop 0
    v_mov_b32 v170, v164
    v_mov_b32 v171, v165
    s_nop 1
    v_permlane16_swap_b32 v164, v170
    v_permlane16_swap_b32 v165, v171
    v_add_f32 v164, v164, v170
    v_add_f32 v165, v165, v171
    v_mov_b32 v170, v164
    v_mov_b32 v171, v165
    s_nop 1
    v_permlane32_swap_b32 v164, v170
    v_permlane32_swap_b32 v165, v171
    v_add_f32 v164, v164, v170
    v_add_f32 v165, v165, v171
    v_mul_f32 v164, 0x3a800000, v164
    v_mul_f32 v165, 0x3a800000, v165
    v_sub_f32 v132, v100, v164
    v_sub_f32 v133, v101, v164
    v_sub_f32 v134, v102, v164
    v_sub_f32 v135, v103, v164
    v_sub_f32 v136, v104, v164
    v_sub_f32 v137, v105, v164
    v_sub_f32 v138, v106, v164
    v_sub_f32 v139, v107, v164
    v_sub_f32 v140, v108, v164
    v_sub_f32 v141, v109, v164
    v_sub_f32 v142, v110, v164
    v_sub_f32 v143, v111, v164
    v_sub_f32 v144, v112, v164
    v_sub_f32 v145, v113, v164
    v_sub_f32 v146, v114, v164
    v_sub_f32 v147, v115, v164
    v_sub_f32 v148, v116, v165
    v_sub_f32 v149, v117, v165
    v_sub_f32 v150, v118, v165
    v_sub_f32 v151, v119, v165
    v_sub_f32 v152, v120, v165
    v_sub_f32 v153, v121, v165
    v_sub_f32 v154, v122, v165
    v_sub_f32 v155, v123, v165
    v_sub_f32 v156, v124, v165
    v_sub_f32 v157, v125, v165
    v_sub_f32 v158, v126, v165
    v_sub_f32 v159, v127, v165
    v_sub_f32 v160, v128, v165
    v_sub_f32 v161, v129, v165
    v_sub_f32 v162, v130, v165
    v_sub_f32 v163, v131, v165
    v_pk_mul_f32 v[132:133], v[132:133], v[132:133]
    v_pk_mul_f32 v[134:135], v[134:135], v[134:135]
    v_pk_mul_f32 v[136:137], v[136:137], v[136:137]
    v_pk_mul_f32 v[138:139], v[138:139], v[138:139]
    v_pk_mul_f32 v[140:141], v[140:141], v[140:141]
    v_pk_mul_f32 v[142:143], v[142:143], v[142:143]
    v_pk_mul_f32 v[144:145], v[144:145], v[144:145]
    v_pk_mul_f32 v[146:147], v[146:147], v[146:147]
    v_pk_mul_f32 v[148:149], v[148:149], v[148:149]
    v_pk_mul_f32 v[150:151], v[150:151], v[150:151]
    v_pk_mul_f32 v[152:153], v[152:153], v[152:153]
    v_pk_mul_f32 v[154:155], v[154:155], v[154:155]
    v_pk_mul_f32 v[156:157], v[156:157], v[156:157]
    v_pk_mul_f32 v[158:159], v[158:159], v[158:159]
    v_pk_mul_f32 v[160:161], v[160:161], v[160:161]
    v_pk_mul_f32 v[162:163], v[162:163], v[162:163]
    v_pk_add_f32 v[132:133], v[132:133], v[140:141]
    v_pk_add_f32 v[134:135], v[134:135], v[142:143]
    v_pk_add_f32 v[136:137], v[136:137], v[144:145]
    v_pk_add_f32 v[138:139], v[138:139], v[146:147]
    v_pk_add_f32 v[148:149], v[148:149], v[156:157]
    v_pk_add_f32 v[150:151], v[150:151], v[158:159]
    v_pk_add_f32 v[152:153], v[152:153], v[160:161]
    v_pk_add_f32 v[154:155], v[154:155], v[162:163]
    v_pk_add_f32 v[132:133], v[132:133], v[136:137]
    v_pk_add_f32 v[134:135], v[134:135], v[138:139]
    v_pk_add_f32 v[148:149], v[148:149], v[152:153]
    v_pk_add_f32 v[150:151], v[150:151], v[154:155]
    v_pk_add_f32 v[132:133], v[132:133], v[134:135]
    v_pk_add_f32 v[148:149], v[148:149], v[150:151]
    v_add_f32 v166, v132, v133
    v_add_f32 v167, v148, v149
    s_nop 0
    v_add_f32_dpp v166, v166, v166 row_ror:1 row_mask:0xf bank_mask:0xf
    v_add_f32_dpp v167, v167, v167 row_ror:1 row_mask:0xf bank_mask:0xf
    s_nop 0
    v_add_f32_dpp v166, v166, v166 row_ror:2 row_mask:0xf bank_mask:0xf
    v_add_f32_dpp v167, v167, v167 row_ror:2 row_mask:0xf bank_mask:0xf
    s_nop 0
    v_add_f32_dpp v166, v166, v166 row_ror:4 row_mask:0xf bank_mask:0xf
    v_add_f32_dpp v167, v167, v167 row_ror:4 row_mask:0xf bank_mask:0xf
    s_nop 0
    v_add_f32_dpp v166, v166, v166 row_ror:8 row_mask:0xf bank_mask:0xf
    v_add_f32_dpp v167, v167, v167 row_ror:8 row_mask:0xf bank_mask:0xf
    s_nop 0
    v_mov_b32 v170, v166
    v_mov_b32 v171, v167
    s_nop 1
    v_permlane16_swap_b32 v166, v170
    v_permlane16_swap_b32 v167, v171
    v_add_f32 v166, v166, v170
    v_add_f32 v167, v167, v171
    v_mov_b32 v170, v166
    v_mov_b32 v171, v167
    s_nop 1
    v_permlane32_swap_b32 v166, v170
    v_permlane32_swap_b32 v167, v171
    v_add_f32 v166, v166, v170
    v_add_f32 v167, v167, v171
    v_mul_f32 v166, 0x3a800000, v166
    v_mul_f32 v167, 0x3a800000, v167
    v_cvt_pk_bf16_f32 v170, v164, v166
    v_cvt_pk_bf16_f32 v171, v165, v167
    v_lshlrev_b32 v164, 16, v170
    v_lshlrev_b32 v165, 16, v171
    v_and_b32 v166, s63, v170
    v_and_b32 v167, s63, v171
    v_add_f32 v166, 0x3727c5ac, v166
    v_add_f32 v167, 0x3727c5ac, v167
    v_cvt_pk_bf16_f32 v166, v166, v166
    v_cvt_pk_bf16_f32 v167, v167, v167
    v_and_b32 v166, s63, v166
    v_and_b32 v167, s63, v167
    v_sqrt_f32 v166, v166
    v_sqrt_f32 v167, v167
    v_sub_f32 v132, v100, v164
    v_sub_f32 v133, v101, v164
    v_sub_f32 v134, v102, v164
    v_sub_f32 v135, v103, v164
    v_sub_f32 v136, v104, v164
    v_sub_f32 v137, v105, v164
    v_sub_f32 v138, v106, v164
    v_sub_f32 v139, v107, v164
    v_sub_f32 v140, v108, v164
    v_sub_f32 v141, v109, v164
    v_sub_f32 v142, v110, v164
    v_sub_f32 v143, v111, v164
    v_sub_f32 v144, v112, v164
    v_sub_f32 v145, v113, v164
    v_sub_f32 v146, v114, v164
    v_sub_f32 v147, v115, v164
    v_sub_f32 v148, v116, v165
    v_sub_f32 v149, v117, v165
    v_sub_f32 v150, v118, v165
    v_sub_f32 v151, v119, v165
    v_sub_f32 v152, v120, v165
    v_sub_f32 v153, v121, v165
    v_sub_f32 v154, v122, v165
    v_sub_f32 v155, v123, v165
    v_sub_f32 v156, v124, v165
    v_sub_f32 v157, v125, v165
    v_sub_f32 v158, v126, v165
    v_sub_f32 v159, v127, v165
    v_sub_f32 v160, v128, v165
    v_sub_f32 v161, v129, v165
    v_sub_f32 v162, v130, v165
    v_sub_f32 v163, v131, v165
    v_cvt_pk_bf16_f32 v166, v166, v166
    v_cvt_pk_bf16_f32 v167, v167, v167
    v_and_b32 v166, s63, v166
    v_and_b32 v167, s63, v167
    v_rcp_f32 v168, v166
    v_rcp_f32 v169, v167
    v_cvt_pk_bf16_f32 v64, v132, v133
    v_cvt_pk_bf16_f32 v65, v134, v135
    v_cvt_pk_bf16_f32 v66, v136, v137
    v_cvt_pk_bf16_f32 v67, v138, v139
    v_cvt_pk_bf16_f32 v68, v140, v141
    v_cvt_pk_bf16_f32 v69, v142, v143
    v_cvt_pk_bf16_f32 v70, v144, v145
    v_cvt_pk_bf16_f32 v71, v146, v147
    v_cvt_pk_bf16_f32 v72, v148, v149
    v_cvt_pk_bf16_f32 v73, v150, v151
    v_cvt_pk_bf16_f32 v74, v152, v153
    v_cvt_pk_bf16_f32 v75, v154, v155
    v_cvt_pk_bf16_f32 v76, v156, v157
    v_cvt_pk_bf16_f32 v77, v158, v159
    v_cvt_pk_bf16_f32 v78, v160, v161
    v_cvt_pk_bf16_f32 v79, v162, v163
    v_fma_f32 v170, -v166, v168, 1.0
    v_fma_f32 v171, -v167, v169, 1.0
    v_fmac_f32 v168, v170, v168
    v_fmac_f32 v169, v171, v169
    v_lshlrev_b32 v100, 16, v64
    v_and_b32 v101, s63, v64
    v_lshlrev_b32 v102, 16, v65
    v_and_b32 v103, s63, v65
    v_lshlrev_b32 v104, 16, v66
    v_and_b32 v105, s63, v66
    v_lshlrev_b32 v106, 16, v67
    v_and_b32 v107, s63, v67
    v_lshlrev_b32 v108, 16, v68
    v_and_b32 v109, s63, v68
    v_lshlrev_b32 v110, 16, v69
    v_and_b32 v111, s63, v69
    v_lshlrev_b32 v112, 16, v70
    v_and_b32 v113, s63, v70
    v_lshlrev_b32 v114, 16, v71
    v_and_b32 v115, s63, v71
    v_lshlrev_b32 v116, 16, v72
    v_and_b32 v117, s63, v72
    v_lshlrev_b32 v118, 16, v73
    v_and_b32 v119, s63, v73
    v_lshlrev_b32 v120, 16, v74
    v_and_b32 v121, s63, v74
    v_lshlrev_b32 v122, 16, v75
    v_and_b32 v123, s63, v75
    v_lshlrev_b32 v124, 16, v76
    v_and_b32 v125, s63, v76
    v_lshlrev_b32 v126, 16, v77
    v_and_b32 v127, s63, v77
    v_lshlrev_b32 v128, 16, v78
    v_and_b32 v129, s63, v78
    v_lshlrev_b32 v130, 16, v79
    v_and_b32 v131, s63, v79
    v_mul_f32 v132, v100, v168
    v_mul_f32 v133, v101, v168
    v_mul_f32 v134, v102, v168
    v_mul_f32 v135, v103, v168
    v_mul_f32 v136, v104, v168
    v_mul_f32 v137, v105, v168
    v_mul_f32 v138, v106, v168
    v_mul_f32 v139, v107, v168
    v_mul_f32 v140, v108, v168
    v_mul_f32 v141, v109, v168
    v_mul_f32 v142, v110, v168
    v_mul_f32 v143, v111, v168
    v_mul_f32 v144, v112, v168
    v_mul_f32 v145, v113, v168
    v_mul_f32 v146, v114, v168
    v_mul_f32 v147, v115, v168
    v_mul_f32 v148, v116, v169
    v_mul_f32 v149, v117, v169
    v_mul_f32 v150, v118, v169
    v_mul_f32 v151, v119, v169
    v_mul_f32 v152, v120, v169
    v_mul_f32 v153, v121, v169
    v_mul_f32 v154, v122, v169
    v_mul_f32 v155, v123, v169
    v_mul_f32 v156, v124, v169
    v_mul_f32 v157, v125, v169
    v_mul_f32 v158, v126, v169
    v_mul_f32 v159, v127, v169
    v_mul_f32 v160, v128, v169
    v_mul_f32 v161, v129, v169
    v_mul_f32 v162, v130, v169
    v_mul_f32 v163, v131, v169
    v_cvt_pk_bf16_f32 v64, v132, v133
    v_cvt_pk_bf16_f32 v65, v134, v135
    v_cvt_pk_bf16_f32 v66, v136, v137
    v_cvt_pk_bf16_f32 v67, v138, v139
    v_cvt_pk_bf16_f32 v68, v140, v141
    v_cvt_pk_bf16_f32 v69, v142, v143
    v_cvt_pk_bf16_f32 v70, v144, v145
    v_cvt_pk_bf16_f32 v71, v146, v147
    v_cvt_pk_bf16_f32 v72, v148, v149
    v_cvt_pk_bf16_f32 v73, v150, v151
    v_cvt_pk_bf16_f32 v74, v152, v153
    v_cvt_pk_bf16_f32 v75, v154, v155
    v_cvt_pk_bf16_f32 v76, v156, v157
    v_cvt_pk_bf16_f32 v77, v158, v159
    v_cvt_pk_bf16_f32 v78, v160, v161
    v_cvt_pk_bf16_f32 v79, v162, v163
    v_mov_b32 v4, 0
    buffer_load_dword v62, v4, s[92:95], 0 offen sc1
    s_lshr_b32 s30, s36, 19
    s_lshl_b32 s30, s30, 19
    s_bfe_u32 s3, s36, 0x8000b
    s_lshl_b32 s31, s3, 7
    s_add_u32 s30, s30, s31
    s_bfe_u32 s3, s3, 0x30001
    v_xor_b32 v7, s3, v6
    v_lshl_add_u32 v7, v7, 4, v5
    s_add_u32 s31, s30, 262144
    buffer_store_dwordx4 v[64:67], v7, s[12:15], s30 offen sc1
    buffer_store_dwordx4 v[68:71], v7, s[12:15], s31 offen sc1
    s_lshr_b32 s30, s37, 19
    s_lshl_b32 s30, s30, 19
    s_bfe_u32 s3, s37, 0x8000b
    s_lshl_b32 s31, s3, 7
    s_add_u32 s30, s30, s31
    s_bfe_u32 s3, s3, 0x30001
    v_xor_b32 v7, s3, v6
    v_lshl_add_u32 v7, v7, 4, v5
    s_add_u32 s31, s30, 262144
    buffer_store_dwordx4 v[72:75], v7, s[12:15], s30 offen sc1
    buffer_store_dwordx4 v[76:79], v7, s[12:15], s31 offen sc1
    v_add_u32 v2, s28, v44
    v_add_u32 v4, s34, v44
    ds_write_b128 v2, v[64:67]
    ds_write_b128 v2, v[68:71] offset:1024
    ds_write_b128 v4, v[72:75] offset:8192
    ds_write_b128 v4, v[76:79] offset:9216
    s_waitcnt vmcnt(0) lgkmcnt(0)
    s_mov_b32 s33, 0
L_g_nonce:
    v_readfirstlane_b32 s62, v62
    s_add_u32 s33, s33, 1
    s_cmp_lg_u32 s62, 0
    s_cbranch_scc1 L_g_nonced
    v_mov_b32 v4, 0
    buffer_load_dword v62, v4, s[92:95], 0 offen sc1
    s_waitcnt vmcnt(0)
    s_cmp_lt_u32 s33, 0x40000
    s_cbranch_scc1 L_g_nonce
L_g_nonced:
    s_barrier
    s_cmp_lg_u32 s24, 0
    s_cbranch_scc1 L_g_fa
    s_lshl_b32 s3, s2, 2
    v_mov_b32 v2, s62
    v_mov_b32 v3, s3
    s_mov_b64 exec, 1
    buffer_store_dword v2, v3, s[48:51], 0 offen offset:2048 sc1
    s_mov_b64 exec, -1
L_g_fa:
    s_mov_b32 s28, 0
    v_mov_b32 v100, v0
    v_mov_b32 v136, 131072
    v_mov_b32 v137, 147456
    v_mov_b32 v138, 1.0
L_g_fold:
    v_lshlrev_b32 v101, 1, v100
    v_sub_u32 v102, 2048, v101
    v_and_b32 v102, 2047, v102
    v_add_u32 v128, v136, v101
    v_add_u32 v129, v136, v102
    v_sub_u32 v130, v136, v101
    ds_read_u16_d16_hi v108, v128 offset:0
    ds_read_u16_d16_hi v109, v128 offset:2048
    ds_read_u16_d16_hi v110, v128 offset:4096
    ds_read_u16_d16_hi v111, v128 offset:6144
    ds_read_u16_d16_hi v112, v129 offset:0
    ds_read_u16_d16_hi v113, v129 offset:2048
    ds_read_u16_d16_hi v114, v129 offset:4096
    ds_read_u16_d16_hi v115, v129 offset:6144
    ds_read_u16_d16_hi v116, v130 offset:1024
    ds_read_u16_d16_hi v117, v130 offset:3072
    ds_read_u16_d16_hi v118, v130 offset:5120
    ds_read_u16_d16_hi v119, v130 offset:7168
    ds_read_u16_d16_hi v120, v128 offset:1024
    ds_read_u16_d16_hi v121, v128 offset:3072
    ds_read_u16_d16_hi v122, v128 offset:5120
    ds_read_u16_d16_hi v123, v128 offset:7168
    v_add_u32 v107, v137, v101
    v_and_b32 v105, 255, v100
    v_cmp_eq_u32 vcc, 0, v105
    v_mul_f32 v106, 0.5, v138
    s_nop 0
    v_cndmask_b32 v105, v138, v106, vcc
    v_cmp_ge_u32 vcc, 256, v100
    s_waitcnt lgkmcnt(12)
    v_and_b32 v108, s63, v108
    v_and_b32 v109, s63, v109
    v_and_b32 v110, s63, v110
    v_and_b32 v111, s63, v111
    v_add_f32 v124, v108, v109
    v_sub_f32 v125, v108, v109
    v_add_f32 v126, v110, v111
    v_sub_f32 v127, v110, v111
    v_add_f32 v108, v124, v126
    v_sub_f32 v109, v124, v126
    v_sub_f32 v110, v125, v127
    v_add_f32 v111, v125, v127
    s_waitcnt lgkmcnt(8)
    v_and_b32 v112, s63, v112
    v_and_b32 v113, s63, v113
    v_and_b32 v114, s63, v114
    v_and_b32 v115, s63, v115
    v_add_f32 v124, v112, v113
    v_sub_f32 v125, v112, v113
    v_add_f32 v126, v114, v115
    v_sub_f32 v127, v114, v115
    v_add_f32 v112, v124, v126
    v_sub_f32 v113, v124, v126
    v_sub_f32 v114, v125, v127
    v_add_f32 v115, v125, v127
    s_waitcnt lgkmcnt(4)
    v_and_b32 v116, s63, v116
    v_and_b32 v117, s63, v117
    v_and_b32 v118, s63, v118
    v_and_b32 v119, s63, v119
    v_add_f32 v124, v116, v117
    v_sub_f32 v125, v116, v117
    v_add_f32 v126, v118, v119
    v_sub_f32 v127, v118, v119
    v_add_f32 v116, v124, v126
    v_sub_f32 v117, v124, v126
    v_sub_f32 v118, v125, v127
    v_add_f32 v119, v125, v127
    s_waitcnt lgkmcnt(0)
    v_and_b32 v120, s63, v120
    v_and_b32 v121, s63, v121
    v_and_b32 v122, s63, v122
    v_and_b32 v123, s63, v123
    v_add_f32 v124, v120, v121
    v_sub_f32 v125, v120, v121
    v_add_f32 v126, v122, v123
    v_sub_f32 v127, v122, v123
    v_add_f32 v120, v124, v126
    v_sub_f32 v121, v124, v126
    v_sub_f32 v122, v125, v127
    v_add_f32 v123, v125, v127
    v_add_f32 v124, v108, v112
    v_add_f32 v125, v116, v120
    v_add_f32 v126, v124, v125
    v_sub_f32 v127, v124, v125
    v_mul_f32 v126, v126, v105
    v_mul_f32 v127, v127, v105
    v_cvt_pk_bf16_f32 v132, v126, v127
    v_cndmask_b32 v132, 0, v132, vcc
    ds_write_b16 v107, v132 offset:0
    ds_write_b16_d16_hi v107, v132 offset:576
    v_add_f32 v124, v109, v113
    v_add_f32 v125, v117, v121
    v_add_f32 v126, v124, v125
    v_sub_f32 v127, v124, v125
    v_mul_f32 v126, v126, v105
    v_mul_f32 v127, v127, v105
    v_cvt_pk_bf16_f32 v133, v126, v127
    v_cndmask_b32 v133, 0, v133, vcc
    ds_write_b16 v107, v133 offset:1152
    ds_write_b16_d16_hi v107, v133 offset:1728
    v_sub_f32 v124, v110, v114
    v_sub_f32 v125, v118, v122
    v_sub_f32 v126, v124, v125
    v_add_f32 v127, v124, v125
    v_mul_f32 v126, v126, v105
    v_mul_f32 v127, v127, v105
    v_cvt_pk_bf16_f32 v134, v126, v127
    v_cndmask_b32 v134, 0, v134, vcc
    ds_write_b16 v107, v134 offset:2304
    ds_write_b16_d16_hi v107, v134 offset:2880
    v_sub_f32 v124, v111, v115
    v_sub_f32 v125, v119, v123
    v_sub_f32 v126, v124, v125
    v_add_f32 v127, v124, v125
    v_mul_f32 v126, v126, v105
    v_mul_f32 v127, v127, v105
    v_cvt_pk_bf16_f32 v135, v126, v127
    v_cndmask_b32 v135, 0, v135, vcc
    ds_write_b16 v107, v135 offset:3456
    ds_write_b16_d16_hi v107, v135 offset:4032
    s_add_u32 s28, s28, 1
    s_cmp_lg_u32 s28, 1
    s_cbranch_scc1 L_g_j2
    v_add_u32 v136, 8192, v136
    v_add_u32 v137, 4608, v137
    v_mov_b32 v138, 1.0
    s_branch L_g_fold
L_g_j2:
    s_cmp_lg_u32 s28, 2
    s_cbranch_scc1 L_g_j3
    s_cmp_lg_u32 s24, 3
    s_cbranch_scc1 L_g_j3s
    v_and_b32 v100, 31, v1
    v_add_u32 v100, 256, v100
    v_lshrrev_b32 v101, 5, v1
    v_lshlrev_b32 v136, 13, v101
    v_add_u32 v136, 131072, v136
    v_mul_u32_u24 v137, 4608, v101
    v_add_u32 v137, 147456, v137
    s_branch L_g_fold
L_g_j3s:
    s_add_u32 s28, s28, 1
L_g_j3:
L_g_foldd:
    s_waitcnt lgkmcnt(0)
    s_barrier
    v_mov_b32 v100, v0
    s_mul_i32 s34, s76, 1152
    s_mov_b32 s30, 626688
    s_mov_b32 s29, 294912
    s_mov_b32 s31, 2
    v_lshlrev_b32 v101, 4, v100
    v_add_u32 v101, 147456, v101
    ds_read_b128 v[108:111], v101
    v_mul_u32_u24 v102, 911, v100
    v_lshrrev_b32 v102, 16, v102
    v_mul_u32_u24 v103, 72, v102
    v_sub_u32 v103, v100, v103
    v_and_b32 v104, 3, v102
    v_lshrrev_b32 v102, 2, v102
    v_mul_lo_u32 v104, v104, s30
    v_lshl_add_u32 v103, v103, 4, v104
    v_mul_lo_u32 v104, v102, s29
    v_add_u32 v112, v103, v104
    v_cmp_gt_u32 vcc, s31, v102
    v_add_u32 v100, 256, v100
    v_mov_b32 v104, 0x7ff00000
    v_cndmask_b32 v112, v104, v112, vcc
    v_lshlrev_b32 v101, 4, v100
    v_add_u32 v101, 147456, v101
    ds_read_b128 v[116:119], v101
    v_mul_u32_u24 v102, 911, v100
    v_lshrrev_b32 v102, 16, v102
    v_mul_u32_u24 v103, 72, v102
    v_sub_u32 v103, v100, v103
    v_and_b32 v104, 3, v102
    v_lshrrev_b32 v102, 2, v102
    v_mul_lo_u32 v104, v104, s30
    v_lshl_add_u32 v103, v103, 4, v104
    v_mul_lo_u32 v104, v102, s29
    v_add_u32 v120, v103, v104
    v_cmp_gt_u32 vcc, s31, v102
    v_add_u32 v100, 256, v100
    v_mov_b32 v104, 0x7ff00000
    v_cndmask_b32 v120, v104, v120, vcc
    v_lshlrev_b32 v101, 4, v100
    v_add_u32 v101, 147456, v101
    ds_read_b128 v[124:127], v101
    v_mul_u32_u24 v102, 911, v100
    v_lshrrev_b32 v102, 16, v102
    v_mul_u32_u24 v103, 72, v102
    v_sub_u32 v103, v100, v103
    v_and_b32 v104, 3, v102
    v_lshrrev_b32 v102, 2, v102
    v_mul_lo_u32 v104, v104, s30
    v_lshl_add_u32 v103, v103, 4, v104
    v_mul_lo_u32 v104, v102, s29
    v_add_u32 v128, v103, v104
    v_cmp_gt_u32 vcc, s31, v102
    v_add_u32 v100, 256, v100
    v_mov_b32 v104, 0x7ff00000
    v_cndmask_b32 v128, v104, v128, vcc
    s_waitcnt lgkmcnt(0)
    s_lshl_b32 s30, s24, 13
    v_add_u32 v8, s30, v44
    v_add_u32 v9, 4096, v8
    s_add_u32 s31, s30, 131072
    s_lshl_b32 s28, s97, 15
    s_mov_b32 s29, s56
    s_lshl_b32 s3, s25, 19
    s_add_u32 s12, s4, s3
    s_addc_u32 s13, s5, 0
    s_mov_b32 s14, 524288
    s_mov_b32 s15, 0x00020000
    s_cmp_lg_u32 s24, 0
    s_cbranch_scc1 L_snap
    buffer_load_dwordx4 v[12:15], v44, s[48:51], 0 offen offset:2048 sc1
L_snap:
    s_lshr_b32 s3, s2, 3
    s_and_b32 s52, s27, 3
    s_lshl_b32 s52, s52, 2
    s_and_b32 s53, s3, 3
    s_add_u32 s52, s52, s53
    s_lshr_b32 s53, s27, 2
    s_lshl_b32 s53, s53, 3
    s_lshr_b32 s3, s3, 2
    s_add_u32 s53, s53, s3
    s_lshl_b32 s3, s53, 7
    s_add_u32 s40, s44, s3
    s_addc_u32 s41, s45, 0
    s_sub_u32 s42, 7340032, s3
    s_mov_b32 s43, 0x00020000
    s_mov_b32 s46, 7340032
    s_mov_b32 s47, 0x00020000
    v_lshrrev_b32 v2, 3, v1
    v_lshlrev_b32 v2, 11, v2
    v_lshrrev_b32 v3, 4, v1
    v_lshlrev_b32 v3, 1, v3
    v_and_b32 v4, 7, v1
    v_xor_b32 v4, v4, v3
    v_lshl_add_u32 v40, v4, 4, v2
    v_add_u32 v41, 15360, v40
    v_add_u32 v42, 30720, v40
    v_add_u32 v43, 46080, v40
    s_lshl_b32 s70, s24, 14
    s_add_u32 s68, s70, 98304
    s_add_u32 s70, s70, 32768
    s_lshl_b32 s69, s24, 13
    v_lshrrev_b32 v2, 2, v1
    v_lshlrev_b32 v2, 7, v2
    v_and_b32 v4, 3, v1
    v_lshl_add_u32 v2, v4, 3, v2
    v_bfe_u32 v3, v1, 3, 2
    v_xor_b32 v4, 0, v3
    v_lshl_add_u32 v4, v4, 5, v2
    v_add_u32 v48, s68, v4
    v_add_u32 v52, s69, v4
    v_add_u32 v56, s70, v4
    v_xor_b32 v4, 1, v3
    v_lshl_add_u32 v4, v4, 5, v2
    v_add_u32 v49, s68, v4
    v_add_u32 v53, s69, v4
    v_add_u32 v57, s70, v4
    v_xor_b32 v4, 2, v3
    v_lshl_add_u32 v4, v4, 5, v2
    v_add_u32 v50, s68, v4
    v_add_u32 v54, s69, v4
    v_add_u32 v58, s70, v4
    v_xor_b32 v4, 3, v3
    v_lshl_add_u32 v4, v4, 5, v2
    v_add_u32 v51, s68, v4
    v_add_u32 v55, s69, v4
    v_add_u32 v59, s70, v4
    s_and_b32 s3, s52, 3
    s_lshl_b32 s3, s3, 1
    s_and_b32 s71, s53, 7
    s_add_u32 s71, s71, s3
    s_cmp_ge_u32 s71, 7
    s_cselect_b32 s3, 7, 0
    s_sub_u32 s71, s71, s3
    s_min_u32 s71, s71, 0
    s_mul_i32 s100, s24, 1835008
    s_add_u32 s101, s100, 1835008
    s_lshl_b32 s54, s71, 18
    s_add_u32 s54, s54, s100
    s_add_u32 s55, s54, 65536
    s_lshl_b32 s88, s25, 1
    s_and_b32 s3, s24, 1
    s_add_u32 s88, s88, s3
    s_mul_i32 s88, s88, 56
    s_lshl_b32 s3, s26, 1
    s_add_u32 s88, s88, s3
    s_lshr_b32 s3, s24, 1
    s_add_u32 s88, s88, s3
    s_lshl_b32 s88, s88, 14
    s_add_u32 s88, s88, 4194304
    s_add_u32 s88, s88, s4
    s_addc_u32 s89, s5, 0
    s_mov_b32 s90, 16384
    s_mov_b32 s91, 0x00020000
    s_mul_i32 s56, s25, 28
    s_add_u32 s56, s56, s26
    s_add_u32 s58, s56, s24
    s_and_b32 s58, s58, 3
    s_and_b32 s59, s24, 1
    s_add_u32 s59, s59, 4
    s_lshl_b32 s56, s56, 2
    s_add_u32 s56, s56, s24
    s_lshl_b32 s56, s56, 13
    s_add_u32 s57, s56, 4096
    v_lshlrev_b32 v36, 6, v1
    s_getpc_b64 s[84:85]
L_pc:
    s_add_u32 s84, s84, L_late-L_pc
    s_addc_u32 s85, s85, 0
    s_mov_b32 s86, L_dft-L_late
    s_mov_b32 s87, 0x00020000
    s_lshr_b32 s63, s2, 3
    s_and_b32 s63, s63, 1
    s_lshl_b32 s63, s63, 2
    s_add_u32 s63, s63, s24
    s_lshl_b32 s63, s63, 12
    s_lshl_b32 s3, s2, 2
    v_mov_b32 v10, 0x7ff00000
    v_writelane_b32 v10, s3, 0
    v_mov_b32 v11, s62
    s_lshl_b32 s78, s25, 5
    s_add_u32 s78, s78, s26
    s_lshl_b32 s78, s78, 2
    s_and_b32 s3, s24, 1
    s_lshl_b32 s3, s3, 7
    v_and_b32 v2, 15, v1
    v_add_u32 v2, s3, v2
    v_lshlrev_b32 v2, 7, v2
    v_lshrrev_b32 v3, 4, v1
    v_bfe_u32 v4, v1, 1, 3
    v_xor_b32 v3, v3, v4
    v_xor_b32 v4, 0, v3
    v_lshl_add_u32 v24, v4, 4, v2
    v_add_u32 v26, 0x8000, v24
    v_xor_b32 v4, 4, v3
    v_lshl_add_u32 v25, v4, 4, v2
    v_add_u32 v27, 0x8000, v25
    v_lshrrev_b32 v2, 4, v1
    v_bfe_u32 v3, v1, 2, 2
    v_lshl_add_u32 v2, v2, 3, v3
    v_lshlrev_b32 v2, 8, v2
    v_and_b32 v4, 3, v1
    v_lshl_add_u32 v2, v4, 3, v2
    v_bfe_u32 v4, v1, 4, 1
    v_lshl_add_u32 v3, v4, 2, v3
    s_lshr_b32 s3, s24, 1
    s_lshl_b32 s3, s3, 2
    v_xor_b32 v3, s3, v3
    s_mov_b32 s33, 65536
    v_xor_b32 v4, 0, v3
    v_lshl_add_u32 v32, v4, 5, v2
    v_add_u32 v28, s33, v32
    v_xor_b32 v4, 1, v3
    v_lshl_add_u32 v33, v4, 5, v2
    v_add_u32 v29, s33, v33
    v_xor_b32 v4, 2, v3
    v_lshl_add_u32 v34, v4, 5, v2
    v_add_u32 v30, s33, v34
    v_xor_b32 v4, 3, v3
    v_lshl_add_u32 v35, v4, 5, v2
    v_add_u32 v31, s33, v35
    s_cmp_lg_u32 s24, 0
    s_cbranch_scc1 L_g_paad
    s_mov_b32 s32, 0
    s_branch L_g_paae
L_g_paa:
    buffer_load_dwordx4 v[12:15], v44, s[48:51], 0 offen offset:2048 sc1
L_g_paae:
    s_waitcnt vmcnt(0)
    v_xor_b32 v12, s62, v12
    v_xor_b32 v13, s62, v13
    v_xor_b32 v14, s62, v14
    v_xor_b32 v15, s62, v15
    v_or3_b32 v12, v12, v13, v14
    v_or_b32 v12, v12, v15
    v_cmp_ne_u32 vcc, 0, v12
    s_add_u32 s32, s32, 1
    s_nop 2
    s_cbranch_vccz L_g_paad
    s_cmp_lt_u32 s32, 0x40000
    s_cbranch_scc1 L_g_paa
L_g_paad:
    s_barrier
    s_mov_b32 m0, s30
    s_nop 0
    buffer_load_dwordx4 v8, s[12:15], s28 offen offset:0 sc1 lds
    buffer_load_dwordx4 v8, s[12:15], s28 offen offset:1024 sc1 lds
    buffer_load_dwordx4 v8, s[12:15], s28 offen offset:2048 sc1 lds
    buffer_load_dwordx4 v8, s[12:15], s28 offen offset:3072 sc1 lds
    s_add_u32 m0, s30, 4096
    s_nop 0
    buffer_load_dwordx4 v9, s[12:15], s28 offen offset:0 sc1 lds
    buffer_load_dwordx4 v9, s[12:15], s28 offen offset:1024 sc1 lds
    buffer_load_dwordx4 v9, s[12:15], s28 offen offset:2048 sc1 lds
    buffer_load_dwordx4 v9, s[12:15], s28 offen offset:3072 sc1 lds
    s_add_u32 s98, s98, 1
    s_xor_b32 s28, s98, s97
    s_lshl_b32 s28, s28, 15
    s_xor_b32 s30, s30, 0x8000
    s_mov_b32 m0, s30
    s_nop 0
    buffer_load_dwordx4 v8, s[12:15], s28 offen offset:0 sc1 lds
    buffer_load_dwordx4 v8, s[12:15], s28 offen offset:1024 sc1 lds
    buffer_load_dwordx4 v8, s[12:15], s28 offen offset:2048 sc1 lds
    buffer_load_dwordx4 v8, s[12:15], s28 offen offset:3072 sc1 lds
    s_add_u32 m0, s30, 4096
    s_nop 0
    buffer_load_dwordx4 v9, s[12:15], s28 offen offset:0 sc1 lds
    buffer_load_dwordx4 v9, s[12:15], s28 offen offset:1024 sc1 lds
    buffer_load_dwordx4 v9, s[12:15], s28 offen offset:2048 sc1 lds
    buffer_load_dwordx4 v9, s[12:15], s28 offen offset:3072 sc1 lds
    s_add_u32 s98, s98, 1
    s_xor_b32 s28, s98, s97
    s_lshl_b32 s28, s28, 15
    s_xor_b32 s30, s30, 0x8000
    buffer_store_dwordx4 v[108:111], v112, s[20:23], s34 offen sc1
    buffer_store_dwordx4 v[116:119], v120, s[20:23], s34 offen sc1
    buffer_store_dwordx4 v[124:127], v128, s[20:23], s34 offen sc1
    s_mov_b32 m0, s31
    s_nop 0
    buffer_load_dwordx4 v16, s[16:19], s29 offen offset:0 lds
    buffer_load_dwordx4 v17, s[16:19], s29 offen offset:1024 lds
    buffer_load_dwordx4 v18, s[16:19], s29 offen offset:2048 lds
    buffer_load_dwordx4 v19, s[16:19], s29 offen offset:3072 lds
    s_add_u32 m0, s31, 4096
    s_nop 0
    buffer_load_dwordx4 v20, s[16:19], s29 offen offset:0 lds
    buffer_load_dwordx4 v21, s[16:19], s29 offen offset:1024 lds
    buffer_load_dwordx4 v22, s[16:19], s29 offen offset:2048 lds
    buffer_load_dwordx4 v23, s[16:19], s29 offen offset:3072 lds
    s_add_u32 s99, s99, 1
    s_xor_b32 s29, s99, s97
    s_mul_i32 s29, s29, 458752
    s_add_u32 s31, s31, 0x8000
    s_cmp_ge_u32 s31, 163840
    s_cselect_b32 s3, 98304, 0
    s_sub_u32 s31, s31, s3
    s_waitcnt vmcnt(19)
    s_barrier
    ds_read_b64_tr_b16 v[64:65], v28 offset:0
    ds_read_b64_tr_b16 v[66:67], v28 offset:1024
    ds_read_b64_tr_b16 v[68:69], v28 offset:8192
    ds_read_b64_tr_b16 v[70:71], v28 offset:9216
    ds_read_b128 v[128:131], v24 offset:0
    ds_read_b128 v[132:135], v25 offset:0
    ds_read_b128 v[136:139], v24 offset:2048
    ds_read_b128 v[140:143], v25 offset:2048
    ds_read_b128 v[144:147], v24 offset:4096
    ds_read_b128 v[148:151], v25 offset:4096
    ds_read_b128 v[152:155], v24 offset:6144
    ds_read_b128 v[156:159], v25 offset:6144
    ds_read_b128 v[160:163], v24 offset:8192
    ds_read_b128 v[164:167], v25 offset:8192
    ds_read_b128 v[168:171], v24 offset:10240
    ds_read_b128 v[172:175], v25 offset:10240
    ds_read_b128 v[176:179], v24 offset:12288
    ds_read_b128 v[180:183], v25 offset:12288
    ds_read_b128 v[184:187], v24 offset:14336
    ds_read_b128 v[188:191], v25 offset:14336
    ds_read_b64_tr_b16 v[72:73], v29 offset:0
    ds_read_b64_tr_b16 v[74:75], v29 offset:1024
    ds_read_b64_tr_b16 v[76:77], v29 offset:8192
    ds_read_b64_tr_b16 v[78:79], v29 offset:9216
    ds_read_b64_tr_b16 v[80:81], v30 offset:0
    ds_read_b64_tr_b16 v[82:83], v30 offset:1024
    ds_read_b64_tr_b16 v[84:85], v30 offset:8192
    ds_read_b64_tr_b16 v[86:87], v30 offset:9216
    ds_read_b64_tr_b16 v[88:89], v31 offset:0
    ds_read_b64_tr_b16 v[90:91], v31 offset:1024
    ds_read_b64_tr_b16 v[92:93], v31 offset:8192
    ds_read_b64_tr_b16 v[94:95], v31 offset:9216
    ds_read_b64_tr_b16 v[96:97], v28 offset:16384
    ds_read_b64_tr_b16 v[98:99], v28 offset:17408
    ds_read_b64_tr_b16 v[100:101], v28 offset:24576
    ds_read_b64_tr_b16 v[102:103], v28 offset:25600
    ds_read_b64_tr_b16 v[104:105], v29 offset:16384
    ds_read_b64_tr_b16 v[106:107], v29 offset:17408
    ds_read_b64_tr_b16 v[108:109], v29 offset:24576
    ds_read_b64_tr_b16 v[110:111], v29 offset:25600
    ds_read_b64_tr_b16 v[112:113], v30 offset:16384
    ds_read_b64_tr_b16 v[114:115], v30 offset:17408
    ds_read_b64_tr_b16 v[116:117], v30 offset:24576
    ds_read_b64_tr_b16 v[118:119], v30 offset:25600
    ds_read_b64_tr_b16 v[120:121], v31 offset:16384
    ds_read_b64_tr_b16 v[122:123], v31 offset:17408
    ds_read_b64_tr_b16 v[124:125], v31 offset:24576
    ds_read_b64_tr_b16 v[126:127], v31 offset:25600
    s_waitcnt lgkmcnt(0)
    v_mfma_f32_16x16x32_bf16 a[0:3], v[64:67], v[128:131], 0
    v_mfma_f32_16x16x32_bf16 a[0:3], v[68:71], v[132:135], a[0:3]
    v_mfma_f32_16x16x32_bf16 a[4:7], v[64:67], v[136:139], 0
    v_mfma_f32_16x16x32_bf16 a[4:7], v[68:71], v[140:143], a[4:7]
    v_mfma_f32_16x16x32_bf16 a[8:11], v[64:67], v[144:147], 0
    s_add_u32 s33, s33, 0x8000
    v_mfma_f32_16x16x32_bf16 a[8:11], v[68:71], v[148:151], a[8:11]
    s_cmp_ge_u32 s33, 163840
    v_mfma_f32_16x16x32_bf16 a[12:15], v[64:67], v[152:155], 0
    s_cselect_b32 s33, 65536, s33
    v_mfma_f32_16x16x32_bf16 a[12:15], v[68:71], v[156:159], a[12:15]
    v_add_u32 v28, s33, v32
    v_mfma_f32_16x16x32_bf16 a[16:19], v[64:67], v[160:163], 0
    v_add_u32 v29, s33, v33
    v_mfma_f32_16x16x32_bf16 a[16:19], v[68:71], v[164:167], a[16:19]
    v_add_u32 v30, s33, v34
    v_mfma_f32_16x16x32_bf16 a[20:23], v[64:67], v[168:171], 0
    v_add_u32 v31, s33, v35
    v_mfma_f32_16x16x32_bf16 a[20:23], v[68:71], v[172:175], a[20:23]
    s_cmp_lg_u32 s24, 0
    s_cselect_b32 s3, 0x7ff00000, 0
    v_mfma_f32_16x16x32_bf16 a[24:27], v[64:67], v[176:179], 0
    v_or_b32 v3, s3, v10
    v_mfma_f32_16x16x32_bf16 a[24:27], v[68:71], v[180:183], a[24:27]
    s_waitcnt lgkmcnt(0) vmcnt(8)
    s_barrier
    v_mfma_f32_16x16x32_bf16 a[28:31], v[64:67], v[184:187], 0
    buffer_store_dword v11, v3, s[48:51], 0 offen offset:3072 sc1
    v_mfma_f32_16x16x32_bf16 a[28:31], v[68:71], v[188:191], a[28:31]
    s_mov_b32 m0, s30
    v_mfma_f32_16x16x32_bf16 a[32:35], v[72:75], v[128:131], 0
    ds_read_b64_tr_b16 v[64:65], v28 offset:0
    v_mfma_f32_16x16x32_bf16 a[32:35], v[76:79], v[132:135], a[32:35]
    buffer_load_dwordx4 v8, s[12:15], s28 offen offset:0 sc1 lds
    v_mfma_f32_16x16x32_bf16 a[36:39], v[72:75], v[136:139], 0
    ds_read_b64_tr_b16 v[66:67], v28 offset:1024
    v_mfma_f32_16x16x32_bf16 a[36:39], v[76:79], v[140:143], a[36:39]
    v_mfma_f32_16x16x32_bf16 a[40:43], v[72:75], v[144:147], 0
    ds_read_b64_tr_b16 v[68:69], v28 offset:8192
    v_mfma_f32_16x16x32_bf16 a[40:43], v[76:79], v[148:151], a[40:43]
    buffer_load_dwordx4 v8, s[12:15], s28 offen offset:1024 sc1 lds
    v_mfma_f32_16x16x32_bf16 a[44:47], v[72:75], v[152:155], 0
    ds_read_b64_tr_b16 v[70:71], v28 offset:9216
    v_mfma_f32_16x16x32_bf16 a[44:47], v[76:79], v[156:159], a[44:47]
    v_mfma_f32_16x16x32_bf16 a[48:51], v[72:75], v[160:163], 0
    ds_read_b128 v[192:195], v26 offset:0
    v_mfma_f32_16x16x32_bf16 a[48:51], v[76:79], v[164:167], a[48:51]
    buffer_load_dwordx4 v8, s[12:15], s28 offen offset:2048 sc1 lds
    v_mfma_f32_16x16x32_bf16 a[52:55], v[72:75], v[168:171], 0
    ds_read_b128 v[196:199], v27 offset:0
    v_mfma_f32_16x16x32_bf16 a[52:55], v[76:79], v[172:175], a[52:55]
    v_mfma_f32_16x16x32_bf16 a[56:59], v[72:75], v[176:179], 0
    ds_read_b128 v[200:203], v26 offset:2048
    v_mfma_f32_16x16x32_bf16 a[56:59], v[76:79], v[180:183], a[56:59]
    buffer_load_dwordx4 v8, s[12:15], s28 offen offset:3072 sc1 lds
    v_mfma_f32_16x16x32_bf16 a[60:63], v[72:75], v[184:187], 0
    v_mfma_f32_16x16x32_bf16 a[60:63], v[76:79], v[188:191], a[60:63]
    s_add_u32 m0, s30, 4096
    v_mfma_f32_16x16x32_bf16 a[64:67], v[80:83], v[128:131], 0
    ds_read_b64_tr_b16 v[72:73], v29 offset:0
    v_mfma_f32_16x16x32_bf16 a[64:67], v[84:87], v[132:135], a[64:67]
    buffer_load_dwordx4 v9, s[12:15], s28 offen offset:0 sc1 lds
    v_mfma_f32_16x16x32_bf16 a[68:71], v[80:83], v[136:139], 0
    ds_read_b64_tr_b16 v[74:75], v29 offset:1024
    v_mfma_f32_16x16x32_bf16 a[68:71], v[84:87], v[140:143], a[68:71]
    v_mfma_f32_16x16x32_bf16 a[72:75], v[80:83], v[144:147], 0
    ds_read_b64_tr_b16 v[76:77], v29 offset:8192
    v_mfma_f32_16x16x32_bf16 a[72:75], v[84:87], v[148:151], a[72:75]
    buffer_load_dwordx4 v9, s[12:15], s28 offen offset:1024 sc1 lds
    v_mfma_f32_16x16x32_bf16 a[76:79], v[80:83], v[152:155], 0
    ds_read_b64_tr_b16 v[78:79], v29 offset:9216
    v_mfma_f32_16x16x32_bf16 a[76:79], v[84:87], v[156:159], a[76:79]
    v_mfma_f32_16x16x32_bf16 a[80:83], v[80:83], v[160:163], 0
    ds_read_b128 v[204:207], v27 offset:2048
    v_mfma_f32_16x16x32_bf16 a[80:83], v[84:87], v[164:167], a[80:83]
    buffer_load_dwordx4 v9, s[12:15], s28 offen offset:2048 sc1 lds
    v_mfma_f32_16x16x32_bf16 a[84:87], v[80:83], v[168:171], 0
    ds_read_b128 v[208:211], v26 offset:4096
    v_mfma_f32_16x16x32_bf16 a[84:87], v[84:87], v[172:175], a[84:87]
    v_mfma_f32_16x16x32_bf16 a[88:91], v[80:83], v[176:179], 0
    ds_read_b128 v[212:215], v27 offset:4096
    v_mfma_f32_16x16x32_bf16 a[88:91], v[84:87], v[180:183], a[88:91]
    buffer_load_dwordx4 v9, s[12:15], s28 offen offset:3072 sc1 lds
    v_mfma_f32_16x16x32_bf16 a[92:95], v[80:83], v[184:187], 0
    s_add_u32 s98, s98, 1
    s_xor_b32 s28, s98, s97
    s_lshl_b32 s28, s28, 15
    s_xor_b32 s30, s30, 0x8000
    v_mfma_f32_16x16x32_bf16 a[92:95], v[84:87], v[188:191], a[92:95]
    s_mov_b32 m0, s31
    v_mfma_f32_16x16x32_bf16 a[96:99], v[88:91], v[128:131], 0
    ds_read_b64_tr_b16 v[80:81], v30 offset:0
    v_mfma_f32_16x16x32_bf16 a[96:99], v[92:95], v[132:135], a[96:99]
    buffer_load_dwordx4 v16, s[16:19], s29 offen offset:0 lds
    v_mfma_f32_16x16x32_bf16 a[100:103], v[88:91], v[136:139], 0
    ds_read_b64_tr_b16 v[82:83], v30 offset:1024
    v_mfma_f32_16x16x32_bf16 a[100:103], v[92:95], v[140:143], a[100:103]
    v_mfma_f32_16x16x32_bf16 a[104:107], v[88:91], v[144:147], 0
    ds_read_b64_tr_b16 v[84:85], v30 offset:8192
    v_mfma_f32_16x16x32_bf16 a[104:107], v[92:95], v[148:151], a[104:107]
    buffer_load_dwordx4 v17, s[16:19], s29 offen offset:1024 lds
    v_mfma_f32_16x16x32_bf16 a[108:111], v[88:91], v[152:155], 0
    ds_read_b64_tr_b16 v[86:87], v30 offset:9216
    v_mfma_f32_16x16x32_bf16 a[108:111], v[92:95], v[156:159], a[108:111]
    v_mfma_f32_16x16x32_bf16 a[112:115], v[88:91], v[160:163], 0
    ds_read_b128 v[216:219], v26 offset:6144
    v_mfma_f32_16x16x32_bf16 a[112:115], v[92:95], v[164:167], a[112:115]
    buffer_load_dwordx4 v18, s[16:19], s29 offen offset:2048 lds
    v_mfma_f32_16x16x32_bf16 a[116:119], v[88:91], v[168:171], 0
    ds_read_b128 v[220:223], v27 offset:6144
    v_mfma_f32_16x16x32_bf16 a[116:119], v[92:95], v[172:175], a[116:119]
    v_mfma_f32_16x16x32_bf16 a[120:123], v[88:91], v[176:179], 0
    ds_read_b128 v[224:227], v26 offset:8192
    v_mfma_f32_16x16x32_bf16 a[120:123], v[92:95], v[180:183], a[120:123]
    buffer_load_dwordx4 v19, s[16:19], s29 offen offset:3072 lds
    v_mfma_f32_16x16x32_bf16 a[124:127], v[88:91], v[184:187], 0
    v_mfma_f32_16x16x32_bf16 a[124:127], v[92:95], v[188:191], a[124:127]
    s_add_u32 m0, s31, 4096
    v_mfma_f32_16x16x32_bf16 a[128:131], v[96:99], v[128:131], 0
    ds_read_b64_tr_b16 v[88:89], v31 offset:0
    v_mfma_f32_16x16x32_bf16 a[128:131], v[100:103], v[132:135], a[128:131]
    buffer_load_dwordx4 v20, s[16:19], s29 offen offset:0 lds
    v_mfma_f32_16x16x32_bf16 a[132:135], v[96:99], v[136:139], 0
    ds_read_b64_tr_b16 v[90:91], v31 offset:1024
    v_mfma_f32_16x16x32_bf16 a[132:135], v[100:103], v[140:143], a[132:135]
    v_mfma_f32_16x16x32_bf16 a[136:139], v[96:99], v[144:147], 0
    ds_read_b64_tr_b16 v[92:93], v31 offset:8192
    v_mfma_f32_16x16x32_bf16 a[136:139], v[100:103], v[148:151], a[136:139]
    buffer_load_dwordx4 v21, s[16:19], s29 offen offset:1024 lds
    v_mfma_f32_16x16x32_bf16 a[140:143], v[96:99], v[152:155], 0
    ds_read_b64_tr_b16 v[94:95], v31 offset:9216
    v_mfma_f32_16x16x32_bf16 a[140:143], v[100:103], v[156:159], a[140:143]
    v_mfma_f32_16x16x32_bf16 a[144:147], v[96:99], v[160:163], 0
    ds_read_b128 v[228:231], v27 offset:8192
    v_mfma_f32_16x16x32_bf16 a[144:147], v[100:103], v[164:167], a[144:147]
    buffer_load_dwordx4 v22, s[16:19], s29 offen offset:2048 lds
    v_mfma_f32_16x16x32_bf16 a[148:151], v[96:99], v[168:171], 0
    ds_read_b128 v[232:235], v26 offset:10240
    v_mfma_f32_16x16x32_bf16 a[148:151], v[100:103], v[172:175], a[148:151]
    v_mfma_f32_16x16x32_bf16 a[152:155], v[96:99], v[176:179], 0
    ds_read_b128 v[236:239], v27 offset:10240
    v_mfma_f32_16x16x32_bf16 a[152:155], v[100:103], v[180:183], a[152:155]
    buffer_load_dwordx4 v23, s[16:19], s29 offen offset:3072 lds
    v_mfma_f32_16x16x32_bf16 a[156:159], v[96:99], v[184:187], 0
    s_add_u32 s99, s99, 1
    s_xor_b32 s29, s99, s97
    s_mul_i32 s29, s29, 458752
    s_add_u32 s31, s31, 0x8000
    s_cmp_ge_u32 s31, 163840
    s_cselect_b32 s3, 98304, 0
    s_sub_u32 s31, s31, s3
    v_mfma_f32_16x16x32_bf16 a[156:159], v[100:103], v[188:191], a[156:159]
    v_mfma_f32_16x16x32_bf16 a[160:163], v[104:107], v[128:131], 0
    ds_read_b64_tr_b16 v[96:97], v28 offset:16384
    v_mfma_f32_16x16x32_bf16 a[160:163], v[108:111], v[132:135], a[160:163]
    v_mfma_f32_16x16x32_bf16 a[164:167], v[104:107], v[136:139], 0
    ds_read_b64_tr_b16 v[98:99], v28 offset:17408
    v_mfma_f32_16x16x32_bf16 a[164:167], v[108:111], v[140:143], a[164:167]
    v_mfma_f32_16x16x32_bf16 a[168:171], v[104:107], v[144:147], 0
    ds_read_b64_tr_b16 v[100:101], v28 offset:24576
    v_mfma_f32_16x16x32_bf16 a[168:171], v[108:111], v[148:151], a[168:171]
    v_mfma_f32_16x16x32_bf16 a[172:175], v[104:107], v[152:155], 0
    ds_read_b64_tr_b16 v[102:103], v28 offset:25600
    v_mfma_f32_16x16x32_bf16 a[172:175], v[108:111], v[156:159], a[172:175]
    v_mfma_f32_16x16x32_bf16 a[176:179], v[104:107], v[160:163], 0
    ds_read_b128 v[240:243], v26 offset:12288
    v_mfma_f32_16x16x32_bf16 a[176:179], v[108:111], v[164:167], a[176:179]
    v_mfma_f32_16x16x32_bf16 a[180:183], v[104:107], v[168:171], 0
    ds_read_b128 v[244:247], v27 offset:12288
    v_mfma_f32_16x16x32_bf16 a[180:183], v[108:111], v[172:175], a[180:183]
    v_mfma_f32_16x16x32_bf16 a[184:187], v[104:107], v[176:179], 0
    ds_read_b128 v[248:251], v26 offset:14336
    v_mfma_f32_16x16x32_bf16 a[184:187], v[108:111], v[180:183], a[184:187]
    v_mfma_f32_16x16x32_bf16 a[188:191], v[104:107], v[184:187], 0
    v_mfma_f32_16x16x32_bf16 a[188:191], v[108:111], v[188:191], a[188:191]
    v_mfma_f32_16x16x32_bf16 a[192:195], v[112:115], v[128:131], 0
    ds_read_b64_tr_b16 v[104:105], v29 offset:16384
    v_mfma_f32_16x16x32_bf16 a[192:195], v[116:119], v[132:135], a[192:195]
    v_mfma_f32_16x16x32_bf16 a[196:199], v[112:115], v[136:139], 0
    ds_read_b64_tr_b16 v[106:107], v29 offset:17408
    v_mfma_f32_16x16x32_bf16 a[196:199], v[116:119], v[140:143], a[196:199]
    v_mfma_f32_16x16x32_bf16 a[200:203], v[112:115], v[144:147], 0
    ds_read_b64_tr_b16 v[108:109], v29 offset:24576
    v_mfma_f32_16x16x32_bf16 a[200:203], v[116:119], v[148:151], a[200:203]
    v_mfma_f32_16x16x32_bf16 a[204:207], v[112:115], v[152:155], 0
    ds_read_b64_tr_b16 v[110:111], v29 offset:25600
    v_mfma_f32_16x16x32_bf16 a[204:207], v[116:119], v[156:159], a[204:207]
    v_mfma_f32_16x16x32_bf16 a[208:211], v[112:115], v[160:163], 0
    ds_read_b128 v[252:255], v27 offset:14336
    v_mfma_f32_16x16x32_bf16 a[208:211], v[116:119], v[164:167], a[208:211]
    v_mfma_f32_16x16x32_bf16 a[212:215], v[112:115], v[168:171], 0
    v_mfma_f32_16x16x32_bf16 a[212:215], v[116:119], v[172:175], a[212:215]
    v_mfma_f32_16x16x32_bf16 a[216:219], v[112:115], v[176:179], 0
    v_mfma_f32_16x16x32_bf16 a[216:219], v[116:119], v[180:183], a[216:219]
    v_mfma_f32_16x16x32_bf16 a[220:223], v[112:115], v[184:187], 0
    v_mfma_f32_16x16x32_bf16 a[220:223], v[116:119], v[188:191], a[220:223]
    v_mfma_f32_16x16x32_bf16 a[224:227], v[120:123], v[128:131], 0
    ds_read_b64_tr_b16 v[112:113], v30 offset:16384
    v_mfma_f32_16x16x32_bf16 a[224:227], v[124:127], v[132:135], a[224:227]
    v_mfma_f32_16x16x32_bf16 a[228:231], v[120:123], v[136:139], 0
    ds_read_b64_tr_b16 v[114:115], v30 offset:17408
    v_mfma_f32_16x16x32_bf16 a[228:231], v[124:127], v[140:143], a[228:231]
    v_mfma_f32_16x16x32_bf16 a[232:235], v[120:123], v[144:147], 0
    ds_read_b64_tr_b16 v[116:117], v30 offset:24576
    v_mfma_f32_16x16x32_bf16 a[232:235], v[124:127], v[148:151], a[232:235]
    v_mfma_f32_16x16x32_bf16 a[236:239], v[120:123], v[152:155], 0
    ds_read_b64_tr_b16 v[118:119], v30 offset:25600
    v_mfma_f32_16x16x32_bf16 a[236:239], v[124:127], v[156:159], a[236:239]
    v_mfma_f32_16x16x32_bf16 a[240:243], v[120:123], v[160:163], 0
    v_mfma_f32_16x16x32_bf16 a[240:243], v[124:127], v[164:167], a[240:243]
    v_mfma_f32_16x16x32_bf16 a[244:247], v[120:123], v[168:171], 0
    v_mfma_f32_16x16x32_bf16 a[244:247], v[124:127], v[172:175], a[244:247]
    v_mfma_f32_16x16x32_bf16 a[248:251], v[120:123], v[176:179], 0
    v_mfma_f32_16x16x32_bf16 a[248:251], v[124:127], v[180:183], a[248:251]
    v_mfma_f32_16x16x32_bf16 a[252:255], v[120:123], v[184:187], 0
    v_mfma_f32_16x16x32_bf16 a[252:255], v[124:127], v[188:191], a[252:255]
    s_mov_b32 s32, 0
.p2align 6
L_loop:
    s_waitcnt lgkmcnt(0)
    v_mfma_f32_16x16x32_bf16 a[0:3], v[64:67], v[192:195], a[0:3]
    ds_read_b64_tr_b16 v[120:121], v31 offset:16384
    v_mfma_f32_16x16x32_bf16 a[0:3], v[68:71], v[196:199], a[0:3]
    ds_read_b64_tr_b16 v[122:123], v31 offset:17408
    v_mfma_f32_16x16x32_bf16 a[4:7], v[64:67], v[200:203], a[4:7]
    ds_read_b64_tr_b16 v[124:125], v31 offset:24576
    v_mfma_f32_16x16x32_bf16 a[4:7], v[68:71], v[204:207], a[4:7]
    ds_read_b64_tr_b16 v[126:127], v31 offset:25600
    v_mfma_f32_16x16x32_bf16 a[8:11], v[64:67], v[208:211], a[8:11]
    s_add_u32 s33, s33, 0x8000
    v_mfma_f32_16x16x32_bf16 a[8:11], v[68:71], v[212:215], a[8:11]
    s_cmp_ge_u32 s33, 163840
    v_mfma_f32_16x16x32_bf16 a[12:15], v[64:67], v[216:219], a[12:15]
    s_cselect_b32 s33, 65536, s33
    v_mfma_f32_16x16x32_bf16 a[12:15], v[68:71], v[220:223], a[12:15]
    v_add_u32 v28, s33, v32
    v_mfma_f32_16x16x32_bf16 a[16:19], v[64:67], v[224:227], a[16:19]
    v_add_u32 v29, s33, v33
    v_mfma_f32_16x16x32_bf16 a[16:19], v[68:71], v[228:231], a[16:19]
    v_add_u32 v30, s33, v34
    v_mfma_f32_16x16x32_bf16 a[20:23], v[64:67], v[232:235], a[20:23]
    v_add_u32 v31, s33, v35
    v_mfma_f32_16x16x32_bf16 a[20:23], v[68:71], v[236:239], a[20:23]
    v_mfma_f32_16x16x32_bf16 a[24:27], v[64:67], v[240:243], a[24:27]
    v_mfma_f32_16x16x32_bf16 a[24:27], v[68:71], v[244:247], a[24:27]
    s_waitcnt lgkmcnt(0) vmcnt(8)
    s_barrier
    s_cmp_eq_u32 s32, s58
    s_cselect_b32 s3, 0, 0x7ff00000
    v_or_b32 v2, s3, v36
    v_mfma_f32_16x16x32_bf16 a[28:31], v[64:67], v[248:251], a[28:31]
    buffer_load_dword v38, v2, s[44:47], s56 offen
    v_mfma_f32_16x16x32_bf16 a[28:31], v[68:71], v[252:255], a[28:31]
    s_mov_b32 m0, s30
    v_mfma_f32_16x16x32_bf16 a[32:35], v[72:75], v[192:195], a[32:35]
    ds_read_b64_tr_b16 v[64:65], v28 offset:0
    v_mfma_f32_16x16x32_bf16 a[32:35], v[76:79], v[196:199], a[32:35]
    buffer_load_dwordx4 v8, s[12:15], s28 offen offset:0 sc1 lds
    v_mfma_f32_16x16x32_bf16 a[36:39], v[72:75], v[200:203], a[36:39]
    ds_read_b64_tr_b16 v[66:67], v28 offset:1024
    v_mfma_f32_16x16x32_bf16 a[36:39], v[76:79], v[204:207], a[36:39]
    v_mfma_f32_16x16x32_bf16 a[40:43], v[72:75], v[208:211], a[40:43]
    ds_read_b64_tr_b16 v[68:69], v28 offset:8192
    v_mfma_f32_16x16x32_bf16 a[40:43], v[76:79], v[212:215], a[40:43]
    buffer_load_dwordx4 v8, s[12:15], s28 offen offset:1024 sc1 lds
    v_mfma_f32_16x16x32_bf16 a[44:47], v[72:75], v[216:219], a[44:47]
    ds_read_b64_tr_b16 v[70:71], v28 offset:9216
    v_mfma_f32_16x16x32_bf16 a[44:47], v[76:79], v[220:223], a[44:47]
    v_mfma_f32_16x16x32_bf16 a[48:51], v[72:75], v[224:227], a[48:51]
    ds_read_b128 v[128:131], v24 offset:0
    v_mfma_f32_16x16x32_bf16 a[48:51], v[76:79], v[228:231], a[48:51]
    buffer_load_dwordx4 v8, s[12:15], s28 offen offset:2048 sc1 lds
    v_mfma_f32_16x16x32_bf16 a[52:55], v[72:75], v[232:235], a[52:55]
    ds_read_b128 v[132:135], v25 offset:0
    v_mfma_f32_16x16x32_bf16 a[52:55], v[76:79], v[236:239], a[52:55]
    v_mfma_f32_16x16x32_bf16 a[56:59], v[72:75], v[240:243], a[56:59]
    ds_read_b128 v[136:139], v24 offset:2048
    v_mfma_f32_16x16x32_bf16 a[56:59], v[76:79], v[244:247], a[56:59]
    buffer_load_dwordx4 v8, s[12:15], s28 offen offset:3072 sc1 lds
    v_mfma_f32_16x16x32_bf16 a[60:63], v[72:75], v[248:251], a[60:63]
    v_mfma_f32_16x16x32_bf16 a[60:63], v[76:79], v[252:255], a[60:63]
    s_add_u32 m0, s30, 4096
    v_mfma_f32_16x16x32_bf16 a[64:67], v[80:83], v[192:195], a[64:67]
    ds_read_b64_tr_b16 v[72:73], v29 offset:0
    v_mfma_f32_16x16x32_bf16 a[64:67], v[84:87], v[196:199], a[64:67]
    buffer_load_dwordx4 v9, s[12:15], s28 offen offset:0 sc1 lds
    v_mfma_f32_16x16x32_bf16 a[68:71], v[80:83], v[200:203], a[68:71]
    ds_read_b64_tr_b16 v[74:75], v29 offset:1024
    v_mfma_f32_16x16x32_bf16 a[68:71], v[84:87], v[204:207], a[68:71]
    v_mfma_f32_16x16x32_bf16 a[72:75], v[80:83], v[208:211], a[72:75]
    ds_read_b64_tr_b16 v[76:77], v29 offset:8192
    v_mfma_f32_16x16x32_bf16 a[72:75], v[84:87], v[212:215], a[72:75]
    buffer_load_dwordx4 v9, s[12:15], s28 offen offset:1024 sc1 lds
    v_mfma_f32_16x16x32_bf16 a[76:79], v[80:83], v[216:219], a[76:79]
    ds_read_b64_tr_b16 v[78:79], v29 offset:9216
    v_mfma_f32_16x16x32_bf16 a[76:79], v[84:87], v[220:223], a[76:79]
    v_mfma_f32_16x16x32_bf16 a[80:83], v[80:83], v[224:227], a[80:83]
    ds_read_b128 v[140:143], v25 offset:2048
    v_mfma_f32_16x16x32_bf16 a[80:83], v[84:87], v[228:231], a[80:83]
    buffer_load_dwordx4 v9, s[12:15], s28 offen offset:2048 sc1 lds
    v_mfma_f32_16x16x32_bf16 a[84:87], v[80:83], v[232:235], a[84:87]
    ds_read_b128 v[144:147], v24 offset:4096
    v_mfma_f32_16x16x32_bf16 a[84:87], v[84:87], v[236:239], a[84:87]
    v_mfma_f32_16x16x32_bf16 a[88:91], v[80:83], v[240:243], a[88:91]
    ds_read_b128 v[148:151], v25 offset:4096
    v_mfma_f32_16x16x32_bf16 a[88:91], v[84:87], v[244:247], a[88:91]
    buffer_load_dwordx4 v9, s[12:15], s28 offen offset:3072 sc1 lds
    v_mfma_f32_16x16x32_bf16 a[92:95], v[80:83], v[248:251], a[92:95]
    s_add_u32 s98, s98, 1
    s_xor_b32 s28, s98, s97
    s_lshl_b32 s28, s28, 15
    s_xor_b32 s30, s30, 0x8000
    v_mfma_f32_16x16x32_bf16 a[92:95], v[84:87], v[252:255], a[92:95]
    s_mov_b32 m0, s31
    v_mfma_f32_16x16x32_bf16 a[96:99], v[88:91], v[192:195], a[96:99]
    ds_read_b64_tr_b16 v[80:81], v30 offset:0
    v_mfma_f32_16x16x32_bf16 a[96:99], v[92:95], v[196:199], a[96:99]
    buffer_load_dwordx4 v16, s[16:19], s29 offen offset:0 lds
    v_mfma_f32_16x16x32_bf16 a[100:103], v[88:91], v[200:203], a[100:103]
    ds_read_b64_tr_b16 v[82:83], v30 offset:1024
    v_mfma_f32_16x16x32_bf16 a[100:103], v[92:95], v[204:207], a[100:103]
    v_mfma_f32_16x16x32_bf16 a[104:107], v[88:91], v[208:211], a[104:107]
    ds_read_b64_tr_b16 v[84:85], v30 offset:8192
    v_mfma_f32_16x16x32_bf16 a[104:107], v[92:95], v[212:215], a[104:107]
    buffer_load_dwordx4 v17, s[16:19], s29 offen offset:1024 lds
    v_mfma_f32_16x16x32_bf16 a[108:111], v[88:91], v[216:219], a[108:111]
    ds_read_b64_tr_b16 v[86:87], v30 offset:9216
    v_mfma_f32_16x16x32_bf16 a[108:111], v[92:95], v[220:223], a[108:111]
    v_mfma_f32_16x16x32_bf16 a[112:115], v[88:91], v[224:227], a[112:115]
    ds_read_b128 v[152:155], v24 offset:6144
    v_mfma_f32_16x16x32_bf16 a[112:115], v[92:95], v[228:231], a[112:115]
    buffer_load_dwordx4 v18, s[16:19], s29 offen offset:2048 lds
    v_mfma_f32_16x16x32_bf16 a[116:119], v[88:91], v[232:235], a[116:119]
    ds_read_b128 v[156:159], v25 offset:6144
    v_mfma_f32_16x16x32_bf16 a[116:119], v[92:95], v[236:239], a[116:119]
    v_mfma_f32_16x16x32_bf16 a[120:123], v[88:91], v[240:243], a[120:123]
    ds_read_b128 v[160:163], v24 offset:8192
    v_mfma_f32_16x16x32_bf16 a[120:123], v[92:95], v[244:247], a[120:123]
    buffer_load_dwordx4 v19, s[16:19], s29 offen offset:3072 lds
    v_mfma_f32_16x16x32_bf16 a[124:127], v[88:91], v[248:251], a[124:127]
    v_mfma_f32_16x16x32_bf16 a[124:127], v[92:95], v[252:255], a[124:127]
    s_add_u32 m0, s31, 4096
    v_mfma_f32_16x16x32_bf16 a[128:131], v[96:99], v[192:195], a[128:131]
    ds_read_b64_tr_b16 v[88:89], v31 offset:0
    v_mfma_f32_16x16x32_bf16 a[128:131], v[100:103], v[196:199], a[128:131]
    buffer_load_dwordx4 v20, s[16:19], s29 offen offset:0 lds
    v_mfma_f32_16x16x32_bf16 a[132:135], v[96:99], v[200:203], a[132:135]
    ds_read_b64_tr_b16 v[90:91], v31 offset:1024
    v_mfma_f32_16x16x32_bf16 a[132:135], v[100:103], v[204:207], a[132:135]
    v_mfma_f32_16x16x32_bf16 a[136:139], v[96:99], v[208:211], a[136:139]
    ds_read_b64_tr_b16 v[92:93], v31 offset:8192
    v_mfma_f32_16x16x32_bf16 a[136:139], v[100:103], v[212:215], a[136:139]
    buffer_load_dwordx4 v21, s[16:19], s29 offen offset:1024 lds
    v_mfma_f32_16x16x32_bf16 a[140:143], v[96:99], v[216:219], a[140:143]
    ds_read_b64_tr_b16 v[94:95], v31 offset:9216
    v_mfma_f32_16x16x32_bf16 a[140:143], v[100:103], v[220:223], a[140:143]
    v_mfma_f32_16x16x32_bf16 a[144:147], v[96:99], v[224:227], a[144:147]
    ds_read_b128 v[164:167], v25 offset:8192
    v_mfma_f32_16x16x32_bf16 a[144:147], v[100:103], v[228:231], a[144:147]
    buffer_load_dwordx4 v22, s[16:19], s29 offen offset:2048 lds
    v_mfma_f32_16x16x32_bf16 a[148:151], v[96:99], v[232:235], a[148:151]
    ds_read_b128 v[168:171], v24 offset:10240
    v_mfma_f32_16x16x32_bf16 a[148:151], v[100:103], v[236:239], a[148:151]
    v_mfma_f32_16x16x32_bf16 a[152:155], v[96:99], v[240:243], a[152:155]
    ds_read_b128 v[172:175], v25 offset:10240
    v_mfma_f32_16x16x32_bf16 a[152:155], v[100:103], v[244:247], a[152:155]
    buffer_load_dwordx4 v23, s[16:19], s29 offen offset:3072 lds
    v_mfma_f32_16x16x32_bf16 a[156:159], v[96:99], v[248:251], a[156:159]
    s_add_u32 s99, s99, 1
    s_xor_b32 s29, s99, s97
    s_mul_i32 s29, s29, 458752
    s_add_u32 s31, s31, 0x8000
    s_cmp_ge_u32 s31, 163840
    s_cselect_b32 s3, 98304, 0
    s_sub_u32 s31, s31, s3
    v_mfma_f32_16x16x32_bf16 a[156:159], v[100:103], v[252:255], a[156:159]
    v_mfma_f32_16x16x32_bf16 a[160:163], v[104:107], v[192:195], a[160:163]
    ds_read_b64_tr_b16 v[96:97], v28 offset:16384
    v_mfma_f32_16x16x32_bf16 a[160:163], v[108:111], v[196:199], a[160:163]
    v_mfma_f32_16x16x32_bf16 a[164:167], v[104:107], v[200:203], a[164:167]
    ds_read_b64_tr_b16 v[98:99], v28 offset:17408
    v_mfma_f32_16x16x32_bf16 a[164:167], v[108:111], v[204:207], a[164:167]
    v_mfma_f32_16x16x32_bf16 a[168:171], v[104:107], v[208:211], a[168:171]
    ds_read_b64_tr_b16 v[100:101], v28 offset:24576
    v_mfma_f32_16x16x32_bf16 a[168:171], v[108:111], v[212:215], a[168:171]
    v_mfma_f32_16x16x32_bf16 a[172:175], v[104:107], v[216:219], a[172:175]
    ds_read_b64_tr_b16 v[102:103], v28 offset:25600
    v_mfma_f32_16x16x32_bf16 a[172:175], v[108:111], v[220:223], a[172:175]
    v_mfma_f32_16x16x32_bf16 a[176:179], v[104:107], v[224:227], a[176:179]
    ds_read_b128 v[176:179], v24 offset:12288
    v_mfma_f32_16x16x32_bf16 a[176:179], v[108:111], v[228:231], a[176:179]
    v_mfma_f32_16x16x32_bf16 a[180:183], v[104:107], v[232:235], a[180:183]
    ds_read_b128 v[180:183], v25 offset:12288
    v_mfma_f32_16x16x32_bf16 a[180:183], v[108:111], v[236:239], a[180:183]
    v_mfma_f32_16x16x32_bf16 a[184:187], v[104:107], v[240:243], a[184:187]
    ds_read_b128 v[184:187], v24 offset:14336
    v_mfma_f32_16x16x32_bf16 a[184:187], v[108:111], v[244:247], a[184:187]
    v_mfma_f32_16x16x32_bf16 a[188:191], v[104:107], v[248:251], a[188:191]
    v_mfma_f32_16x16x32_bf16 a[188:191], v[108:111], v[252:255], a[188:191]
    v_mfma_f32_16x16x32_bf16 a[192:195], v[112:115], v[192:195], a[192:195]
    ds_read_b64_tr_b16 v[104:105], v29 offset:16384
    v_mfma_f32_16x16x32_bf16 a[192:195], v[116:119], v[196:199], a[192:195]
    v_mfma_f32_16x16x32_bf16 a[196:199], v[112:115], v[200:203], a[196:199]
    ds_read_b64_tr_b16 v[106:107], v29 offset:17408
    v_mfma_f32_16x16x32_bf16 a[196:199], v[116:119], v[204:207], a[196:199]
    v_mfma_f32_16x16x32_bf16 a[200:203], v[112:115], v[208:211], a[200:203]
    ds_read_b64_tr_b16 v[108:109], v29 offset:24576
    v_mfma_f32_16x16x32_bf16 a[200:203], v[116:119], v[212:215], a[200:203]
    v_mfma_f32_16x16x32_bf16 a[204:207], v[112:115], v[216:219], a[204:207]
    ds_read_b64_tr_b16 v[110:111], v29 offset:25600
    v_mfma_f32_16x16x32_bf16 a[204:207], v[116:119], v[220:223], a[204:207]
    v_mfma_f32_16x16x32_bf16 a[208:211], v[112:115], v[224:227], a[208:211]
    ds_read_b128 v[188:191], v25 offset:14336
    v_mfma_f32_16x16x32_bf16 a[208:211], v[116:119], v[228:231], a[208:211]
    v_mfma_f32_16x16x32_bf16 a[212:215], v[112:115], v[232:235], a[212:215]
    v_mfma_f32_16x16x32_bf16 a[212:215], v[116:119], v[236:239], a[212:215]
    v_mfma_f32_16x16x32_bf16 a[216:219], v[112:115], v[240:243], a[216:219]
    v_mfma_f32_16x16x32_bf16 a[216:219], v[116:119], v[244:247], a[216:219]
    v_mfma_f32_16x16x32_bf16 a[220:223], v[112:115], v[248:251], a[220:223]
    v_mfma_f32_16x16x32_bf16 a[220:223], v[116:119], v[252:255], a[220:223]
    v_mfma_f32_16x16x32_bf16 a[224:227], v[120:123], v[192:195], a[224:227]
    ds_read_b64_tr_b16 v[112:113], v30 offset:16384
    v_mfma_f32_16x16x32_bf16 a[224:227], v[124:127], v[196:199], a[224:227]
    v_mfma_f32_16x16x32_bf16 a[228:231], v[120:123], v[200:203], a[228:231]
    ds_read_b64_tr_b16 v[114:115], v30 offset:17408
    v_mfma_f32_16x16x32_bf16 a[228:231], v[124:127], v[204:207], a[228:231]
    v_mfma_f32_16x16x32_bf16 a[232:235], v[120:123], v[208:211], a[232:235]
    ds_read_b64_tr_b16 v[116:117], v30 offset:24576
    v_mfma_f32_16x16x32_bf16 a[232:235], v[124:127], v[212:215], a[232:235]
    v_mfma_f32_16x16x32_bf16 a[236:239], v[120:123], v[216:219], a[236:239]
    ds_read_b64_tr_b16 v[118:119], v30 offset:25600
    v_mfma_f32_16x16x32_bf16 a[236:239], v[124:127], v[220:223], a[236:239]
    v_mfma_f32_16x16x32_bf16 a[240:243], v[120:123], v[224:227], a[240:243]
    v_mfma_f32_16x16x32_bf16 a[240:243], v[124:127], v[228:231], a[240:243]
    v_mfma_f32_16x16x32_bf16 a[244:247], v[120:123], v[232:235], a[244:247]
    v_mfma_f32_16x16x32_bf16 a[244:247], v[124:127], v[236:239], a[244:247]
    v_mfma_f32_16x16x32_bf16 a[248:251], v[120:123], v[240:243], a[248:251]
    v_mfma_f32_16x16x32_bf16 a[248:251], v[124:127], v[244:247], a[248:251]
    v_mfma_f32_16x16x32_bf16 a[252:255], v[120:123], v[248:251], a[252:255]
    v_mfma_f32_16x16x32_bf16 a[252:255], v[124:127], v[252:255], a[252:255]
    s_waitcnt lgkmcnt(0)
    v_mfma_f32_16x16x32_bf16 a[0:3], v[64:67], v[128:131], a[0:3]
    ds_read_b64_tr_b16 v[120:121], v31 offset:16384
    v_mfma_f32_16x16x32_bf16 a[0:3], v[68:71], v[132:135], a[0:3]
    ds_read_b64_tr_b16 v[122:123], v31 offset:17408
    v_mfma_f32_16x16x32_bf16 a[4:7], v[64:67], v[136:139], a[4:7]
    ds_read_b64_tr_b16 v[124:125], v31 offset:24576
    v_mfma_f32_16x16x32_bf16 a[4:7], v[68:71], v[140:143], a[4:7]
    ds_read_b64_tr_b16 v[126:127], v31 offset:25600
    v_mfma_f32_16x16x32_bf16 a[8:11], v[64:67], v[144:147], a[8:11]
    s_add_u32 s33, s33, 0x8000
    v_mfma_f32_16x16x32_bf16 a[8:11], v[68:71], v[148:151], a[8:11]
    s_cmp_ge_u32 s33, 163840
    v_mfma_f32_16x16x32_bf16 a[12:15], v[64:67], v[152:155], a[12:15]
    s_cselect_b32 s33, 65536, s33
    v_mfma_f32_16x16x32_bf16 a[12:15], v[68:71], v[156:159], a[12:15]
    v_add_u32 v28, s33, v32
    v_mfma_f32_16x16x32_bf16 a[16:19], v[64:67], v[160:163], a[16:19]
    v_add_u32 v29, s33, v33
    v_mfma_f32_16x16x32_bf16 a[16:19], v[68:71], v[164:167], a[16:19]
    v_add_u32 v30, s33, v34
    v_mfma_f32_16x16x32_bf16 a[20:23], v[64:67], v[168:171], a[20:23]
    v_add_u32 v31, s33, v35
    v_mfma_f32_16x16x32_bf16 a[20:23], v[68:71], v[172:175], a[20:23]
    v_mfma_f32_16x16x32_bf16 a[24:27], v[64:67], v[176:179], a[24:27]
    v_mfma_f32_16x16x32_bf16 a[24:27], v[68:71], v[180:183], a[24:27]
    s_waitcnt lgkmcnt(0) vmcnt(8)
    s_barrier
    s_cmp_eq_u32 s32, s58
    s_cselect_b32 s3, 0, 0x7ff00000
    v_or_b32 v2, s3, v36
    v_mfma_f32_16x16x32_bf16 a[28:31], v[64:67], v[184:187], a[28:31]
    buffer_load_dword v37, v2, s[44:47], s57 offen
    v_mfma_f32_16x16x32_bf16 a[28:31], v[68:71], v[188:191], a[28:31]
    s_mov_b32 m0, s30
    v_mfma_f32_16x16x32_bf16 a[32:35], v[72:75], v[128:131], a[32:35]
    ds_read_b64_tr_b16 v[64:65], v28 offset:0
    v_mfma_f32_16x16x32_bf16 a[32:35], v[76:79], v[132:135], a[32:35]
    buffer_load_dwordx4 v8, s[12:15], s28 offen offset:0 sc1 lds
    v_mfma_f32_16x16x32_bf16 a[36:39], v[72:75], v[136:139], a[36:39]
    ds_read_b64_tr_b16 v[66:67], v28 offset:1024
    v_mfma_f32_16x16x32_bf16 a[36:39], v[76:79], v[140:143], a[36:39]
    v_mfma_f32_16x16x32_bf16 a[40:43], v[72:75], v[144:147], a[40:43]
    ds_read_b64_tr_b16 v[68:69], v28 offset:8192
    v_mfma_f32_16x16x32_bf16 a[40:43], v[76:79], v[148:151], a[40:43]
    buffer_load_dwordx4 v8, s[12:15], s28 offen offset:1024 sc1 lds
    v_mfma_f32_16x16x32_bf16 a[44:47], v[72:75], v[152:155], a[44:47]
    ds_read_b64_tr_b16 v[70:71], v28 offset:9216
    v_mfma_f32_16x16x32_bf16 a[44:47], v[76:79], v[156:159], a[44:47]
    v_mfma_f32_16x16x32_bf16 a[48:51], v[72:75], v[160:163], a[48:51]
    ds_read_b128 v[192:195], v26 offset:0
    v_mfma_f32_16x16x32_bf16 a[48:51], v[76:79], v[164:167], a[48:51]
    buffer_load_dwordx4 v8, s[12:15], s28 offen offset:2048 sc1 lds
    v_mfma_f32_16x16x32_bf16 a[52:55], v[72:75], v[168:171], a[52:55]
    ds_read_b128 v[196:199], v27 offset:0
    v_mfma_f32_16x16x32_bf16 a[52:55], v[76:79], v[172:175], a[52:55]
    v_mfma_f32_16x16x32_bf16 a[56:59], v[72:75], v[176:179], a[56:59]
    ds_read_b128 v[200:203], v26 offset:2048
    v_mfma_f32_16x16x32_bf16 a[56:59], v[76:79], v[180:183], a[56:59]
    buffer_load_dwordx4 v8, s[12:15], s28 offen offset:3072 sc1 lds
    v_mfma_f32_16x16x32_bf16 a[60:63], v[72:75], v[184:187], a[60:63]
    v_mfma_f32_16x16x32_bf16 a[60:63], v[76:79], v[188:191], a[60:63]
    s_add_u32 m0, s30, 4096
    v_mfma_f32_16x16x32_bf16 a[64:67], v[80:83], v[128:131], a[64:67]
    ds_read_b64_tr_b16 v[72:73], v29 offset:0
    v_mfma_f32_16x16x32_bf16 a[64:67], v[84:87], v[132:135], a[64:67]
    buffer_load_dwordx4 v9, s[12:15], s28 offen offset:0 sc1 lds
    v_mfma_f32_16x16x32_bf16 a[68:71], v[80:83], v[136:139], a[68:71]
    ds_read_b64_tr_b16 v[74:75], v29 offset:1024
    v_mfma_f32_16x16x32_bf16 a[68:71], v[84:87], v[140:143], a[68:71]
    v_mfma_f32_16x16x32_bf16 a[72:75], v[80:83], v[144:147], a[72:75]
    ds_read_b64_tr_b16 v[76:77], v29 offset:8192
    v_mfma_f32_16x16x32_bf16 a[72:75], v[84:87], v[148:151], a[72:75]
    buffer_load_dwordx4 v9, s[12:15], s28 offen offset:1024 sc1 lds
    v_mfma_f32_16x16x32_bf16 a[76:79], v[80:83], v[152:155], a[76:79]
    ds_read_b64_tr_b16 v[78:79], v29 offset:9216
    v_mfma_f32_16x16x32_bf16 a[76:79], v[84:87], v[156:159], a[76:79]
    v_mfma_f32_16x16x32_bf16 a[80:83], v[80:83], v[160:163], a[80:83]
    ds_read_b128 v[204:207], v27 offset:2048
    v_mfma_f32_16x16x32_bf16 a[80:83], v[84:87], v[164:167], a[80:83]
    buffer_load_dwordx4 v9, s[12:15], s28 offen offset:2048 sc1 lds
    v_mfma_f32_16x16x32_bf16 a[84:87], v[80:83], v[168:171], a[84:87]
    ds_read_b128 v[208:211], v26 offset:4096
    v_mfma_f32_16x16x32_bf16 a[84:87], v[84:87], v[172:175], a[84:87]
    v_mfma_f32_16x16x32_bf16 a[88:91], v[80:83], v[176:179], a[88:91]
    ds_read_b128 v[212:215], v27 offset:4096
    v_mfma_f32_16x16x32_bf16 a[88:91], v[84:87], v[180:183], a[88:91]
    buffer_load_dwordx4 v9, s[12:15], s28 offen offset:3072 sc1 lds
    v_mfma_f32_16x16x32_bf16 a[92:95], v[80:83], v[184:187], a[92:95]
    s_add_u32 s98, s98, 1
    s_xor_b32 s28, s98, s97
    s_lshl_b32 s28, s28, 15
    s_xor_b32 s30, s30, 0x8000
    v_mfma_f32_16x16x32_bf16 a[92:95], v[84:87], v[188:191], a[92:95]
    s_mov_b32 m0, s31
    v_mfma_f32_16x16x32_bf16 a[96:99], v[88:91], v[128:131], a[96:99]
    ds_read_b64_tr_b16 v[80:81], v30 offset:0
    v_mfma_f32_16x16x32_bf16 a[96:99], v[92:95], v[132:135], a[96:99]
    buffer_load_dwordx4 v16, s[16:19], s29 offen offset:0 lds
    v_mfma_f32_16x16x32_bf16 a[100:103], v[88:91], v[136:139], a[100:103]
    ds_read_b64_tr_b16 v[82:83], v30 offset:1024
    v_mfma_f32_16x16x32_bf16 a[100:103], v[92:95], v[140:143], a[100:103]
    v_mfma_f32_16x16x32_bf16 a[104:107], v[88:91], v[144:147], a[104:107]
    ds_read_b64_tr_b16 v[84:85], v30 offset:8192
    v_mfma_f32_16x16x32_bf16 a[104:107], v[92:95], v[148:151], a[104:107]
    buffer_load_dwordx4 v17, s[16:19], s29 offen offset:1024 lds
    v_mfma_f32_16x16x32_bf16 a[108:111], v[88:91], v[152:155], a[108:111]
    ds_read_b64_tr_b16 v[86:87], v30 offset:9216
    v_mfma_f32_16x16x32_bf16 a[108:111], v[92:95], v[156:159], a[108:111]
    v_mfma_f32_16x16x32_bf16 a[112:115], v[88:91], v[160:163], a[112:115]
    ds_read_b128 v[216:219], v26 offset:6144
    v_mfma_f32_16x16x32_bf16 a[112:115], v[92:95], v[164:167], a[112:115]
    buffer_load_dwordx4 v18, s[16:19], s29 offen offset:2048 lds
    v_mfma_f32_16x16x32_bf16 a[116:119], v[88:91], v[168:171], a[116:119]
    ds_read_b128 v[220:223], v27 offset:6144
    v_mfma_f32_16x16x32_bf16 a[116:119], v[92:95], v[172:175], a[116:119]
    v_mfma_f32_16x16x32_bf16 a[120:123], v[88:91], v[176:179], a[120:123]
    ds_read_b128 v[224:227], v26 offset:8192
    v_mfma_f32_16x16x32_bf16 a[120:123], v[92:95], v[180:183], a[120:123]
    buffer_load_dwordx4 v19, s[16:19], s29 offen offset:3072 lds
    v_mfma_f32_16x16x32_bf16 a[124:127], v[88:91], v[184:187], a[124:127]
    v_mfma_f32_16x16x32_bf16 a[124:127], v[92:95], v[188:191], a[124:127]
    s_add_u32 m0, s31, 4096
    v_mfma_f32_16x16x32_bf16 a[128:131], v[96:99], v[128:131], a[128:131]
    ds_read_b64_tr_b16 v[88:89], v31 offset:0
    v_mfma_f32_16x16x32_bf16 a[128:131], v[100:103], v[132:135], a[128:131]
    buffer_load_dwordx4 v20, s[16:19], s29 offen offset:0 lds
    v_mfma_f32_16x16x32_bf16 a[132:135], v[96:99], v[136:139], a[132:135]
    ds_read_b64_tr_b16 v[90:91], v31 offset:1024
    v_mfma_f32_16x16x32_bf16 a[132:135], v[100:103], v[140:143], a[132:135]
    v_mfma_f32_16x16x32_bf16 a[136:139], v[96:99], v[144:147], a[136:139]
    ds_read_b64_tr_b16 v[92:93], v31 offset:8192
    v_mfma_f32_16x16x32_bf16 a[136:139], v[100:103], v[148:151], a[136:139]
    buffer_load_dwordx4 v21, s[16:19], s29 offen offset:1024 lds
    v_mfma_f32_16x16x32_bf16 a[140:143], v[96:99], v[152:155], a[140:143]
    ds_read_b64_tr_b16 v[94:95], v31 offset:9216
    v_mfma_f32_16x16x32_bf16 a[140:143], v[100:103], v[156:159], a[140:143]
    v_mfma_f32_16x16x32_bf16 a[144:147], v[96:99], v[160:163], a[144:147]
    ds_read_b128 v[228:231], v27 offset:8192
    v_mfma_f32_16x16x32_bf16 a[144:147], v[100:103], v[164:167], a[144:147]
    buffer_load_dwordx4 v22, s[16:19], s29 offen offset:2048 lds
    v_mfma_f32_16x16x32_bf16 a[148:151], v[96:99], v[168:171], a[148:151]
    ds_read_b128 v[232:235], v26 offset:10240
    v_mfma_f32_16x16x32_bf16 a[148:151], v[100:103], v[172:175], a[148:151]
    v_mfma_f32_16x16x32_bf16 a[152:155], v[96:99], v[176:179], a[152:155]
    ds_read_b128 v[236:239], v27 offset:10240
    v_mfma_f32_16x16x32_bf16 a[152:155], v[100:103], v[180:183], a[152:155]
    buffer_load_dwordx4 v23, s[16:19], s29 offen offset:3072 lds
    v_mfma_f32_16x16x32_bf16 a[156:159], v[96:99], v[184:187], a[156:159]
    s_add_u32 s99, s99, 1
    s_xor_b32 s29, s99, s97
    s_mul_i32 s29, s29, 458752
    s_add_u32 s31, s31, 0x8000
    s_cmp_ge_u32 s31, 163840
    s_cselect_b32 s3, 98304, 0
    s_sub_u32 s31, s31, s3
    v_mfma_f32_16x16x32_bf16 a[156:159], v[100:103], v[188:191], a[156:159]
    v_mfma_f32_16x16x32_bf16 a[160:163], v[104:107], v[128:131], a[160:163]
    ds_read_b64_tr_b16 v[96:97], v28 offset:16384
    v_mfma_f32_16x16x32_bf16 a[160:163], v[108:111], v[132:135], a[160:163]
    v_mfma_f32_16x16x32_bf16 a[164:167], v[104:107], v[136:139], a[164:167]
    ds_read_b64_tr_b16 v[98:99], v28 offset:17408
    v_mfma_f32_16x16x32_bf16 a[164:167], v[108:111], v[140:143], a[164:167]
    v_mfma_f32_16x16x32_bf16 a[168:171], v[104:107], v[144:147], a[168:171]
    ds_read_b64_tr_b16 v[100:101], v28 offset:24576
    v_mfma_f32_16x16x32_bf16 a[168:171], v[108:111], v[148:151], a[168:171]
    v_mfma_f32_16x16x32_bf16 a[172:175], v[104:107], v[152:155], a[172:175]
    ds_read_b64_tr_b16 v[102:103], v28 offset:25600
    v_mfma_f32_16x16x32_bf16 a[172:175], v[108:111], v[156:159], a[172:175]
    v_mfma_f32_16x16x32_bf16 a[176:179], v[104:107], v[160:163], a[176:179]
    ds_read_b128 v[240:243], v26 offset:12288
    v_mfma_f32_16x16x32_bf16 a[176:179], v[108:111], v[164:167], a[176:179]
    v_mfma_f32_16x16x32_bf16 a[180:183], v[104:107], v[168:171], a[180:183]
    ds_read_b128 v[244:247], v27 offset:12288
    s_cmp_eq_u32 s32, s59
    s_cselect_b32 s3, 0, 0x7ff00000
    v_or_b32 v2, s3, v36
    v_mfma_f32_16x16x32_bf16 a[180:183], v[108:111], v[172:175], a[180:183]
    buffer_load_dword v39, v2, s[84:87], s63 offen
    v_mfma_f32_16x16x32_bf16 a[184:187], v[104:107], v[176:179], a[184:187]
    ds_read_b128 v[248:251], v26 offset:14336
    v_mfma_f32_16x16x32_bf16 a[184:187], v[108:111], v[180:183], a[184:187]
    v_mfma_f32_16x16x32_bf16 a[188:191], v[104:107], v[184:187], a[188:191]
    v_mfma_f32_16x16x32_bf16 a[188:191], v[108:111], v[188:191], a[188:191]
    v_mfma_f32_16x16x32_bf16 a[192:195], v[112:115], v[128:131], a[192:195]
    ds_read_b64_tr_b16 v[104:105], v29 offset:16384
    v_mfma_f32_16x16x32_bf16 a[192:195], v[116:119], v[132:135], a[192:195]
    v_mfma_f32_16x16x32_bf16 a[196:199], v[112:115], v[136:139], a[196:199]
    ds_read_b64_tr_b16 v[106:107], v29 offset:17408
    v_mfma_f32_16x16x32_bf16 a[196:199], v[116:119], v[140:143], a[196:199]
    v_mfma_f32_16x16x32_bf16 a[200:203], v[112:115], v[144:147], a[200:203]
    ds_read_b64_tr_b16 v[108:109], v29 offset:24576
    v_mfma_f32_16x16x32_bf16 a[200:203], v[116:119], v[148:151], a[200:203]
    v_mfma_f32_16x16x32_bf16 a[204:207], v[112:115], v[152:155], a[204:207]
    ds_read_b64_tr_b16 v[110:111], v29 offset:25600
    v_mfma_f32_16x16x32_bf16 a[204:207], v[116:119], v[156:159], a[204:207]
    v_mfma_f32_16x16x32_bf16 a[208:211], v[112:115], v[160:163], a[208:211]
    ds_read_b128 v[252:255], v27 offset:14336
    v_mfma_f32_16x16x32_bf16 a[208:211], v[116:119], v[164:167], a[208:211]
    v_mfma_f32_16x16x32_bf16 a[212:215], v[112:115], v[168:171], a[212:215]
    v_mfma_f32_16x16x32_bf16 a[212:215], v[116:119], v[172:175], a[212:215]
    v_mfma_f32_16x16x32_bf16 a[216:219], v[112:115], v[176:179], a[216:219]
    v_mfma_f32_16x16x32_bf16 a[216:219], v[116:119], v[180:183], a[216:219]
    v_mfma_f32_16x16x32_bf16 a[220:223], v[112:115], v[184:187], a[220:223]
    v_mfma_f32_16x16x32_bf16 a[220:223], v[116:119], v[188:191], a[220:223]
    v_mfma_f32_16x16x32_bf16 a[224:227], v[120:123], v[128:131], a[224:227]
    ds_read_b64_tr_b16 v[112:113], v30 offset:16384
    v_mfma_f32_16x16x32_bf16 a[224:227], v[124:127], v[132:135], a[224:227]
    v_mfma_f32_16x16x32_bf16 a[228:231], v[120:123], v[136:139], a[228:231]
    ds_read_b64_tr_b16 v[114:115], v30 offset:17408
    v_mfma_f32_16x16x32_bf16 a[228:231], v[124:127], v[140:143], a[228:231]
    v_mfma_f32_16x16x32_bf16 a[232:235], v[120:123], v[144:147], a[232:235]
    ds_read_b64_tr_b16 v[116:117], v30 offset:24576
    v_mfma_f32_16x16x32_bf16 a[232:235], v[124:127], v[148:151], a[232:235]
    v_mfma_f32_16x16x32_bf16 a[236:239], v[120:123], v[152:155], a[236:239]
    ds_read_b64_tr_b16 v[118:119], v30 offset:25600
    v_mfma_f32_16x16x32_bf16 a[236:239], v[124:127], v[156:159], a[236:239]
    v_mfma_f32_16x16x32_bf16 a[240:243], v[120:123], v[160:163], a[240:243]
    v_mfma_f32_16x16x32_bf16 a[240:243], v[124:127], v[164:167], a[240:243]
    v_mfma_f32_16x16x32_bf16 a[244:247], v[120:123], v[168:171], a[244:247]
    v_mfma_f32_16x16x32_bf16 a[244:247], v[124:127], v[172:175], a[244:247]
    v_mfma_f32_16x16x32_bf16 a[248:251], v[120:123], v[176:179], a[248:251]
    v_mfma_f32_16x16x32_bf16 a[248:251], v[124:127], v[180:183], a[248:251]
    v_mfma_f32_16x16x32_bf16 a[252:255], v[120:123], v[184:187], a[252:255]
    v_mfma_f32_16x16x32_bf16 a[252:255], v[124:127], v[188:191], a[252:255]
    s_add_u32 s32, s32, 1
    s_cmp_lt_u32 s32, 6
    s_cbranch_scc1 L_loop
L_late:
    s_waitcnt lgkmcnt(0)
    v_mfma_f32_16x16x32_bf16 a[0:3], v[64:67], v[192:195], a[0:3]
    ds_read_b64_tr_b16 v[120:121], v31 offset:16384
    v_mfma_f32_16x16x32_bf16 a[0:3], v[68:71], v[196:199], a[0:3]
    ds_read_b64_tr_b16 v[122:123], v31 offset:17408
    v_mfma_f32_16x16x32_bf16 a[4:7], v[64:67], v[200:203], a[4:7]
    ds_read_b64_tr_b16 v[124:125], v31 offset:24576
    v_mfma_f32_16x16x32_bf16 a[4:7], v[68:71], v[204:207], a[4:7]
    ds_read_b64_tr_b16 v[126:127], v31 offset:25600
    v_mfma_f32_16x16x32_bf16 a[8:11], v[64:67], v[208:211], a[8:11]
    s_add_u32 s33, s33, 0x8000
    v_mfma_f32_16x16x32_bf16 a[8:11], v[68:71], v[212:215], a[8:11]
    s_cmp_ge_u32 s33, 163840
    v_mfma_f32_16x16x32_bf16 a[12:15], v[64:67], v[216:219], a[12:15]
    s_cselect_b32 s33, 65536, s33
    v_mfma_f32_16x16x32_bf16 a[12:15], v[68:71], v[220:223], a[12:15]
    v_add_u32 v28, s33, v32
    v_mfma_f32_16x16x32_bf16 a[16:19], v[64:67], v[224:227], a[16:19]
    v_add_u32 v29, s33, v33
    v_mfma_f32_16x16x32_bf16 a[16:19], v[68:71], v[228:231], a[16:19]
    v_add_u32 v30, s33, v34
    v_mfma_f32_16x16x32_bf16 a[20:23], v[64:67], v[232:235], a[20:23]
    v_add_u32 v31, s33, v35
    v_mfma_f32_16x16x32_bf16 a[20:23], v[68:71], v[236:239], a[20:23]
    v_mfma_f32_16x16x32_bf16 a[24:27], v[64:67], v[240:243], a[24:27]
    v_mfma_f32_16x16x32_bf16 a[24:27], v[68:71], v[244:247], a[24:27]
    s_waitcnt lgkmcnt(0) vmcnt(8)
    s_barrier
    v_mfma_f32_16x16x32_bf16 a[28:31], v[64:67], v[248:251], a[28:31]
    v_mfma_f32_16x16x32_bf16 a[28:31], v[68:71], v[252:255], a[28:31]
    s_mov_b32 m0, s30
    v_mfma_f32_16x16x32_bf16 a[32:35], v[72:75], v[192:195], a[32:35]
    ds_read_b64_tr_b16 v[64:65], v28 offset:0
    v_mfma_f32_16x16x32_bf16 a[32:35], v[76:79], v[196:199], a[32:35]
    buffer_load_dwordx4 v8, s[12:15], s28 offen offset:0 sc1 lds
    v_mfma_f32_16x16x32_bf16 a[36:39], v[72:75], v[200:203], a[36:39]
    ds_read_b64_tr_b16 v[66:67], v28 offset:1024
    v_mfma_f32_16x16x32_bf16 a[36:39], v[76:79], v[204:207], a[36:39]
    v_mfma_f32_16x16x32_bf16 a[40:43], v[72:75], v[208:211], a[40:43]
    ds_read_b64_tr_b16 v[68:69], v28 offset:8192
    v_mfma_f32_16x16x32_bf16 a[40:43], v[76:79], v[212:215], a[40:43]
    buffer_load_dwordx4 v8, s[12:15], s28 offen offset:1024 sc1 lds
    v_mfma_f32_16x16x32_bf16 a[44:47], v[72:75], v[216:219], a[44:47]
    ds_read_b64_tr_b16 v[70:71], v28 offset:9216
    v_mfma_f32_16x16x32_bf16 a[44:47], v[76:79], v[220:223], a[44:47]
    v_mfma_f32_16x16x32_bf16 a[48:51], v[72:75], v[224:227], a[48:51]
    ds_read_b128 v[128:131], v24 offset:0
    v_mfma_f32_16x16x32_bf16 a[48:51], v[76:79], v[228:231], a[48:51]
    buffer_load_dwordx4 v8, s[12:15], s28 offen offset:2048 sc1 lds
    v_mfma_f32_16x16x32_bf16 a[52:55], v[72:75], v[232:235], a[52:55]
    ds_read_b128 v[132:135], v25 offset:0
    v_mfma_f32_16x16x32_bf16 a[52:55], v[76:79], v[236:239], a[52:55]
    v_mfma_f32_16x16x32_bf16 a[56:59], v[72:75], v[240:243], a[56:59]
    ds_read_b128 v[136:139], v24 offset:2048
    v_mfma_f32_16x16x32_bf16 a[56:59], v[76:79], v[244:247], a[56:59]
    buffer_load_dwordx4 v8, s[12:15], s28 offen offset:3072 sc1 lds
    v_mfma_f32_16x16x32_bf16 a[60:63], v[72:75], v[248:251], a[60:63]
    v_mfma_f32_16x16x32_bf16 a[60:63], v[76:79], v[252:255], a[60:63]
    s_add_u32 m0, s30, 4096
    v_mfma_f32_16x16x32_bf16 a[64:67], v[80:83], v[192:195], a[64:67]
    ds_read_b64_tr_b16 v[72:73], v29 offset:0
    v_mfma_f32_16x16x32_bf16 a[64:67], v[84:87], v[196:199], a[64:67]
    buffer_load_dwordx4 v9, s[12:15], s28 offen offset:0 sc1 lds
    v_mfma_f32_16x16x32_bf16 a[68:71], v[80:83], v[200:203], a[68:71]
    ds_read_b64_tr_b16 v[74:75], v29 offset:1024
    v_mfma_f32_16x16x32_bf16 a[68:71], v[84:87], v[204:207], a[68:71]
    v_mfma_f32_16x16x32_bf16 a[72:75], v[80:83], v[208:211], a[72:75]
    ds_read_b64_tr_b16 v[76:77], v29 offset:8192
    v_mfma_f32_16x16x32_bf16 a[72:75], v[84:87], v[212:215], a[72:75]
    buffer_load_dwordx4 v9, s[12:15], s28 offen offset:1024 sc1 lds
    v_mfma_f32_16x16x32_bf16 a[76:79], v[80:83], v[216:219], a[76:79]
    ds_read_b64_tr_b16 v[78:79], v29 offset:9216
    v_mfma_f32_16x16x32_bf16 a[76:79], v[84:87], v[220:223], a[76:79]
    v_mfma_f32_16x16x32_bf16 a[80:83], v[80:83], v[224:227], a[80:83]
    ds_read_b128 v[140:143], v25 offset:2048
    v_mfma_f32_16x16x32_bf16 a[80:83], v[84:87], v[228:231], a[80:83]
    buffer_load_dwordx4 v9, s[12:15], s28 offen offset:2048 sc1 lds
    v_mfma_f32_16x16x32_bf16 a[84:87], v[80:83], v[232:235], a[84:87]
    ds_read_b128 v[144:147], v24 offset:4096
    v_mfma_f32_16x16x32_bf16 a[84:87], v[84:87], v[236:239], a[84:87]
    v_mfma_f32_16x16x32_bf16 a[88:91], v[80:83], v[240:243], a[88:91]
    ds_read_b128 v[148:151], v25 offset:4096
    v_mfma_f32_16x16x32_bf16 a[88:91], v[84:87], v[244:247], a[88:91]
    buffer_load_dwordx4 v9, s[12:15], s28 offen offset:3072 sc1 lds
    v_mfma_f32_16x16x32_bf16 a[92:95], v[80:83], v[248:251], a[92:95]
    s_add_u32 s98, s98, 1
    s_xor_b32 s28, s98, s97
    s_lshl_b32 s28, s28, 15
    s_xor_b32 s30, s30, 0x8000
    v_mfma_f32_16x16x32_bf16 a[92:95], v[84:87], v[252:255], a[92:95]
    v_mfma_f32_16x16x32_bf16 a[96:99], v[88:91], v[192:195], a[96:99]
    ds_read_b64_tr_b16 v[80:81], v30 offset:0
    v_mfma_f32_16x16x32_bf16 a[96:99], v[92:95], v[196:199], a[96:99]
    v_mfma_f32_16x16x32_bf16 a[100:103], v[88:91], v[200:203], a[100:103]
    ds_read_b64_tr_b16 v[82:83], v30 offset:1024
    v_mfma_f32_16x16x32_bf16 a[100:103], v[92:95], v[204:207], a[100:103]
    v_mfma_f32_16x16x32_bf16 a[104:107], v[88:91], v[208:211], a[104:107]
    ds_read_b64_tr_b16 v[84:85], v30 offset:8192
    v_mfma_f32_16x16x32_bf16 a[104:107], v[92:95], v[212:215], a[104:107]
    v_mfma_f32_16x16x32_bf16 a[108:111], v[88:91], v[216:219], a[108:111]
    ds_read_b64_tr_b16 v[86:87], v30 offset:9216
    v_mfma_f32_16x16x32_bf16 a[108:111], v[92:95], v[220:223], a[108:111]
    v_mfma_f32_16x16x32_bf16 a[112:115], v[88:91], v[224:227], a[112:115]
    ds_read_b128 v[152:155], v24 offset:6144
    v_mfma_f32_16x16x32_bf16 a[112:115], v[92:95], v[228:231], a[112:115]
    v_mfma_f32_16x16x32_bf16 a[116:119], v[88:91], v[232:235], a[116:119]
    ds_read_b128 v[156:159], v25 offset:6144
    v_mfma_f32_16x16x32_bf16 a[116:119], v[92:95], v[236:239], a[116:119]
    v_mfma_f32_16x16x32_bf16 a[120:123], v[88:91], v[240:243], a[120:123]
    ds_read_b128 v[160:163], v24 offset:8192
    v_mfma_f32_16x16x32_bf16 a[120:123], v[92:95], v[244:247], a[120:123]
    v_mfma_f32_16x16x32_bf16 a[124:127], v[88:91], v[248:251], a[124:127]
    v_mfma_f32_16x16x32_bf16 a[124:127], v[92:95], v[252:255], a[124:127]
    v_mfma_f32_16x16x32_bf16 a[128:131], v[96:99], v[192:195], a[128:131]
    ds_read_b64_tr_b16 v[88:89], v31 offset:0
    v_mfma_f32_16x16x32_bf16 a[128:131], v[100:103], v[196:199], a[128:131]
    v_mfma_f32_16x16x32_bf16 a[132:135], v[96:99], v[200:203], a[132:135]
    ds_read_b64_tr_b16 v[90:91], v31 offset:1024
    v_mfma_f32_16x16x32_bf16 a[132:135], v[100:103], v[204:207], a[132:135]
    v_mfma_f32_16x16x32_bf16 a[136:139], v[96:99], v[208:211], a[136:139]
    ds_read_b64_tr_b16 v[92:93], v31 offset:8192
    v_mfma_f32_16x16x32_bf16 a[136:139], v[100:103], v[212:215], a[136:139]
    v_mfma_f32_16x16x32_bf16 a[140:143], v[96:99], v[216:219], a[140:143]
    ds_read_b64_tr_b16 v[94:95], v31 offset:9216
    v_mfma_f32_16x16x32_bf16 a[140:143], v[100:103], v[220:223], a[140:143]
    v_mfma_f32_16x16x32_bf16 a[144:147], v[96:99], v[224:227], a[144:147]
    ds_read_b128 v[164:167], v25 offset:8192
    v_mfma_f32_16x16x32_bf16 a[144:147], v[100:103], v[228:231], a[144:147]
    v_mfma_f32_16x16x32_bf16 a[148:151], v[96:99], v[232:235], a[148:151]
    ds_read_b128 v[168:171], v24 offset:10240
    v_mfma_f32_16x16x32_bf16 a[148:151], v[100:103], v[236:239], a[148:151]
    v_mfma_f32_16x16x32_bf16 a[152:155], v[96:99], v[240:243], a[152:155]
    ds_read_b128 v[172:175], v25 offset:10240
    v_mfma_f32_16x16x32_bf16 a[152:155], v[100:103], v[244:247], a[152:155]
    v_mfma_f32_16x16x32_bf16 a[156:159], v[96:99], v[248:251], a[156:159]
    v_mfma_f32_16x16x32_bf16 a[156:159], v[100:103], v[252:255], a[156:159]
    v_mfma_f32_16x16x32_bf16 a[160:163], v[104:107], v[192:195], a[160:163]
    ds_read_b64_tr_b16 v[96:97], v28 offset:16384
    v_mfma_f32_16x16x32_bf16 a[160:163], v[108:111], v[196:199], a[160:163]
    v_mfma_f32_16x16x32_bf16 a[164:167], v[104:107], v[200:203], a[164:167]
    ds_read_b64_tr_b16 v[98:99], v28 offset:17408
    v_mfma_f32_16x16x32_bf16 a[164:167], v[108:111], v[204:207], a[164:167]
    v_mfma_f32_16x16x32_bf16 a[168:171], v[104:107], v[208:211], a[168:171]
    ds_read_b64_tr_b16 v[100:101], v28 offset:24576
    v_mfma_f32_16x16x32_bf16 a[168:171], v[108:111], v[212:215], a[168:171]
    v_mfma_f32_16x16x32_bf16 a[172:175], v[104:107], v[216:219], a[172:175]
    ds_read_b64_tr_b16 v[102:103], v28 offset:25600
    v_mfma_f32_16x16x32_bf16 a[172:175], v[108:111], v[220:223], a[172:175]
    v_mfma_f32_16x16x32_bf16 a[176:179], v[104:107], v[224:227], a[176:179]
    ds_read_b128 v[176:179], v24 offset:12288
    v_mfma_f32_16x16x32_bf16 a[176:179], v[108:111], v[228:231], a[176:179]
    v_mfma_f32_16x16x32_bf16 a[180:183], v[104:107], v[232:235], a[180:183]
    ds_read_b128 v[180:183], v25 offset:12288
    v_mfma_f32_16x16x32_bf16 a[180:183], v[108:111], v[236:239], a[180:183]
    v_mfma_f32_16x16x32_bf16 a[184:187], v[104:107], v[240:243], a[184:187]
    ds_read_b128 v[184:187], v24 offset:14336
    v_mfma_f32_16x16x32_bf16 a[184:187], v[108:111], v[244:247], a[184:187]
    v_mfma_f32_16x16x32_bf16 a[188:191], v[104:107], v[248:251], a[188:191]
    v_mfma_f32_16x16x32_bf16 a[188:191], v[108:111], v[252:255], a[188:191]
    v_mfma_f32_16x16x32_bf16 a[192:195], v[112:115], v[192:195], a[192:195]
    ds_read_b64_tr_b16 v[104:105], v29 offset:16384
    v_mfma_f32_16x16x32_bf16 a[192:195], v[116:119], v[196:199], a[192:195]
    v_mfma_f32_16x16x32_bf16 a[196:199], v[112:115], v[200:203], a[196:199]
    ds_read_b64_tr_b16 v[106:107], v29 offset:17408
    v_mfma_f32_16x16x32_bf16 a[196:199], v[116:119], v[204:207], a[196:199]
    v_mfma_f32_16x16x32_bf16 a[200:203], v[112:115], v[208:211], a[200:203]
    ds_read_b64_tr_b16 v[108:109], v29 offset:24576
    v_mfma_f32_16x16x32_bf16 a[200:203], v[116:119], v[212:215], a[200:203]
    v_mfma_f32_16x16x32_bf16 a[204:207], v[112:115], v[216:219], a[204:207]
    ds_read_b64_tr_b16 v[110:111], v29 offset:25600
    v_mfma_f32_16x16x32_bf16 a[204:207], v[116:119], v[220:223], a[204:207]
    v_mfma_f32_16x16x32_bf16 a[208:211], v[112:115], v[224:227], a[208:211]
    ds_read_b128 v[188:191], v25 offset:14336
    v_mfma_f32_16x16x32_bf16 a[208:211], v[116:119], v[228:231], a[208:211]
    v_mfma_f32_16x16x32_bf16 a[212:215], v[112:115], v[232:235], a[212:215]
    v_mfma_f32_16x16x32_bf16 a[212:215], v[116:119], v[236:239], a[212:215]
    v_mfma_f32_16x16x32_bf16 a[216:219], v[112:115], v[240:243], a[216:219]
    v_mfma_f32_16x16x32_bf16 a[216:219], v[116:119], v[244:247], a[216:219]
    v_mfma_f32_16x16x32_bf16 a[220:223], v[112:115], v[248:251], a[220:223]
    v_mfma_f32_16x16x32_bf16 a[220:223], v[116:119], v[252:255], a[220:223]
    v_mfma_f32_16x16x32_bf16 a[224:227], v[120:123], v[192:195], a[224:227]
    ds_read_b64_tr_b16 v[112:113], v30 offset:16384
    v_mfma_f32_16x16x32_bf16 a[224:227], v[124:127], v[196:199], a[224:227]
    v_mfma_f32_16x16x32_bf16 a[228:231], v[120:123], v[200:203], a[228:231]
    ds_read_b64_tr_b16 v[114:115], v30 offset:17408
    v_mfma_f32_16x16x32_bf16 a[228:231], v[124:127], v[204:207], a[228:231]
    v_mfma_f32_16x16x32_bf16 a[232:235], v[120:123], v[208:211], a[232:235]
    ds_read_b64_tr_b16 v[116:117], v30 offset:24576
    v_mfma_f32_16x16x32_bf16 a[232:235], v[124:127], v[212:215], a[232:235]
    v_mfma_f32_16x16x32_bf16 a[236:239], v[120:123], v[216:219], a[236:239]
    ds_read_b64_tr_b16 v[118:119], v30 offset:25600
    v_mfma_f32_16x16x32_bf16 a[236:239], v[124:127], v[220:223], a[236:239]
    v_mfma_f32_16x16x32_bf16 a[240:243], v[120:123], v[224:227], a[240:243]
    v_mfma_f32_16x16x32_bf16 a[240:243], v[124:127], v[228:231], a[240:243]
    v_mfma_f32_16x16x32_bf16 a[244:247], v[120:123], v[232:235], a[244:247]
    v_mfma_f32_16x16x32_bf16 a[244:247], v[124:127], v[236:239], a[244:247]
    v_mfma_f32_16x16x32_bf16 a[248:251], v[120:123], v[240:243], a[248:251]
    v_mfma_f32_16x16x32_bf16 a[248:251], v[124:127], v[244:247], a[248:251]
    v_mfma_f32_16x16x32_bf16 a[252:255], v[120:123], v[248:251], a[252:255]
    v_mfma_f32_16x16x32_bf16 a[252:255], v[124:127], v[252:255], a[252:255]
    s_waitcnt lgkmcnt(0)
    v_mfma_f32_16x16x32_bf16 a[0:3], v[64:67], v[128:131], a[0:3]
    ds_read_b64_tr_b16 v[120:121], v31 offset:16384
    v_mfma_f32_16x16x32_bf16 a[0:3], v[68:71], v[132:135], a[0:3]
    ds_read_b64_tr_b16 v[122:123], v31 offset:17408
    v_mfma_f32_16x16x32_bf16 a[4:7], v[64:67], v[136:139], a[4:7]
    ds_read_b64_tr_b16 v[124:125], v31 offset:24576
    v_mfma_f32_16x16x32_bf16 a[4:7], v[68:71], v[140:143], a[4:7]
    ds_read_b64_tr_b16 v[126:127], v31 offset:25600
    v_mfma_f32_16x16x32_bf16 a[8:11], v[64:67], v[144:147], a[8:11]
    s_add_u32 s33, s33, 0x8000
    v_mfma_f32_16x16x32_bf16 a[8:11], v[68:71], v[148:151], a[8:11]
    s_cmp_ge_u32 s33, 163840
    v_mfma_f32_16x16x32_bf16 a[12:15], v[64:67], v[152:155], a[12:15]
    s_cselect_b32 s33, 65536, s33
    v_mfma_f32_16x16x32_bf16 a[12:15], v[68:71], v[156:159], a[12:15]
    v_add_u32 v28, s33, v32
    v_mfma_f32_16x16x32_bf16 a[16:19], v[64:67], v[160:163], a[16:19]
    v_add_u32 v29, s33, v33
    v_mfma_f32_16x16x32_bf16 a[16:19], v[68:71], v[164:167], a[16:19]
    v_add_u32 v30, s33, v34
    v_mfma_f32_16x16x32_bf16 a[20:23], v[64:67], v[168:171], a[20:23]
    v_add_u32 v31, s33, v35
    v_mfma_f32_16x16x32_bf16 a[20:23], v[68:71], v[172:175], a[20:23]
    v_mfma_f32_16x16x32_bf16 a[24:27], v[64:67], v[176:179], a[24:27]
    v_mfma_f32_16x16x32_bf16 a[24:27], v[68:71], v[180:183], a[24:27]
    s_waitcnt lgkmcnt(0) vmcnt(0)
    s_barrier
    v_mfma_f32_16x16x32_bf16 a[28:31], v[64:67], v[184:187], a[28:31]
    v_mfma_f32_16x16x32_bf16 a[28:31], v[68:71], v[188:191], a[28:31]
    s_add_u32 m0, s68, 0
    v_mfma_f32_16x16x32_bf16 a[32:35], v[72:75], v[128:131], a[32:35]
    ds_read_b64_tr_b16 v[64:65], v28 offset:0
    v_mfma_f32_16x16x32_bf16 a[32:35], v[76:79], v[132:135], a[32:35]
    buffer_load_dwordx4 v40, s[40:43], s54 offen offset:0 lds
    v_mfma_f32_16x16x32_bf16 a[36:39], v[72:75], v[136:139], a[36:39]
    ds_read_b64_tr_b16 v[66:67], v28 offset:1024
    v_mfma_f32_16x16x32_bf16 a[36:39], v[76:79], v[140:143], a[36:39]
    v_mfma_f32_16x16x32_bf16 a[40:43], v[72:75], v[144:147], a[40:43]
    ds_read_b64_tr_b16 v[68:69], v28 offset:8192
    v_mfma_f32_16x16x32_bf16 a[40:43], v[76:79], v[148:151], a[40:43]
    buffer_load_dwordx4 v41, s[40:43], s54 offen offset:1024 lds
    v_mfma_f32_16x16x32_bf16 a[44:47], v[72:75], v[152:155], a[44:47]
    ds_read_b64_tr_b16 v[70:71], v28 offset:9216
    v_mfma_f32_16x16x32_bf16 a[44:47], v[76:79], v[156:159], a[44:47]
    v_mfma_f32_16x16x32_bf16 a[48:51], v[72:75], v[160:163], a[48:51]
    ds_read_b128 v[192:195], v26 offset:0
    v_mfma_f32_16x16x32_bf16 a[48:51], v[76:79], v[164:167], a[48:51]
    buffer_load_dwordx4 v42, s[40:43], s54 offen offset:2048 lds
    v_mfma_f32_16x16x32_bf16 a[52:55], v[72:75], v[168:171], a[52:55]
    ds_read_b128 v[196:199], v27 offset:0
    v_mfma_f32_16x16x32_bf16 a[52:55], v[76:79], v[172:175], a[52:55]
    v_mfma_f32_16x16x32_bf16 a[56:59], v[72:75], v[176:179], a[56:59]
    ds_read_b128 v[200:203], v26 offset:2048
    v_mfma_f32_16x16x32_bf16 a[56:59], v[76:79], v[180:183], a[56:59]
    buffer_load_dwordx4 v43, s[40:43], s54 offen offset:3072 lds
    v_mfma_f32_16x16x32_bf16 a[60:63], v[72:75], v[184:187], a[60:63]
    v_mfma_f32_16x16x32_bf16 a[60:63], v[76:79], v[188:191], a[60:63]
    s_add_u32 m0, s68, 4096
    v_mfma_f32_16x16x32_bf16 a[64:67], v[80:83], v[128:131], a[64:67]
    ds_read_b64_tr_b16 v[72:73], v29 offset:0
    v_mfma_f32_16x16x32_bf16 a[64:67], v[84:87], v[132:135], a[64:67]
    buffer_load_dwordx4 v40, s[40:43], s55 offen offset:0 lds
    v_mfma_f32_16x16x32_bf16 a[68:71], v[80:83], v[136:139], a[68:71]
    ds_read_b64_tr_b16 v[74:75], v29 offset:1024
    v_mfma_f32_16x16x32_bf16 a[68:71], v[84:87], v[140:143], a[68:71]
    v_mfma_f32_16x16x32_bf16 a[72:75], v[80:83], v[144:147], a[72:75]
    ds_read_b64_tr_b16 v[76:77], v29 offset:8192
    v_mfma_f32_16x16x32_bf16 a[72:75], v[84:87], v[148:151], a[72:75]
    buffer_load_dwordx4 v41, s[40:43], s55 offen offset:1024 lds
    v_mfma_f32_16x16x32_bf16 a[76:79], v[80:83], v[152:155], a[76:79]
    ds_read_b64_tr_b16 v[78:79], v29 offset:9216
    v_mfma_f32_16x16x32_bf16 a[76:79], v[84:87], v[156:159], a[76:79]
    v_mfma_f32_16x16x32_bf16 a[80:83], v[80:83], v[160:163], a[80:83]
    ds_read_b128 v[204:207], v27 offset:2048
    v_mfma_f32_16x16x32_bf16 a[80:83], v[84:87], v[164:167], a[80:83]
    buffer_load_dwordx4 v42, s[40:43], s55 offen offset:2048 lds
    v_mfma_f32_16x16x32_bf16 a[84:87], v[80:83], v[168:171], a[84:87]
    ds_read_b128 v[208:211], v26 offset:4096
    v_mfma_f32_16x16x32_bf16 a[84:87], v[84:87], v[172:175], a[84:87]
    v_mfma_f32_16x16x32_bf16 a[88:91], v[80:83], v[176:179], a[88:91]
    ds_read_b128 v[212:215], v27 offset:4096
    v_mfma_f32_16x16x32_bf16 a[88:91], v[84:87], v[180:183], a[88:91]
    buffer_load_dwordx4 v43, s[40:43], s55 offen offset:3072 lds
    v_mfma_f32_16x16x32_bf16 a[92:95], v[80:83], v[184:187], a[92:95]
    s_add_u32 s54, s54, 131072
    s_cmp_eq_u32 s54, s101
    s_cselect_b32 s54, s100, s54
    s_add_u32 s55, s54, 65536
    v_mfma_f32_16x16x32_bf16 a[92:95], v[84:87], v[188:191], a[92:95]
    s_add_u32 m0, s68, 8192
    v_mfma_f32_16x16x32_bf16 a[96:99], v[88:91], v[128:131], a[96:99]
    ds_read_b64_tr_b16 v[80:81], v30 offset:0
    v_mfma_f32_16x16x32_bf16 a[96:99], v[92:95], v[132:135], a[96:99]
    buffer_load_dwordx4 v40, s[40:43], s54 offen offset:0 lds
    v_mfma_f32_16x16x32_bf16 a[100:103], v[88:91], v[136:139], a[100:103]
    ds_read_b64_tr_b16 v[82:83], v30 offset:1024
    v_mfma_f32_16x16x32_bf16 a[100:103], v[92:95], v[140:143], a[100:103]
    v_mfma_f32_16x16x32_bf16 a[104:107], v[88:91], v[144:147], a[104:107]
    ds_read_b64_tr_b16 v[84:85], v30 offset:8192
    v_mfma_f32_16x16x32_bf16 a[104:107], v[92:95], v[148:151], a[104:107]
    buffer_load_dwordx4 v41, s[40:43], s54 offen offset:1024 lds
    v_mfma_f32_16x16x32_bf16 a[108:111], v[88:91], v[152:155], a[108:111]
    ds_read_b64_tr_b16 v[86:87], v30 offset:9216
    v_mfma_f32_16x16x32_bf16 a[108:111], v[92:95], v[156:159], a[108:111]
    v_mfma_f32_16x16x32_bf16 a[112:115], v[88:91], v[160:163], a[112:115]
    ds_read_b128 v[216:219], v26 offset:6144
    v_mfma_f32_16x16x32_bf16 a[112:115], v[92:95], v[164:167], a[112:115]
    buffer_load_dwordx4 v42, s[40:43], s54 offen offset:2048 lds
    v_mfma_f32_16x16x32_bf16 a[116:119], v[88:91], v[168:171], a[116:119]
    ds_read_b128 v[220:223], v27 offset:6144
    v_mfma_f32_16x16x32_bf16 a[116:119], v[92:95], v[172:175], a[116:119]
    v_mfma_f32_16x16x32_bf16 a[120:123], v[88:91], v[176:179], a[120:123]
    ds_read_b128 v[224:227], v26 offset:8192
    v_mfma_f32_16x16x32_bf16 a[120:123], v[92:95], v[180:183], a[120:123]
    buffer_load_dwordx4 v43, s[40:43], s54 offen offset:3072 lds
    v_mfma_f32_16x16x32_bf16 a[124:127], v[88:91], v[184:187], a[124:127]
    v_mfma_f32_16x16x32_bf16 a[124:127], v[92:95], v[188:191], a[124:127]
    s_add_u32 m0, s68, 12288
    v_mfma_f32_16x16x32_bf16 a[128:131], v[96:99], v[128:131], a[128:131]
    ds_read_b64_tr_b16 v[88:89], v31 offset:0
    v_mfma_f32_16x16x32_bf16 a[128:131], v[100:103], v[132:135], a[128:131]
    buffer_load_dwordx4 v40, s[40:43], s55 offen offset:0 lds
    v_mfma_f32_16x16x32_bf16 a[132:135], v[96:99], v[136:139], a[132:135]
    ds_read_b64_tr_b16 v[90:91], v31 offset:1024
    v_mfma_f32_16x16x32_bf16 a[132:135], v[100:103], v[140:143], a[132:135]
    v_mfma_f32_16x16x32_bf16 a[136:139], v[96:99], v[144:147], a[136:139]
    ds_read_b64_tr_b16 v[92:93], v31 offset:8192
    v_mfma_f32_16x16x32_bf16 a[136:139], v[100:103], v[148:151], a[136:139]
    buffer_load_dwordx4 v41, s[40:43], s55 offen offset:1024 lds
    v_mfma_f32_16x16x32_bf16 a[140:143], v[96:99], v[152:155], a[140:143]
    ds_read_b64_tr_b16 v[94:95], v31 offset:9216
    v_mfma_f32_16x16x32_bf16 a[140:143], v[100:103], v[156:159], a[140:143]
    v_mfma_f32_16x16x32_bf16 a[144:147], v[96:99], v[160:163], a[144:147]
    ds_read_b128 v[228:231], v27 offset:8192
    v_mfma_f32_16x16x32_bf16 a[144:147], v[100:103], v[164:167], a[144:147]
    buffer_load_dwordx4 v42, s[40:43], s55 offen offset:2048 lds
    v_mfma_f32_16x16x32_bf16 a[148:151], v[96:99], v[168:171], a[148:151]
    ds_read_b128 v[232:235], v26 offset:10240
    v_mfma_f32_16x16x32_bf16 a[148:151], v[100:103], v[172:175], a[148:151]
    v_mfma_f32_16x16x32_bf16 a[152:155], v[96:99], v[176:179], a[152:155]
    ds_read_b128 v[236:239], v27 offset:10240
    v_mfma_f32_16x16x32_bf16 a[152:155], v[100:103], v[180:183], a[152:155]
    buffer_load_dwordx4 v43, s[40:43], s55 offen offset:3072 lds
    v_mfma_f32_16x16x32_bf16 a[156:159], v[96:99], v[184:187], a[156:159]
    s_add_u32 s54, s54, 131072
    s_cmp_eq_u32 s54, s101
    s_cselect_b32 s54, s100, s54
    s_add_u32 s55, s54, 65536
    v_mfma_f32_16x16x32_bf16 a[156:159], v[100:103], v[188:191], a[156:159]
    s_add_u32 m0, s69, 0
    v_mfma_f32_16x16x32_bf16 a[160:163], v[104:107], v[128:131], a[160:163]
    ds_read_b64_tr_b16 v[96:97], v28 offset:16384
    v_mfma_f32_16x16x32_bf16 a[160:163], v[108:111], v[132:135], a[160:163]
    buffer_load_dwordx4 v40, s[40:43], s54 offen offset:0 lds
    v_mfma_f32_16x16x32_bf16 a[164:167], v[104:107], v[136:139], a[164:167]
    ds_read_b64_tr_b16 v[98:99], v28 offset:17408
    v_mfma_f32_16x16x32_bf16 a[164:167], v[108:111], v[140:143], a[164:167]
    v_mfma_f32_16x16x32_bf16 a[168:171], v[104:107], v[144:147], a[168:171]
    ds_read_b64_tr_b16 v[100:101], v28 offset:24576
    v_mfma_f32_16x16x32_bf16 a[168:171], v[108:111], v[148:151], a[168:171]
    buffer_load_dwordx4 v41, s[40:43], s54 offen offset:1024 lds
    v_mfma_f32_16x16x32_bf16 a[172:175], v[104:107], v[152:155], a[172:175]
    ds_read_b64_tr_b16 v[102:103], v28 offset:25600
    v_mfma_f32_16x16x32_bf16 a[172:175], v[108:111], v[156:159], a[172:175]
    v_mfma_f32_16x16x32_bf16 a[176:179], v[104:107], v[160:163], a[176:179]
    ds_read_b128 v[240:243], v26 offset:12288
    v_mfma_f32_16x16x32_bf16 a[176:179], v[108:111], v[164:167], a[176:179]
    buffer_load_dwordx4 v42, s[40:43], s54 offen offset:2048 lds
    v_mfma_f32_16x16x32_bf16 a[180:183], v[104:107], v[168:171], a[180:183]
    ds_read_b128 v[244:247], v27 offset:12288
    v_mfma_f32_16x16x32_bf16 a[180:183], v[108:111], v[172:175], a[180:183]
    v_mfma_f32_16x16x32_bf16 a[184:187], v[104:107], v[176:179], a[184:187]
    ds_read_b128 v[248:251], v26 offset:14336
    v_mfma_f32_16x16x32_bf16 a[184:187], v[108:111], v[180:183], a[184:187]
    buffer_load_dwordx4 v43, s[40:43], s54 offen offset:3072 lds
    v_mfma_f32_16x16x32_bf16 a[188:191], v[104:107], v[184:187], a[188:191]
    v_mfma_f32_16x16x32_bf16 a[188:191], v[108:111], v[188:191], a[188:191]
    s_add_u32 m0, s69, 4096
    v_mfma_f32_16x16x32_bf16 a[192:195], v[112:115], v[128:131], a[192:195]
    ds_read_b64_tr_b16 v[104:105], v29 offset:16384
    v_mfma_f32_16x16x32_bf16 a[192:195], v[116:119], v[132:135], a[192:195]
    buffer_load_dwordx4 v40, s[40:43], s55 offen offset:0 lds
    v_mfma_f32_16x16x32_bf16 a[196:199], v[112:115], v[136:139], a[196:199]
    ds_read_b64_tr_b16 v[106:107], v29 offset:17408
    v_mfma_f32_16x16x32_bf16 a[196:199], v[116:119], v[140:143], a[196:199]
    v_mfma_f32_16x16x32_bf16 a[200:203], v[112:115], v[144:147], a[200:203]
    ds_read_b64_tr_b16 v[108:109], v29 offset:24576
    v_mfma_f32_16x16x32_bf16 a[200:203], v[116:119], v[148:151], a[200:203]
    buffer_load_dwordx4 v41, s[40:43], s55 offen offset:1024 lds
    v_mfma_f32_16x16x32_bf16 a[204:207], v[112:115], v[152:155], a[204:207]
    ds_read_b64_tr_b16 v[110:111], v29 offset:25600
    v_mfma_f32_16x16x32_bf16 a[204:207], v[116:119], v[156:159], a[204:207]
    v_mfma_f32_16x16x32_bf16 a[208:211], v[112:115], v[160:163], a[208:211]
    ds_read_b128 v[252:255], v27 offset:14336
    v_mfma_f32_16x16x32_bf16 a[208:211], v[116:119], v[164:167], a[208:211]
    buffer_load_dwordx4 v42, s[40:43], s55 offen offset:2048 lds
    v_mfma_f32_16x16x32_bf16 a[212:215], v[112:115], v[168:171], a[212:215]
    v_mfma_f32_16x16x32_bf16 a[212:215], v[116:119], v[172:175], a[212:215]
    v_mfma_f32_16x16x32_bf16 a[216:219], v[112:115], v[176:179], a[216:219]
    v_mfma_f32_16x16x32_bf16 a[216:219], v[116:119], v[180:183], a[216:219]
    buffer_load_dwordx4 v43, s[40:43], s55 offen offset:3072 lds
    v_mfma_f32_16x16x32_bf16 a[220:223], v[112:115], v[184:187], a[220:223]
    s_add_u32 s54, s54, 131072
    s_cmp_eq_u32 s54, s101
    s_cselect_b32 s54, s100, s54
    s_add_u32 s55, s54, 65536
    v_mfma_f32_16x16x32_bf16 a[220:223], v[116:119], v[188:191], a[220:223]
    v_mfma_f32_16x16x32_bf16 a[224:227], v[120:123], v[128:131], a[224:227]
    ds_read_b64_tr_b16 v[112:113], v30 offset:16384
    v_mfma_f32_16x16x32_bf16 a[224:227], v[124:127], v[132:135], a[224:227]
    v_mfma_f32_16x16x32_bf16 a[228:231], v[120:123], v[136:139], a[228:231]
    ds_read_b64_tr_b16 v[114:115], v30 offset:17408
    v_mfma_f32_16x16x32_bf16 a[228:231], v[124:127], v[140:143], a[228:231]
    v_mfma_f32_16x16x32_bf16 a[232:235], v[120:123], v[144:147], a[232:235]
    ds_read_b64_tr_b16 v[116:117], v30 offset:24576
    v_mfma_f32_16x16x32_bf16 a[232:235], v[124:127], v[148:151], a[232:235]
    v_mfma_f32_16x16x32_bf16 a[236:239], v[120:123], v[152:155], a[236:239]
    ds_read_b64_tr_b16 v[118:119], v30 offset:25600
    v_mfma_f32_16x16x32_bf16 a[236:239], v[124:127], v[156:159], a[236:239]
    v_mfma_f32_16x16x32_bf16 a[240:243], v[120:123], v[160:163], a[240:243]
    v_mfma_f32_16x16x32_bf16 a[240:243], v[124:127], v[164:167], a[240:243]
    v_mfma_f32_16x16x32_bf16 a[244:247], v[120:123], v[168:171], a[244:247]
    v_mfma_f32_16x16x32_bf16 a[244:247], v[124:127], v[172:175], a[244:247]
    v_mfma_f32_16x16x32_bf16 a[248:251], v[120:123], v[176:179], a[248:251]
    v_mfma_f32_16x16x32_bf16 a[248:251], v[124:127], v[180:183], a[248:251]
    v_mfma_f32_16x16x32_bf16 a[252:255], v[120:123], v[184:187], a[252:255]
    v_mfma_f32_16x16x32_bf16 a[252:255], v[124:127], v[188:191], a[252:255]
    s_waitcnt lgkmcnt(0)
    ds_read_b64_tr_b16 v[120:121], v31 offset:16384
    ds_read_b64_tr_b16 v[122:123], v31 offset:17408
    ds_read_b64_tr_b16 v[124:125], v31 offset:24576
    ds_read_b64_tr_b16 v[126:127], v31 offset:25600
    v_mfma_f32_16x16x32_bf16 a[0:3], v[64:67], v[192:195], a[0:3]
    s_mov_b32 s34, 0
    v_mfma_f32_16x16x32_bf16 a[0:3], v[68:71], v[196:199], a[0:3]
    v_mfma_f32_16x16x32_bf16 a[128:131], v[96:99], v[192:195], a[128:131]
    v_mfma_f32_16x16x32_bf16 a[128:131], v[100:103], v[196:199], a[128:131]
    v_mfma_f32_16x16x32_bf16 a[32:35], v[72:75], v[192:195], a[32:35]
    v_mfma_f32_16x16x32_bf16 a[32:35], v[76:79], v[196:199], a[32:35]
    v_mfma_f32_16x16x32_bf16 a[160:163], v[104:107], v[192:195], a[160:163]
    v_mfma_f32_16x16x32_bf16 a[160:163], v[108:111], v[196:199], a[160:163]
    v_mfma_f32_16x16x32_bf16 a[64:67], v[80:83], v[192:195], a[64:67]
    v_mfma_f32_16x16x32_bf16 a[64:67], v[84:87], v[196:199], a[64:67]
    v_mfma_f32_16x16x32_bf16 a[192:195], v[112:115], v[192:195], a[192:195]
    v_mfma_f32_16x16x32_bf16 a[192:195], v[116:119], v[196:199], a[192:195]
    v_mfma_f32_16x16x32_bf16 a[96:99], v[88:91], v[192:195], a[96:99]
    s_waitcnt lgkmcnt(0)
    v_mfma_f32_16x16x32_bf16 a[96:99], v[92:95], v[196:199], a[96:99]
    s_barrier
    v_mfma_f32_16x16x32_bf16 a[224:227], v[120:123], v[192:195], a[224:227]
    v_mfma_f32_16x16x32_bf16 a[224:227], v[124:127], v[196:199], a[224:227]
    v_mfma_f32_16x16x32_bf16 a[4:7], v[64:67], v[200:203], a[4:7]
    v_mfma_f32_16x16x32_bf16 a[4:7], v[68:71], v[204:207], a[4:7]
    v_mfma_f32_16x16x32_bf16 a[132:135], v[96:99], v[200:203], a[132:135]
    v_mfma_f32_16x16x32_bf16 a[132:135], v[100:103], v[204:207], a[132:135]
    v_accvgpr_read_b32 v136, a0
    v_accvgpr_read_b32 v144, a128
    v_accvgpr_read_b32 v137, a1
    v_accvgpr_read_b32 v145, a129
    v_mfma_f32_16x16x32_bf16 a[36:39], v[72:75], v[200:203], a[36:39]
    v_accvgpr_read_b32 v138, a2
    v_accvgpr_read_b32 v146, a130
    v_accvgpr_read_b32 v139, a3
    v_accvgpr_read_b32 v147, a131
    v_mfma_f32_16x16x32_bf16 a[36:39], v[76:79], v[204:207], a[36:39]
    v_accvgpr_read_b32 v140, a32
    v_accvgpr_read_b32 v148, a160
    v_accvgpr_read_b32 v141, a33
    v_accvgpr_read_b32 v149, a161
    v_mfma_f32_16x16x32_bf16 a[164:167], v[104:107], v[200:203], a[164:167]
    v_accvgpr_read_b32 v142, a34
    v_accvgpr_read_b32 v150, a162
    v_accvgpr_read_b32 v143, a35
    v_accvgpr_read_b32 v151, a163
    v_mfma_f32_16x16x32_bf16 a[164:167], v[108:111], v[204:207], a[164:167]
    v_pk_mul_f32 v[136:137], v[136:137], v[144:145]
    v_pk_mul_f32 v[138:139], v[138:139], v[146:147]
    v_pk_mul_f32 v[140:141], v[140:141], v[148:149]
    v_pk_mul_f32 v[142:143], v[142:143], v[150:151]
    v_mfma_f32_16x16x32_bf16 a[68:71], v[80:83], v[200:203], a[68:71]
    v_cvt_pk_bf16_f32 v128, v136, v137
    v_cvt_pk_bf16_f32 v129, v138, v139
    v_cvt_pk_bf16_f32 v130, v140, v141
    v_cvt_pk_bf16_f32 v131, v142, v143
    v_mfma_f32_16x16x32_bf16 a[68:71], v[84:87], v[204:207], a[68:71]
    buffer_store_dwordx4 v[128:131], v44, s[88:91], s34 offen offset:0 sc1
    v_accvgpr_read_b32 v160, a64
    v_accvgpr_read_b32 v168, a192
    v_mfma_f32_16x16x32_bf16 a[196:199], v[112:115], v[200:203], a[196:199]
    v_accvgpr_read_b32 v161, a65
    v_accvgpr_read_b32 v169, a193
    v_accvgpr_read_b32 v162, a66
    v_accvgpr_read_b32 v170, a194
    v_mfma_f32_16x16x32_bf16 a[196:199], v[116:119], v[204:207], a[196:199]
    v_accvgpr_read_b32 v163, a67
    v_accvgpr_read_b32 v171, a195
    v_accvgpr_read_b32 v164, a96
    v_accvgpr_read_b32 v172, a224
    v_mfma_f32_16x16x32_bf16 a[100:103], v[88:91], v[200:203], a[100:103]
    v_accvgpr_read_b32 v165, a97
    v_accvgpr_read_b32 v173, a225
    v_accvgpr_read_b32 v166, a98
    v_accvgpr_read_b32 v174, a226
    v_mfma_f32_16x16x32_bf16 a[100:103], v[92:95], v[204:207], a[100:103]
    v_accvgpr_read_b32 v167, a99
    v_accvgpr_read_b32 v175, a227
    v_pk_mul_f32 v[160:161], v[160:161], v[168:169]
    v_pk_mul_f32 v[162:163], v[162:163], v[170:171]
    v_mfma_f32_16x16x32_bf16 a[228:231], v[120:123], v[200:203], a[228:231]
    v_pk_mul_f32 v[164:165], v[164:165], v[172:173]
    v_pk_mul_f32 v[166:167], v[166:167], v[174:175]
    v_cvt_pk_bf16_f32 v152, v160, v161
    v_cvt_pk_bf16_f32 v153, v162, v163
    v_mfma_f32_16x16x32_bf16 a[228:231], v[124:127], v[204:207], a[228:231]
    v_cvt_pk_bf16_f32 v154, v164, v165
    v_cvt_pk_bf16_f32 v155, v166, v167
    buffer_store_dwordx4 v[152:155], v44, s[88:91], s34 offen offset:1024 sc1
    v_mfma_f32_16x16x32_bf16 a[8:11], v[64:67], v[208:211], a[8:11]
    v_mfma_f32_16x16x32_bf16 a[8:11], v[68:71], v[212:215], a[8:11]
    v_mfma_f32_16x16x32_bf16 a[136:139], v[96:99], v[208:211], a[136:139]
    v_mfma_f32_16x16x32_bf16 a[136:139], v[100:103], v[212:215], a[136:139]
    v_accvgpr_read_b32 v136, a4
    v_accvgpr_read_b32 v144, a132
    v_accvgpr_read_b32 v137, a5
    v_accvgpr_read_b32 v145, a133
    v_accvgpr_read_b32 v138, a6
    v_mfma_f32_16x16x32_bf16 a[40:43], v[72:75], v[208:211], a[40:43]
    v_accvgpr_read_b32 v146, a134
    v_accvgpr_read_b32 v139, a7
    v_accvgpr_read_b32 v147, a135
    v_accvgpr_read_b32 v140, a36
    v_accvgpr_read_b32 v148, a164
    v_mfma_f32_16x16x32_bf16 a[40:43], v[76:79], v[212:215], a[40:43]
    v_accvgpr_read_b32 v141, a37
    v_accvgpr_read_b32 v149, a165
    v_accvgpr_read_b32 v142, a38
    v_accvgpr_read_b32 v150, a166
    v_mfma_f32_16x16x32_bf16 a[168:171], v[104:107], v[208:211], a[168:171]
    v_accvgpr_read_b32 v143, a39
    v_accvgpr_read_b32 v151, a167
    v_pk_mul_f32 v[136:137], v[136:137], v[144:145]
    v_pk_mul_f32 v[138:139], v[138:139], v[146:147]
    v_pk_mul_f32 v[140:141], v[140:141], v[148:149]
    v_mfma_f32_16x16x32_bf16 a[168:171], v[108:111], v[212:215], a[168:171]
    v_pk_mul_f32 v[142:143], v[142:143], v[150:151]
    v_cvt_pk_bf16_f32 v128, v136, v137
    v_cvt_pk_bf16_f32 v129, v138, v139
    v_cvt_pk_bf16_f32 v130, v140, v141
    v_cvt_pk_bf16_f32 v131, v142, v143
    v_mfma_f32_16x16x32_bf16 a[72:75], v[80:83], v[208:211], a[72:75]
    buffer_store_dwordx4 v[128:131], v44, s[88:91], s34 offen offset:2048 sc1
    v_accvgpr_read_b32 v160, a68
    v_accvgpr_read_b32 v168, a196
    v_accvgpr_read_b32 v161, a69
    v_mfma_f32_16x16x32_bf16 a[72:75], v[84:87], v[212:215], a[72:75]
    v_accvgpr_read_b32 v169, a197
    v_accvgpr_read_b32 v162, a70
    v_accvgpr_read_b32 v170, a198
    v_accvgpr_read_b32 v163, a71
    v_accvgpr_read_b32 v171, a199
    v_mfma_f32_16x16x32_bf16 a[200:203], v[112:115], v[208:211], a[200:203]
    v_accvgpr_read_b32 v164, a100
    v_accvgpr_read_b32 v172, a228
    v_accvgpr_read_b32 v165, a101
    v_accvgpr_read_b32 v173, a229
    v_mfma_f32_16x16x32_bf16 a[200:203], v[116:119], v[212:215], a[200:203]
    v_accvgpr_read_b32 v166, a102
    v_accvgpr_read_b32 v174, a230
    v_accvgpr_read_b32 v167, a103
    v_accvgpr_read_b32 v175, a231
    v_pk_mul_f32 v[160:161], v[160:161], v[168:169]
    v_mfma_f32_16x16x32_bf16 a[104:107], v[88:91], v[208:211], a[104:107]
    v_pk_mul_f32 v[162:163], v[162:163], v[170:171]
    v_pk_mul_f32 v[164:165], v[164:165], v[172:173]
    v_pk_mul_f32 v[166:167], v[166:167], v[174:175]
    v_cvt_pk_bf16_f32 v152, v160, v161
    v_cvt_pk_bf16_f32 v153, v162, v163
    v_mfma_f32_16x16x32_bf16 a[104:107], v[92:95], v[212:215], a[104:107]
    v_cvt_pk_bf16_f32 v154, v164, v165
    v_cvt_pk_bf16_f32 v155, v166, v167
    buffer_store_dwordx4 v[152:155], v44, s[88:91], s34 offen offset:3072 sc1
    s_add_u32 s34, s34, 4096
    v_mfma_f32_16x16x32_bf16 a[232:235], v[120:123], v[208:211], a[232:235]
    s_waitcnt vmcnt(4)
    ds_read_b64_tr_b16 a[128:129], v48 offset:0
    ds_read_b64_tr_b16 a[130:131], v48 offset:2048
    ds_read_b64_tr_b16 a[160:161], v49 offset:0
    ds_read_b64_tr_b16 a[162:163], v49 offset:2048
    v_mfma_f32_16x16x32_bf16 a[232:235], v[124:127], v[212:215], a[232:235]
    ds_read_b64_tr_b16 a[192:193], v50 offset:0
    ds_read_b64_tr_b16 a[194:195], v50 offset:2048
    ds_read_b64_tr_b16 a[224:225], v51 offset:0
    ds_read_b64_tr_b16 a[226:227], v51 offset:2048
    v_mfma_f32_16x16x32_bf16 a[12:15], v[64:67], v[216:219], a[12:15]
    v_mfma_f32_16x16x32_bf16 a[12:15], v[68:71], v[220:223], a[12:15]
    v_mfma_f32_16x16x32_bf16 a[140:143], v[96:99], v[216:219], a[140:143]
    v_mfma_f32_16x16x32_bf16 a[140:143], v[100:103], v[220:223], a[140:143]
    v_accvgpr_read_b32 v136, a8
    v_accvgpr_read_b32 v144, a136
    v_accvgpr_read_b32 v137, a9
    v_accvgpr_read_b32 v145, a137
    v_accvgpr_read_b32 v138, a10
    v_mfma_f32_16x16x32_bf16 a[44:47], v[72:75], v[216:219], a[44:47]
    v_accvgpr_read_b32 v146, a138
    v_accvgpr_read_b32 v139, a11
    v_accvgpr_read_b32 v147, a139
    v_accvgpr_read_b32 v140, a40
    v_mfma_f32_16x16x32_bf16 a[44:47], v[76:79], v[220:223], a[44:47]
    v_accvgpr_read_b32 v148, a168
    v_accvgpr_read_b32 v141, a41
    v_accvgpr_read_b32 v149, a169
    v_accvgpr_read_b32 v142, a42
    v_accvgpr_read_b32 v150, a170
    v_mfma_f32_16x16x32_bf16 a[172:175], v[104:107], v[216:219], a[172:175]
    v_accvgpr_read_b32 v143, a43
    v_accvgpr_read_b32 v151, a171
    v_pk_mul_f32 v[136:137], v[136:137], v[144:145]
    v_pk_mul_f32 v[138:139], v[138:139], v[146:147]
    v_mfma_f32_16x16x32_bf16 a[172:175], v[108:111], v[220:223], a[172:175]
    v_pk_mul_f32 v[140:141], v[140:141], v[148:149]
    v_pk_mul_f32 v[142:143], v[142:143], v[150:151]
    v_cvt_pk_bf16_f32 v128, v136, v137
    v_cvt_pk_bf16_f32 v129, v138, v139
    v_cvt_pk_bf16_f32 v130, v140, v141
    v_mfma_f32_16x16x32_bf16 a[76:79], v[80:83], v[216:219], a[76:79]
    v_cvt_pk_bf16_f32 v131, v142, v143
    buffer_store_dwordx4 v[128:131], v44, s[88:91], s34 offen offset:0 sc1
    v_accvgpr_read_b32 v160, a72
    v_accvgpr_read_b32 v168, a200
    v_mfma_f32_16x16x32_bf16 a[76:79], v[84:87], v[220:223], a[76:79]
    v_accvgpr_read_b32 v161, a73
    v_accvgpr_read_b32 v169, a201
    v_accvgpr_read_b32 v162, a74
    v_accvgpr_read_b32 v170, a202
    v_accvgpr_read_b32 v163, a75
    v_mfma_f32_16x16x32_bf16 a[204:207], v[112:115], v[216:219], a[204:207]
    v_accvgpr_read_b32 v171, a203
    v_accvgpr_read_b32 v164, a104
    v_accvgpr_read_b32 v172, a232
    v_accvgpr_read_b32 v165, a105
    v_mfma_f32_16x16x32_bf16 a[204:207], v[116:119], v[220:223], a[204:207]
    v_accvgpr_read_b32 v173, a233
    v_accvgpr_read_b32 v166, a106
    v_accvgpr_read_b32 v174, a234
    v_accvgpr_read_b32 v167, a107
    v_accvgpr_read_b32 v175, a235
    v_mfma_f32_16x16x32_bf16 a[108:111], v[88:91], v[216:219], a[108:111]
    v_pk_mul_f32 v[160:161], v[160:161], v[168:169]
    v_pk_mul_f32 v[162:163], v[162:163], v[170:171]
    v_pk_mul_f32 v[164:165], v[164:165], v[172:173]
    v_pk_mul_f32 v[166:167], v[166:167], v[174:175]
    v_mfma_f32_16x16x32_bf16 a[108:111], v[92:95], v[220:223], a[108:111]
    v_cvt_pk_bf16_f32 v152, v160, v161
    v_cvt_pk_bf16_f32 v153, v162, v163
    v_cvt_pk_bf16_f32 v154, v164, v165
    v_cvt_pk_bf16_f32 v155, v166, v167
    buffer_store_dwordx4 v[152:155], v44, s[88:91], s34 offen offset:1024 sc1
    v_mfma_f32_16x16x32_bf16 a[236:239], v[120:123], v[216:219], a[236:239]
    ds_read_b64_tr_b16 a[132:133], v48 offset:4096
    ds_read_b64_tr_b16 a[134:135], v48 offset:6144
    ds_read_b64_tr_b16 a[164:165], v49 offset:4096
    ds_read_b64_tr_b16 a[166:167], v49 offset:6144
    v_mfma_f32_16x16x32_bf16 a[236:239], v[124:127], v[220:223], a[236:239]
    ds_read_b64_tr_b16 a[196:197], v50 offset:4096
    ds_read_b64_tr_b16 a[198:199], v50 offset:6144
    ds_read_b64_tr_b16 a[228:229], v51 offset:4096
    ds_read_b64_tr_b16 a[230:231], v51 offset:6144
    v_mfma_f32_16x16x32_bf16 a[16:19], v[64:67], v[224:227], a[16:19]
    v_mfma_f32_16x16x32_bf16 a[16:19], v[68:71], v[228:231], a[16:19]
    v_mfma_f32_16x16x32_bf16 a[144:147], v[96:99], v[224:227], a[144:147]
    v_mfma_f32_16x16x32_bf16 a[144:147], v[100:103], v[228:231], a[144:147]
    v_accvgpr_read_b32 v136, a12
    v_accvgpr_read_b32 v144, a140
    v_accvgpr_read_b32 v137, a13
    v_accvgpr_read_b32 v145, a141
    v_accvgpr_read_b32 v138, a14
    v_mfma_f32_16x16x32_bf16 a[48:51], v[72:75], v[224:227], a[48:51]
    v_accvgpr_read_b32 v146, a142
    v_accvgpr_read_b32 v139, a15
    v_accvgpr_read_b32 v147, a143
    v_accvgpr_read_b32 v140, a44
    v_accvgpr_read_b32 v148, a172
    v_mfma_f32_16x16x32_bf16 a[48:51], v[76:79], v[228:231], a[48:51]
    v_accvgpr_read_b32 v141, a45
    v_accvgpr_read_b32 v149, a173
    v_accvgpr_read_b32 v142, a46
    v_accvgpr_read_b32 v150, a174
    v_mfma_f32_16x16x32_bf16 a[176:179], v[104:107], v[224:227], a[176:179]
    v_accvgpr_read_b32 v143, a47
    v_accvgpr_read_b32 v151, a175
    v_pk_mul_f32 v[136:137], v[136:137], v[144:145]
    v_pk_mul_f32 v[138:139], v[138:139], v[146:147]
    v_pk_mul_f32 v[140:141], v[140:141], v[148:149]
    v_mfma_f32_16x16x32_bf16 a[176:179], v[108:111], v[228:231], a[176:179]
    v_pk_mul_f32 v[142:143], v[142:143], v[150:151]
    v_cvt_pk_bf16_f32 v128, v136, v137
    v_cvt_pk_bf16_f32 v129, v138, v139
    v_cvt_pk_bf16_f32 v130, v140, v141
    v_mfma_f32_16x16x32_bf16 a[80:83], v[80:83], v[224:227], a[80:83]
    v_cvt_pk_bf16_f32 v131, v142, v143
    buffer_store_dwordx4 v[128:131], v44, s[88:91], s34 offen offset:2048 sc1
    v_accvgpr_read_b32 v160, a76
    v_accvgpr_read_b32 v168, a204
    v_accvgpr_read_b32 v161, a77
    v_mfma_f32_16x16x32_bf16 a[80:83], v[84:87], v[228:231], a[80:83]
    v_accvgpr_read_b32 v169, a205
    v_accvgpr_read_b32 v162, a78
    v_accvgpr_read_b32 v170, a206
    v_accvgpr_read_b32 v163, a79
    v_mfma_f32_16x16x32_bf16 a[208:211], v[112:115], v[224:227], a[208:211]
    v_accvgpr_read_b32 v171, a207
    v_accvgpr_read_b32 v164, a108
    v_accvgpr_read_b32 v172, a236
    v_accvgpr_read_b32 v165, a109
    v_accvgpr_read_b32 v173, a237
    v_mfma_f32_16x16x32_bf16 a[208:211], v[116:119], v[228:231], a[208:211]
    v_accvgpr_read_b32 v166, a110
    v_accvgpr_read_b32 v174, a238
    v_accvgpr_read_b32 v167, a111
    v_accvgpr_read_b32 v175, a239
    v_mfma_f32_16x16x32_bf16 a[112:115], v[88:91], v[224:227], a[112:115]
    v_pk_mul_f32 v[160:161], v[160:161], v[168:169]
    v_pk_mul_f32 v[162:163], v[162:163], v[170:171]
    v_pk_mul_f32 v[164:165], v[164:165], v[172:173]
    v_pk_mul_f32 v[166:167], v[166:167], v[174:175]
    v_cvt_pk_bf16_f32 v152, v160, v161
    v_mfma_f32_16x16x32_bf16 a[112:115], v[92:95], v[228:231], a[112:115]
    v_cvt_pk_bf16_f32 v153, v162, v163
    v_cvt_pk_bf16_f32 v154, v164, v165
    v_cvt_pk_bf16_f32 v155, v166, v167
    buffer_store_dwordx4 v[152:155], v44, s[88:91], s34 offen offset:3072 sc1
    v_mfma_f32_16x16x32_bf16 a[240:243], v[120:123], v[224:227], a[240:243]
    s_add_u32 s34, s34, 4096
    ds_read_b64_tr_b16 a[136:137], v48 offset:8192
    ds_read_b64_tr_b16 a[138:139], v48 offset:10240
    ds_read_b64_tr_b16 a[168:169], v49 offset:8192
    ds_read_b64_tr_b16 a[170:171], v49 offset:10240
    v_mfma_f32_16x16x32_bf16 a[240:243], v[124:127], v[228:231], a[240:243]
    ds_read_b64_tr_b16 a[200:201], v50 offset:8192
    ds_read_b64_tr_b16 a[202:203], v50 offset:10240
    ds_read_b64_tr_b16 a[232:233], v51 offset:8192
    ds_read_b64_tr_b16 a[234:235], v51 offset:10240
    v_mfma_f32_16x16x32_bf16 a[20:23], v[64:67], v[232:235], a[20:23]
    v_mfma_f32_16x16x32_bf16 a[20:23], v[68:71], v[236:239], a[20:23]
    v_mfma_f32_16x16x32_bf16 a[148:151], v[96:99], v[232:235], a[148:151]
    v_mfma_f32_16x16x32_bf16 a[148:151], v[100:103], v[236:239], a[148:151]
    v_accvgpr_read_b32 v136, a16
    v_accvgpr_read_b32 v144, a144
    v_accvgpr_read_b32 v137, a17
    v_accvgpr_read_b32 v145, a145
    v_accvgpr_read_b32 v138, a18
    v_mfma_f32_16x16x32_bf16 a[52:55], v[72:75], v[232:235], a[52:55]
    v_accvgpr_read_b32 v146, a146
    v_accvgpr_read_b32 v139, a19
    v_accvgpr_read_b32 v147, a147
    v_accvgpr_read_b32 v140, a48
    v_mfma_f32_16x16x32_bf16 a[52:55], v[76:79], v[236:239], a[52:55]
    v_accvgpr_read_b32 v148, a176
    v_accvgpr_read_b32 v141, a49
    v_accvgpr_read_b32 v149, a177
    v_accvgpr_read_b32 v142, a50
    v_accvgpr_read_b32 v150, a178
    v_mfma_f32_16x16x32_bf16 a[180:183], v[104:107], v[232:235], a[180:183]
    v_accvgpr_read_b32 v143, a51
    v_accvgpr_read_b32 v151, a179
    v_pk_mul_f32 v[136:137], v[136:137], v[144:145]
    v_pk_mul_f32 v[138:139], v[138:139], v[146:147]
    v_mfma_f32_16x16x32_bf16 a[180:183], v[108:111], v[236:239], a[180:183]
    v_pk_mul_f32 v[140:141], v[140:141], v[148:149]
    v_pk_mul_f32 v[142:143], v[142:143], v[150:151]
    v_cvt_pk_bf16_f32 v128, v136, v137
    v_cvt_pk_bf16_f32 v129, v138, v139
    v_cvt_pk_bf16_f32 v130, v140, v141
    v_mfma_f32_16x16x32_bf16 a[84:87], v[80:83], v[232:235], a[84:87]
    v_cvt_pk_bf16_f32 v131, v142, v143
    buffer_store_dwordx4 v[128:131], v44, s[88:91], s34 offen offset:0 sc1
    v_accvgpr_read_b32 v160, a80
    v_accvgpr_read_b32 v168, a208
    v_mfma_f32_16x16x32_bf16 a[84:87], v[84:87], v[236:239], a[84:87]
    v_accvgpr_read_b32 v161, a81
    v_accvgpr_read_b32 v169, a209
    v_accvgpr_read_b32 v162, a82
    v_accvgpr_read_b32 v170, a210
    v_accvgpr_read_b32 v163, a83
    v_mfma_f32_16x16x32_bf16 a[212:215], v[112:115], v[232:235], a[212:215]
    v_accvgpr_read_b32 v171, a211
    v_accvgpr_read_b32 v164, a112
    v_accvgpr_read_b32 v172, a240
    v_accvgpr_read_b32 v165, a113
    v_mfma_f32_16x16x32_bf16 a[212:215], v[116:119], v[236:239], a[212:215]
    v_accvgpr_read_b32 v173, a241
    v_accvgpr_read_b32 v166, a114
    v_accvgpr_read_b32 v174, a242
    v_accvgpr_read_b32 v167, a115
    v_accvgpr_read_b32 v175, a243
    v_mfma_f32_16x16x32_bf16 a[116:119], v[88:91], v[232:235], a[116:119]
    v_pk_mul_f32 v[160:161], v[160:161], v[168:169]
    v_pk_mul_f32 v[162:163], v[162:163], v[170:171]
    v_pk_mul_f32 v[164:165], v[164:165], v[172:173]
    v_pk_mul_f32 v[166:167], v[166:167], v[174:175]
    v_mfma_f32_16x16x32_bf16 a[116:119], v[92:95], v[236:239], a[116:119]
    v_cvt_pk_bf16_f32 v152, v160, v161
    v_cvt_pk_bf16_f32 v153, v162, v163
    v_cvt_pk_bf16_f32 v154, v164, v165
    v_cvt_pk_bf16_f32 v155, v166, v167
    buffer_store_dwordx4 v[152:155], v44, s[88:91], s34 offen offset:1024 sc1
    v_mfma_f32_16x16x32_bf16 a[244:247], v[120:123], v[232:235], a[244:247]
    ds_read_b64_tr_b16 a[140:141], v48 offset:12288
    ds_read_b64_tr_b16 a[142:143], v48 offset:14336
    ds_read_b64_tr_b16 a[172:173], v49 offset:12288
    ds_read_b64_tr_b16 a[174:175], v49 offset:14336
    v_mfma_f32_16x16x32_bf16 a[244:247], v[124:127], v[236:239], a[244:247]
    ds_read_b64_tr_b16 a[204:205], v50 offset:12288
    ds_read_b64_tr_b16 a[206:207], v50 offset:14336
    ds_read_b64_tr_b16 a[236:237], v51 offset:12288
    ds_read_b64_tr_b16 a[238:239], v51 offset:14336
    v_mfma_f32_16x16x32_bf16 a[24:27], v[64:67], v[240:243], a[24:27]
    v_mfma_f32_16x16x32_bf16 a[24:27], v[68:71], v[244:247], a[24:27]
    v_mfma_f32_16x16x32_bf16 a[152:155], v[96:99], v[240:243], a[152:155]
    v_mfma_f32_16x16x32_bf16 a[152:155], v[100:103], v[244:247], a[152:155]
    v_accvgpr_read_b32 v136, a20
    v_accvgpr_read_b32 v144, a148
    v_accvgpr_read_b32 v137, a21
    v_accvgpr_read_b32 v145, a149
    v_accvgpr_read_b32 v138, a22
    v_mfma_f32_16x16x32_bf16 a[56:59], v[72:75], v[240:243], a[56:59]
    v_accvgpr_read_b32 v146, a150
    v_accvgpr_read_b32 v139, a23
    v_accvgpr_read_b32 v147, a151
    v_accvgpr_read_b32 v140, a52
    v_accvgpr_read_b32 v148, a180
    v_mfma_f32_16x16x32_bf16 a[56:59], v[76:79], v[244:247], a[56:59]
    v_accvgpr_read_b32 v141, a53
    v_accvgpr_read_b32 v149, a181
    v_accvgpr_read_b32 v142, a54
    v_accvgpr_read_b32 v150, a182
    v_mfma_f32_16x16x32_bf16 a[184:187], v[104:107], v[240:243], a[184:187]
    v_accvgpr_read_b32 v143, a55
    v_accvgpr_read_b32 v151, a183
    v_pk_mul_f32 v[136:137], v[136:137], v[144:145]
    v_pk_mul_f32 v[138:139], v[138:139], v[146:147]
    v_pk_mul_f32 v[140:141], v[140:141], v[148:149]
    v_mfma_f32_16x16x32_bf16 a[184:187], v[108:111], v[244:247], a[184:187]
    v_pk_mul_f32 v[142:143], v[142:143], v[150:151]
    v_cvt_pk_bf16_f32 v128, v136, v137
    v_cvt_pk_bf16_f32 v129, v138, v139
    v_cvt_pk_bf16_f32 v130, v140, v141
    v_mfma_f32_16x16x32_bf16 a[88:91], v[80:83], v[240:243], a[88:91]
    v_cvt_pk_bf16_f32 v131, v142, v143
    buffer_store_dwordx4 v[128:131], v44, s[88:91], s34 offen offset:2048 sc1
    v_accvgpr_read_b32 v160, a84
    v_accvgpr_read_b32 v168, a212
    v_accvgpr_read_b32 v161, a85
    v_mfma_f32_16x16x32_bf16 a[88:91], v[84:87], v[244:247], a[88:91]
    v_accvgpr_read_b32 v169, a213
    v_accvgpr_read_b32 v162, a86
    v_accvgpr_read_b32 v170, a214
    v_accvgpr_read_b32 v163, a87
    v_mfma_f32_16x16x32_bf16 a[216:219], v[112:115], v[240:243], a[216:219]
    v_accvgpr_read_b32 v171, a215
    v_accvgpr_read_b32 v164, a116
    v_accvgpr_read_b32 v172, a244
    v_accvgpr_read_b32 v165, a117
    v_accvgpr_read_b32 v173, a245
    v_mfma_f32_16x16x32_bf16 a[216:219], v[116:119], v[244:247], a[216:219]
    v_accvgpr_read_b32 v166, a118
    v_accvgpr_read_b32 v174, a246
    v_accvgpr_read_b32 v167, a119
    v_accvgpr_read_b32 v175, a247
    v_mfma_f32_16x16x32_bf16 a[120:123], v[88:91], v[240:243], a[120:123]
    v_pk_mul_f32 v[160:161], v[160:161], v[168:169]
    v_pk_mul_f32 v[162:163], v[162:163], v[170:171]
    v_pk_mul_f32 v[164:165], v[164:165], v[172:173]
    v_pk_mul_f32 v[166:167], v[166:167], v[174:175]
    v_cvt_pk_bf16_f32 v152, v160, v161
    v_mfma_f32_16x16x32_bf16 a[120:123], v[92:95], v[244:247], a[120:123]
    v_cvt_pk_bf16_f32 v153, v162, v163
    v_cvt_pk_bf16_f32 v154, v164, v165
    v_cvt_pk_bf16_f32 v155, v166, v167
    buffer_store_dwordx4 v[152:155], v44, s[88:91], s34 offen offset:3072 sc1
    v_mfma_f32_16x16x32_bf16 a[248:251], v[120:123], v[240:243], a[248:251]
    s_add_u32 s34, s34, 4096
    ds_read_b64_tr_b16 a[144:145], v52 offset:0
    ds_read_b64_tr_b16 a[146:147], v52 offset:2048
    ds_read_b64_tr_b16 a[176:177], v53 offset:0
    ds_read_b64_tr_b16 a[178:179], v53 offset:2048
    v_mfma_f32_16x16x32_bf16 a[248:251], v[124:127], v[244:247], a[248:251]
    ds_read_b64_tr_b16 a[208:209], v54 offset:0
    ds_read_b64_tr_b16 a[210:211], v54 offset:2048
    ds_read_b64_tr_b16 a[240:241], v55 offset:0
    ds_read_b64_tr_b16 a[242:243], v55 offset:2048
    v_mfma_f32_16x16x32_bf16 a[28:31], v[64:67], v[248:251], a[28:31]
    v_mfma_f32_16x16x32_bf16 a[28:31], v[68:71], v[252:255], a[28:31]
    v_mfma_f32_16x16x32_bf16 a[156:159], v[96:99], v[248:251], a[156:159]
    v_mfma_f32_16x16x32_bf16 a[156:159], v[100:103], v[252:255], a[156:159]
    v_accvgpr_read_b32 v136, a24
    v_accvgpr_read_b32 v144, a152
    v_accvgpr_read_b32 v137, a25
    v_accvgpr_read_b32 v145, a153
    v_accvgpr_read_b32 v138, a26
    v_mfma_f32_16x16x32_bf16 a[60:63], v[72:75], v[248:251], a[60:63]
    v_accvgpr_read_b32 v146, a154
    v_accvgpr_read_b32 v139, a27
    v_accvgpr_read_b32 v147, a155
    v_accvgpr_read_b32 v140, a56
    v_mfma_f32_16x16x32_bf16 a[60:63], v[76:79], v[252:255], a[60:63]
    v_accvgpr_read_b32 v148, a184
    v_accvgpr_read_b32 v141, a57
    v_accvgpr_read_b32 v149, a185
    v_accvgpr_read_b32 v142, a58
    v_accvgpr_read_b32 v150, a186
    v_mfma_f32_16x16x32_bf16 a[188:191], v[104:107], v[248:251], a[188:191]
    v_accvgpr_read_b32 v143, a59
    v_accvgpr_read_b32 v151, a187
    v_pk_mul_f32 v[136:137], v[136:137], v[144:145]
    v_pk_mul_f32 v[138:139], v[138:139], v[146:147]
    v_mfma_f32_16x16x32_bf16 a[188:191], v[108:111], v[252:255], a[188:191]
    v_pk_mul_f32 v[140:141], v[140:141], v[148:149]
    v_pk_mul_f32 v[142:143], v[142:143], v[150:151]
    v_cvt_pk_bf16_f32 v128, v136, v137
    v_cvt_pk_bf16_f32 v129, v138, v139
    v_cvt_pk_bf16_f32 v130, v140, v141
    v_mfma_f32_16x16x32_bf16 a[92:95], v[80:83], v[248:251], a[92:95]
    v_cvt_pk_bf16_f32 v131, v142, v143
    buffer_store_dwordx4 v[128:131], v44, s[88:91], s34 offen offset:0 sc1
    v_accvgpr_read_b32 v160, a88
    v_accvgpr_read_b32 v168, a216
    v_mfma_f32_16x16x32_bf16 a[92:95], v[84:87], v[252:255], a[92:95]
    v_accvgpr_read_b32 v161, a89
    v_accvgpr_read_b32 v169, a217
    v_accvgpr_read_b32 v162, a90
    v_accvgpr_read_b32 v170, a218
    v_accvgpr_read_b32 v163, a91
    v_mfma_f32_16x16x32_bf16 a[220:223], v[112:115], v[248:251], a[220:223]
    v_accvgpr_read_b32 v171, a219
    v_accvgpr_read_b32 v164, a120
    v_accvgpr_read_b32 v172, a248
    v_accvgpr_read_b32 v165, a121
    v_mfma_f32_16x16x32_bf16 a[220:223], v[116:119], v[252:255], a[220:223]
    v_accvgpr_read_b32 v173, a249
    v_accvgpr_read_b32 v166, a122
    v_accvgpr_read_b32 v174, a250
    v_accvgpr_read_b32 v167, a123
    v_accvgpr_read_b32 v175, a251
    v_mfma_f32_16x16x32_bf16 a[124:127], v[88:91], v[248:251], a[124:127]
    v_pk_mul_f32 v[160:161], v[160:161], v[168:169]
    v_pk_mul_f32 v[162:163], v[162:163], v[170:171]
    v_pk_mul_f32 v[164:165], v[164:165], v[172:173]
    v_pk_mul_f32 v[166:167], v[166:167], v[174:175]
    v_mfma_f32_16x16x32_bf16 a[124:127], v[92:95], v[252:255], a[124:127]
    v_cvt_pk_bf16_f32 v152, v160, v161
    v_cvt_pk_bf16_f32 v153, v162, v163
    v_cvt_pk_bf16_f32 v154, v164, v165
    v_cvt_pk_bf16_f32 v155, v166, v167
    buffer_store_dwordx4 v[152:155], v44, s[88:91], s34 offen offset:1024 sc1
    v_mfma_f32_16x16x32_bf16 a[252:255], v[120:123], v[248:251], a[252:255]
    ds_read_b64_tr_b16 a[148:149], v52 offset:4096
    ds_read_b64_tr_b16 a[150:151], v52 offset:6144
    ds_read_b64_tr_b16 a[180:181], v53 offset:4096
    ds_read_b64_tr_b16 a[182:183], v53 offset:6144
    v_mfma_f32_16x16x32_bf16 a[252:255], v[124:127], v[252:255], a[252:255]
    ds_read_b64_tr_b16 a[212:213], v54 offset:4096
    ds_read_b64_tr_b16 a[214:215], v54 offset:6144
    ds_read_b64_tr_b16 a[244:245], v55 offset:4096
    ds_read_b64_tr_b16 a[246:247], v55 offset:6144
    s_nop 7
    v_accvgpr_read_b32 v136, a28
    v_accvgpr_read_b32 v144, a156
    v_accvgpr_read_b32 v137, a29
    v_accvgpr_read_b32 v145, a157
    v_accvgpr_read_b32 v138, a30
    v_accvgpr_read_b32 v146, a158
    v_accvgpr_read_b32 v139, a31
    v_accvgpr_read_b32 v147, a159
    v_accvgpr_read_b32 v140, a60
    v_accvgpr_read_b32 v148, a188
    v_accvgpr_read_b32 v141, a61
    v_accvgpr_read_b32 v149, a189
    v_accvgpr_read_b32 v142, a62
    v_accvgpr_read_b32 v150, a190
    v_accvgpr_read_b32 v143, a63
    v_accvgpr_read_b32 v151, a191
    v_pk_mul_f32 v[136:137], v[136:137], v[144:145]
    v_pk_mul_f32 v[138:139], v[138:139], v[146:147]
    v_pk_mul_f32 v[140:141], v[140:141], v[148:149]
    v_pk_mul_f32 v[142:143], v[142:143], v[150:151]
    v_cvt_pk_bf16_f32 v128, v136, v137
    v_cvt_pk_bf16_f32 v129, v138, v139
    v_cvt_pk_bf16_f32 v130, v140, v141
    v_cvt_pk_bf16_f32 v131, v142, v143
    buffer_store_dwordx4 v[128:131], v44, s[88:91], s34 offen offset:2048 sc1
    v_accvgpr_read_b32 v160, a92
    v_accvgpr_read_b32 v168, a220
    v_accvgpr_read_b32 v161, a93
    v_accvgpr_read_b32 v169, a221
    v_accvgpr_read_b32 v162, a94
    v_accvgpr_read_b32 v170, a222
    v_accvgpr_read_b32 v163, a95
    v_accvgpr_read_b32 v171, a223
    v_accvgpr_read_b32 v164, a124
    v_accvgpr_read_b32 v172, a252
    v_accvgpr_read_b32 v165, a125
    v_accvgpr_read_b32 v173, a253
    v_accvgpr_read_b32 v166, a126
    v_accvgpr_read_b32 v174, a254
    v_accvgpr_read_b32 v167, a127
    v_accvgpr_read_b32 v175, a255
    v_pk_mul_f32 v[160:161], v[160:161], v[168:169]
    v_pk_mul_f32 v[162:163], v[162:163], v[170:171]
    v_pk_mul_f32 v[164:165], v[164:165], v[172:173]
    v_pk_mul_f32 v[166:167], v[166:167], v[174:175]
    v_cvt_pk_bf16_f32 v152, v160, v161
    v_cvt_pk_bf16_f32 v153, v162, v163
    v_cvt_pk_bf16_f32 v154, v164, v165
    v_cvt_pk_bf16_f32 v155, v166, v167
    buffer_store_dwordx4 v[152:155], v44, s[88:91], s34 offen offset:3072 sc1
    s_add_u32 s34, s34, 4096
    s_add_u32 m0, s70, 0
    s_nop 0
    buffer_load_dwordx4 v40, s[40:43], s54 offen offset:0 lds
    buffer_load_dwordx4 v41, s[40:43], s54 offen offset:1024 lds
    buffer_load_dwordx4 v42, s[40:43], s54 offen offset:2048 lds
    buffer_load_dwordx4 v43, s[40:43], s54 offen offset:3072 lds
    s_add_u32 m0, s70, 4096
    s_nop 0
    buffer_load_dwordx4 v40, s[40:43], s55 offen offset:0 lds
    buffer_load_dwordx4 v41, s[40:43], s55 offen offset:1024 lds
    buffer_load_dwordx4 v42, s[40:43], s55 offen offset:2048 lds
    buffer_load_dwordx4 v43, s[40:43], s55 offen offset:3072 lds
    s_add_u32 s54, s54, 131072
    s_cmp_eq_u32 s54, s101
    s_cselect_b32 s54, s100, s54
    s_add_u32 s55, s54, 65536
    s_add_u32 m0, s70, 8192
    s_nop 0
    buffer_load_dwordx4 v40, s[40:43], s54 offen offset:0 lds
    buffer_load_dwordx4 v41, s[40:43], s54 offen offset:1024 lds
    buffer_load_dwordx4 v42, s[40:43], s54 offen offset:2048 lds
    buffer_load_dwordx4 v43, s[40:43], s54 offen offset:3072 lds
    s_add_u32 m0, s70, 12288
    s_nop 0
    buffer_load_dwordx4 v40, s[40:43], s55 offen offset:0 lds
    buffer_load_dwordx4 v41, s[40:43], s55 offen offset:1024 lds
    buffer_load_dwordx4 v42, s[40:43], s55 offen offset:2048 lds
    buffer_load_dwordx4 v43, s[40:43], s55 offen offset:3072 lds
    s_add_u32 s54, s54, 131072
    s_cmp_eq_u32 s54, s101
    s_cselect_b32 s54, s100, s54
    s_add_u32 s55, s54, 65536
    s_waitcnt vmcnt(16) lgkmcnt(0)
    s_barrier
    s_cmp_lg_u32 s24, 0
    s_cbranch_scc1 L_g4
    v_mov_b32 v2, s62
    v_mov_b32 v3, s78
    s_mov_b64 exec, 1
    buffer_store_dword v2, v3, s[48:51], 0 offen sc1
    s_mov_b64 exec, -1
L_g4:
    s_mul_i32 s3, s52, 917504
    s_add_u32 s3, s3, 4194304
    s_add_u32 s12, s4, s3
    s_addc_u32 s13, s5, 0
    s_mov_b32 s14, 917504
    s_mov_b32 s15, 0x00020000
    v_add_u32 v45, 4096, v44
    v_add_u32 v46, 8192, v44
    v_add_u32 v47, 12288, v44
    s_lshr_b32 s29, s100, 3
    s_lshr_b32 s30, s101, 3
    s_lshl_b32 s28, s71, 15
    s_add_u32 s28, s28, s29
    s_add_u32 m0, s68, 0
    s_nop 0
    buffer_load_dwordx4 v40, s[40:43], s54 offen offset:0 lds
    buffer_load_dwordx4 v41, s[40:43], s54 offen offset:1024 lds
    buffer_load_dwordx4 v42, s[40:43], s54 offen offset:2048 lds
    buffer_load_dwordx4 v43, s[40:43], s54 offen offset:3072 lds
    s_add_u32 m0, s68, 4096
    s_nop 0
    buffer_load_dwordx4 v40, s[40:43], s55 offen offset:0 lds
    buffer_load_dwordx4 v41, s[40:43], s55 offen offset:1024 lds
    buffer_load_dwordx4 v42, s[40:43], s55 offen offset:2048 lds
    buffer_load_dwordx4 v43, s[40:43], s55 offen offset:3072 lds
    s_add_u32 s54, s54, 131072
    s_cmp_eq_u32 s54, s101
    s_cselect_b32 s54, s100, s54
    s_add_u32 s55, s54, 65536
    s_add_u32 m0, s68, 8192
    s_nop 0
    buffer_load_dwordx4 v40, s[40:43], s54 offen offset:0 lds
    buffer_load_dwordx4 v41, s[40:43], s54 offen offset:1024 lds
    buffer_load_dwordx4 v42, s[40:43], s54 offen offset:2048 lds
    buffer_load_dwordx4 v43, s[40:43], s54 offen offset:3072 lds
    s_add_u32 m0, s68, 12288
    s_nop 0
    buffer_load_dwordx4 v40, s[40:43], s55 offen offset:0 lds
    buffer_load_dwordx4 v41, s[40:43], s55 offen offset:1024 lds
    buffer_load_dwordx4 v42, s[40:43], s55 offen offset:2048 lds
    buffer_load_dwordx4 v43, s[40:43], s55 offen offset:3072 lds
    s_add_u32 s54, s54, 131072
    s_cmp_eq_u32 s54, s101
    s_cselect_b32 s54, s100, s54
    s_add_u32 s55, s54, 65536
    s_add_u32 m0, s69, 0
    s_nop 0
    buffer_load_dwordx4 v40, s[40:43], s54 offen offset:0 lds
    buffer_load_dwordx4 v41, s[40:43], s54 offen offset:1024 lds
    buffer_load_dwordx4 v42, s[40:43], s54 offen offset:2048 lds
    buffer_load_dwordx4 v43, s[40:43], s54 offen offset:3072 lds
    s_add_u32 m0, s69, 4096
    s_nop 0
    buffer_load_dwordx4 v40, s[40:43], s55 offen offset:0 lds
    buffer_load_dwordx4 v41, s[40:43], s55 offen offset:1024 lds
    buffer_load_dwordx4 v42, s[40:43], s55 offen offset:2048 lds
    buffer_load_dwordx4 v43, s[40:43], s55 offen offset:3072 lds
    s_add_u32 s54, s54, 131072
    s_cmp_eq_u32 s54, s101
    s_cselect_b32 s54, s100, s54
    s_add_u32 s55, s54, 65536
    s_waitcnt vmcnt(32)
    ds_read_b64_tr_b16 a[152:153], v56 offset:0
    ds_read_b64_tr_b16 a[154:155], v56 offset:2048
    ds_read_b64_tr_b16 a[184:185], v57 offset:0
    ds_read_b64_tr_b16 a[186:187], v57 offset:2048
    ds_read_b64_tr_b16 a[216:217], v58 offset:0
    ds_read_b64_tr_b16 a[218:219], v58 offset:2048
    ds_read_b64_tr_b16 a[248:249], v59 offset:0
    ds_read_b64_tr_b16 a[250:251], v59 offset:2048
    ds_read_b64_tr_b16 a[156:157], v56 offset:4096
    ds_read_b64_tr_b16 a[158:159], v56 offset:6144
    ds_read_b64_tr_b16 a[188:189], v57 offset:4096
    ds_read_b64_tr_b16 a[190:191], v57 offset:6144
    ds_read_b64_tr_b16 a[220:221], v58 offset:4096
    ds_read_b64_tr_b16 a[222:223], v58 offset:6144
    ds_read_b64_tr_b16 a[252:253], v59 offset:4096
    ds_read_b64_tr_b16 a[254:255], v59 offset:6144
    v_and_b32 v2, 15, v1
    v_lshlrev_b32 v2, 8, v2
    v_lshrrev_b32 v3, 4, v1
    v_and_b32 v4, 7, v1
    v_xor_b32 v3, v3, v4
    v_lshl_add_u32 v5, v3, 4, v2
    v_add_u32 v22, s68, v5
    v_add_u32 v24, s70, v5
    v_xor_b32 v5, 64, v5
    v_add_u32 v23, s68, v5
    v_add_u32 v25, s70, v5
    v_lshrrev_b32 v5, 3, v1
    v_lshlrev_b32 v2, 8, v5
    s_and_b32 s3, s24, 1
    s_lshl_b32 s3, s3, 13
    s_cmp_lt_u32 s24, 2
    s_cselect_b32 s35, 0x10000, 0
    s_add_u32 s3, s3, s35
    s_add_u32 s3, s3, 32768
    v_add_u32 v2, s3, v2
    v_lshlrev_b32 v3, 1, v4
    v_xor_b32 v3, v3, v5
    v_lshl_add_u32 v20, v3, 4, v2
    v_xor_b32 v21, 16, v20
    s_waitcnt lgkmcnt(0)
    v_lshlrev_b32 v26, 2, v1
    s_lshr_b32 s34, s52, 1
    s_lshl_b32 s34, s34, 7
    buffer_load_dword v7, v26, s[48:51], s34 offen sc1
    s_add_u32 m0, s70, 0
    s_nop 0
    buffer_load_dwordx4 v40, s[40:43], s54 offen offset:0 lds
    buffer_load_dwordx4 v41, s[40:43], s54 offen offset:1024 lds
    buffer_load_dwordx4 v42, s[40:43], s54 offen offset:2048 lds
    buffer_load_dwordx4 v43, s[40:43], s54 offen offset:3072 lds
    s_add_u32 m0, s70, 4096
    s_nop 0
    buffer_load_dwordx4 v40, s[40:43], s55 offen offset:0 lds
    buffer_load_dwordx4 v41, s[40:43], s55 offen offset:1024 lds
    buffer_load_dwordx4 v42, s[40:43], s55 offen offset:2048 lds
    buffer_load_dwordx4 v43, s[40:43], s55 offen offset:3072 lds
    s_add_u32 s54, s54, 131072
    s_cmp_eq_u32 s54, s101
    s_cselect_b32 s54, s100, s54
    s_add_u32 s55, s54, 65536
    s_lshl_b32 s3, s52, 7
    s_lshl_b32 s35, s24, 5
    s_add_u32 s3, s3, s35
    v_add_u32 v5, s3, v5
    s_lshl_b32 s3, s53, 7
    v_lshlrev_b32 v3, 4, v4
    v_add_u32 v3, s3, v3
    v_sub_u32 v6, 2034, v3
    s_cmp_ge_u32 s53, 8
    s_cselect_b64 vcc, -1, 0
    v_cndmask_b32 v6, v3, v6, vcc
    v_lshl_add_u32 v27, v5, 11, v3
    v_add_u32 v4, 0, v5
    v_sub_u32 v2, 2048, v4
    v_min_u32 v4, v4, v2
    v_mul_u32_u24 v4, 1280, v4
    v_add_u32 v28, v4, v6
    v_add_u32 v4, 8, v5
    v_sub_u32 v2, 2048, v4
    v_min_u32 v4, v4, v2
    v_mul_u32_u24 v4, 1280, v4
    v_add_u32 v29, v4, v6
    v_add_u32 v4, 16, v5
    v_sub_u32 v2, 2048, v4
    v_min_u32 v4, v4, v2
    v_mul_u32_u24 v4, 1280, v4
    v_add_u32 v30, v4, v6
    v_add_u32 v4, 24, v5
    v_sub_u32 v2, 2048, v4
    v_min_u32 v4, v4, v2
    v_mul_u32_u24 v4, 1280, v4
    v_add_u32 v31, v4, v6
    s_mov_b32 s16, s6
    s_mov_b32 s17, s7
    s_mov_b32 s18, 4194304
    s_mov_b32 s19, 0x00020000
    s_mov_b32 s8, s60
    s_mov_b32 s9, s61
    s_mov_b32 s10, 4194304
    s_mov_b32 s11, 0x00020000
    s_add_u32 s20, s4, 20971520
    s_addc_u32 s21, s5, 0
    s_mov_b32 s22, 4457728
    s_mov_b32 s23, 0x00020000
    s_mov_b32 s36, 3145728
    s_xor_b32 s3, s52, s53
    s_and_b32 s3, s3, 8
    s_cselect_b32 s56, 1.0, -1.0
    s_mov_b32 s57, s56
    s_mov_b32 s58, 0xbfb8aa3b
    s_mov_b32 s59, s58
    s_mov_b32 s39, 0xffff0000
    s_mul_i32 s72, s24, 7
    s_add_u32 s73, s72, 7
    s_add_u32 s74, s72, s71
    s_waitcnt vmcnt(8)
    v_cmp_eq_u32 vcc, s62, v7
    s_nop 3
    s_mov_b32 s75, vcc_lo
    s_bitcmp1_b32 s75, s74
    s_cbranch_scc1 L_ok0
    s_mov_b32 s35, 0
L_sp0:
    buffer_load_dword v7, v26, s[48:51], s34 offen sc1
    s_waitcnt vmcnt(0)
    v_cmp_eq_u32 vcc, s62, v7
    s_add_u32 s35, s35, 1
    s_nop 2
    s_mov_b32 s75, vcc_lo
    s_bitcmp1_b32 s75, s74
    s_cbranch_scc1 L_ok0
    s_sleep 2
    s_cmp_lt_u32 s35, 0x40000
    s_cbranch_scc1 L_sp0
L_ok0:
    s_add_u32 s74, s74, 1
    s_cmp_eq_u32 s74, s73
    s_cselect_b32 s74, s72, s74
    buffer_load_dwordx4 v[64:67], v44, s[12:15], s28 offen offset:0 sc1
    buffer_load_dwordx4 v[68:71], v44, s[12:15], s28 offen offset:2048 sc1
    buffer_load_dwordx4 v[72:75], v45, s[12:15], s28 offen offset:0 sc1
    buffer_load_dwordx4 v[76:79], v45, s[12:15], s28 offen offset:2048 sc1
    buffer_load_dwordx4 v[80:83], v46, s[12:15], s28 offen offset:0 sc1
    buffer_load_dwordx4 v[84:87], v46, s[12:15], s28 offen offset:2048 sc1
    buffer_load_dwordx4 v[88:91], v47, s[12:15], s28 offen offset:0 sc1
    buffer_load_dwordx4 v[92:95], v47, s[12:15], s28 offen offset:2048 sc1
    buffer_load_dwordx4 v[96:99], v44, s[12:15], s28 offen offset:1024 sc1
    buffer_load_dwordx4 v[100:103], v44, s[12:15], s28 offen offset:3072 sc1
    buffer_load_dwordx4 v[104:107], v45, s[12:15], s28 offen offset:1024 sc1
    buffer_load_dwordx4 v[108:111], v45, s[12:15], s28 offen offset:3072 sc1
    buffer_load_dwordx4 v[112:115], v46, s[12:15], s28 offen offset:1024 sc1
    buffer_load_dwordx4 v[116:119], v46, s[12:15], s28 offen offset:3072 sc1
    buffer_load_dwordx4 v[120:123], v47, s[12:15], s28 offen offset:1024 sc1
    buffer_load_dwordx4 v[124:127], v47, s[12:15], s28 offen offset:3072 sc1
    s_add_u32 s28, s28, 16384
    s_cmp_eq_u32 s28, s30
    s_cselect_b32 s28, s29, s28
    buffer_load_dwordx4 v[128:131], v44, s[12:15], s28 offen offset:0 sc1
    buffer_load_dwordx4 v[132:135], v44, s[12:15], s28 offen offset:2048 sc1
    buffer_load_dwordx4 v[136:139], v45, s[12:15], s28 offen offset:0 sc1
    buffer_load_dwordx4 v[140:143], v45, s[12:15], s28 offen offset:2048 sc1
    buffer_load_dwordx4 v[144:147], v46, s[12:15], s28 offen offset:0 sc1
    buffer_load_dwordx4 v[148:151], v46, s[12:15], s28 offen offset:2048 sc1
    buffer_load_dwordx4 v[152:155], v47, s[12:15], s28 offen offset:0 sc1
    buffer_load_dwordx4 v[156:159], v47, s[12:15], s28 offen offset:2048 sc1
    buffer_load_dwordx4 v[160:163], v44, s[12:15], s28 offen offset:1024 sc1
    buffer_load_dwordx4 v[164:167], v44, s[12:15], s28 offen offset:3072 sc1
    buffer_load_dwordx4 v[168:171], v45, s[12:15], s28 offen offset:1024 sc1
    buffer_load_dwordx4 v[172:175], v45, s[12:15], s28 offen offset:3072 sc1
    buffer_load_dwordx4 v[176:179], v46, s[12:15], s28 offen offset:1024 sc1
    buffer_load_dwordx4 v[180:183], v46, s[12:15], s28 offen offset:3072 sc1
    buffer_load_dwordx4 v[184:187], v47, s[12:15], s28 offen offset:1024 sc1
    buffer_load_dwordx4 v[188:191], v47, s[12:15], s28 offen offset:3072 sc1
    s_add_u32 s28, s28, 16384
    s_cmp_eq_u32 s28, s30
    s_cselect_b32 s28, s29, s28
    s_bitcmp1_b32 s75, s74
    s_cbranch_scc1 L_ok1
    s_mov_b32 s35, 0
L_sp1:
    buffer_load_dword v7, v26, s[48:51], s34 offen sc1
    s_waitcnt vmcnt(0)
    v_cmp_eq_u32 vcc, s62, v7
    s_add_u32 s35, s35, 1
    s_nop 2
    s_mov_b32 s75, vcc_lo
    s_bitcmp1_b32 s75, s74
    s_cbranch_scc1 L_ok1
    s_sleep 2
    s_cmp_lt_u32 s35, 0x40000
    s_cbranch_scc1 L_sp1
L_ok1:
    s_add_u32 s74, s74, 1
    s_cmp_eq_u32 s74, s73
    s_cselect_b32 s74, s72, s74
    buffer_load_dwordx4 v[192:195], v44, s[12:15], s28 offen offset:0 sc1
    buffer_load_dwordx4 v[196:199], v44, s[12:15], s28 offen offset:2048 sc1
    buffer_load_dwordx4 v[200:203], v45, s[12:15], s28 offen offset:0 sc1
    buffer_load_dwordx4 v[204:207], v45, s[12:15], s28 offen offset:2048 sc1
    buffer_load_dwordx4 v[208:211], v46, s[12:15], s28 offen offset:0 sc1
    buffer_load_dwordx4 v[212:215], v46, s[12:15], s28 offen offset:2048 sc1
    buffer_load_dwordx4 v[216:219], v47, s[12:15], s28 offen offset:0 sc1
    buffer_load_dwordx4 v[220:223], v47, s[12:15], s28 offen offset:2048 sc1
    s_waitcnt lgkmcnt(0) vmcnt(32)
    v_mfma_f32_16x16x32_bf16 a[0:3], a[128:131], v[64:67], 0
    v_mfma_f32_16x16x32_bf16 a[4:7], a[128:131], v[68:71], 0
    buffer_load_dwordx4 v[224:227], v44, s[12:15], s28 offen offset:1024 sc1
    v_mfma_f32_16x16x32_bf16 a[8:11], a[128:131], v[72:75], 0
    v_mfma_f32_16x16x32_bf16 a[12:15], a[128:131], v[76:79], 0
    v_mfma_f32_16x16x32_bf16 a[16:19], a[128:131], v[80:83], 0
    buffer_load_dwordx4 v[228:231], v44, s[12:15], s28 offen offset:3072 sc1
    v_mfma_f32_16x16x32_bf16 a[20:23], a[128:131], v[84:87], 0
    v_mfma_f32_16x16x32_bf16 a[24:27], a[128:131], v[88:91], 0
    v_mfma_f32_16x16x32_bf16 a[28:31], a[128:131], v[92:95], 0
    v_mfma_f32_16x16x32_bf16 a[32:35], a[160:163], v[64:67], 0
    buffer_load_dwordx4 v[232:235], v45, s[12:15], s28 offen offset:1024 sc1
    v_mfma_f32_16x16x32_bf16 a[36:39], a[160:163], v[68:71], 0
    v_mfma_f32_16x16x32_bf16 a[40:43], a[160:163], v[72:75], 0
    v_mfma_f32_16x16x32_bf16 a[44:47], a[160:163], v[76:79], 0
    v_mfma_f32_16x16x32_bf16 a[48:51], a[160:163], v[80:83], 0
    buffer_load_dwordx4 v[236:239], v45, s[12:15], s28 offen offset:3072 sc1
    v_mfma_f32_16x16x32_bf16 a[52:55], a[160:163], v[84:87], 0
    v_mfma_f32_16x16x32_bf16 a[56:59], a[160:163], v[88:91], 0
    v_mfma_f32_16x16x32_bf16 a[60:63], a[160:163], v[92:95], 0
    v_mfma_f32_16x16x32_bf16 a[64:67], a[192:195], v[64:67], 0
    buffer_load_dwordx4 v[240:243], v46, s[12:15], s28 offen offset:1024 sc1
    v_mfma_f32_16x16x32_bf16 a[68:71], a[192:195], v[68:71], 0
    v_mfma_f32_16x16x32_bf16 a[72:75], a[192:195], v[72:75], 0
    v_mfma_f32_16x16x32_bf16 a[76:79], a[192:195], v[76:79], 0
    buffer_load_dwordx4 v[244:247], v46, s[12:15], s28 offen offset:3072 sc1
    v_mfma_f32_16x16x32_bf16 a[80:83], a[192:195], v[80:83], 0
    v_mfma_f32_16x16x32_bf16 a[84:87], a[192:195], v[84:87], 0
    v_mfma_f32_16x16x32_bf16 a[88:91], a[192:195], v[88:91], 0
    v_mfma_f32_16x16x32_bf16 a[92:95], a[192:195], v[92:95], 0
    buffer_load_dwordx4 v[248:251], v47, s[12:15], s28 offen offset:1024 sc1
    v_mfma_f32_16x16x32_bf16 a[96:99], a[224:227], v[64:67], 0
    v_mfma_f32_16x16x32_bf16 a[100:103], a[224:227], v[68:71], 0
    v_mfma_f32_16x16x32_bf16 a[104:107], a[224:227], v[72:75], 0
    v_mfma_f32_16x16x32_bf16 a[108:111], a[224:227], v[76:79], 0
    buffer_load_dwordx4 v[252:255], v47, s[12:15], s28 offen offset:3072 sc1
    v_mfma_f32_16x16x32_bf16 a[112:115], a[224:227], v[80:83], 0
    s_add_u32 s28, s28, 16384
    s_cmp_eq_u32 s28, s30
    s_cselect_b32 s28, s29, s28
    v_mfma_f32_16x16x32_bf16 a[116:119], a[224:227], v[84:87], 0
    v_mfma_f32_16x16x32_bf16 a[120:123], a[224:227], v[88:91], 0
    v_mfma_f32_16x16x32_bf16 a[124:127], a[224:227], v[92:95], 0
    s_waitcnt lgkmcnt(0) vmcnt(32)
    v_mfma_f32_16x16x32_bf16 a[0:3], a[132:135], v[96:99], a[0:3]
    v_mfma_f32_16x16x32_bf16 a[4:7], a[132:135], v[100:103], a[4:7]
    buffer_load_dwordx4 v[64:67], v44, s[12:15], s28 offen offset:0 sc1
    v_mfma_f32_16x16x32_bf16 a[8:11], a[132:135], v[104:107], a[8:11]
    v_mfma_f32_16x16x32_bf16 a[12:15], a[132:135], v[108:111], a[12:15]
    v_mfma_f32_16x16x32_bf16 a[16:19], a[132:135], v[112:115], a[16:19]
    buffer_load_dwordx4 v[68:71], v44, s[12:15], s28 offen offset:2048 sc1
    v_mfma_f32_16x16x32_bf16 a[20:23], a[132:135], v[116:119], a[20:23]
    v_mfma_f32_16x16x32_bf16 a[24:27], a[132:135], v[120:123], a[24:27]
    v_mfma_f32_16x16x32_bf16 a[28:31], a[132:135], v[124:127], a[28:31]
    v_mfma_f32_16x16x32_bf16 a[32:35], a[164:167], v[96:99], a[32:35]
    buffer_load_dwordx4 v[72:75], v45, s[12:15], s28 offen offset:0 sc1
    v_mfma_f32_16x16x32_bf16 a[36:39], a[164:167], v[100:103], a[36:39]
    v_mfma_f32_16x16x32_bf16 a[40:43], a[164:167], v[104:107], a[40:43]
    v_mfma_f32_16x16x32_bf16 a[44:47], a[164:167], v[108:111], a[44:47]
    v_mfma_f32_16x16x32_bf16 a[48:51], a[164:167], v[112:115], a[48:51]
    buffer_load_dwordx4 v[76:79], v45, s[12:15], s28 offen offset:2048 sc1
    v_mfma_f32_16x16x32_bf16 a[52:55], a[164:167], v[116:119], a[52:55]
    v_mfma_f32_16x16x32_bf16 a[56:59], a[164:167], v[120:123], a[56:59]
    v_mfma_f32_16x16x32_bf16 a[60:63], a[164:167], v[124:127], a[60:63]
    v_mfma_f32_16x16x32_bf16 a[64:67], a[196:199], v[96:99], a[64:67]
    buffer_load_dwordx4 v[80:83], v46, s[12:15], s28 offen offset:0 sc1
    v_mfma_f32_16x16x32_bf16 a[68:71], a[196:199], v[100:103], a[68:71]
    v_mfma_f32_16x16x32_bf16 a[72:75], a[196:199], v[104:107], a[72:75]
    v_mfma_f32_16x16x32_bf16 a[76:79], a[196:199], v[108:111], a[76:79]
    buffer_load_dwordx4 v[84:87], v46, s[12:15], s28 offen offset:2048 sc1
    v_mfma_f32_16x16x32_bf16 a[80:83], a[196:199], v[112:115], a[80:83]
    v_mfma_f32_16x16x32_bf16 a[84:87], a[196:199], v[116:119], a[84:87]
    v_mfma_f32_16x16x32_bf16 a[88:91], a[196:199], v[120:123], a[88:91]
    v_mfma_f32_16x16x32_bf16 a[92:95], a[196:199], v[124:127], a[92:95]
    buffer_load_dwordx4 v[88:91], v47, s[12:15], s28 offen offset:0 sc1
    v_mfma_f32_16x16x32_bf16 a[96:99], a[228:231], v[96:99], a[96:99]
    v_mfma_f32_16x16x32_bf16 a[100:103], a[228:231], v[100:103], a[100:103]
    v_mfma_f32_16x16x32_bf16 a[104:107], a[228:231], v[104:107], a[104:107]
    v_mfma_f32_16x16x32_bf16 a[108:111], a[228:231], v[108:111], a[108:111]
    buffer_load_dwordx4 v[92:95], v47, s[12:15], s28 offen offset:2048 sc1
    v_mfma_f32_16x16x32_bf16 a[112:115], a[228:231], v[112:115], a[112:115]
    v_mfma_f32_16x16x32_bf16 a[116:119], a[228:231], v[116:119], a[116:119]
    v_mfma_f32_16x16x32_bf16 a[120:123], a[228:231], v[120:123], a[120:123]
    v_mfma_f32_16x16x32_bf16 a[124:127], a[228:231], v[124:127], a[124:127]
    s_waitcnt lgkmcnt(0) vmcnt(32)
    v_mfma_f32_16x16x32_bf16 a[0:3], a[136:139], v[128:131], a[0:3]
    v_mfma_f32_16x16x32_bf16 a[4:7], a[136:139], v[132:135], a[4:7]
    buffer_load_dwordx4 v[96:99], v44, s[12:15], s28 offen offset:1024 sc1
    v_mfma_f32_16x16x32_bf16 a[8:11], a[136:139], v[136:139], a[8:11]
    v_mfma_f32_16x16x32_bf16 a[12:15], a[136:139], v[140:143], a[12:15]
    v_mfma_f32_16x16x32_bf16 a[16:19], a[136:139], v[144:147], a[16:19]
    buffer_load_dwordx4 v[100:103], v44, s[12:15], s28 offen offset:3072 sc1
    v_mfma_f32_16x16x32_bf16 a[20:23], a[136:139], v[148:151], a[20:23]
    v_mfma_f32_16x16x32_bf16 a[24:27], a[136:139], v[152:155], a[24:27]
    v_mfma_f32_16x16x32_bf16 a[28:31], a[136:139], v[156:159], a[28:31]
    v_mfma_f32_16x16x32_bf16 a[32:35], a[168:171], v[128:131], a[32:35]
    buffer_load_dwordx4 v[104:107], v45, s[12:15], s28 offen offset:1024 sc1
    v_mfma_f32_16x16x32_bf16 a[36:39], a[168:171], v[132:135], a[36:39]
    v_mfma_f32_16x16x32_bf16 a[40:43], a[168:171], v[136:139], a[40:43]
    v_mfma_f32_16x16x32_bf16 a[44:47], a[168:171], v[140:143], a[44:47]
    v_mfma_f32_16x16x32_bf16 a[48:51], a[168:171], v[144:147], a[48:51]
    buffer_load_dwordx4 v[108:111], v45, s[12:15], s28 offen offset:3072 sc1
    v_mfma_f32_16x16x32_bf16 a[52:55], a[168:171], v[148:151], a[52:55]
    v_mfma_f32_16x16x32_bf16 a[56:59], a[168:171], v[152:155], a[56:59]
    v_mfma_f32_16x16x32_bf16 a[60:63], a[168:171], v[156:159], a[60:63]
    v_mfma_f32_16x16x32_bf16 a[64:67], a[200:203], v[128:131], a[64:67]
    buffer_load_dwordx4 v[112:115], v46, s[12:15], s28 offen offset:1024 sc1
    v_mfma_f32_16x16x32_bf16 a[68:71], a[200:203], v[132:135], a[68:71]
    v_mfma_f32_16x16x32_bf16 a[72:75], a[200:203], v[136:139], a[72:75]
    v_mfma_f32_16x16x32_bf16 a[76:79], a[200:203], v[140:143], a[76:79]
    buffer_load_dwordx4 v[116:119], v46, s[12:15], s28 offen offset:3072 sc1
    v_mfma_f32_16x16x32_bf16 a[80:83], a[200:203], v[144:147], a[80:83]
    v_mfma_f32_16x16x32_bf16 a[84:87], a[200:203], v[148:151], a[84:87]
    v_mfma_f32_16x16x32_bf16 a[88:91], a[200:203], v[152:155], a[88:91]
    v_mfma_f32_16x16x32_bf16 a[92:95], a[200:203], v[156:159], a[92:95]
    buffer_load_dwordx4 v[120:123], v47, s[12:15], s28 offen offset:1024 sc1
    v_mfma_f32_16x16x32_bf16 a[96:99], a[232:235], v[128:131], a[96:99]
    v_mfma_f32_16x16x32_bf16 a[100:103], a[232:235], v[132:135], a[100:103]
    v_mfma_f32_16x16x32_bf16 a[104:107], a[232:235], v[136:139], a[104:107]
    v_mfma_f32_16x16x32_bf16 a[108:111], a[232:235], v[140:143], a[108:111]
    buffer_load_dwordx4 v[124:127], v47, s[12:15], s28 offen offset:3072 sc1
    v_mfma_f32_16x16x32_bf16 a[112:115], a[232:235], v[144:147], a[112:115]
    s_add_u32 s28, s28, 16384
    s_cmp_eq_u32 s28, s30
    s_cselect_b32 s28, s29, s28
    v_mfma_f32_16x16x32_bf16 a[116:119], a[232:235], v[148:151], a[116:119]
    v_mfma_f32_16x16x32_bf16 a[120:123], a[232:235], v[152:155], a[120:123]
    v_mfma_f32_16x16x32_bf16 a[124:127], a[232:235], v[156:159], a[124:127]
    s_waitcnt lgkmcnt(0) vmcnt(32)
    v_mfma_f32_16x16x32_bf16 a[0:3], a[140:143], v[160:163], a[0:3]
    s_bitcmp1_b32 s75, s74
    s_cbranch_scc1 L_ok2
    s_mov_b32 s35, 0
L_sp2:
    buffer_load_dword v7, v26, s[48:51], s34 offen sc1
    s_waitcnt vmcnt(0)
    v_cmp_eq_u32 vcc, s62, v7
    s_add_u32 s35, s35, 1
    s_nop 2
    s_mov_b32 s75, vcc_lo
    s_bitcmp1_b32 s75, s74
    s_cbranch_scc1 L_ok2
    s_sleep 2
    s_cmp_lt_u32 s35, 0x40000
    s_cbranch_scc1 L_sp2
L_ok2:
    s_add_u32 s74, s74, 1
    s_cmp_eq_u32 s74, s73
    s_cselect_b32 s74, s72, s74
    v_mfma_f32_16x16x32_bf16 a[4:7], a[140:143], v[164:167], a[4:7]
    buffer_load_dwordx4 v[128:131], v44, s[12:15], s28 offen offset:0 sc1
    v_mfma_f32_16x16x32_bf16 a[8:11], a[140:143], v[168:171], a[8:11]
    v_mfma_f32_16x16x32_bf16 a[12:15], a[140:143], v[172:175], a[12:15]
    v_mfma_f32_16x16x32_bf16 a[16:19], a[140:143], v[176:179], a[16:19]
    buffer_load_dwordx4 v[132:135], v44, s[12:15], s28 offen offset:2048 sc1
    v_mfma_f32_16x16x32_bf16 a[20:23], a[140:143], v[180:183], a[20:23]
    v_mfma_f32_16x16x32_bf16 a[24:27], a[140:143], v[184:187], a[24:27]
    v_mfma_f32_16x16x32_bf16 a[28:31], a[140:143], v[188:191], a[28:31]
    v_mfma_f32_16x16x32_bf16 a[32:35], a[172:175], v[160:163], a[32:35]
    buffer_load_dwordx4 v[136:139], v45, s[12:15], s28 offen offset:0 sc1
    v_mfma_f32_16x16x32_bf16 a[36:39], a[172:175], v[164:167], a[36:39]
    v_mfma_f32_16x16x32_bf16 a[40:43], a[172:175], v[168:171], a[40:43]
    v_mfma_f32_16x16x32_bf16 a[44:47], a[172:175], v[172:175], a[44:47]
    v_mfma_f32_16x16x32_bf16 a[48:51], a[172:175], v[176:179], a[48:51]
    buffer_load_dwordx4 v[140:143], v45, s[12:15], s28 offen offset:2048 sc1
    v_mfma_f32_16x16x32_bf16 a[52:55], a[172:175], v[180:183], a[52:55]
    v_mfma_f32_16x16x32_bf16 a[56:59], a[172:175], v[184:187], a[56:59]
    v_mfma_f32_16x16x32_bf16 a[60:63], a[172:175], v[188:191], a[60:63]
    v_mfma_f32_16x16x32_bf16 a[64:67], a[204:207], v[160:163], a[64:67]
    buffer_load_dwordx4 v[144:147], v46, s[12:15], s28 offen offset:0 sc1
    v_mfma_f32_16x16x32_bf16 a[68:71], a[204:207], v[164:167], a[68:71]
    v_mfma_f32_16x16x32_bf16 a[72:75], a[204:207], v[168:171], a[72:75]
    v_mfma_f32_16x16x32_bf16 a[76:79], a[204:207], v[172:175], a[76:79]
    buffer_load_dwordx4 v[148:151], v46, s[12:15], s28 offen offset:2048 sc1
    v_mfma_f32_16x16x32_bf16 a[80:83], a[204:207], v[176:179], a[80:83]
    v_mfma_f32_16x16x32_bf16 a[84:87], a[204:207], v[180:183], a[84:87]
    v_mfma_f32_16x16x32_bf16 a[88:91], a[204:207], v[184:187], a[88:91]
    v_mfma_f32_16x16x32_bf16 a[92:95], a[204:207], v[188:191], a[92:95]
    buffer_load_dwordx4 v[152:155], v47, s[12:15], s28 offen offset:0 sc1
    v_mfma_f32_16x16x32_bf16 a[96:99], a[236:239], v[160:163], a[96:99]
    v_mfma_f32_16x16x32_bf16 a[100:103], a[236:239], v[164:167], a[100:103]
    v_mfma_f32_16x16x32_bf16 a[104:107], a[236:239], v[168:171], a[104:107]
    v_mfma_f32_16x16x32_bf16 a[108:111], a[236:239], v[172:175], a[108:111]
    buffer_load_dwordx4 v[156:159], v47, s[12:15], s28 offen offset:2048 sc1
    v_mfma_f32_16x16x32_bf16 a[112:115], a[236:239], v[176:179], a[112:115]
    v_mfma_f32_16x16x32_bf16 a[116:119], a[236:239], v[180:183], a[116:119]
    v_mfma_f32_16x16x32_bf16 a[120:123], a[236:239], v[184:187], a[120:123]
    v_mfma_f32_16x16x32_bf16 a[124:127], a[236:239], v[188:191], a[124:127]
    s_waitcnt lgkmcnt(0) vmcnt(32)
    v_mfma_f32_16x16x32_bf16 a[0:3], a[144:147], v[192:195], a[0:3]
    v_mfma_f32_16x16x32_bf16 a[4:7], a[144:147], v[196:199], a[4:7]
    buffer_load_dwordx4 v[160:163], v44, s[12:15], s28 offen offset:1024 sc1
    v_mfma_f32_16x16x32_bf16 a[8:11], a[144:147], v[200:203], a[8:11]
    v_mfma_f32_16x16x32_bf16 a[12:15], a[144:147], v[204:207], a[12:15]
    v_mfma_f32_16x16x32_bf16 a[16:19], a[144:147], v[208:211], a[16:19]
    buffer_load_dwordx4 v[164:167], v44, s[12:15], s28 offen offset:3072 sc1
    v_mfma_f32_16x16x32_bf16 a[20:23], a[144:147], v[212:215], a[20:23]
    v_mfma_f32_16x16x32_bf16 a[24:27], a[144:147], v[216:219], a[24:27]
    v_mfma_f32_16x16x32_bf16 a[28:31], a[144:147], v[220:223], a[28:31]
    v_mfma_f32_16x16x32_bf16 a[32:35], a[176:179], v[192:195], a[32:35]
    buffer_load_dwordx4 v[168:171], v45, s[12:15], s28 offen offset:1024 sc1
    v_mfma_f32_16x16x32_bf16 a[36:39], a[176:179], v[196:199], a[36:39]
    v_mfma_f32_16x16x32_bf16 a[40:43], a[176:179], v[200:203], a[40:43]
    v_mfma_f32_16x16x32_bf16 a[44:47], a[176:179], v[204:207], a[44:47]
    v_mfma_f32_16x16x32_bf16 a[48:51], a[176:179], v[208:211], a[48:51]
    buffer_load_dwordx4 v[172:175], v45, s[12:15], s28 offen offset:3072 sc1
    v_mfma_f32_16x16x32_bf16 a[52:55], a[176:179], v[212:215], a[52:55]
    v_mfma_f32_16x16x32_bf16 a[56:59], a[176:179], v[216:219], a[56:59]
    v_mfma_f32_16x16x32_bf16 a[60:63], a[176:179], v[220:223], a[60:63]
    v_mfma_f32_16x16x32_bf16 a[64:67], a[208:211], v[192:195], a[64:67]
    buffer_load_dwordx4 v[176:179], v46, s[12:15], s28 offen offset:1024 sc1
    v_mfma_f32_16x16x32_bf16 a[68:71], a[208:211], v[196:199], a[68:71]
    v_mfma_f32_16x16x32_bf16 a[72:75], a[208:211], v[200:203], a[72:75]
    v_mfma_f32_16x16x32_bf16 a[76:79], a[208:211], v[204:207], a[76:79]
    buffer_load_dwordx4 v[180:183], v46, s[12:15], s28 offen offset:3072 sc1
    v_mfma_f32_16x16x32_bf16 a[80:83], a[208:211], v[208:211], a[80:83]
    v_mfma_f32_16x16x32_bf16 a[84:87], a[208:211], v[212:215], a[84:87]
    v_mfma_f32_16x16x32_bf16 a[88:91], a[208:211], v[216:219], a[88:91]
    v_mfma_f32_16x16x32_bf16 a[92:95], a[208:211], v[220:223], a[92:95]
    buffer_load_dwordx4 v[184:187], v47, s[12:15], s28 offen offset:1024 sc1
    v_mfma_f32_16x16x32_bf16 a[96:99], a[240:243], v[192:195], a[96:99]
    v_mfma_f32_16x16x32_bf16 a[100:103], a[240:243], v[196:199], a[100:103]
    v_mfma_f32_16x16x32_bf16 a[104:107], a[240:243], v[200:203], a[104:107]
    v_mfma_f32_16x16x32_bf16 a[108:111], a[240:243], v[204:207], a[108:111]
    buffer_load_dwordx4 v[188:191], v47, s[12:15], s28 offen offset:3072 sc1
    v_mfma_f32_16x16x32_bf16 a[112:115], a[240:243], v[208:211], a[112:115]
    s_add_u32 s28, s28, 16384
    s_cmp_eq_u32 s28, s30
    s_cselect_b32 s28, s29, s28
    v_mfma_f32_16x16x32_bf16 a[116:119], a[240:243], v[212:215], a[116:119]
    v_mfma_f32_16x16x32_bf16 a[120:123], a[240:243], v[216:219], a[120:123]
    v_mfma_f32_16x16x32_bf16 a[124:127], a[240:243], v[220:223], a[124:127]
    s_waitcnt lgkmcnt(0) vmcnt(32)
    v_mfma_f32_16x16x32_bf16 a[0:3], a[148:151], v[224:227], a[0:3]
    v_mfma_f32_16x16x32_bf16 a[4:7], a[148:151], v[228:231], a[4:7]
    buffer_load_dwordx4 v[192:195], v44, s[12:15], s28 offen offset:0 sc1
    v_mfma_f32_16x16x32_bf16 a[8:11], a[148:151], v[232:235], a[8:11]
    v_mfma_f32_16x16x32_bf16 a[12:15], a[148:151], v[236:239], a[12:15]
    v_mfma_f32_16x16x32_bf16 a[16:19], a[148:151], v[240:243], a[16:19]
    buffer_load_dwordx4 v[196:199], v44, s[12:15], s28 offen offset:2048 sc1
    v_mfma_f32_16x16x32_bf16 a[20:23], a[148:151], v[244:247], a[20:23]
    v_mfma_f32_16x16x32_bf16 a[24:27], a[148:151], v[248:251], a[24:27]
    v_mfma_f32_16x16x32_bf16 a[28:31], a[148:151], v[252:255], a[28:31]
    v_mfma_f32_16x16x32_bf16 a[32:35], a[180:183], v[224:227], a[32:35]
    buffer_load_dwordx4 v[200:203], v45, s[12:15], s28 offen offset:0 sc1
    v_mfma_f32_16x16x32_bf16 a[36:39], a[180:183], v[228:231], a[36:39]
    v_mfma_f32_16x16x32_bf16 a[40:43], a[180:183], v[232:235], a[40:43]
    v_mfma_f32_16x16x32_bf16 a[44:47], a[180:183], v[236:239], a[44:47]
    v_mfma_f32_16x16x32_bf16 a[48:51], a[180:183], v[240:243], a[48:51]
    buffer_load_dwordx4 v[204:207], v45, s[12:15], s28 offen offset:2048 sc1
    v_mfma_f32_16x16x32_bf16 a[52:55], a[180:183], v[244:247], a[52:55]
    v_mfma_f32_16x16x32_bf16 a[56:59], a[180:183], v[248:251], a[56:59]
    v_mfma_f32_16x16x32_bf16 a[60:63], a[180:183], v[252:255], a[60:63]
    v_mfma_f32_16x16x32_bf16 a[64:67], a[212:215], v[224:227], a[64:67]
    buffer_load_dwordx4 v[208:211], v46, s[12:15], s28 offen offset:0 sc1
    v_mfma_f32_16x16x32_bf16 a[68:71], a[212:215], v[228:231], a[68:71]
    v_mfma_f32_16x16x32_bf16 a[72:75], a[212:215], v[232:235], a[72:75]
    v_mfma_f32_16x16x32_bf16 a[76:79], a[212:215], v[236:239], a[76:79]
    buffer_load_dwordx4 v[212:215], v46, s[12:15], s28 offen offset:2048 sc1
    v_mfma_f32_16x16x32_bf16 a[80:83], a[212:215], v[240:243], a[80:83]
    v_mfma_f32_16x16x32_bf16 a[84:87], a[212:215], v[244:247], a[84:87]
    v_mfma_f32_16x16x32_bf16 a[88:91], a[212:215], v[248:251], a[88:91]
    v_mfma_f32_16x16x32_bf16 a[92:95], a[212:215], v[252:255], a[92:95]
    buffer_load_dwordx4 v[216:219], v47, s[12:15], s28 offen offset:0 sc1
    v_mfma_f32_16x16x32_bf16 a[96:99], a[244:247], v[224:227], a[96:99]
    v_mfma_f32_16x16x32_bf16 a[100:103], a[244:247], v[228:231], a[100:103]
    v_mfma_f32_16x16x32_bf16 a[104:107], a[244:247], v[232:235], a[104:107]
    v_mfma_f32_16x16x32_bf16 a[108:111], a[244:247], v[236:239], a[108:111]
    buffer_load_dwordx4 v[220:223], v47, s[12:15], s28 offen offset:2048 sc1
    v_mfma_f32_16x16x32_bf16 a[112:115], a[244:247], v[240:243], a[112:115]
    v_mfma_f32_16x16x32_bf16 a[116:119], a[244:247], v[244:247], a[116:119]
    v_mfma_f32_16x16x32_bf16 a[120:123], a[244:247], v[248:251], a[120:123]
    v_mfma_f32_16x16x32_bf16 a[124:127], a[244:247], v[252:255], a[124:127]
    s_waitcnt lgkmcnt(0) vmcnt(32)
    v_mfma_f32_16x16x32_bf16 a[0:3], a[152:155], v[64:67], a[0:3]
    v_mfma_f32_16x16x32_bf16 a[4:7], a[152:155], v[68:71], a[4:7]
    buffer_load_dwordx4 v[224:227], v44, s[12:15], s28 offen offset:1024 sc1
    v_mfma_f32_16x16x32_bf16 a[8:11], a[152:155], v[72:75], a[8:11]
    v_mfma_f32_16x16x32_bf16 a[12:15], a[152:155], v[76:79], a[12:15]
    v_mfma_f32_16x16x32_bf16 a[16:19], a[152:155], v[80:83], a[16:19]
    buffer_load_dwordx4 v[228:231], v44, s[12:15], s28 offen offset:3072 sc1
    v_mfma_f32_16x16x32_bf16 a[20:23], a[152:155], v[84:87], a[20:23]
    v_mfma_f32_16x16x32_bf16 a[24:27], a[152:155], v[88:91], a[24:27]
    v_mfma_f32_16x16x32_bf16 a[28:31], a[152:155], v[92:95], a[28:31]
    v_mfma_f32_16x16x32_bf16 a[32:35], a[184:187], v[64:67], a[32:35]
    buffer_load_dwordx4 v[232:235], v45, s[12:15], s28 offen offset:1024 sc1
    v_mfma_f32_16x16x32_bf16 a[36:39], a[184:187], v[68:71], a[36:39]
    v_mfma_f32_16x16x32_bf16 a[40:43], a[184:187], v[72:75], a[40:43]
    v_mfma_f32_16x16x32_bf16 a[44:47], a[184:187], v[76:79], a[44:47]
    v_mfma_f32_16x16x32_bf16 a[48:51], a[184:187], v[80:83], a[48:51]
    buffer_load_dwordx4 v[236:239], v45, s[12:15], s28 offen offset:3072 sc1
    v_mfma_f32_16x16x32_bf16 a[52:55], a[184:187], v[84:87], a[52:55]
    v_mfma_f32_16x16x32_bf16 a[56:59], a[184:187], v[88:91], a[56:59]
    v_mfma_f32_16x16x32_bf16 a[60:63], a[184:187], v[92:95], a[60:63]
    v_mfma_f32_16x16x32_bf16 a[64:67], a[216:219], v[64:67], a[64:67]
    buffer_load_dwordx4 v[240:243], v46, s[12:15], s28 offen offset:1024 sc1
    v_mfma_f32_16x16x32_bf16 a[68:71], a[216:219], v[68:71], a[68:71]
    v_mfma_f32_16x16x32_bf16 a[72:75], a[216:219], v[72:75], a[72:75]
    v_mfma_f32_16x16x32_bf16 a[76:79], a[216:219], v[76:79], a[76:79]
    buffer_load_dwordx4 v[244:247], v46, s[12:15], s28 offen offset:3072 sc1
    v_mfma_f32_16x16x32_bf16 a[80:83], a[216:219], v[80:83], a[80:83]
    v_mfma_f32_16x16x32_bf16 a[84:87], a[216:219], v[84:87], a[84:87]
    v_mfma_f32_16x16x32_bf16 a[88:91], a[216:219], v[88:91], a[88:91]
    v_mfma_f32_16x16x32_bf16 a[92:95], a[216:219], v[92:95], a[92:95]
    buffer_load_dwordx4 v[248:251], v47, s[12:15], s28 offen offset:1024 sc1
    v_mfma_f32_16x16x32_bf16 a[96:99], a[248:251], v[64:67], a[96:99]
    v_mfma_f32_16x16x32_bf16 a[100:103], a[248:251], v[68:71], a[100:103]
    v_mfma_f32_16x16x32_bf16 a[104:107], a[248:251], v[72:75], a[104:107]
    v_mfma_f32_16x16x32_bf16 a[108:111], a[248:251], v[76:79], a[108:111]
    buffer_load_dwordx4 v[252:255], v47, s[12:15], s28 offen offset:3072 sc1
    v_mfma_f32_16x16x32_bf16 a[112:115], a[248:251], v[80:83], a[112:115]
    s_add_u32 s28, s28, 16384
    s_cmp_eq_u32 s28, s30
    s_cselect_b32 s28, s29, s28
    v_mfma_f32_16x16x32_bf16 a[116:119], a[248:251], v[84:87], a[116:119]
    v_mfma_f32_16x16x32_bf16 a[120:123], a[248:251], v[88:91], a[120:123]
    v_mfma_f32_16x16x32_bf16 a[124:127], a[248:251], v[92:95], a[124:127]
    s_waitcnt lgkmcnt(0) vmcnt(32)
    v_mfma_f32_16x16x32_bf16 a[0:3], a[156:159], v[96:99], a[0:3]
    ds_read_b64_tr_b16 a[128:129], v56 offset:8192
    s_bitcmp1_b32 s75, s74
    s_cbranch_scc1 L_ok3
    s_mov_b32 s35, 0
L_sp3:
    buffer_load_dword v7, v26, s[48:51], s34 offen sc1
    s_waitcnt vmcnt(0)
    v_cmp_eq_u32 vcc, s62, v7
    s_add_u32 s35, s35, 1
    s_nop 2
    s_mov_b32 s75, vcc_lo
    s_bitcmp1_b32 s75, s74
    s_cbranch_scc1 L_ok3
    s_sleep 2
    s_cmp_lt_u32 s35, 0x40000
    s_cbranch_scc1 L_sp3
L_ok3:
    s_add_u32 s74, s74, 1
    s_cmp_eq_u32 s74, s73
    s_cselect_b32 s74, s72, s74
    v_mfma_f32_16x16x32_bf16 a[4:7], a[156:159], v[100:103], a[4:7]
    buffer_load_dwordx4 v[64:67], v44, s[12:15], s28 offen offset:0 sc1
    v_mfma_f32_16x16x32_bf16 a[8:11], a[156:159], v[104:107], a[8:11]
    ds_read_b64_tr_b16 a[130:131], v56 offset:10240
    v_mfma_f32_16x16x32_bf16 a[12:15], a[156:159], v[108:111], a[12:15]
    v_mfma_f32_16x16x32_bf16 a[16:19], a[156:159], v[112:115], a[16:19]
    ds_read_b64_tr_b16 a[160:161], v57 offset:8192
    buffer_load_dwordx4 v[68:71], v44, s[12:15], s28 offen offset:2048 sc1
    v_mfma_f32_16x16x32_bf16 a[20:23], a[156:159], v[116:119], a[20:23]
    v_mfma_f32_16x16x32_bf16 a[24:27], a[156:159], v[120:123], a[24:27]
    ds_read_b64_tr_b16 a[162:163], v57 offset:10240
    v_mfma_f32_16x16x32_bf16 a[28:31], a[156:159], v[124:127], a[28:31]
    v_mfma_f32_16x16x32_bf16 a[32:35], a[188:191], v[96:99], a[32:35]
    ds_read_b64_tr_b16 a[192:193], v58 offset:8192
    buffer_load_dwordx4 v[72:75], v45, s[12:15], s28 offen offset:0 sc1
    v_mfma_f32_16x16x32_bf16 a[36:39], a[188:191], v[100:103], a[36:39]
    v_mfma_f32_16x16x32_bf16 a[40:43], a[188:191], v[104:107], a[40:43]
    ds_read_b64_tr_b16 a[194:195], v58 offset:10240
    v_mfma_f32_16x16x32_bf16 a[44:47], a[188:191], v[108:111], a[44:47]
    v_mfma_f32_16x16x32_bf16 a[48:51], a[188:191], v[112:115], a[48:51]
    ds_read_b64_tr_b16 a[224:225], v59 offset:8192
    buffer_load_dwordx4 v[76:79], v45, s[12:15], s28 offen offset:2048 sc1
    v_mfma_f32_16x16x32_bf16 a[52:55], a[188:191], v[116:119], a[52:55]
    v_mfma_f32_16x16x32_bf16 a[56:59], a[188:191], v[120:123], a[56:59]
    ds_read_b64_tr_b16 a[226:227], v59 offset:10240
    v_mfma_f32_16x16x32_bf16 a[60:63], a[188:191], v[124:127], a[60:63]
    v_mfma_f32_16x16x32_bf16 a[64:67], a[220:223], v[96:99], a[64:67]
    buffer_load_dwordx4 v[80:83], v46, s[12:15], s28 offen offset:0 sc1
    v_mfma_f32_16x16x32_bf16 a[68:71], a[220:223], v[100:103], a[68:71]
    v_mfma_f32_16x16x32_bf16 a[72:75], a[220:223], v[104:107], a[72:75]
    v_mfma_f32_16x16x32_bf16 a[76:79], a[220:223], v[108:111], a[76:79]
    buffer_load_dwordx4 v[84:87], v46, s[12:15], s28 offen offset:2048 sc1
    v_mfma_f32_16x16x32_bf16 a[80:83], a[220:223], v[112:115], a[80:83]
    v_mfma_f32_16x16x32_bf16 a[84:87], a[220:223], v[116:119], a[84:87]
    v_mfma_f32_16x16x32_bf16 a[88:91], a[220:223], v[120:123], a[88:91]
    v_mfma_f32_16x16x32_bf16 a[92:95], a[220:223], v[124:127], a[92:95]
    buffer_load_dwordx4 v[88:91], v47, s[12:15], s28 offen offset:0 sc1
    v_mfma_f32_16x16x32_bf16 a[96:99], a[252:255], v[96:99], a[96:99]
    v_mfma_f32_16x16x32_bf16 a[100:103], a[252:255], v[100:103], a[100:103]
    v_mfma_f32_16x16x32_bf16 a[104:107], a[252:255], v[104:107], a[104:107]
    v_mfma_f32_16x16x32_bf16 a[108:111], a[252:255], v[108:111], a[108:111]
    buffer_load_dwordx4 v[92:95], v47, s[12:15], s28 offen offset:2048 sc1
    v_mfma_f32_16x16x32_bf16 a[112:115], a[252:255], v[112:115], a[112:115]
    v_mfma_f32_16x16x32_bf16 a[116:119], a[252:255], v[116:119], a[116:119]
    v_mfma_f32_16x16x32_bf16 a[120:123], a[252:255], v[120:123], a[120:123]
    v_mfma_f32_16x16x32_bf16 a[124:127], a[252:255], v[124:127], a[124:127]
    s_waitcnt lgkmcnt(0) vmcnt(32)
    v_mfma_f32_16x16x32_bf16 a[0:3], a[128:131], v[128:131], a[0:3]
    ds_read_b64_tr_b16 a[132:133], v56 offset:12288
    v_mfma_f32_16x16x32_bf16 a[4:7], a[128:131], v[132:135], a[4:7]
    buffer_load_dwordx4 v[96:99], v44, s[12:15], s28 offen offset:1024 sc1
    v_mfma_f32_16x16x32_bf16 a[8:11], a[128:131], v[136:139], a[8:11]
    ds_read_b64_tr_b16 a[134:135], v56 offset:14336
    v_mfma_f32_16x16x32_bf16 a[12:15], a[128:131], v[140:143], a[12:15]
    buffer_load_dwordx4 v[100:103], v44, s[12:15], s28 offen offset:3072 sc1
    v_mfma_f32_16x16x32_bf16 a[16:19], a[128:131], v[144:147], a[16:19]
    ds_read_b64_tr_b16 a[164:165], v57 offset:12288
    v_mfma_f32_16x16x32_bf16 a[20:23], a[128:131], v[148:151], a[20:23]
    v_mfma_f32_16x16x32_bf16 a[24:27], a[128:131], v[152:155], a[24:27]
    ds_read_b64_tr_b16 a[166:167], v57 offset:14336
    buffer_load_dwordx4 v[104:107], v45, s[12:15], s28 offen offset:1024 sc1
    v_mfma_f32_16x16x32_bf16 a[28:31], a[128:131], v[156:159], a[28:31]
    v_mfma_f32_16x16x32_bf16 a[32:35], a[160:163], v[128:131], a[32:35]
    ds_read_b64_tr_b16 a[196:197], v58 offset:12288
    buffer_load_dwordx4 v[108:111], v45, s[12:15], s28 offen offset:3072 sc1
    v_mfma_f32_16x16x32_bf16 a[36:39], a[160:163], v[132:135], a[36:39]
    v_mfma_f32_16x16x32_bf16 a[40:43], a[160:163], v[136:139], a[40:43]
    ds_read_b64_tr_b16 a[198:199], v58 offset:14336
    v_mfma_f32_16x16x32_bf16 a[44:47], a[160:163], v[140:143], a[44:47]
    buffer_load_dwordx4 v[112:115], v46, s[12:15], s28 offen offset:1024 sc1
    v_mfma_f32_16x16x32_bf16 a[48:51], a[160:163], v[144:147], a[48:51]
    ds_read_b64_tr_b16 a[228:229], v59 offset:12288
    v_mfma_f32_16x16x32_bf16 a[52:55], a[160:163], v[148:151], a[52:55]
    buffer_load_dwordx4 v[116:119], v46, s[12:15], s28 offen offset:3072 sc1
    v_mfma_f32_16x16x32_bf16 a[56:59], a[160:163], v[152:155], a[56:59]
    ds_read_b64_tr_b16 a[230:231], v59 offset:14336
    v_mfma_f32_16x16x32_bf16 a[60:63], a[160:163], v[156:159], a[60:63]
    v_mfma_f32_16x16x32_bf16 a[64:67], a[192:195], v[128:131], a[64:67]
    buffer_load_dwordx4 v[120:123], v47, s[12:15], s28 offen offset:1024 sc1
    v_mfma_f32_16x16x32_bf16 a[68:71], a[192:195], v[132:135], a[68:71]
    v_mfma_f32_16x16x32_bf16 a[72:75], a[192:195], v[136:139], a[72:75]
    buffer_load_dwordx4 v[124:127], v47, s[12:15], s28 offen offset:3072 sc1
    v_mfma_f32_16x16x32_bf16 a[76:79], a[192:195], v[140:143], a[76:79]
    s_add_u32 s28, s28, 16384
    s_cmp_eq_u32 s28, s30
    s_cselect_b32 s28, s29, s28
    v_mfma_f32_16x16x32_bf16 a[80:83], a[192:195], v[144:147], a[80:83]
    s_add_u32 m0, s70, 8192
    v_mfma_f32_16x16x32_bf16 a[84:87], a[192:195], v[148:151], a[84:87]
    buffer_load_dwordx4 v40, s[40:43], s54 offen offset:0 lds
    v_mfma_f32_16x16x32_bf16 a[88:91], a[192:195], v[152:155], a[88:91]
    v_mfma_f32_16x16x32_bf16 a[92:95], a[192:195], v[156:159], a[92:95]
    buffer_load_dwordx4 v41, s[40:43], s54 offen offset:1024 lds
    v_mfma_f32_16x16x32_bf16 a[96:99], a[224:227], v[128:131], a[96:99]
    v_mfma_f32_16x16x32_bf16 a[100:103], a[224:227], v[132:135], a[100:103]
    v_mfma_f32_16x16x32_bf16 a[104:107], a[224:227], v[136:139], a[104:107]
    buffer_load_dwordx4 v42, s[40:43], s54 offen offset:2048 lds
    v_mfma_f32_16x16x32_bf16 a[108:111], a[224:227], v[140:143], a[108:111]
    v_mfma_f32_16x16x32_bf16 a[112:115], a[224:227], v[144:147], a[112:115]
    buffer_load_dwordx4 v43, s[40:43], s54 offen offset:3072 lds
    v_mfma_f32_16x16x32_bf16 a[116:119], a[224:227], v[148:151], a[116:119]
    v_mfma_f32_16x16x32_bf16 a[120:123], a[224:227], v[152:155], a[120:123]
    v_mfma_f32_16x16x32_bf16 a[124:127], a[224:227], v[156:159], a[124:127]
    s_waitcnt lgkmcnt(0) vmcnt(36)
    v_mfma_f32_16x16x32_bf16 a[0:3], a[132:135], v[160:163], a[0:3]
    ds_read_b64_tr_b16 a[128:129], v48 offset:0
    v_mfma_f32_16x16x32_bf16 a[4:7], a[132:135], v[164:167], a[4:7]
    buffer_load_dwordx4 v[128:131], v44, s[12:15], s28 offen offset:0 sc1
    v_mfma_f32_16x16x32_bf16 a[8:11], a[132:135], v[168:171], a[8:11]
    ds_read_b64_tr_b16 a[130:131], v48 offset:2048
    v_mfma_f32_16x16x32_bf16 a[12:15], a[132:135], v[172:175], a[12:15]
    buffer_load_dwordx4 v[132:135], v44, s[12:15], s28 offen offset:2048 sc1
    v_mfma_f32_16x16x32_bf16 a[16:19], a[132:135], v[176:179], a[16:19]
    ds_read_b64_tr_b16 a[160:161], v49 offset:0
    v_mfma_f32_16x16x32_bf16 a[20:23], a[132:135], v[180:183], a[20:23]
    v_mfma_f32_16x16x32_bf16 a[24:27], a[132:135], v[184:187], a[24:27]
    ds_read_b64_tr_b16 a[162:163], v49 offset:2048
    buffer_load_dwordx4 v[136:139], v45, s[12:15], s28 offen offset:0 sc1
    v_mfma_f32_16x16x32_bf16 a[28:31], a[132:135], v[188:191], a[28:31]
    v_mfma_f32_16x16x32_bf16 a[32:35], a[164:167], v[160:163], a[32:35]
    ds_read_b64_tr_b16 a[192:193], v50 offset:0
    buffer_load_dwordx4 v[140:143], v45, s[12:15], s28 offen offset:2048 sc1
    v_mfma_f32_16x16x32_bf16 a[36:39], a[164:167], v[164:167], a[36:39]
    v_mfma_f32_16x16x32_bf16 a[40:43], a[164:167], v[168:171], a[40:43]
    ds_read_b64_tr_b16 a[194:195], v50 offset:2048
    v_mfma_f32_16x16x32_bf16 a[44:47], a[164:167], v[172:175], a[44:47]
    buffer_load_dwordx4 v[144:147], v46, s[12:15], s28 offen offset:0 sc1
    v_mfma_f32_16x16x32_bf16 a[48:51], a[164:167], v[176:179], a[48:51]
    ds_read_b64_tr_b16 a[224:225], v51 offset:0
    v_mfma_f32_16x16x32_bf16 a[52:55], a[164:167], v[180:183], a[52:55]
    buffer_load_dwordx4 v[148:151], v46, s[12:15], s28 offen offset:2048 sc1
    v_mfma_f32_16x16x32_bf16 a[56:59], a[164:167], v[184:187], a[56:59]
    ds_read_b64_tr_b16 a[226:227], v51 offset:2048
    v_mfma_f32_16x16x32_bf16 a[60:63], a[164:167], v[188:191], a[60:63]
    v_mfma_f32_16x16x32_bf16 a[64:67], a[196:199], v[160:163], a[64:67]
    buffer_load_dwordx4 v[152:155], v47, s[12:15], s28 offen offset:0 sc1
    v_mfma_f32_16x16x32_bf16 a[68:71], a[196:199], v[164:167], a[68:71]
    v_mfma_f32_16x16x32_bf16 a[72:75], a[196:199], v[168:171], a[72:75]
    buffer_load_dwordx4 v[156:159], v47, s[12:15], s28 offen offset:2048 sc1
    v_mfma_f32_16x16x32_bf16 a[76:79], a[196:199], v[172:175], a[76:79]
    v_mfma_f32_16x16x32_bf16 a[80:83], a[196:199], v[176:179], a[80:83]
    s_add_u32 m0, s70, 12288
    v_mfma_f32_16x16x32_bf16 a[84:87], a[196:199], v[180:183], a[84:87]
    buffer_load_dwordx4 v40, s[40:43], s55 offen offset:0 lds
    v_mfma_f32_16x16x32_bf16 a[88:91], a[196:199], v[184:187], a[88:91]
    v_mfma_f32_16x16x32_bf16 a[92:95], a[196:199], v[188:191], a[92:95]
    buffer_load_dwordx4 v41, s[40:43], s55 offen offset:1024 lds
    v_mfma_f32_16x16x32_bf16 a[96:99], a[228:231], v[160:163], a[96:99]
    v_mfma_f32_16x16x32_bf16 a[100:103], a[228:231], v[164:167], a[100:103]
    v_mfma_f32_16x16x32_bf16 a[104:107], a[228:231], v[168:171], a[104:107]
    buffer_load_dwordx4 v42, s[40:43], s55 offen offset:2048 lds
    v_mfma_f32_16x16x32_bf16 a[108:111], a[228:231], v[172:175], a[108:111]
    v_mfma_f32_16x16x32_bf16 a[112:115], a[228:231], v[176:179], a[112:115]
    buffer_load_dwordx4 v43, s[40:43], s55 offen offset:3072 lds
    v_mfma_f32_16x16x32_bf16 a[116:119], a[228:231], v[180:183], a[116:119]
    v_mfma_f32_16x16x32_bf16 a[120:123], a[228:231], v[184:187], a[120:123]
    v_mfma_f32_16x16x32_bf16 a[124:127], a[228:231], v[188:191], a[124:127]
    s_add_u32 s54, s54, 131072
    s_cmp_eq_u32 s54, s101
    s_cselect_b32 s54, s100, s54
    s_add_u32 s55, s54, 65536
    s_waitcnt lgkmcnt(0) vmcnt(40)
    v_mfma_f32_16x16x32_bf16 a[0:3], a[128:131], v[192:195], a[0:3]
    ds_read_b64_tr_b16 a[132:133], v48 offset:4096
    v_mfma_f32_16x16x32_bf16 a[4:7], a[128:131], v[196:199], a[4:7]
    buffer_load_dwordx4 v[160:163], v44, s[12:15], s28 offen offset:1024 sc1
    v_mfma_f32_16x16x32_bf16 a[8:11], a[128:131], v[200:203], a[8:11]
    ds_read_b64_tr_b16 a[134:135], v48 offset:6144
    v_mfma_f32_16x16x32_bf16 a[12:15], a[128:131], v[204:207], a[12:15]
    buffer_load_dwordx4 v[164:167], v44, s[12:15], s28 offen offset:3072 sc1
    v_mfma_f32_16x16x32_bf16 a[16:19], a[128:131], v[208:211], a[16:19]
    ds_read_b64_tr_b16 a[164:165], v49 offset:4096
    v_mfma_f32_16x16x32_bf16 a[20:23], a[128:131], v[212:215], a[20:23]
    v_mfma_f32_16x16x32_bf16 a[24:27], a[128:131], v[216:219], a[24:27]
    ds_read_b64_tr_b16 a[166:167], v49 offset:6144
    buffer_load_dwordx4 v[168:171], v45, s[12:15], s28 offen offset:1024 sc1
    v_mfma_f32_16x16x32_bf16 a[28:31], a[128:131], v[220:223], a[28:31]
    v_mfma_f32_16x16x32_bf16 a[32:35], a[160:163], v[192:195], a[32:35]
    ds_read_b64_tr_b16 a[196:197], v50 offset:4096
    buffer_load_dwordx4 v[172:175], v45, s[12:15], s28 offen offset:3072 sc1
    v_mfma_f32_16x16x32_bf16 a[36:39], a[160:163], v[196:199], a[36:39]
    v_mfma_f32_16x16x32_bf16 a[40:43], a[160:163], v[200:203], a[40:43]
    ds_read_b64_tr_b16 a[198:199], v50 offset:6144
    v_mfma_f32_16x16x32_bf16 a[44:47], a[160:163], v[204:207], a[44:47]
    buffer_load_dwordx4 v[176:179], v46, s[12:15], s28 offen offset:1024 sc1
    v_mfma_f32_16x16x32_bf16 a[48:51], a[160:163], v[208:211], a[48:51]
    ds_read_b64_tr_b16 a[228:229], v51 offset:4096
    v_mfma_f32_16x16x32_bf16 a[52:55], a[160:163], v[212:215], a[52:55]
    buffer_load_dwordx4 v[180:183], v46, s[12:15], s28 offen offset:3072 sc1
    v_mfma_f32_16x16x32_bf16 a[56:59], a[160:163], v[216:219], a[56:59]
    ds_read_b64_tr_b16 a[230:231], v51 offset:6144
    v_mfma_f32_16x16x32_bf16 a[60:63], a[160:163], v[220:223], a[60:63]
    v_mfma_f32_16x16x32_bf16 a[64:67], a[192:195], v[192:195], a[64:67]
    buffer_load_dwordx4 v[184:187], v47, s[12:15], s28 offen offset:1024 sc1
    v_mfma_f32_16x16x32_bf16 a[68:71], a[192:195], v[196:199], a[68:71]
    v_mfma_f32_16x16x32_bf16 a[72:75], a[192:195], v[200:203], a[72:75]
    buffer_load_dwordx4 v[188:191], v47, s[12:15], s28 offen offset:3072 sc1
    v_mfma_f32_16x16x32_bf16 a[76:79], a[192:195], v[204:207], a[76:79]
    s_add_u32 s28, s28, 16384
    s_cmp_eq_u32 s28, s30
    s_cselect_b32 s28, s29, s28
    v_mfma_f32_16x16x32_bf16 a[80:83], a[192:195], v[208:211], a[80:83]
    s_add_u32 m0, s68, 0
    v_mfma_f32_16x16x32_bf16 a[84:87], a[192:195], v[212:215], a[84:87]
    buffer_load_dwordx4 v40, s[40:43], s54 offen offset:0 lds
    v_mfma_f32_16x16x32_bf16 a[88:91], a[192:195], v[216:219], a[88:91]
    v_mfma_f32_16x16x32_bf16 a[92:95], a[192:195], v[220:223], a[92:95]
    buffer_load_dwordx4 v41, s[40:43], s54 offen offset:1024 lds
    v_mfma_f32_16x16x32_bf16 a[96:99], a[224:227], v[192:195], a[96:99]
    v_mfma_f32_16x16x32_bf16 a[100:103], a[224:227], v[196:199], a[100:103]
    v_mfma_f32_16x16x32_bf16 a[104:107], a[224:227], v[200:203], a[104:107]
    buffer_load_dwordx4 v42, s[40:43], s54 offen offset:2048 lds
    v_mfma_f32_16x16x32_bf16 a[108:111], a[224:227], v[204:207], a[108:111]
    v_mfma_f32_16x16x32_bf16 a[112:115], a[224:227], v[208:211], a[112:115]
    buffer_load_dwordx4 v43, s[40:43], s54 offen offset:3072 lds
    v_mfma_f32_16x16x32_bf16 a[116:119], a[224:227], v[212:215], a[116:119]
    v_mfma_f32_16x16x32_bf16 a[120:123], a[224:227], v[216:219], a[120:123]
    v_mfma_f32_16x16x32_bf16 a[124:127], a[224:227], v[220:223], a[124:127]
    s_waitcnt lgkmcnt(0) vmcnt(44)
    v_mfma_f32_16x16x32_bf16 a[0:3], a[132:135], v[224:227], a[0:3]
    ds_read_b64_tr_b16 a[128:129], v48 offset:8192
    s_bitcmp1_b32 s75, s74
    s_cbranch_scc1 L_ok4
    s_mov_b32 s35, 0
L_sp4:
    buffer_load_dword v7, v26, s[48:51], s34 offen sc1
    s_waitcnt vmcnt(0)
    v_cmp_eq_u32 vcc, s62, v7
    s_add_u32 s35, s35, 1
    s_nop 2
    s_mov_b32 s75, vcc_lo
    s_bitcmp1_b32 s75, s74
    s_cbranch_scc1 L_ok4
    s_sleep 2
    s_cmp_lt_u32 s35, 0x40000
    s_cbranch_scc1 L_sp4
L_ok4:
    s_add_u32 s74, s74, 1
    s_cmp_eq_u32 s74, s73
    s_cselect_b32 s74, s72, s74
    v_mfma_f32_16x16x32_bf16 a[4:7], a[132:135], v[228:231], a[4:7]
    buffer_load_dwordx4 v[192:195], v44, s[12:15], s28 offen offset:0 sc1
    v_mfma_f32_16x16x32_bf16 a[8:11], a[132:135], v[232:235], a[8:11]
    ds_read_b64_tr_b16 a[130:131], v48 offset:10240
    v_mfma_f32_16x16x32_bf16 a[12:15], a[132:135], v[236:239], a[12:15]
    buffer_load_dwordx4 v[196:199], v44, s[12:15], s28 offen offset:2048 sc1
    v_mfma_f32_16x16x32_bf16 a[16:19], a[132:135], v[240:243], a[16:19]
    ds_read_b64_tr_b16 a[160:161], v49 offset:8192
    v_mfma_f32_16x16x32_bf16 a[20:23], a[132:135], v[244:247], a[20:23]
    v_mfma_f32_16x16x32_bf16 a[24:27], a[132:135], v[248:251], a[24:27]
    ds_read_b64_tr_b16 a[162:163], v49 offset:10240
    buffer_load_dwordx4 v[200:203], v45, s[12:15], s28 offen offset:0 sc1
    v_mfma_f32_16x16x32_bf16 a[28:31], a[132:135], v[252:255], a[28:31]
    v_mfma_f32_16x16x32_bf16 a[32:35], a[164:167], v[224:227], a[32:35]
    ds_read_b64_tr_b16 a[192:193], v50 offset:8192
    buffer_load_dwordx4 v[204:207], v45, s[12:15], s28 offen offset:2048 sc1
    v_mfma_f32_16x16x32_bf16 a[36:39], a[164:167], v[228:231], a[36:39]
    v_mfma_f32_16x16x32_bf16 a[40:43], a[164:167], v[232:235], a[40:43]
    ds_read_b64_tr_b16 a[194:195], v50 offset:10240
    v_mfma_f32_16x16x32_bf16 a[44:47], a[164:167], v[236:239], a[44:47]
    buffer_load_dwordx4 v[208:211], v46, s[12:15], s28 offen offset:0 sc1
    v_mfma_f32_16x16x32_bf16 a[48:51], a[164:167], v[240:243], a[48:51]
    ds_read_b64_tr_b16 a[224:225], v51 offset:8192
    v_mfma_f32_16x16x32_bf16 a[52:55], a[164:167], v[244:247], a[52:55]
    buffer_load_dwordx4 v[212:215], v46, s[12:15], s28 offen offset:2048 sc1
    v_mfma_f32_16x16x32_bf16 a[56:59], a[164:167], v[248:251], a[56:59]
    ds_read_b64_tr_b16 a[226:227], v51 offset:10240
    v_mfma_f32_16x16x32_bf16 a[60:63], a[164:167], v[252:255], a[60:63]
    v_mfma_f32_16x16x32_bf16 a[64:67], a[196:199], v[224:227], a[64:67]
    buffer_load_dwordx4 v[216:219], v47, s[12:15], s28 offen offset:0 sc1
    v_mfma_f32_16x16x32_bf16 a[68:71], a[196:199], v[228:231], a[68:71]
    v_mfma_f32_16x16x32_bf16 a[72:75], a[196:199], v[232:235], a[72:75]
    buffer_load_dwordx4 v[220:223], v47, s[12:15], s28 offen offset:2048 sc1
    v_mfma_f32_16x16x32_bf16 a[76:79], a[196:199], v[236:239], a[76:79]
    v_mfma_f32_16x16x32_bf16 a[80:83], a[196:199], v[240:243], a[80:83]
    s_add_u32 m0, s68, 4096
    v_mfma_f32_16x16x32_bf16 a[84:87], a[196:199], v[244:247], a[84:87]
    buffer_load_dwordx4 v40, s[40:43], s55 offen offset:0 lds
    v_mfma_f32_16x16x32_bf16 a[88:91], a[196:199], v[248:251], a[88:91]
    v_mfma_f32_16x16x32_bf16 a[92:95], a[196:199], v[252:255], a[92:95]
    buffer_load_dwordx4 v41, s[40:43], s55 offen offset:1024 lds
    v_mfma_f32_16x16x32_bf16 a[96:99], a[228:231], v[224:227], a[96:99]
    v_mfma_f32_16x16x32_bf16 a[100:103], a[228:231], v[228:231], a[100:103]
    v_mfma_f32_16x16x32_bf16 a[104:107], a[228:231], v[232:235], a[104:107]
    buffer_load_dwordx4 v42, s[40:43], s55 offen offset:2048 lds
    v_mfma_f32_16x16x32_bf16 a[108:111], a[228:231], v[236:239], a[108:111]
    v_mfma_f32_16x16x32_bf16 a[112:115], a[228:231], v[240:243], a[112:115]
    buffer_load_dwordx4 v43, s[40:43], s55 offen offset:3072 lds
    v_mfma_f32_16x16x32_bf16 a[116:119], a[228:231], v[244:247], a[116:119]
    v_mfma_f32_16x16x32_bf16 a[120:123], a[228:231], v[248:251], a[120:123]
    v_mfma_f32_16x16x32_bf16 a[124:127], a[228:231], v[252:255], a[124:127]
    s_add_u32 s54, s54, 131072
    s_cmp_eq_u32 s54, s101
    s_cselect_b32 s54, s100, s54
    s_add_u32 s55, s54, 65536
    s_waitcnt lgkmcnt(0) vmcnt(48)
    v_mfma_f32_16x16x32_bf16 a[0:3], a[128:131], v[64:67], a[0:3]
    ds_read_b64_tr_b16 a[132:133], v48 offset:12288
    v_mfma_f32_16x16x32_bf16 a[4:7], a[128:131], v[68:71], a[4:7]
    buffer_load_dwordx4 v[224:227], v44, s[12:15], s28 offen offset:1024 sc1
    v_mfma_f32_16x16x32_bf16 a[8:11], a[128:131], v[72:75], a[8:11]
    ds_read_b64_tr_b16 a[134:135], v48 offset:14336
    v_mfma_f32_16x16x32_bf16 a[12:15], a[128:131], v[76:79], a[12:15]
    buffer_load_dwordx4 v[228:231], v44, s[12:15], s28 offen offset:3072 sc1
    v_mfma_f32_16x16x32_bf16 a[16:19], a[128:131], v[80:83], a[16:19]
    ds_read_b64_tr_b16 a[164:165], v49 offset:12288
    v_mfma_f32_16x16x32_bf16 a[20:23], a[128:131], v[84:87], a[20:23]
    v_mfma_f32_16x16x32_bf16 a[24:27], a[128:131], v[88:91], a[24:27]
    ds_read_b64_tr_b16 a[166:167], v49 offset:14336
    buffer_load_dwordx4 v[232:235], v45, s[12:15], s28 offen offset:1024 sc1
    v_mfma_f32_16x16x32_bf16 a[28:31], a[128:131], v[92:95], a[28:31]
    v_mfma_f32_16x16x32_bf16 a[32:35], a[160:163], v[64:67], a[32:35]
    ds_read_b64_tr_b16 a[196:197], v50 offset:12288
    buffer_load_dwordx4 v[236:239], v45, s[12:15], s28 offen offset:3072 sc1
    v_mfma_f32_16x16x32_bf16 a[36:39], a[160:163], v[68:71], a[36:39]
    v_mfma_f32_16x16x32_bf16 a[40:43], a[160:163], v[72:75], a[40:43]
    ds_read_b64_tr_b16 a[198:199], v50 offset:14336
    v_mfma_f32_16x16x32_bf16 a[44:47], a[160:163], v[76:79], a[44:47]
    buffer_load_dwordx4 v[240:243], v46, s[12:15], s28 offen offset:1024 sc1
    v_mfma_f32_16x16x32_bf16 a[48:51], a[160:163], v[80:83], a[48:51]
    ds_read_b64_tr_b16 a[228:229], v51 offset:12288
    v_mfma_f32_16x16x32_bf16 a[52:55], a[160:163], v[84:87], a[52:55]
    buffer_load_dwordx4 v[244:247], v46, s[12:15], s28 offen offset:3072 sc1
    v_mfma_f32_16x16x32_bf16 a[56:59], a[160:163], v[88:91], a[56:59]
    ds_read_b64_tr_b16 a[230:231], v51 offset:14336
    v_mfma_f32_16x16x32_bf16 a[60:63], a[160:163], v[92:95], a[60:63]
    v_mfma_f32_16x16x32_bf16 a[64:67], a[192:195], v[64:67], a[64:67]
    buffer_load_dwordx4 v[248:251], v47, s[12:15], s28 offen offset:1024 sc1
    v_mfma_f32_16x16x32_bf16 a[68:71], a[192:195], v[68:71], a[68:71]
    v_mfma_f32_16x16x32_bf16 a[72:75], a[192:195], v[72:75], a[72:75]
    buffer_load_dwordx4 v[252:255], v47, s[12:15], s28 offen offset:3072 sc1
    v_mfma_f32_16x16x32_bf16 a[76:79], a[192:195], v[76:79], a[76:79]
    s_add_u32 s28, s28, 16384
    s_cmp_eq_u32 s28, s30
    s_cselect_b32 s28, s29, s28
    v_mfma_f32_16x16x32_bf16 a[80:83], a[192:195], v[80:83], a[80:83]
    s_add_u32 m0, s68, 8192
    v_mfma_f32_16x16x32_bf16 a[84:87], a[192:195], v[84:87], a[84:87]
    buffer_load_dwordx4 v40, s[40:43], s54 offen offset:0 lds
    v_mfma_f32_16x16x32_bf16 a[88:91], a[192:195], v[88:91], a[88:91]
    v_mfma_f32_16x16x32_bf16 a[92:95], a[192:195], v[92:95], a[92:95]
    buffer_load_dwordx4 v41, s[40:43], s54 offen offset:1024 lds
    v_mfma_f32_16x16x32_bf16 a[96:99], a[224:227], v[64:67], a[96:99]
    v_mfma_f32_16x16x32_bf16 a[100:103], a[224:227], v[68:71], a[100:103]
    v_mfma_f32_16x16x32_bf16 a[104:107], a[224:227], v[72:75], a[104:107]
    buffer_load_dwordx4 v42, s[40:43], s54 offen offset:2048 lds
    v_mfma_f32_16x16x32_bf16 a[108:111], a[224:227], v[76:79], a[108:111]
    v_mfma_f32_16x16x32_bf16 a[112:115], a[224:227], v[80:83], a[112:115]
    buffer_load_dwordx4 v43, s[40:43], s54 offen offset:3072 lds
    v_mfma_f32_16x16x32_bf16 a[116:119], a[224:227], v[84:87], a[116:119]
    v_mfma_f32_16x16x32_bf16 a[120:123], a[224:227], v[88:91], a[120:123]
    v_mfma_f32_16x16x32_bf16 a[124:127], a[224:227], v[92:95], a[124:127]
    s_waitcnt lgkmcnt(0) vmcnt(52)
    v_mfma_f32_16x16x32_bf16 a[0:3], a[132:135], v[96:99], a[0:3]
    ds_read_b64_tr_b16 a[128:129], v52 offset:0
    v_mfma_f32_16x16x32_bf16 a[4:7], a[132:135], v[100:103], a[4:7]
    buffer_load_dwordx4 v[64:67], v44, s[12:15], s28 offen offset:0 sc1
    v_mfma_f32_16x16x32_bf16 a[8:11], a[132:135], v[104:107], a[8:11]
    ds_read_b64_tr_b16 a[130:131], v52 offset:2048
    v_mfma_f32_16x16x32_bf16 a[12:15], a[132:135], v[108:111], a[12:15]
    buffer_load_dwordx4 v[68:71], v44, s[12:15], s28 offen offset:2048 sc1
    v_mfma_f32_16x16x32_bf16 a[16:19], a[132:135], v[112:115], a[16:19]
    ds_read_b64_tr_b16 a[160:161], v53 offset:0
    v_mfma_f32_16x16x32_bf16 a[20:23], a[132:135], v[116:119], a[20:23]
    v_mfma_f32_16x16x32_bf16 a[24:27], a[132:135], v[120:123], a[24:27]
    ds_read_b64_tr_b16 a[162:163], v53 offset:2048
    buffer_load_dwordx4 v[72:75], v45, s[12:15], s28 offen offset:0 sc1
    v_mfma_f32_16x16x32_bf16 a[28:31], a[132:135], v[124:127], a[28:31]
    v_mfma_f32_16x16x32_bf16 a[32:35], a[164:167], v[96:99], a[32:35]
    ds_read_b64_tr_b16 a[192:193], v54 offset:0
    buffer_load_dwordx4 v[76:79], v45, s[12:15], s28 offen offset:2048 sc1
    v_mfma_f32_16x16x32_bf16 a[36:39], a[164:167], v[100:103], a[36:39]
    v_mfma_f32_16x16x32_bf16 a[40:43], a[164:167], v[104:107], a[40:43]
    ds_read_b64_tr_b16 a[194:195], v54 offset:2048
    v_mfma_f32_16x16x32_bf16 a[44:47], a[164:167], v[108:111], a[44:47]
    buffer_load_dwordx4 v[80:83], v46, s[12:15], s28 offen offset:0 sc1
    v_mfma_f32_16x16x32_bf16 a[48:51], a[164:167], v[112:115], a[48:51]
    ds_read_b64_tr_b16 a[224:225], v55 offset:0
    v_mfma_f32_16x16x32_bf16 a[52:55], a[164:167], v[116:119], a[52:55]
    buffer_load_dwordx4 v[84:87], v46, s[12:15], s28 offen offset:2048 sc1
    v_mfma_f32_16x16x32_bf16 a[56:59], a[164:167], v[120:123], a[56:59]
    ds_read_b64_tr_b16 a[226:227], v55 offset:2048
    v_mfma_f32_16x16x32_bf16 a[60:63], a[164:167], v[124:127], a[60:63]
    v_mfma_f32_16x16x32_bf16 a[64:67], a[196:199], v[96:99], a[64:67]
    buffer_load_dwordx4 v[88:91], v47, s[12:15], s28 offen offset:0 sc1
    v_mfma_f32_16x16x32_bf16 a[68:71], a[196:199], v[100:103], a[68:71]
    v_mfma_f32_16x16x32_bf16 a[72:75], a[196:199], v[104:107], a[72:75]
    buffer_load_dwordx4 v[92:95], v47, s[12:15], s28 offen offset:2048 sc1
    v_mfma_f32_16x16x32_bf16 a[76:79], a[196:199], v[108:111], a[76:79]
    v_mfma_f32_16x16x32_bf16 a[80:83], a[196:199], v[112:115], a[80:83]
    s_add_u32 m0, s68, 12288
    v_mfma_f32_16x16x32_bf16 a[84:87], a[196:199], v[116:119], a[84:87]
    buffer_load_dwordx4 v40, s[40:43], s55 offen offset:0 lds
    v_mfma_f32_16x16x32_bf16 a[88:91], a[196:199], v[120:123], a[88:91]
    v_mfma_f32_16x16x32_bf16 a[92:95], a[196:199], v[124:127], a[92:95]
    buffer_load_dwordx4 v41, s[40:43], s55 offen offset:1024 lds
    v_mfma_f32_16x16x32_bf16 a[96:99], a[228:231], v[96:99], a[96:99]
    v_mfma_f32_16x16x32_bf16 a[100:103], a[228:231], v[100:103], a[100:103]
    v_mfma_f32_16x16x32_bf16 a[104:107], a[228:231], v[104:107], a[104:107]
    buffer_load_dwordx4 v42, s[40:43], s55 offen offset:2048 lds
    v_mfma_f32_16x16x32_bf16 a[108:111], a[228:231], v[108:111], a[108:111]
    v_mfma_f32_16x16x32_bf16 a[112:115], a[228:231], v[112:115], a[112:115]
    buffer_load_dwordx4 v43, s[40:43], s55 offen offset:3072 lds
    v_mfma_f32_16x16x32_bf16 a[116:119], a[228:231], v[116:119], a[116:119]
    v_mfma_f32_16x16x32_bf16 a[120:123], a[228:231], v[120:123], a[120:123]
    v_mfma_f32_16x16x32_bf16 a[124:127], a[228:231], v[124:127], a[124:127]
    s_add_u32 s54, s54, 131072
    s_cmp_eq_u32 s54, s101
    s_cselect_b32 s54, s100, s54
    s_add_u32 s55, s54, 65536
    s_waitcnt lgkmcnt(0) vmcnt(52)
    v_mfma_f32_16x16x32_bf16 a[0:3], a[128:131], v[128:131], a[0:3]
    ds_read_b64_tr_b16 a[132:133], v52 offset:4096
    v_mfma_f32_16x16x32_bf16 a[4:7], a[128:131], v[132:135], a[4:7]
    buffer_load_dwordx4 v[96:99], v44, s[12:15], s28 offen offset:1024 sc1
    v_mfma_f32_16x16x32_bf16 a[8:11], a[128:131], v[136:139], a[8:11]
    ds_read_b64_tr_b16 a[134:135], v52 offset:6144
    v_mfma_f32_16x16x32_bf16 a[12:15], a[128:131], v[140:143], a[12:15]
    buffer_load_dwordx4 v[100:103], v44, s[12:15], s28 offen offset:3072 sc1
    v_mfma_f32_16x16x32_bf16 a[16:19], a[128:131], v[144:147], a[16:19]
    ds_read_b64_tr_b16 a[164:165], v53 offset:4096
    v_mfma_f32_16x16x32_bf16 a[20:23], a[128:131], v[148:151], a[20:23]
    v_mfma_f32_16x16x32_bf16 a[24:27], a[128:131], v[152:155], a[24:27]
    ds_read_b64_tr_b16 a[166:167], v53 offset:6144
    buffer_load_dwordx4 v[104:107], v45, s[12:15], s28 offen offset:1024 sc1
    v_mfma_f32_16x16x32_bf16 a[28:31], a[128:131], v[156:159], a[28:31]
    v_mfma_f32_16x16x32_bf16 a[32:35], a[160:163], v[128:131], a[32:35]
    ds_read_b64_tr_b16 a[196:197], v54 offset:4096
    buffer_load_dwordx4 v[108:111], v45, s[12:15], s28 offen offset:3072 sc1
    v_mfma_f32_16x16x32_bf16 a[36:39], a[160:163], v[132:135], a[36:39]
    v_mfma_f32_16x16x32_bf16 a[40:43], a[160:163], v[136:139], a[40:43]
    ds_read_b64_tr_b16 a[198:199], v54 offset:6144
    v_mfma_f32_16x16x32_bf16 a[44:47], a[160:163], v[140:143], a[44:47]
    buffer_load_dwordx4 v[112:115], v46, s[12:15], s28 offen offset:1024 sc1
    v_mfma_f32_16x16x32_bf16 a[48:51], a[160:163], v[144:147], a[48:51]
    ds_read_b64_tr_b16 a[228:229], v55 offset:4096
    v_mfma_f32_16x16x32_bf16 a[52:55], a[160:163], v[148:151], a[52:55]
    buffer_load_dwordx4 v[116:119], v46, s[12:15], s28 offen offset:3072 sc1
    v_mfma_f32_16x16x32_bf16 a[56:59], a[160:163], v[152:155], a[56:59]
    ds_read_b64_tr_b16 a[230:231], v55 offset:6144
    v_mfma_f32_16x16x32_bf16 a[60:63], a[160:163], v[156:159], a[60:63]
    v_mfma_f32_16x16x32_bf16 a[64:67], a[192:195], v[128:131], a[64:67]
    buffer_load_dwordx4 v[120:123], v47, s[12:15], s28 offen offset:1024 sc1
    v_mfma_f32_16x16x32_bf16 a[68:71], a[192:195], v[132:135], a[68:71]
    v_mfma_f32_16x16x32_bf16 a[72:75], a[192:195], v[136:139], a[72:75]
    buffer_load_dwordx4 v[124:127], v47, s[12:15], s28 offen offset:3072 sc1
    v_mfma_f32_16x16x32_bf16 a[76:79], a[192:195], v[140:143], a[76:79]
    s_add_u32 s28, s28, 16384
    s_cmp_eq_u32 s28, s30
    s_cselect_b32 s28, s29, s28
    v_mfma_f32_16x16x32_bf16 a[80:83], a[192:195], v[144:147], a[80:83]
    s_add_u32 m0, s69, 0
    v_mfma_f32_16x16x32_bf16 a[84:87], a[192:195], v[148:151], a[84:87]
    buffer_load_dwordx4 v40, s[40:43], s54 offen offset:0 lds
    v_mfma_f32_16x16x32_bf16 a[88:91], a[192:195], v[152:155], a[88:91]
    v_mfma_f32_16x16x32_bf16 a[92:95], a[192:195], v[156:159], a[92:95]
    buffer_load_dwordx4 v41, s[40:43], s54 offen offset:1024 lds
    v_mfma_f32_16x16x32_bf16 a[96:99], a[224:227], v[128:131], a[96:99]
    v_mfma_f32_16x16x32_bf16 a[100:103], a[224:227], v[132:135], a[100:103]
    v_mfma_f32_16x16x32_bf16 a[104:107], a[224:227], v[136:139], a[104:107]
    buffer_load_dwordx4 v42, s[40:43], s54 offen offset:2048 lds
    v_mfma_f32_16x16x32_bf16 a[108:111], a[224:227], v[140:143], a[108:111]
    v_mfma_f32_16x16x32_bf16 a[112:115], a[224:227], v[144:147], a[112:115]
    buffer_load_dwordx4 v43, s[40:43], s54 offen offset:3072 lds
    v_mfma_f32_16x16x32_bf16 a[116:119], a[224:227], v[148:151], a[116:119]
    v_mfma_f32_16x16x32_bf16 a[120:123], a[224:227], v[152:155], a[120:123]
    v_mfma_f32_16x16x32_bf16 a[124:127], a[224:227], v[156:159], a[124:127]
    s_waitcnt lgkmcnt(0) vmcnt(52)
    v_mfma_f32_16x16x32_bf16 a[0:3], a[132:135], v[160:163], a[0:3]
    ds_read_b64_tr_b16 a[128:129], v56 offset:0
    s_bitcmp1_b32 s75, s74
    s_cbranch_scc1 L_ok5
    s_mov_b32 s35, 0
L_sp5:
    buffer_load_dword v7, v26, s[48:51], s34 offen sc1
    s_waitcnt vmcnt(0)
    v_cmp_eq_u32 vcc, s62, v7
    s_add_u32 s35, s35, 1
    s_nop 2
    s_mov_b32 s75, vcc_lo
    s_bitcmp1_b32 s75, s74
    s_cbranch_scc1 L_ok5
    s_sleep 2
    s_cmp_lt_u32 s35, 0x40000
    s_cbranch_scc1 L_sp5
L_ok5:
    s_add_u32 s74, s74, 1
    s_cmp_eq_u32 s74, s73
    s_cselect_b32 s74, s72, s74
    v_mfma_f32_16x16x32_bf16 a[4:7], a[132:135], v[164:167], a[4:7]
    buffer_load_dwordx4 v[128:131], v44, s[12:15], s28 offen offset:0 sc1
    v_mfma_f32_16x16x32_bf16 a[8:11], a[132:135], v[168:171], a[8:11]
    ds_read_b64_tr_b16 a[130:131], v56 offset:2048
    v_mfma_f32_16x16x32_bf16 a[12:15], a[132:135], v[172:175], a[12:15]
    buffer_load_dwordx4 v[132:135], v44, s[12:15], s28 offen offset:2048 sc1
    v_mfma_f32_16x16x32_bf16 a[16:19], a[132:135], v[176:179], a[16:19]
    ds_read_b64_tr_b16 a[160:161], v57 offset:0
    v_mfma_f32_16x16x32_bf16 a[20:23], a[132:135], v[180:183], a[20:23]
    v_mfma_f32_16x16x32_bf16 a[24:27], a[132:135], v[184:187], a[24:27]
    ds_read_b64_tr_b16 a[162:163], v57 offset:2048
    buffer_load_dwordx4 v[136:139], v45, s[12:15], s28 offen offset:0 sc1
    v_mfma_f32_16x16x32_bf16 a[28:31], a[132:135], v[188:191], a[28:31]
    v_mfma_f32_16x16x32_bf16 a[32:35], a[164:167], v[160:163], a[32:35]
    ds_read_b64_tr_b16 a[192:193], v58 offset:0
    buffer_load_dwordx4 v[140:143], v45, s[12:15], s28 offen offset:2048 sc1
    v_mfma_f32_16x16x32_bf16 a[36:39], a[164:167], v[164:167], a[36:39]
    v_mfma_f32_16x16x32_bf16 a[40:43], a[164:167], v[168:171], a[40:43]
    ds_read_b64_tr_b16 a[194:195], v58 offset:2048
    v_mfma_f32_16x16x32_bf16 a[44:47], a[164:167], v[172:175], a[44:47]
    buffer_load_dwordx4 v[144:147], v46, s[12:15], s28 offen offset:0 sc1
    v_mfma_f32_16x16x32_bf16 a[48:51], a[164:167], v[176:179], a[48:51]
    ds_read_b64_tr_b16 a[224:225], v59 offset:0
    v_mfma_f32_16x16x32_bf16 a[52:55], a[164:167], v[180:183], a[52:55]
    buffer_load_dwordx4 v[148:151], v46, s[12:15], s28 offen offset:2048 sc1
    v_mfma_f32_16x16x32_bf16 a[56:59], a[164:167], v[184:187], a[56:59]
    ds_read_b64_tr_b16 a[226:227], v59 offset:2048
    v_mfma_f32_16x16x32_bf16 a[60:63], a[164:167], v[188:191], a[60:63]
    v_mfma_f32_16x16x32_bf16 a[64:67], a[196:199], v[160:163], a[64:67]
    buffer_load_dwordx4 v[152:155], v47, s[12:15], s28 offen offset:0 sc1
    v_mfma_f32_16x16x32_bf16 a[68:71], a[196:199], v[164:167], a[68:71]
    v_mfma_f32_16x16x32_bf16 a[72:75], a[196:199], v[168:171], a[72:75]
    buffer_load_dwordx4 v[156:159], v47, s[12:15], s28 offen offset:2048 sc1
    v_mfma_f32_16x16x32_bf16 a[76:79], a[196:199], v[172:175], a[76:79]
    v_mfma_f32_16x16x32_bf16 a[80:83], a[196:199], v[176:179], a[80:83]
    s_add_u32 m0, s69, 4096
    v_mfma_f32_16x16x32_bf16 a[84:87], a[196:199], v[180:183], a[84:87]
    buffer_load_dwordx4 v40, s[40:43], s55 offen offset:0 lds
    v_mfma_f32_16x16x32_bf16 a[88:91], a[196:199], v[184:187], a[88:91]
    v_mfma_f32_16x16x32_bf16 a[92:95], a[196:199], v[188:191], a[92:95]
    buffer_load_dwordx4 v41, s[40:43], s55 offen offset:1024 lds
    v_mfma_f32_16x16x32_bf16 a[96:99], a[228:231], v[160:163], a[96:99]
    v_mfma_f32_16x16x32_bf16 a[100:103], a[228:231], v[164:167], a[100:103]
    v_mfma_f32_16x16x32_bf16 a[104:107], a[228:231], v[168:171], a[104:107]
    buffer_load_dwordx4 v42, s[40:43], s55 offen offset:2048 lds
    v_mfma_f32_16x16x32_bf16 a[108:111], a[228:231], v[172:175], a[108:111]
    v_mfma_f32_16x16x32_bf16 a[112:115], a[228:231], v[176:179], a[112:115]
    buffer_load_dwordx4 v43, s[40:43], s55 offen offset:3072 lds
    v_mfma_f32_16x16x32_bf16 a[116:119], a[228:231], v[180:183], a[116:119]
    v_mfma_f32_16x16x32_bf16 a[120:123], a[228:231], v[184:187], a[120:123]
    v_mfma_f32_16x16x32_bf16 a[124:127], a[228:231], v[188:191], a[124:127]
    s_add_u32 s54, s54, 131072
    s_cmp_eq_u32 s54, s101
    s_cselect_b32 s54, s100, s54
    s_add_u32 s55, s54, 65536
    s_waitcnt lgkmcnt(0) vmcnt(52)
    v_mfma_f32_16x16x32_bf16 a[0:3], a[128:131], v[192:195], a[0:3]
    ds_read_b64_tr_b16 a[132:133], v56 offset:4096
    v_mfma_f32_16x16x32_bf16 a[4:7], a[128:131], v[196:199], a[4:7]
    buffer_load_dwordx4 v[160:163], v44, s[12:15], s28 offen offset:1024 sc1
    v_mfma_f32_16x16x32_bf16 a[8:11], a[128:131], v[200:203], a[8:11]
    ds_read_b64_tr_b16 a[134:135], v56 offset:6144
    v_mfma_f32_16x16x32_bf16 a[12:15], a[128:131], v[204:207], a[12:15]
    buffer_load_dwordx4 v[164:167], v44, s[12:15], s28 offen offset:3072 sc1
    v_mfma_f32_16x16x32_bf16 a[16:19], a[128:131], v[208:211], a[16:19]
    ds_read_b64_tr_b16 a[164:165], v57 offset:4096
    v_mfma_f32_16x16x32_bf16 a[20:23], a[128:131], v[212:215], a[20:23]
    v_mfma_f32_16x16x32_bf16 a[24:27], a[128:131], v[216:219], a[24:27]
    ds_read_b64_tr_b16 a[166:167], v57 offset:6144
    buffer_load_dwordx4 v[168:171], v45, s[12:15], s28 offen offset:1024 sc1
    v_mfma_f32_16x16x32_bf16 a[28:31], a[128:131], v[220:223], a[28:31]
    v_mfma_f32_16x16x32_bf16 a[32:35], a[160:163], v[192:195], a[32:35]
    ds_read_b64_tr_b16 a[196:197], v58 offset:4096
    buffer_load_dwordx4 v[172:175], v45, s[12:15], s28 offen offset:3072 sc1
    v_mfma_f32_16x16x32_bf16 a[36:39], a[160:163], v[196:199], a[36:39]
    v_mfma_f32_16x16x32_bf16 a[40:43], a[160:163], v[200:203], a[40:43]
    ds_read_b64_tr_b16 a[198:199], v58 offset:6144
    v_mfma_f32_16x16x32_bf16 a[44:47], a[160:163], v[204:207], a[44:47]
    buffer_load_dwordx4 v[176:179], v46, s[12:15], s28 offen offset:1024 sc1
    v_mfma_f32_16x16x32_bf16 a[48:51], a[160:163], v[208:211], a[48:51]
    ds_read_b64_tr_b16 a[228:229], v59 offset:4096
    v_mfma_f32_16x16x32_bf16 a[52:55], a[160:163], v[212:215], a[52:55]
    buffer_load_dwordx4 v[180:183], v46, s[12:15], s28 offen offset:3072 sc1
    v_mfma_f32_16x16x32_bf16 a[56:59], a[160:163], v[216:219], a[56:59]
    ds_read_b64_tr_b16 a[230:231], v59 offset:6144
    v_mfma_f32_16x16x32_bf16 a[60:63], a[160:163], v[220:223], a[60:63]
    v_mfma_f32_16x16x32_bf16 a[64:67], a[192:195], v[192:195], a[64:67]
    buffer_load_dwordx4 v[184:187], v47, s[12:15], s28 offen offset:1024 sc1
    v_mfma_f32_16x16x32_bf16 a[68:71], a[192:195], v[196:199], a[68:71]
    v_mfma_f32_16x16x32_bf16 a[72:75], a[192:195], v[200:203], a[72:75]
    buffer_load_dwordx4 v[188:191], v47, s[12:15], s28 offen offset:3072 sc1
    v_mfma_f32_16x16x32_bf16 a[76:79], a[192:195], v[204:207], a[76:79]
    s_add_u32 s28, s28, 16384
    s_cmp_eq_u32 s28, s30
    s_cselect_b32 s28, s29, s28
    v_mfma_f32_16x16x32_bf16 a[80:83], a[192:195], v[208:211], a[80:83]
    s_add_u32 m0, s70, 0
    v_mfma_f32_16x16x32_bf16 a[84:87], a[192:195], v[212:215], a[84:87]
    buffer_load_dwordx4 v40, s[40:43], s54 offen offset:0 lds
    v_mfma_f32_16x16x32_bf16 a[88:91], a[192:195], v[216:219], a[88:91]
    v_mfma_f32_16x16x32_bf16 a[92:95], a[192:195], v[220:223], a[92:95]
    buffer_load_dwordx4 v41, s[40:43], s54 offen offset:1024 lds
    v_mfma_f32_16x16x32_bf16 a[96:99], a[224:227], v[192:195], a[96:99]
    v_mfma_f32_16x16x32_bf16 a[100:103], a[224:227], v[196:199], a[100:103]
    v_mfma_f32_16x16x32_bf16 a[104:107], a[224:227], v[200:203], a[104:107]
    buffer_load_dwordx4 v42, s[40:43], s54 offen offset:2048 lds
    v_mfma_f32_16x16x32_bf16 a[108:111], a[224:227], v[204:207], a[108:111]
    v_mfma_f32_16x16x32_bf16 a[112:115], a[224:227], v[208:211], a[112:115]
    buffer_load_dwordx4 v43, s[40:43], s54 offen offset:3072 lds
    v_mfma_f32_16x16x32_bf16 a[116:119], a[224:227], v[212:215], a[116:119]
    v_mfma_f32_16x16x32_bf16 a[120:123], a[224:227], v[216:219], a[120:123]
    v_mfma_f32_16x16x32_bf16 a[124:127], a[224:227], v[220:223], a[124:127]
    s_waitcnt lgkmcnt(0) vmcnt(52)
    v_mfma_f32_16x16x32_bf16 a[0:3], a[132:135], v[224:227], a[0:3]
    ds_read_b64_tr_b16 a[128:129], v56 offset:8192
    v_mfma_f32_16x16x32_bf16 a[4:7], a[132:135], v[228:231], a[4:7]
    buffer_load_dwordx4 v[192:195], v44, s[12:15], s28 offen offset:0 sc1
    v_mfma_f32_16x16x32_bf16 a[8:11], a[132:135], v[232:235], a[8:11]
    ds_read_b64_tr_b16 a[130:131], v56 offset:10240
    v_mfma_f32_16x16x32_bf16 a[12:15], a[132:135], v[236:239], a[12:15]
    buffer_load_dwordx4 v[196:199], v44, s[12:15], s28 offen offset:2048 sc1
    v_mfma_f32_16x16x32_bf16 a[16:19], a[132:135], v[240:243], a[16:19]
    ds_read_b64_tr_b16 a[160:161], v57 offset:8192
    v_mfma_f32_16x16x32_bf16 a[20:23], a[132:135], v[244:247], a[20:23]
    v_mfma_f32_16x16x32_bf16 a[24:27], a[132:135], v[248:251], a[24:27]
    ds_read_b64_tr_b16 a[162:163], v57 offset:10240
    buffer_load_dwordx4 v[200:203], v45, s[12:15], s28 offen offset:0 sc1
    v_mfma_f32_16x16x32_bf16 a[28:31], a[132:135], v[252:255], a[28:31]
    v_mfma_f32_16x16x32_bf16 a[32:35], a[164:167], v[224:227], a[32:35]
    ds_read_b64_tr_b16 a[192:193], v58 offset:8192
    buffer_load_dwordx4 v[204:207], v45, s[12:15], s28 offen offset:2048 sc1
    v_mfma_f32_16x16x32_bf16 a[36:39], a[164:167], v[228:231], a[36:39]
    v_mfma_f32_16x16x32_bf16 a[40:43], a[164:167], v[232:235], a[40:43]
    ds_read_b64_tr_b16 a[194:195], v58 offset:10240
    v_mfma_f32_16x16x32_bf16 a[44:47], a[164:167], v[236:239], a[44:47]
    buffer_load_dwordx4 v[208:211], v46, s[12:15], s28 offen offset:0 sc1
    v_mfma_f32_16x16x32_bf16 a[48:51], a[164:167], v[240:243], a[48:51]
    ds_read_b64_tr_b16 a[224:225], v59 offset:8192
    v_mfma_f32_16x16x32_bf16 a[52:55], a[164:167], v[244:247], a[52:55]
    buffer_load_dwordx4 v[212:215], v46, s[12:15], s28 offen offset:2048 sc1
    v_mfma_f32_16x16x32_bf16 a[56:59], a[164:167], v[248:251], a[56:59]
    ds_read_b64_tr_b16 a[226:227], v59 offset:10240
    v_mfma_f32_16x16x32_bf16 a[60:63], a[164:167], v[252:255], a[60:63]
    v_mfma_f32_16x16x32_bf16 a[64:67], a[196:199], v[224:227], a[64:67]
    buffer_load_dwordx4 v[216:219], v47, s[12:15], s28 offen offset:0 sc1
    v_mfma_f32_16x16x32_bf16 a[68:71], a[196:199], v[228:231], a[68:71]
    v_mfma_f32_16x16x32_bf16 a[72:75], a[196:199], v[232:235], a[72:75]
    buffer_load_dwordx4 v[220:223], v47, s[12:15], s28 offen offset:2048 sc1
    v_mfma_f32_16x16x32_bf16 a[76:79], a[196:199], v[236:239], a[76:79]
    v_mfma_f32_16x16x32_bf16 a[80:83], a[196:199], v[240:243], a[80:83]
    s_add_u32 m0, s70, 4096
    v_mfma_f32_16x16x32_bf16 a[84:87], a[196:199], v[244:247], a[84:87]
    buffer_load_dwordx4 v40, s[40:43], s55 offen offset:0 lds
    v_mfma_f32_16x16x32_bf16 a[88:91], a[196:199], v[248:251], a[88:91]
    v_mfma_f32_16x16x32_bf16 a[92:95], a[196:199], v[252:255], a[92:95]
    buffer_load_dwordx4 v41, s[40:43], s55 offen offset:1024 lds
    v_mfma_f32_16x16x32_bf16 a[96:99], a[228:231], v[224:227], a[96:99]
    v_mfma_f32_16x16x32_bf16 a[100:103], a[228:231], v[228:231], a[100:103]
    v_mfma_f32_16x16x32_bf16 a[104:107], a[228:231], v[232:235], a[104:107]
    buffer_load_dwordx4 v42, s[40:43], s55 offen offset:2048 lds
    v_mfma_f32_16x16x32_bf16 a[108:111], a[228:231], v[236:239], a[108:111]
    v_mfma_f32_16x16x32_bf16 a[112:115], a[228:231], v[240:243], a[112:115]
    buffer_load_dwordx4 v43, s[40:43], s55 offen offset:3072 lds
    v_mfma_f32_16x16x32_bf16 a[116:119], a[228:231], v[244:247], a[116:119]
    v_mfma_f32_16x16x32_bf16 a[120:123], a[228:231], v[248:251], a[120:123]
    v_mfma_f32_16x16x32_bf16 a[124:127], a[228:231], v[252:255], a[124:127]
    s_add_u32 s54, s54, 131072
    s_cmp_eq_u32 s54, s101
    s_cselect_b32 s54, s100, s54
    s_add_u32 s55, s54, 65536
    s_waitcnt lgkmcnt(0) vmcnt(52)
    v_mfma_f32_16x16x32_bf16 a[0:3], a[128:131], v[64:67], a[0:3]
    ds_read_b64_tr_b16 a[132:133], v56 offset:12288
    v_mfma_f32_16x16x32_bf16 a[4:7], a[128:131], v[68:71], a[4:7]
    buffer_load_dwordx4 v[224:227], v44, s[12:15], s28 offen offset:1024 sc1
    v_mfma_f32_16x16x32_bf16 a[8:11], a[128:131], v[72:75], a[8:11]
    ds_read_b64_tr_b16 a[134:135], v56 offset:14336
    v_mfma_f32_16x16x32_bf16 a[12:15], a[128:131], v[76:79], a[12:15]
    v_mfma_f32_16x16x32_bf16 a[16:19], a[128:131], v[80:83], a[16:19]
    ds_read_b64_tr_b16 a[164:165], v57 offset:12288
    buffer_load_dwordx4 v[228:231], v44, s[12:15], s28 offen offset:3072 sc1
    v_mfma_f32_16x16x32_bf16 a[20:23], a[128:131], v[84:87], a[20:23]
    v_mfma_f32_16x16x32_bf16 a[24:27], a[128:131], v[88:91], a[24:27]
    ds_read_b64_tr_b16 a[166:167], v57 offset:14336
    v_mfma_f32_16x16x32_bf16 a[28:31], a[128:131], v[92:95], a[28:31]
    v_mfma_f32_16x16x32_bf16 a[32:35], a[160:163], v[64:67], a[32:35]
    ds_read_b64_tr_b16 a[196:197], v58 offset:12288
    buffer_load_dwordx4 v[232:235], v45, s[12:15], s28 offen offset:1024 sc1
    v_mfma_f32_16x16x32_bf16 a[36:39], a[160:163], v[68:71], a[36:39]
    v_mfma_f32_16x16x32_bf16 a[40:43], a[160:163], v[72:75], a[40:43]
    ds_read_b64_tr_b16 a[198:199], v58 offset:14336
    v_mfma_f32_16x16x32_bf16 a[44:47], a[160:163], v[76:79], a[44:47]
    v_mfma_f32_16x16x32_bf16 a[48:51], a[160:163], v[80:83], a[48:51]
    ds_read_b64_tr_b16 a[228:229], v59 offset:12288
    buffer_load_dwordx4 v[236:239], v45, s[12:15], s28 offen offset:3072 sc1
    v_mfma_f32_16x16x32_bf16 a[52:55], a[160:163], v[84:87], a[52:55]
    v_mfma_f32_16x16x32_bf16 a[56:59], a[160:163], v[88:91], a[56:59]
    ds_read_b64_tr_b16 a[230:231], v59 offset:14336
    v_mfma_f32_16x16x32_bf16 a[60:63], a[160:163], v[92:95], a[60:63]
    v_mfma_f32_16x16x32_bf16 a[64:67], a[192:195], v[64:67], a[64:67]
    buffer_load_dwordx4 v[240:243], v46, s[12:15], s28 offen offset:1024 sc1
    v_mfma_f32_16x16x32_bf16 a[68:71], a[192:195], v[68:71], a[68:71]
    v_mfma_f32_16x16x32_bf16 a[72:75], a[192:195], v[72:75], a[72:75]
    v_mfma_f32_16x16x32_bf16 a[76:79], a[192:195], v[76:79], a[76:79]
    buffer_load_dwordx4 v[244:247], v46, s[12:15], s28 offen offset:3072 sc1
    v_mfma_f32_16x16x32_bf16 a[80:83], a[192:195], v[80:83], a[80:83]
    v_mfma_f32_16x16x32_bf16 a[84:87], a[192:195], v[84:87], a[84:87]
    v_mfma_f32_16x16x32_bf16 a[88:91], a[192:195], v[88:91], a[88:91]
    v_mfma_f32_16x16x32_bf16 a[92:95], a[192:195], v[92:95], a[92:95]
    buffer_load_dwordx4 v[248:251], v47, s[12:15], s28 offen offset:1024 sc1
    v_mfma_f32_16x16x32_bf16 a[96:99], a[224:227], v[64:67], a[96:99]
    v_mfma_f32_16x16x32_bf16 a[100:103], a[224:227], v[68:71], a[100:103]
    v_mfma_f32_16x16x32_bf16 a[104:107], a[224:227], v[72:75], a[104:107]
    v_mfma_f32_16x16x32_bf16 a[108:111], a[224:227], v[76:79], a[108:111]
    buffer_load_dwordx4 v[252:255], v47, s[12:15], s28 offen offset:3072 sc1
    v_mfma_f32_16x16x32_bf16 a[112:115], a[224:227], v[80:83], a[112:115]
    s_add_u32 s28, s28, 16384
    s_cmp_eq_u32 s28, s30
    s_cselect_b32 s28, s29, s28
    v_mfma_f32_16x16x32_bf16 a[116:119], a[224:227], v[84:87], a[116:119]
    v_mfma_f32_16x16x32_bf16 a[120:123], a[224:227], v[88:91], a[120:123]
    v_mfma_f32_16x16x32_bf16 a[124:127], a[224:227], v[92:95], a[124:127]
    s_waitcnt lgkmcnt(0) vmcnt(48)
    v_mfma_f32_16x16x32_bf16 a[0:3], a[132:135], v[96:99], a[0:3]
    ds_read_b64_tr_b16 a[128:129], v48 offset:0
    s_bitcmp1_b32 s75, s74
    s_cbranch_scc1 L_ok6
    s_mov_b32 s35, 0
L_sp6:
    buffer_load_dword v7, v26, s[48:51], s34 offen sc1
    s_waitcnt vmcnt(0)
    v_cmp_eq_u32 vcc, s62, v7
    s_add_u32 s35, s35, 1
    s_nop 2
    s_mov_b32 s75, vcc_lo
    s_bitcmp1_b32 s75, s74
    s_cbranch_scc1 L_ok6
    s_sleep 2
    s_cmp_lt_u32 s35, 0x40000
    s_cbranch_scc1 L_sp6
L_ok6:
    s_add_u32 s74, s74, 1
    s_cmp_eq_u32 s74, s73
    s_cselect_b32 s74, s72, s74
    v_mfma_f32_16x16x32_bf16 a[4:7], a[132:135], v[100:103], a[4:7]
    buffer_load_dwordx4 v[64:67], v44, s[12:15], s28 offen offset:0 sc1
    v_mfma_f32_16x16x32_bf16 a[8:11], a[132:135], v[104:107], a[8:11]
    ds_read_b64_tr_b16 a[130:131], v48 offset:2048
    v_mfma_f32_16x16x32_bf16 a[12:15], a[132:135], v[108:111], a[12:15]
    v_mfma_f32_16x16x32_bf16 a[16:19], a[132:135], v[112:115], a[16:19]
    ds_read_b64_tr_b16 a[160:161], v49 offset:0
    buffer_load_dwordx4 v[68:71], v44, s[12:15], s28 offen offset:2048 sc1
    v_mfma_f32_16x16x32_bf16 a[20:23], a[132:135], v[116:119], a[20:23]
    v_mfma_f32_16x16x32_bf16 a[24:27], a[132:135], v[120:123], a[24:27]
    ds_read_b64_tr_b16 a[162:163], v49 offset:2048
    v_mfma_f32_16x16x32_bf16 a[28:31], a[132:135], v[124:127], a[28:31]
    v_mfma_f32_16x16x32_bf16 a[32:35], a[164:167], v[96:99], a[32:35]
    ds_read_b64_tr_b16 a[192:193], v50 offset:0
    buffer_load_dwordx4 v[72:75], v45, s[12:15], s28 offen offset:0 sc1
    v_mfma_f32_16x16x32_bf16 a[36:39], a[164:167], v[100:103], a[36:39]
    v_mfma_f32_16x16x32_bf16 a[40:43], a[164:167], v[104:107], a[40:43]
    ds_read_b64_tr_b16 a[194:195], v50 offset:2048
    v_mfma_f32_16x16x32_bf16 a[44:47], a[164:167], v[108:111], a[44:47]
    v_mfma_f32_16x16x32_bf16 a[48:51], a[164:167], v[112:115], a[48:51]
    ds_read_b64_tr_b16 a[224:225], v51 offset:0
    buffer_load_dwordx4 v[76:79], v45, s[12:15], s28 offen offset:2048 sc1
    v_mfma_f32_16x16x32_bf16 a[52:55], a[164:167], v[116:119], a[52:55]
    v_mfma_f32_16x16x32_bf16 a[56:59], a[164:167], v[120:123], a[56:59]
    ds_read_b64_tr_b16 a[226:227], v51 offset:2048
    v_mfma_f32_16x16x32_bf16 a[60:63], a[164:167], v[124:127], a[60:63]
    v_mfma_f32_16x16x32_bf16 a[64:67], a[196:199], v[96:99], a[64:67]
    buffer_load_dwordx4 v[80:83], v46, s[12:15], s28 offen offset:0 sc1
    v_mfma_f32_16x16x32_bf16 a[68:71], a[196:199], v[100:103], a[68:71]
    v_mfma_f32_16x16x32_bf16 a[72:75], a[196:199], v[104:107], a[72:75]
    v_mfma_f32_16x16x32_bf16 a[76:79], a[196:199], v[108:111], a[76:79]
    buffer_load_dwordx4 v[84:87], v46, s[12:15], s28 offen offset:2048 sc1
    v_mfma_f32_16x16x32_bf16 a[80:83], a[196:199], v[112:115], a[80:83]
    v_mfma_f32_16x16x32_bf16 a[84:87], a[196:199], v[116:119], a[84:87]
    v_mfma_f32_16x16x32_bf16 a[88:91], a[196:199], v[120:123], a[88:91]
    v_mfma_f32_16x16x32_bf16 a[92:95], a[196:199], v[124:127], a[92:95]
    buffer_load_dwordx4 v[88:91], v47, s[12:15], s28 offen offset:0 sc1
    v_mfma_f32_16x16x32_bf16 a[96:99], a[228:231], v[96:99], a[96:99]
    v_mfma_f32_16x16x32_bf16 a[100:103], a[228:231], v[100:103], a[100:103]
    v_mfma_f32_16x16x32_bf16 a[104:107], a[228:231], v[104:107], a[104:107]
    v_mfma_f32_16x16x32_bf16 a[108:111], a[228:231], v[108:111], a[108:111]
    buffer_load_dwordx4 v[92:95], v47, s[12:15], s28 offen offset:2048 sc1
    v_mfma_f32_16x16x32_bf16 a[112:115], a[228:231], v[112:115], a[112:115]
    v_mfma_f32_16x16x32_bf16 a[116:119], a[228:231], v[116:119], a[116:119]
    v_mfma_f32_16x16x32_bf16 a[120:123], a[228:231], v[120:123], a[120:123]
    v_mfma_f32_16x16x32_bf16 a[124:127], a[228:231], v[124:127], a[124:127]
    s_waitcnt lgkmcnt(0) vmcnt(44)
    v_mfma_f32_16x16x32_bf16 a[0:3], a[128:131], v[128:131], a[0:3]
    ds_read_b64_tr_b16 a[132:133], v48 offset:4096
    v_mfma_f32_16x16x32_bf16 a[4:7], a[128:131], v[132:135], a[4:7]
    buffer_load_dwordx4 v[96:99], v44, s[12:15], s28 offen offset:1024 sc1
    v_mfma_f32_16x16x32_bf16 a[8:11], a[128:131], v[136:139], a[8:11]
    ds_read_b64_tr_b16 a[134:135], v48 offset:6144
    v_mfma_f32_16x16x32_bf16 a[12:15], a[128:131], v[140:143], a[12:15]
    v_mfma_f32_16x16x32_bf16 a[16:19], a[128:131], v[144:147], a[16:19]
    ds_read_b64_tr_b16 a[164:165], v49 offset:4096
    buffer_load_dwordx4 v[100:103], v44, s[12:15], s28 offen offset:3072 sc1
    v_mfma_f32_16x16x32_bf16 a[20:23], a[128:131], v[148:151], a[20:23]
    v_mfma_f32_16x16x32_bf16 a[24:27], a[128:131], v[152:155], a[24:27]
    ds_read_b64_tr_b16 a[166:167], v49 offset:6144
    v_mfma_f32_16x16x32_bf16 a[28:31], a[128:131], v[156:159], a[28:31]
    v_mfma_f32_16x16x32_bf16 a[32:35], a[160:163], v[128:131], a[32:35]
    ds_read_b64_tr_b16 a[196:197], v50 offset:4096
    buffer_load_dwordx4 v[104:107], v45, s[12:15], s28 offen offset:1024 sc1
    v_mfma_f32_16x16x32_bf16 a[36:39], a[160:163], v[132:135], a[36:39]
    v_mfma_f32_16x16x32_bf16 a[40:43], a[160:163], v[136:139], a[40:43]
    ds_read_b64_tr_b16 a[198:199], v50 offset:6144
    v_mfma_f32_16x16x32_bf16 a[44:47], a[160:163], v[140:143], a[44:47]
    v_mfma_f32_16x16x32_bf16 a[48:51], a[160:163], v[144:147], a[48:51]
    ds_read_b64_tr_b16 a[228:229], v51 offset:4096
    buffer_load_dwordx4 v[108:111], v45, s[12:15], s28 offen offset:3072 sc1
    v_mfma_f32_16x16x32_bf16 a[52:55], a[160:163], v[148:151], a[52:55]
    v_mfma_f32_16x16x32_bf16 a[56:59], a[160:163], v[152:155], a[56:59]
    ds_read_b64_tr_b16 a[230:231], v51 offset:6144
    v_mfma_f32_16x16x32_bf16 a[60:63], a[160:163], v[156:159], a[60:63]
    v_mfma_f32_16x16x32_bf16 a[64:67], a[192:195], v[128:131], a[64:67]
    buffer_load_dwordx4 v[112:115], v46, s[12:15], s28 offen offset:1024 sc1
    v_mfma_f32_16x16x32_bf16 a[68:71], a[192:195], v[132:135], a[68:71]
    v_mfma_f32_16x16x32_bf16 a[72:75], a[192:195], v[136:139], a[72:75]
    v_mfma_f32_16x16x32_bf16 a[76:79], a[192:195], v[140:143], a[76:79]
    buffer_load_dwordx4 v[116:119], v46, s[12:15], s28 offen offset:3072 sc1
    v_mfma_f32_16x16x32_bf16 a[80:83], a[192:195], v[144:147], a[80:83]
    v_mfma_f32_16x16x32_bf16 a[84:87], a[192:195], v[148:151], a[84:87]
    v_mfma_f32_16x16x32_bf16 a[88:91], a[192:195], v[152:155], a[88:91]
    v_mfma_f32_16x16x32_bf16 a[92:95], a[192:195], v[156:159], a[92:95]
    buffer_load_dwordx4 v[120:123], v47, s[12:15], s28 offen offset:1024 sc1
    v_mfma_f32_16x16x32_bf16 a[96:99], a[224:227], v[128:131], a[96:99]
    v_mfma_f32_16x16x32_bf16 a[100:103], a[224:227], v[132:135], a[100:103]
    v_mfma_f32_16x16x32_bf16 a[104:107], a[224:227], v[136:139], a[104:107]
    v_mfma_f32_16x16x32_bf16 a[108:111], a[224:227], v[140:143], a[108:111]
    buffer_load_dwordx4 v[124:127], v47, s[12:15], s28 offen offset:3072 sc1
    v_mfma_f32_16x16x32_bf16 a[112:115], a[224:227], v[144:147], a[112:115]
    s_add_u32 s28, s28, 16384
    s_cmp_eq_u32 s28, s30
    s_cselect_b32 s28, s29, s28
    v_mfma_f32_16x16x32_bf16 a[116:119], a[224:227], v[148:151], a[116:119]
    v_mfma_f32_16x16x32_bf16 a[120:123], a[224:227], v[152:155], a[120:123]
    v_mfma_f32_16x16x32_bf16 a[124:127], a[224:227], v[156:159], a[124:127]
    s_waitcnt lgkmcnt(0) vmcnt(40)
    v_mfma_f32_16x16x32_bf16 a[0:3], a[132:135], v[160:163], a[0:3]
    ds_read_b64_tr_b16 a[128:129], v48 offset:8192
    v_mfma_f32_16x16x32_bf16 a[4:7], a[132:135], v[164:167], a[4:7]
    buffer_load_dwordx4 v[128:131], v44, s[12:15], s28 offen offset:0 sc1
    v_mfma_f32_16x16x32_bf16 a[8:11], a[132:135], v[168:171], a[8:11]
    ds_read_b64_tr_b16 a[130:131], v48 offset:10240
    v_mfma_f32_16x16x32_bf16 a[12:15], a[132:135], v[172:175], a[12:15]
    v_mfma_f32_16x16x32_bf16 a[16:19], a[132:135], v[176:179], a[16:19]
    ds_read_b64_tr_b16 a[160:161], v49 offset:8192
    buffer_load_dwordx4 v[132:135], v44, s[12:15], s28 offen offset:2048 sc1
    v_mfma_f32_16x16x32_bf16 a[20:23], a[132:135], v[180:183], a[20:23]
    v_mfma_f32_16x16x32_bf16 a[24:27], a[132:135], v[184:187], a[24:27]
    ds_read_b64_tr_b16 a[162:163], v49 offset:10240
    v_mfma_f32_16x16x32_bf16 a[28:31], a[132:135], v[188:191], a[28:31]
    v_mfma_f32_16x16x32_bf16 a[32:35], a[164:167], v[160:163], a[32:35]
    ds_read_b64_tr_b16 a[192:193], v50 offset:8192
    buffer_load_dwordx4 v[136:139], v45, s[12:15], s28 offen offset:0 sc1
    v_mfma_f32_16x16x32_bf16 a[36:39], a[164:167], v[164:167], a[36:39]
    v_mfma_f32_16x16x32_bf16 a[40:43], a[164:167], v[168:171], a[40:43]
    ds_read_b64_tr_b16 a[194:195], v50 offset:10240
    v_mfma_f32_16x16x32_bf16 a[44:47], a[164:167], v[172:175], a[44:47]
    v_mfma_f32_16x16x32_bf16 a[48:51], a[164:167], v[176:179], a[48:51]
    ds_read_b64_tr_b16 a[224:225], v51 offset:8192
    buffer_load_dwordx4 v[140:143], v45, s[12:15], s28 offen offset:2048 sc1
    v_mfma_f32_16x16x32_bf16 a[52:55], a[164:167], v[180:183], a[52:55]
    v_mfma_f32_16x16x32_bf16 a[56:59], a[164:167], v[184:187], a[56:59]
    ds_read_b64_tr_b16 a[226:227], v51 offset:10240
    v_mfma_f32_16x16x32_bf16 a[60:63], a[164:167], v[188:191], a[60:63]
    v_mfma_f32_16x16x32_bf16 a[64:67], a[196:199], v[160:163], a[64:67]
    buffer_load_dwordx4 v[144:147], v46, s[12:15], s28 offen offset:0 sc1
    v_mfma_f32_16x16x32_bf16 a[68:71], a[196:199], v[164:167], a[68:71]
    v_mfma_f32_16x16x32_bf16 a[72:75], a[196:199], v[168:171], a[72:75]
    v_mfma_f32_16x16x32_bf16 a[76:79], a[196:199], v[172:175], a[76:79]
    buffer_load_dwordx4 v[148:151], v46, s[12:15], s28 offen offset:2048 sc1
    v_mfma_f32_16x16x32_bf16 a[80:83], a[196:199], v[176:179], a[80:83]
    v_mfma_f32_16x16x32_bf16 a[84:87], a[196:199], v[180:183], a[84:87]
    v_mfma_f32_16x16x32_bf16 a[88:91], a[196:199], v[184:187], a[88:91]
    v_mfma_f32_16x16x32_bf16 a[92:95], a[196:199], v[188:191], a[92:95]
    buffer_load_dwordx4 v[152:155], v47, s[12:15], s28 offen offset:0 sc1
    v_mfma_f32_16x16x32_bf16 a[96:99], a[228:231], v[160:163], a[96:99]
    v_mfma_f32_16x16x32_bf16 a[100:103], a[228:231], v[164:167], a[100:103]
    v_mfma_f32_16x16x32_bf16 a[104:107], a[228:231], v[168:171], a[104:107]
    v_mfma_f32_16x16x32_bf16 a[108:111], a[228:231], v[172:175], a[108:111]
    buffer_load_dwordx4 v[156:159], v47, s[12:15], s28 offen offset:2048 sc1
    v_mfma_f32_16x16x32_bf16 a[112:115], a[228:231], v[176:179], a[112:115]
    v_mfma_f32_16x16x32_bf16 a[116:119], a[228:231], v[180:183], a[116:119]
    v_mfma_f32_16x16x32_bf16 a[120:123], a[228:231], v[184:187], a[120:123]
    v_mfma_f32_16x16x32_bf16 a[124:127], a[228:231], v[188:191], a[124:127]
    s_waitcnt lgkmcnt(0) vmcnt(36)
    v_mfma_f32_16x16x32_bf16 a[0:3], a[128:131], v[192:195], a[0:3]
    ds_read_b64_tr_b16 a[132:133], v48 offset:12288
    v_mfma_f32_16x16x32_bf16 a[4:7], a[128:131], v[196:199], a[4:7]
    buffer_load_dwordx4 v[160:163], v44, s[12:15], s28 offen offset:1024 sc1
    v_mfma_f32_16x16x32_bf16 a[8:11], a[128:131], v[200:203], a[8:11]
    ds_read_b64_tr_b16 a[134:135], v48 offset:14336
    v_mfma_f32_16x16x32_bf16 a[12:15], a[128:131], v[204:207], a[12:15]
    v_mfma_f32_16x16x32_bf16 a[16:19], a[128:131], v[208:211], a[16:19]
    ds_read_b64_tr_b16 a[164:165], v49 offset:12288
    buffer_load_dwordx4 v[164:167], v44, s[12:15], s28 offen offset:3072 sc1
    v_mfma_f32_16x16x32_bf16 a[20:23], a[128:131], v[212:215], a[20:23]
    v_mfma_f32_16x16x32_bf16 a[24:27], a[128:131], v[216:219], a[24:27]
    ds_read_b64_tr_b16 a[166:167], v49 offset:14336
    v_mfma_f32_16x16x32_bf16 a[28:31], a[128:131], v[220:223], a[28:31]
    v_mfma_f32_16x16x32_bf16 a[32:35], a[160:163], v[192:195], a[32:35]
    ds_read_b64_tr_b16 a[196:197], v50 offset:12288
    buffer_load_dwordx4 v[168:171], v45, s[12:15], s28 offen offset:1024 sc1
    v_mfma_f32_16x16x32_bf16 a[36:39], a[160:163], v[196:199], a[36:39]
    v_mfma_f32_16x16x32_bf16 a[40:43], a[160:163], v[200:203], a[40:43]
    ds_read_b64_tr_b16 a[198:199], v50 offset:14336
    v_mfma_f32_16x16x32_bf16 a[44:47], a[160:163], v[204:207], a[44:47]
    v_mfma_f32_16x16x32_bf16 a[48:51], a[160:163], v[208:211], a[48:51]
    ds_read_b64_tr_b16 a[228:229], v51 offset:12288
    buffer_load_dwordx4 v[172:175], v45, s[12:15], s28 offen offset:3072 sc1
    v_mfma_f32_16x16x32_bf16 a[52:55], a[160:163], v[212:215], a[52:55]
    v_mfma_f32_16x16x32_bf16 a[56:59], a[160:163], v[216:219], a[56:59]
    ds_read_b64_tr_b16 a[230:231], v51 offset:14336
    v_mfma_f32_16x16x32_bf16 a[60:63], a[160:163], v[220:223], a[60:63]
    v_mfma_f32_16x16x32_bf16 a[64:67], a[192:195], v[192:195], a[64:67]
    buffer_load_dwordx4 v[176:179], v46, s[12:15], s28 offen offset:1024 sc1
    v_mfma_f32_16x16x32_bf16 a[68:71], a[192:195], v[196:199], a[68:71]
    v_mfma_f32_16x16x32_bf16 a[72:75], a[192:195], v[200:203], a[72:75]
    v_mfma_f32_16x16x32_bf16 a[76:79], a[192:195], v[204:207], a[76:79]
    buffer_load_dwordx4 v[180:183], v46, s[12:15], s28 offen offset:3072 sc1
    v_mfma_f32_16x16x32_bf16 a[80:83], a[192:195], v[208:211], a[80:83]
    v_mfma_f32_16x16x32_bf16 a[84:87], a[192:195], v[212:215], a[84:87]
    v_mfma_f32_16x16x32_bf16 a[88:91], a[192:195], v[216:219], a[88:91]
    v_mfma_f32_16x16x32_bf16 a[92:95], a[192:195], v[220:223], a[92:95]
    buffer_load_dwordx4 v[184:187], v47, s[12:15], s28 offen offset:1024 sc1
    v_mfma_f32_16x16x32_bf16 a[96:99], a[224:227], v[192:195], a[96:99]
    v_mfma_f32_16x16x32_bf16 a[100:103], a[224:227], v[196:199], a[100:103]
    v_mfma_f32_16x16x32_bf16 a[104:107], a[224:227], v[200:203], a[104:107]
    v_mfma_f32_16x16x32_bf16 a[108:111], a[224:227], v[204:207], a[108:111]
    buffer_load_dwordx4 v[188:191], v47, s[12:15], s28 offen offset:3072 sc1
    v_mfma_f32_16x16x32_bf16 a[112:115], a[224:227], v[208:211], a[112:115]
    s_add_u32 s28, s28, 16384
    s_cmp_eq_u32 s28, s30
    s_cselect_b32 s28, s29, s28
    v_mfma_f32_16x16x32_bf16 a[116:119], a[224:227], v[212:215], a[116:119]
    v_mfma_f32_16x16x32_bf16 a[120:123], a[224:227], v[216:219], a[120:123]
    buffer_load_dword v7, v26, s[48:51], 0 offen offset:1024 sc1
    v_mfma_f32_16x16x32_bf16 a[124:127], a[224:227], v[220:223], a[124:127]
    s_waitcnt lgkmcnt(0) vmcnt(33)
    v_mfma_f32_16x16x32_bf16 a[0:3], a[132:135], v[224:227], a[0:3]
    ds_read_b64_tr_b16 a[128:129], v52 offset:0
    v_mfma_f32_16x16x32_bf16 a[4:7], a[132:135], v[228:231], a[4:7]
    v_mfma_f32_16x16x32_bf16 a[8:11], a[132:135], v[232:235], a[8:11]
    ds_read_b64_tr_b16 a[130:131], v52 offset:2048
    v_mfma_f32_16x16x32_bf16 a[12:15], a[132:135], v[236:239], a[12:15]
    v_mfma_f32_16x16x32_bf16 a[16:19], a[132:135], v[240:243], a[16:19]
    ds_read_b64_tr_b16 a[160:161], v53 offset:0
    v_mfma_f32_16x16x32_bf16 a[20:23], a[132:135], v[244:247], a[20:23]
    v_mfma_f32_16x16x32_bf16 a[24:27], a[132:135], v[248:251], a[24:27]
    ds_read_b64_tr_b16 a[162:163], v53 offset:2048
    v_mfma_f32_16x16x32_bf16 a[28:31], a[132:135], v[252:255], a[28:31]
    v_mfma_f32_16x16x32_bf16 a[32:35], a[164:167], v[224:227], a[32:35]
    ds_read_b64_tr_b16 a[192:193], v54 offset:0
    v_mfma_f32_16x16x32_bf16 a[36:39], a[164:167], v[228:231], a[36:39]
    v_mfma_f32_16x16x32_bf16 a[40:43], a[164:167], v[232:235], a[40:43]
    ds_read_b64_tr_b16 a[194:195], v54 offset:2048
    v_mfma_f32_16x16x32_bf16 a[44:47], a[164:167], v[236:239], a[44:47]
    v_mfma_f32_16x16x32_bf16 a[48:51], a[164:167], v[240:243], a[48:51]
    ds_read_b64_tr_b16 a[224:225], v55 offset:0
    v_mfma_f32_16x16x32_bf16 a[52:55], a[164:167], v[244:247], a[52:55]
    v_mfma_f32_16x16x32_bf16 a[56:59], a[164:167], v[248:251], a[56:59]
    ds_read_b64_tr_b16 a[226:227], v55 offset:2048
    v_mfma_f32_16x16x32_bf16 a[60:63], a[164:167], v[252:255], a[60:63]
    v_mfma_f32_16x16x32_bf16 a[64:67], a[196:199], v[224:227], a[64:67]
    v_mfma_f32_16x16x32_bf16 a[68:71], a[196:199], v[228:231], a[68:71]
    v_mfma_f32_16x16x32_bf16 a[72:75], a[196:199], v[232:235], a[72:75]
    v_mfma_f32_16x16x32_bf16 a[76:79], a[196:199], v[236:239], a[76:79]
    v_mfma_f32_16x16x32_bf16 a[80:83], a[196:199], v[240:243], a[80:83]
    v_mfma_f32_16x16x32_bf16 a[84:87], a[196:199], v[244:247], a[84:87]
    v_mfma_f32_16x16x32_bf16 a[88:91], a[196:199], v[248:251], a[88:91]
    v_mfma_f32_16x16x32_bf16 a[92:95], a[196:199], v[252:255], a[92:95]
    v_mfma_f32_16x16x32_bf16 a[96:99], a[228:231], v[224:227], a[96:99]
    v_mfma_f32_16x16x32_bf16 a[100:103], a[228:231], v[228:231], a[100:103]
    v_mfma_f32_16x16x32_bf16 a[104:107], a[228:231], v[232:235], a[104:107]
    v_mfma_f32_16x16x32_bf16 a[108:111], a[228:231], v[236:239], a[108:111]
    v_mfma_f32_16x16x32_bf16 a[112:115], a[228:231], v[240:243], a[112:115]
    v_mfma_f32_16x16x32_bf16 a[116:119], a[228:231], v[244:247], a[116:119]
    v_mfma_f32_16x16x32_bf16 a[120:123], a[228:231], v[248:251], a[120:123]
    v_mfma_f32_16x16x32_bf16 a[124:127], a[228:231], v[252:255], a[124:127]
    s_waitcnt vmcnt(0)
    v_cmp_eq_u32 vcc, s62, v7
    s_movk_i32 s34, 1024
    s_nop 2
    s_mov_b32 s75, vcc_lo
    s_and_b32 s3, s75, 268435455
    s_cmp_eq_u32 s3, 268435455
    s_cbranch_scc1 L_ok7
    s_mov_b32 s35, 0
L_sp7:
    buffer_load_dword v7, v26, s[48:51], s34 offen sc1
    s_waitcnt vmcnt(0)
    v_cmp_eq_u32 vcc, s62, v7
    s_add_u32 s35, s35, 1
    s_nop 2
    s_mov_b32 s75, vcc_lo
    s_and_b32 s3, s75, 268435455
    s_cmp_eq_u32 s3, 268435455
    s_cbranch_scc1 L_ok7
    s_sleep 2
    s_cmp_lt_u32 s35, 0x40000
    s_cbranch_scc1 L_sp7
L_ok7:
    s_waitcnt lgkmcnt(0) vmcnt(25)
    v_mfma_f32_16x16x32_bf16 a[0:3], a[128:131], v[64:67], a[0:3]
    ds_read_b64_tr_b16 a[132:133], v52 offset:4096
    s_mov_b32 s3, 0
    v_mfma_f32_16x16x32_bf16 a[4:7], a[128:131], v[68:71], a[4:7]
    buffer_load_dwordx4 v[192:195], v27, s[16:19], s3 offen
    v_mfma_f32_16x16x32_bf16 a[8:11], a[128:131], v[72:75], a[8:11]
    ds_read_b64_tr_b16 a[134:135], v52 offset:6144
    v_mfma_f32_16x16x32_bf16 a[12:15], a[128:131], v[76:79], a[12:15]
    buffer_load_dwordx4 v[196:199], v28, s[20:23], 0 offen sc1
    v_mfma_f32_16x16x32_bf16 a[16:19], a[128:131], v[80:83], a[16:19]
    ds_read_b64_tr_b16 a[164:165], v53 offset:4096
    v_mfma_f32_16x16x32_bf16 a[20:23], a[128:131], v[84:87], a[20:23]
    v_mfma_f32_16x16x32_bf16 a[24:27], a[128:131], v[88:91], a[24:27]
    ds_read_b64_tr_b16 a[166:167], v53 offset:6144
    buffer_load_dwordx4 v[200:203], v28, s[20:23], s36 offen sc1
    v_mfma_f32_16x16x32_bf16 a[28:31], a[128:131], v[92:95], a[28:31]
    s_mov_b32 s3, 16384
    v_mfma_f32_16x16x32_bf16 a[32:35], a[160:163], v[64:67], a[32:35]
    ds_read_b64_tr_b16 a[196:197], v54 offset:4096
    buffer_load_dwordx4 v[204:207], v27, s[16:19], s3 offen
    v_mfma_f32_16x16x32_bf16 a[36:39], a[160:163], v[68:71], a[36:39]
    v_mfma_f32_16x16x32_bf16 a[40:43], a[160:163], v[72:75], a[40:43]
    ds_read_b64_tr_b16 a[198:199], v54 offset:6144
    v_mfma_f32_16x16x32_bf16 a[44:47], a[160:163], v[76:79], a[44:47]
    buffer_load_dwordx4 v[208:211], v29, s[20:23], 0 offen sc1
    v_mfma_f32_16x16x32_bf16 a[48:51], a[160:163], v[80:83], a[48:51]
    ds_read_b64_tr_b16 a[228:229], v55 offset:4096
    v_mfma_f32_16x16x32_bf16 a[52:55], a[160:163], v[84:87], a[52:55]
    buffer_load_dwordx4 v[212:215], v29, s[20:23], s36 offen sc1
    v_mfma_f32_16x16x32_bf16 a[56:59], a[160:163], v[88:91], a[56:59]
    ds_read_b64_tr_b16 a[230:231], v55 offset:6144
    v_mfma_f32_16x16x32_bf16 a[60:63], a[160:163], v[92:95], a[60:63]
    s_mov_b32 s3, 32768
    v_mfma_f32_16x16x32_bf16 a[64:67], a[192:195], v[64:67], a[64:67]
    buffer_load_dwordx4 v[216:219], v27, s[16:19], s3 offen
    v_mfma_f32_16x16x32_bf16 a[68:71], a[192:195], v[68:71], a[68:71]
    v_mfma_f32_16x16x32_bf16 a[72:75], a[192:195], v[72:75], a[72:75]
    buffer_load_dwordx4 v[220:223], v30, s[20:23], 0 offen sc1
    v_mfma_f32_16x16x32_bf16 a[76:79], a[192:195], v[76:79], a[76:79]
    v_mfma_f32_16x16x32_bf16 a[80:83], a[192:195], v[80:83], a[80:83]
    v_mfma_f32_16x16x32_bf16 a[84:87], a[192:195], v[84:87], a[84:87]
    buffer_load_dwordx4 v[224:227], v30, s[20:23], s36 offen sc1
    v_mfma_f32_16x16x32_bf16 a[88:91], a[192:195], v[88:91], a[88:91]
    s_mov_b32 s3, 49152
    v_mfma_f32_16x16x32_bf16 a[92:95], a[192:195], v[92:95], a[92:95]
    buffer_load_dwordx4 v[228:231], v27, s[16:19], s3 offen
    v_mfma_f32_16x16x32_bf16 a[96:99], a[224:227], v[64:67], a[96:99]
    v_mfma_f32_16x16x32_bf16 a[100:103], a[224:227], v[68:71], a[100:103]
    v_mfma_f32_16x16x32_bf16 a[104:107], a[224:227], v[72:75], a[104:107]
    buffer_load_dwordx4 v[232:235], v31, s[20:23], 0 offen sc1
    v_mfma_f32_16x16x32_bf16 a[108:111], a[224:227], v[76:79], a[108:111]
    v_mfma_f32_16x16x32_bf16 a[112:115], a[224:227], v[80:83], a[112:115]
    buffer_load_dwordx4 v[236:239], v31, s[20:23], s36 offen sc1
    v_mfma_f32_16x16x32_bf16 a[116:119], a[224:227], v[84:87], a[116:119]
    v_mfma_f32_16x16x32_bf16 a[120:123], a[224:227], v[88:91], a[120:123]
    v_mfma_f32_16x16x32_bf16 a[124:127], a[224:227], v[92:95], a[124:127]
    s_waitcnt lgkmcnt(0) vmcnt(29)
    v_mfma_f32_16x16x32_bf16 a[0:3], a[132:135], v[96:99], a[0:3]
    ds_read_b64_tr_b16 a[128:129], v56 offset:0
    v_mfma_f32_16x16x32_bf16 a[4:7], a[132:135], v[100:103], a[4:7]
    v_mfma_f32_16x16x32_bf16 a[8:11], a[132:135], v[104:107], a[8:11]
    ds_read_b64_tr_b16 a[130:131], v56 offset:2048
    v_mfma_f32_16x16x32_bf16 a[12:15], a[132:135], v[108:111], a[12:15]
    v_mfma_f32_16x16x32_bf16 a[16:19], a[132:135], v[112:115], a[16:19]
    ds_read_b64_tr_b16 a[160:161], v57 offset:0
    v_mfma_f32_16x16x32_bf16 a[20:23], a[132:135], v[116:119], a[20:23]
    v_mfma_f32_16x16x32_bf16 a[24:27], a[132:135], v[120:123], a[24:27]
    ds_read_b64_tr_b16 a[162:163], v57 offset:2048
    v_mfma_f32_16x16x32_bf16 a[28:31], a[132:135], v[124:127], a[28:31]
    v_mfma_f32_16x16x32_bf16 a[32:35], a[164:167], v[96:99], a[32:35]
    ds_read_b64_tr_b16 a[192:193], v58 offset:0
    v_mfma_f32_16x16x32_bf16 a[36:39], a[164:167], v[100:103], a[36:39]
    v_mfma_f32_16x16x32_bf16 a[40:43], a[164:167], v[104:107], a[40:43]
    ds_read_b64_tr_b16 a[194:195], v58 offset:2048
    v_mfma_f32_16x16x32_bf16 a[44:47], a[164:167], v[108:111], a[44:47]
    v_mfma_f32_16x16x32_bf16 a[48:51], a[164:167], v[112:115], a[48:51]
    ds_read_b64_tr_b16 a[224:225], v59 offset:0
    v_mfma_f32_16x16x32_bf16 a[52:55], a[164:167], v[116:119], a[52:55]
    v_mfma_f32_16x16x32_bf16 a[56:59], a[164:167], v[120:123], a[56:59]
    ds_read_b64_tr_b16 a[226:227], v59 offset:2048
    v_mfma_f32_16x16x32_bf16 a[60:63], a[164:167], v[124:127], a[60:63]
    v_mfma_f32_16x16x32_bf16 a[64:67], a[196:199], v[96:99], a[64:67]
    v_mfma_f32_16x16x32_bf16 a[68:71], a[196:199], v[100:103], a[68:71]
    v_mfma_f32_16x16x32_bf16 a[72:75], a[196:199], v[104:107], a[72:75]
    v_mfma_f32_16x16x32_bf16 a[76:79], a[196:199], v[108:111], a[76:79]
    v_mfma_f32_16x16x32_bf16 a[80:83], a[196:199], v[112:115], a[80:83]
    v_mfma_f32_16x16x32_bf16 a[84:87], a[196:199], v[116:119], a[84:87]
    v_mfma_f32_16x16x32_bf16 a[88:91], a[196:199], v[120:123], a[88:91]
    v_mfma_f32_16x16x32_bf16 a[92:95], a[196:199], v[124:127], a[92:95]
    v_mfma_f32_16x16x32_bf16 a[96:99], a[228:231], v[96:99], a[96:99]
    v_mfma_f32_16x16x32_bf16 a[100:103], a[228:231], v[100:103], a[100:103]
    v_mfma_f32_16x16x32_bf16 a[104:107], a[228:231], v[104:107], a[104:107]
    v_mfma_f32_16x16x32_bf16 a[108:111], a[228:231], v[108:111], a[108:111]
    v_mfma_f32_16x16x32_bf16 a[112:115], a[228:231], v[112:115], a[112:115]
    v_mfma_f32_16x16x32_bf16 a[116:119], a[228:231], v[116:119], a[116:119]
    v_mfma_f32_16x16x32_bf16 a[120:123], a[228:231], v[120:123], a[120:123]
    v_mfma_f32_16x16x32_bf16 a[124:127], a[228:231], v[124:127], a[124:127]
    s_waitcnt lgkmcnt(0) vmcnt(21)
    v_mfma_f32_16x16x32_bf16 a[0:3], a[128:131], v[128:131], a[0:3]
    ds_read_b64_tr_b16 a[132:133], v56 offset:4096
    v_mfma_f32_16x16x32_bf16 a[4:7], a[128:131], v[132:135], a[4:7]
    v_mfma_f32_16x16x32_bf16 a[8:11], a[128:131], v[136:139], a[8:11]
    ds_read_b64_tr_b16 a[134:135], v56 offset:6144
    v_mfma_f32_16x16x32_bf16 a[12:15], a[128:131], v[140:143], a[12:15]
    v_mfma_f32_16x16x32_bf16 a[16:19], a[128:131], v[144:147], a[16:19]
    ds_read_b64_tr_b16 a[164:165], v57 offset:4096
    v_mfma_f32_16x16x32_bf16 a[20:23], a[128:131], v[148:151], a[20:23]
    v_mfma_f32_16x16x32_bf16 a[24:27], a[128:131], v[152:155], a[24:27]
    ds_read_b64_tr_b16 a[166:167], v57 offset:6144
    v_mfma_f32_16x16x32_bf16 a[28:31], a[128:131], v[156:159], a[28:31]
    v_mfma_f32_16x16x32_bf16 a[32:35], a[160:163], v[128:131], a[32:35]
    ds_read_b64_tr_b16 a[196:197], v58 offset:4096
    v_mfma_f32_16x16x32_bf16 a[36:39], a[160:163], v[132:135], a[36:39]
    v_mfma_f32_16x16x32_bf16 a[40:43], a[160:163], v[136:139], a[40:43]
    ds_read_b64_tr_b16 a[198:199], v58 offset:6144
    v_mfma_f32_16x16x32_bf16 a[44:47], a[160:163], v[140:143], a[44:47]
    v_mfma_f32_16x16x32_bf16 a[48:51], a[160:163], v[144:147], a[48:51]
    ds_read_b64_tr_b16 a[228:229], v59 offset:4096
    v_mfma_f32_16x16x32_bf16 a[52:55], a[160:163], v[148:151], a[52:55]
    v_mfma_f32_16x16x32_bf16 a[56:59], a[160:163], v[152:155], a[56:59]
    ds_read_b64_tr_b16 a[230:231], v59 offset:6144
    v_mfma_f32_16x16x32_bf16 a[60:63], a[160:163], v[156:159], a[60:63]
    v_mfma_f32_16x16x32_bf16 a[64:67], a[192:195], v[128:131], a[64:67]
    v_mfma_f32_16x16x32_bf16 a[68:71], a[192:195], v[132:135], a[68:71]
    v_mfma_f32_16x16x32_bf16 a[72:75], a[192:195], v[136:139], a[72:75]
    v_mfma_f32_16x16x32_bf16 a[76:79], a[192:195], v[140:143], a[76:79]
    v_mfma_f32_16x16x32_bf16 a[80:83], a[192:195], v[144:147], a[80:83]
    v_mfma_f32_16x16x32_bf16 a[84:87], a[192:195], v[148:151], a[84:87]
    v_mfma_f32_16x16x32_bf16 a[88:91], a[192:195], v[152:155], a[88:91]
    v_mfma_f32_16x16x32_bf16 a[92:95], a[192:195], v[156:159], a[92:95]
    v_mfma_f32_16x16x32_bf16 a[96:99], a[224:227], v[128:131], a[96:99]
    v_mfma_f32_16x16x32_bf16 a[100:103], a[224:227], v[132:135], a[100:103]
    v_mfma_f32_16x16x32_bf16 a[104:107], a[224:227], v[136:139], a[104:107]
    v_mfma_f32_16x16x32_bf16 a[108:111], a[224:227], v[140:143], a[108:111]
    v_mfma_f32_16x16x32_bf16 a[112:115], a[224:227], v[144:147], a[112:115]
    v_mfma_f32_16x16x32_bf16 a[116:119], a[224:227], v[148:151], a[116:119]
    v_mfma_f32_16x16x32_bf16 a[120:123], a[224:227], v[152:155], a[120:123]
    v_mfma_f32_16x16x32_bf16 a[124:127], a[224:227], v[156:159], a[124:127]
    s_waitcnt lgkmcnt(0) vmcnt(13)
    v_mfma_f32_16x16x32_bf16 a[0:3], a[132:135], v[160:163], a[0:3]
    v_mfma_f32_16x16x32_bf16 a[32:35], a[164:167], v[160:163], a[32:35]
    v_mfma_f32_16x16x32_bf16 a[64:67], a[196:199], v[160:163], a[64:67]
    v_mfma_f32_16x16x32_bf16 a[96:99], a[228:231], v[160:163], a[96:99]
    v_mfma_f32_16x16x32_bf16 a[4:7], a[132:135], v[164:167], a[4:7]
    v_mfma_f32_16x16x32_bf16 a[36:39], a[164:167], v[164:167], a[36:39]
    v_mfma_f32_16x16x32_bf16 a[68:71], a[196:199], v[164:167], a[68:71]
    v_mfma_f32_16x16x32_bf16 a[100:103], a[228:231], v[164:167], a[100:103]
    v_mfma_f32_16x16x32_bf16 a[8:11], a[132:135], v[168:171], a[8:11]
    ds_write_b128 v22, a[0:3] offset:0
    v_mfma_f32_16x16x32_bf16 a[40:43], a[164:167], v[168:171], a[40:43]
    ds_write_b128 v23, a[32:35] offset:0
    v_mfma_f32_16x16x32_bf16 a[72:75], a[196:199], v[168:171], a[72:75]
    ds_write_b128 v22, a[64:67] offset:128
    v_mfma_f32_16x16x32_bf16 a[104:107], a[228:231], v[168:171], a[104:107]
    ds_write_b128 v23, a[96:99] offset:128
    v_mfma_f32_16x16x32_bf16 a[12:15], a[132:135], v[172:175], a[12:15]
    ds_write_b128 v22, a[4:7] offset:4096
    v_mfma_f32_16x16x32_bf16 a[44:47], a[164:167], v[172:175], a[44:47]
    ds_write_b128 v23, a[36:39] offset:4096
    v_mfma_f32_16x16x32_bf16 a[76:79], a[196:199], v[172:175], a[76:79]
    ds_write_b128 v22, a[68:71] offset:4224
    v_mfma_f32_16x16x32_bf16 a[108:111], a[228:231], v[172:175], a[108:111]
    ds_write_b128 v23, a[100:103] offset:4224
    v_mfma_f32_16x16x32_bf16 a[16:19], a[132:135], v[176:179], a[16:19]
    ds_write_b128 v22, a[8:11] offset:8192
    v_mfma_f32_16x16x32_bf16 a[48:51], a[164:167], v[176:179], a[48:51]
    ds_write_b128 v23, a[40:43] offset:8192
    v_mfma_f32_16x16x32_bf16 a[80:83], a[196:199], v[176:179], a[80:83]
    ds_write_b128 v22, a[72:75] offset:8320
    v_mfma_f32_16x16x32_bf16 a[112:115], a[228:231], v[176:179], a[112:115]
    ds_write_b128 v23, a[104:107] offset:8320
    v_mfma_f32_16x16x32_bf16 a[20:23], a[132:135], v[180:183], a[20:23]
    ds_write_b128 v22, a[12:15] offset:12288
    v_mfma_f32_16x16x32_bf16 a[52:55], a[164:167], v[180:183], a[52:55]
    ds_write_b128 v23, a[44:47] offset:12288
    v_mfma_f32_16x16x32_bf16 a[84:87], a[196:199], v[180:183], a[84:87]
    ds_write_b128 v22, a[76:79] offset:12416
    v_mfma_f32_16x16x32_bf16 a[116:119], a[228:231], v[180:183], a[116:119]
    ds_write_b128 v23, a[108:111] offset:12416
    v_mfma_f32_16x16x32_bf16 a[24:27], a[132:135], v[184:187], a[24:27]
    ds_write_b128 v24, a[16:19] offset:0
    v_mfma_f32_16x16x32_bf16 a[56:59], a[164:167], v[184:187], a[56:59]
    ds_write_b128 v25, a[48:51] offset:0
    v_mfma_f32_16x16x32_bf16 a[88:91], a[196:199], v[184:187], a[88:91]
    ds_write_b128 v24, a[80:83] offset:128
    v_mfma_f32_16x16x32_bf16 a[120:123], a[228:231], v[184:187], a[120:123]
    ds_write_b128 v25, a[112:115] offset:128
    v_mfma_f32_16x16x32_bf16 a[28:31], a[132:135], v[188:191], a[28:31]
    ds_write_b128 v24, a[20:23] offset:4096
    v_mfma_f32_16x16x32_bf16 a[60:63], a[164:167], v[188:191], a[60:63]
    ds_write_b128 v25, a[52:55] offset:4096
    v_mfma_f32_16x16x32_bf16 a[92:95], a[196:199], v[188:191], a[92:95]
    ds_write_b128 v24, a[84:87] offset:4224
    v_mfma_f32_16x16x32_bf16 a[124:127], a[228:231], v[188:191], a[124:127]
    ds_write_b128 v25, a[116:119] offset:4224
    s_nop 4
    ds_write_b128 v24, a[24:27] offset:8192
    ds_write_b128 v25, a[56:59] offset:8192
    ds_write_b128 v24, a[88:91] offset:8320
    ds_write_b128 v25, a[120:123] offset:8320
    ds_write_b128 v24, a[28:31] offset:12288
    ds_write_b128 v25, a[60:63] offset:12288
    ds_write_b128 v24, a[92:95] offset:12416
    ds_write_b128 v25, a[124:127] offset:12416
    s_waitcnt lgkmcnt(0)
    s_barrier
    ds_read_b128 v[64:67], v20 offset:0
    ds_read_b128 v[68:71], v21 offset:0
    ds_read_b128 v[72:75], v20 offset:16384
    ds_read_b128 v[76:79], v21 offset:16384
    ds_read_b128 v[80:83], v20 offset:32768
    ds_read_b128 v[84:87], v21 offset:32768
    ds_read_b128 v[88:91], v20 offset:49152
    ds_read_b128 v[92:95], v21 offset:49152
    ds_read_b128 v[96:99], v20 offset:2048
    ds_read_b128 v[100:103], v21 offset:2048
    ds_read_b128 v[104:107], v20 offset:18432
    ds_read_b128 v[108:111], v21 offset:18432
    ds_read_b128 v[112:115], v20 offset:34816
    ds_read_b128 v[116:119], v21 offset:34816
    ds_read_b128 v[120:123], v20 offset:51200
    ds_read_b128 v[124:127], v21 offset:51200
    ds_read_b128 v[128:131], v20 offset:4096
    ds_read_b128 v[132:135], v21 offset:4096
    ds_read_b128 v[136:139], v20 offset:20480
    ds_read_b128 v[140:143], v21 offset:20480
    ds_read_b128 v[144:147], v20 offset:36864
    ds_read_b128 v[148:151], v21 offset:36864
    ds_read_b128 v[152:155], v20 offset:53248
    ds_read_b128 v[156:159], v21 offset:53248
    ds_read_b128 v[160:163], v20 offset:6144
    ds_read_b128 v[164:167], v21 offset:6144
    ds_read_b128 v[168:171], v20 offset:22528
    ds_read_b128 v[172:175], v21 offset:22528
    ds_read_b128 v[176:179], v20 offset:38912
    ds_read_b128 v[180:183], v21 offset:38912
    ds_read_b128 v[184:187], v20 offset:55296
    ds_read_b128 v[188:191], v21 offset:55296
    s_cmp_ge_u32 s53, 8
    s_cbranch_scc1 L_fin1
    s_waitcnt lgkmcnt(15)
    s_waitcnt lgkmcnt(15)
    v_pk_add_f32 v[64:65], v[64:65], v[72:73]
    v_pk_add_f32 v[66:67], v[66:67], v[74:75]
    v_pk_add_f32 v[68:69], v[68:69], v[76:77]
    v_pk_add_f32 v[70:71], v[70:71], v[78:79]
    v_pk_add_f32 v[80:81], v[80:81], v[88:89]
    v_pk_add_f32 v[82:83], v[82:83], v[90:91]
    v_pk_add_f32 v[84:85], v[84:85], v[92:93]
    v_pk_add_f32 v[86:87], v[86:87], v[94:95]
    v_pk_add_f32 v[64:65], v[64:65], v[80:81]
    v_pk_add_f32 v[66:67], v[66:67], v[82:83]
    v_pk_add_f32 v[68:69], v[68:69], v[84:85]
    v_pk_add_f32 v[70:71], v[70:71], v[86:87]
    v_pk_mul_f32 v[32:33], v[64:65], s[58:59]
    v_pk_mul_f32 v[34:35], v[66:67], s[58:59]
    v_pk_mul_f32 v[36:37], v[68:69], s[58:59]
    v_pk_mul_f32 v[38:39], v[70:71], s[58:59]
    v_exp_f32 v32, v32
    v_exp_f32 v33, v33
    v_exp_f32 v34, v34
    v_exp_f32 v35, v35
    v_exp_f32 v36, v36
    v_exp_f32 v37, v37
    v_exp_f32 v38, v38
    v_exp_f32 v39, v39
    s_waitcnt vmcnt(9)
    v_lshlrev_b32 v40, 16, v196
    v_and_b32 v41, s39, v196
    v_lshlrev_b32 v48, 16, v200
    v_and_b32 v49, s39, v200
    v_lshlrev_b32 v42, 16, v197
    v_and_b32 v43, s39, v197
    v_lshlrev_b32 v50, 16, v201
    v_and_b32 v51, s39, v201
    v_lshlrev_b32 v44, 16, v198
    v_and_b32 v45, s39, v198
    v_lshlrev_b32 v52, 16, v202
    v_and_b32 v53, s39, v202
    v_lshlrev_b32 v46, 16, v199
    v_and_b32 v47, s39, v199
    v_lshlrev_b32 v54, 16, v203
    v_and_b32 v55, s39, v203
    v_pk_add_f32 v[32:33], v[32:33], 1.0 op_sel_hi:[1,0]
    v_pk_add_f32 v[34:35], v[34:35], 1.0 op_sel_hi:[1,0]
    v_pk_add_f32 v[36:37], v[36:37], 1.0 op_sel_hi:[1,0]
    v_pk_add_f32 v[38:39], v[38:39], 1.0 op_sel_hi:[1,0]
    v_rcp_f32 v32, v32
    v_rcp_f32 v33, v33
    v_rcp_f32 v34, v34
    v_rcp_f32 v35, v35
    v_rcp_f32 v36, v36
    v_rcp_f32 v37, v37
    v_rcp_f32 v38, v38
    v_rcp_f32 v39, v39
    v_pk_fma_f32 v[40:41], v[48:49], s[56:57], v[40:41]
    v_pk_fma_f32 v[42:43], v[50:51], s[56:57], v[42:43]
    v_pk_fma_f32 v[44:45], v[52:53], s[56:57], v[44:45]
    v_pk_fma_f32 v[46:47], v[54:55], s[56:57], v[46:47]
    v_lshlrev_b32 v48, 16, v192
    v_and_b32 v49, s39, v192
    v_lshlrev_b32 v50, 16, v193
    v_and_b32 v51, s39, v193
    v_lshlrev_b32 v52, 16, v194
    v_and_b32 v53, s39, v194
    v_lshlrev_b32 v54, 16, v195
    v_and_b32 v55, s39, v195
    v_pk_mul_f32 v[32:33], v[32:33], v[64:65]
    v_pk_mul_f32 v[34:35], v[34:35], v[66:67]
    v_pk_mul_f32 v[36:37], v[36:37], v[68:69]
    v_pk_mul_f32 v[38:39], v[38:39], v[70:71]
    v_pk_fma_f32 v[32:33], v[32:33], v[40:41], v[48:49]
    v_pk_fma_f32 v[34:35], v[34:35], v[42:43], v[50:51]
    v_pk_fma_f32 v[36:37], v[36:37], v[44:45], v[52:53]
    v_pk_fma_f32 v[38:39], v[38:39], v[46:47], v[54:55]
    v_cvt_pk_bf16_f32 v192, v32, v33
    v_cvt_pk_bf16_f32 v193, v34, v35
    v_cvt_pk_bf16_f32 v194, v36, v37
    v_cvt_pk_bf16_f32 v195, v38, v39
    s_mov_b32 s3, 0
    buffer_store_dwordx4 v[192:195], v27, s[8:11], s3 offen
    s_waitcnt lgkmcnt(15)
    v_pk_add_f32 v[96:97], v[96:97], v[104:105]
    v_pk_add_f32 v[98:99], v[98:99], v[106:107]
    v_pk_add_f32 v[100:101], v[100:101], v[108:109]
    v_pk_add_f32 v[102:103], v[102:103], v[110:111]
    v_pk_add_f32 v[112:113], v[112:113], v[120:121]
    v_pk_add_f32 v[114:115], v[114:115], v[122:123]
    v_pk_add_f32 v[116:117], v[116:117], v[124:125]
    v_pk_add_f32 v[118:119], v[118:119], v[126:127]
    v_pk_add_f32 v[96:97], v[96:97], v[112:113]
    v_pk_add_f32 v[98:99], v[98:99], v[114:115]
    v_pk_add_f32 v[100:101], v[100:101], v[116:117]
    v_pk_add_f32 v[102:103], v[102:103], v[118:119]
    v_pk_mul_f32 v[32:33], v[96:97], s[58:59]
    v_pk_mul_f32 v[34:35], v[98:99], s[58:59]
    v_pk_mul_f32 v[36:37], v[100:101], s[58:59]
    v_pk_mul_f32 v[38:39], v[102:103], s[58:59]
    v_exp_f32 v32, v32
    v_exp_f32 v33, v33
    v_exp_f32 v34, v34
    v_exp_f32 v35, v35
    v_exp_f32 v36, v36
    v_exp_f32 v37, v37
    v_exp_f32 v38, v38
    v_exp_f32 v39, v39
    s_waitcnt vmcnt(7)
    v_lshlrev_b32 v40, 16, v208
    v_and_b32 v41, s39, v208
    v_lshlrev_b32 v48, 16, v212
    v_and_b32 v49, s39, v212
    v_lshlrev_b32 v42, 16, v209
    v_and_b32 v43, s39, v209
    v_lshlrev_b32 v50, 16, v213
    v_and_b32 v51, s39, v213
    v_lshlrev_b32 v44, 16, v210
    v_and_b32 v45, s39, v210
    v_lshlrev_b32 v52, 16, v214
    v_and_b32 v53, s39, v214
    v_lshlrev_b32 v46, 16, v211
    v_and_b32 v47, s39, v211
    v_lshlrev_b32 v54, 16, v215
    v_and_b32 v55, s39, v215
    v_pk_add_f32 v[32:33], v[32:33], 1.0 op_sel_hi:[1,0]
    v_pk_add_f32 v[34:35], v[34:35], 1.0 op_sel_hi:[1,0]
    v_pk_add_f32 v[36:37], v[36:37], 1.0 op_sel_hi:[1,0]
    v_pk_add_f32 v[38:39], v[38:39], 1.0 op_sel_hi:[1,0]
    v_rcp_f32 v32, v32
    v_rcp_f32 v33, v33
    v_rcp_f32 v34, v34
    v_rcp_f32 v35, v35
    v_rcp_f32 v36, v36
    v_rcp_f32 v37, v37
    v_rcp_f32 v38, v38
    v_rcp_f32 v39, v39
    v_pk_fma_f32 v[40:41], v[48:49], s[56:57], v[40:41]
    v_pk_fma_f32 v[42:43], v[50:51], s[56:57], v[42:43]
    v_pk_fma_f32 v[44:45], v[52:53], s[56:57], v[44:45]
    v_pk_fma_f32 v[46:47], v[54:55], s[56:57], v[46:47]
    v_lshlrev_b32 v48, 16, v204
    v_and_b32 v49, s39, v204
    v_lshlrev_b32 v50, 16, v205
    v_and_b32 v51, s39, v205
    v_lshlrev_b32 v52, 16, v206
    v_and_b32 v53, s39, v206
    v_lshlrev_b32 v54, 16, v207
    v_and_b32 v55, s39, v207
    v_pk_mul_f32 v[32:33], v[32:33], v[96:97]
    v_pk_mul_f32 v[34:35], v[34:35], v[98:99]
    v_pk_mul_f32 v[36:37], v[36:37], v[100:101]
    v_pk_mul_f32 v[38:39], v[38:39], v[102:103]
    v_pk_fma_f32 v[32:33], v[32:33], v[40:41], v[48:49]
    v_pk_fma_f32 v[34:35], v[34:35], v[42:43], v[50:51]
    v_pk_fma_f32 v[36:37], v[36:37], v[44:45], v[52:53]
    v_pk_fma_f32 v[38:39], v[38:39], v[46:47], v[54:55]
    v_cvt_pk_bf16_f32 v204, v32, v33
    v_cvt_pk_bf16_f32 v205, v34, v35
    v_cvt_pk_bf16_f32 v206, v36, v37
    v_cvt_pk_bf16_f32 v207, v38, v39
    s_mov_b32 s3, 16384
    buffer_store_dwordx4 v[204:207], v27, s[8:11], s3 offen
    s_waitcnt lgkmcnt(8)
    v_pk_add_f32 v[128:129], v[128:129], v[136:137]
    v_pk_add_f32 v[130:131], v[130:131], v[138:139]
    v_pk_add_f32 v[132:133], v[132:133], v[140:141]
    v_pk_add_f32 v[134:135], v[134:135], v[142:143]
    v_pk_add_f32 v[144:145], v[144:145], v[152:153]
    v_pk_add_f32 v[146:147], v[146:147], v[154:155]
    v_pk_add_f32 v[148:149], v[148:149], v[156:157]
    v_pk_add_f32 v[150:151], v[150:151], v[158:159]
    v_pk_add_f32 v[128:129], v[128:129], v[144:145]
    v_pk_add_f32 v[130:131], v[130:131], v[146:147]
    v_pk_add_f32 v[132:133], v[132:133], v[148:149]
    v_pk_add_f32 v[134:135], v[134:135], v[150:151]
    v_pk_mul_f32 v[32:33], v[128:129], s[58:59]
    v_pk_mul_f32 v[34:35], v[130:131], s[58:59]
    v_pk_mul_f32 v[36:37], v[132:133], s[58:59]
    v_pk_mul_f32 v[38:39], v[134:135], s[58:59]
    v_exp_f32 v32, v32
    v_exp_f32 v33, v33
    v_exp_f32 v34, v34
    v_exp_f32 v35, v35
    v_exp_f32 v36, v36
    v_exp_f32 v37, v37
    v_exp_f32 v38, v38
    v_exp_f32 v39, v39
    s_waitcnt vmcnt(5)
    v_lshlrev_b32 v40, 16, v220
    v_and_b32 v41, s39, v220
    v_lshlrev_b32 v48, 16, v224
    v_and_b32 v49, s39, v224
    v_lshlrev_b32 v42, 16, v221
    v_and_b32 v43, s39, v221
    v_lshlrev_b32 v50, 16, v225
    v_and_b32 v51, s39, v225
    v_lshlrev_b32 v44, 16, v222
    v_and_b32 v45, s39, v222
    v_lshlrev_b32 v52, 16, v226
    v_and_b32 v53, s39, v226
    v_lshlrev_b32 v46, 16, v223
    v_and_b32 v47, s39, v223
    v_lshlrev_b32 v54, 16, v227
    v_and_b32 v55, s39, v227
    v_pk_add_f32 v[32:33], v[32:33], 1.0 op_sel_hi:[1,0]
    v_pk_add_f32 v[34:35], v[34:35], 1.0 op_sel_hi:[1,0]
    v_pk_add_f32 v[36:37], v[36:37], 1.0 op_sel_hi:[1,0]
    v_pk_add_f32 v[38:39], v[38:39], 1.0 op_sel_hi:[1,0]
    v_rcp_f32 v32, v32
    v_rcp_f32 v33, v33
    v_rcp_f32 v34, v34
    v_rcp_f32 v35, v35
    v_rcp_f32 v36, v36
    v_rcp_f32 v37, v37
    v_rcp_f32 v38, v38
    v_rcp_f32 v39, v39
    v_pk_fma_f32 v[40:41], v[48:49], s[56:57], v[40:41]
    v_pk_fma_f32 v[42:43], v[50:51], s[56:57], v[42:43]
    v_pk_fma_f32 v[44:45], v[52:53], s[56:57], v[44:45]
    v_pk_fma_f32 v[46:47], v[54:55], s[56:57], v[46:47]
    v_lshlrev_b32 v48, 16, v216
    v_and_b32 v49, s39, v216
    v_lshlrev_b32 v50, 16, v217
    v_and_b32 v51, s39, v217
    v_lshlrev_b32 v52, 16, v218
    v_and_b32 v53, s39, v218
    v_lshlrev_b32 v54, 16, v219
    v_and_b32 v55, s39, v219
    v_pk_mul_f32 v[32:33], v[32:33], v[128:129]
    v_pk_mul_f32 v[34:35], v[34:35], v[130:131]
    v_pk_mul_f32 v[36:37], v[36:37], v[132:133]
    v_pk_mul_f32 v[38:39], v[38:39], v[134:135]
    v_pk_fma_f32 v[32:33], v[32:33], v[40:41], v[48:49]
    v_pk_fma_f32 v[34:35], v[34:35], v[42:43], v[50:51]
    v_pk_fma_f32 v[36:37], v[36:37], v[44:45], v[52:53]
    v_pk_fma_f32 v[38:39], v[38:39], v[46:47], v[54:55]
    v_cvt_pk_bf16_f32 v216, v32, v33
    v_cvt_pk_bf16_f32 v217, v34, v35
    v_cvt_pk_bf16_f32 v218, v36, v37
    v_cvt_pk_bf16_f32 v219, v38, v39
    s_mov_b32 s3, 32768
    buffer_store_dwordx4 v[216:219], v27, s[8:11], s3 offen
    s_waitcnt lgkmcnt(0)
    v_pk_add_f32 v[160:161], v[160:161], v[168:169]
    v_pk_add_f32 v[162:163], v[162:163], v[170:171]
    v_pk_add_f32 v[164:165], v[164:165], v[172:173]
    v_pk_add_f32 v[166:167], v[166:167], v[174:175]
    v_pk_add_f32 v[176:177], v[176:177], v[184:185]
    v_pk_add_f32 v[178:179], v[178:179], v[186:187]
    v_pk_add_f32 v[180:181], v[180:181], v[188:189]
    v_pk_add_f32 v[182:183], v[182:183], v[190:191]
    v_pk_add_f32 v[160:161], v[160:161], v[176:177]
    v_pk_add_f32 v[162:163], v[162:163], v[178:179]
    v_pk_add_f32 v[164:165], v[164:165], v[180:181]
    v_pk_add_f32 v[166:167], v[166:167], v[182:183]
    v_pk_mul_f32 v[32:33], v[160:161], s[58:59]
    v_pk_mul_f32 v[34:35], v[162:163], s[58:59]
    v_pk_mul_f32 v[36:37], v[164:165], s[58:59]
    v_pk_mul_f32 v[38:39], v[166:167], s[58:59]
    v_exp_f32 v32, v32
    v_exp_f32 v33, v33
    v_exp_f32 v34, v34
    v_exp_f32 v35, v35
    v_exp_f32 v36, v36
    v_exp_f32 v37, v37
    v_exp_f32 v38, v38
    v_exp_f32 v39, v39
    s_waitcnt vmcnt(3)
    v_lshlrev_b32 v40, 16, v232
    v_and_b32 v41, s39, v232
    v_lshlrev_b32 v48, 16, v236
    v_and_b32 v49, s39, v236
    v_lshlrev_b32 v42, 16, v233
    v_and_b32 v43, s39, v233
    v_lshlrev_b32 v50, 16, v237
    v_and_b32 v51, s39, v237
    v_lshlrev_b32 v44, 16, v234
    v_and_b32 v45, s39, v234
    v_lshlrev_b32 v52, 16, v238
    v_and_b32 v53, s39, v238
    v_lshlrev_b32 v46, 16, v235
    v_and_b32 v47, s39, v235
    v_lshlrev_b32 v54, 16, v239
    v_and_b32 v55, s39, v239
    v_pk_add_f32 v[32:33], v[32:33], 1.0 op_sel_hi:[1,0]
    v_pk_add_f32 v[34:35], v[34:35], 1.0 op_sel_hi:[1,0]
    v_pk_add_f32 v[36:37], v[36:37], 1.0 op_sel_hi:[1,0]
    v_pk_add_f32 v[38:39], v[38:39], 1.0 op_sel_hi:[1,0]
    v_rcp_f32 v32, v32
    v_rcp_f32 v33, v33
    v_rcp_f32 v34, v34
    v_rcp_f32 v35, v35
    v_rcp_f32 v36, v36
    v_rcp_f32 v37, v37
    v_rcp_f32 v38, v38
    v_rcp_f32 v39, v39
    v_pk_fma_f32 v[40:41], v[48:49], s[56:57], v[40:41]
    v_pk_fma_f32 v[42:43], v[50:51], s[56:57], v[42:43]
    v_pk_fma_f32 v[44:45], v[52:53], s[56:57], v[44:45]
    v_pk_fma_f32 v[46:47], v[54:55], s[56:57], v[46:47]
    v_lshlrev_b32 v48, 16, v228
    v_and_b32 v49, s39, v228
    v_lshlrev_b32 v50, 16, v229
    v_and_b32 v51, s39, v229
    v_lshlrev_b32 v52, 16, v230
    v_and_b32 v53, s39, v230
    v_lshlrev_b32 v54, 16, v231
    v_and_b32 v55, s39, v231
    v_pk_mul_f32 v[32:33], v[32:33], v[160:161]
    v_pk_mul_f32 v[34:35], v[34:35], v[162:163]
    v_pk_mul_f32 v[36:37], v[36:37], v[164:165]
    v_pk_mul_f32 v[38:39], v[38:39], v[166:167]
    v_pk_fma_f32 v[32:33], v[32:33], v[40:41], v[48:49]
    v_pk_fma_f32 v[34:35], v[34:35], v[42:43], v[50:51]
    v_pk_fma_f32 v[36:37], v[36:37], v[44:45], v[52:53]
    v_pk_fma_f32 v[38:39], v[38:39], v[46:47], v[54:55]
    v_cvt_pk_bf16_f32 v228, v32, v33
    v_cvt_pk_bf16_f32 v229, v34, v35
    v_cvt_pk_bf16_f32 v230, v36, v37
    v_cvt_pk_bf16_f32 v231, v38, v39
    s_mov_b32 s3, 49152
    buffer_store_dwordx4 v[228:231], v27, s[8:11], s3 offen
    s_branch L_fin
L_fin1:
    s_waitcnt lgkmcnt(15)
    s_waitcnt lgkmcnt(15)
    v_pk_add_f32 v[64:65], v[64:65], v[72:73]
    v_pk_add_f32 v[66:67], v[66:67], v[74:75]
    v_pk_add_f32 v[68:69], v[68:69], v[76:77]
    v_pk_add_f32 v[70:71], v[70:71], v[78:79]
    v_pk_add_f32 v[80:81], v[80:81], v[88:89]
    v_pk_add_f32 v[82:83], v[82:83], v[90:91]
    v_pk_add_f32 v[84:85], v[84:85], v[92:93]
    v_pk_add_f32 v[86:87], v[86:87], v[94:95]
    v_pk_add_f32 v[64:65], v[64:65], v[80:81]
    v_pk_add_f32 v[66:67], v[66:67], v[82:83]
    v_pk_add_f32 v[68:69], v[68:69], v[84:85]
    v_pk_add_f32 v[70:71], v[70:71], v[86:87]
    v_pk_mul_f32 v[32:33], v[64:65], s[58:59]
    v_pk_mul_f32 v[34:35], v[66:67], s[58:59]
    v_pk_mul_f32 v[36:37], v[68:69], s[58:59]
    v_pk_mul_f32 v[38:39], v[70:71], s[58:59]
    v_exp_f32 v32, v32
    v_exp_f32 v33, v33
    v_exp_f32 v34, v34
    v_exp_f32 v35, v35
    v_exp_f32 v36, v36
    v_exp_f32 v37, v37
    v_exp_f32 v38, v38
    v_exp_f32 v39, v39
    s_waitcnt vmcnt(9)
    v_lshlrev_b32 v47, 16, v196
    v_and_b32 v46, s39, v196
    v_lshlrev_b32 v55, 16, v200
    v_and_b32 v54, s39, v200
    v_lshlrev_b32 v45, 16, v197
    v_and_b32 v44, s39, v197
    v_lshlrev_b32 v53, 16, v201
    v_and_b32 v52, s39, v201
    v_lshlrev_b32 v43, 16, v198
    v_and_b32 v42, s39, v198
    v_lshlrev_b32 v51, 16, v202
    v_and_b32 v50, s39, v202
    v_lshlrev_b32 v41, 16, v199
    v_and_b32 v40, s39, v199
    v_lshlrev_b32 v49, 16, v203
    v_and_b32 v48, s39, v203
    v_pk_add_f32 v[32:33], v[32:33], 1.0 op_sel_hi:[1,0]
    v_pk_add_f32 v[34:35], v[34:35], 1.0 op_sel_hi:[1,0]
    v_pk_add_f32 v[36:37], v[36:37], 1.0 op_sel_hi:[1,0]
    v_pk_add_f32 v[38:39], v[38:39], 1.0 op_sel_hi:[1,0]
    v_rcp_f32 v32, v32
    v_rcp_f32 v33, v33
    v_rcp_f32 v34, v34
    v_rcp_f32 v35, v35
    v_rcp_f32 v36, v36
    v_rcp_f32 v37, v37
    v_rcp_f32 v38, v38
    v_rcp_f32 v39, v39
    v_pk_fma_f32 v[40:41], v[48:49], s[56:57], v[40:41]
    v_pk_fma_f32 v[42:43], v[50:51], s[56:57], v[42:43]
    v_pk_fma_f32 v[44:45], v[52:53], s[56:57], v[44:45]
    v_pk_fma_f32 v[46:47], v[54:55], s[56:57], v[46:47]
    v_lshlrev_b32 v48, 16, v192
    v_and_b32 v49, s39, v192
    v_lshlrev_b32 v50, 16, v193
    v_and_b32 v51, s39, v193
    v_lshlrev_b32 v52, 16, v194
    v_and_b32 v53, s39, v194
    v_lshlrev_b32 v54, 16, v195
    v_and_b32 v55, s39, v195
    v_pk_mul_f32 v[32:33], v[32:33], v[64:65]
    v_pk_mul_f32 v[34:35], v[34:35], v[66:67]
    v_pk_mul_f32 v[36:37], v[36:37], v[68:69]
    v_pk_mul_f32 v[38:39], v[38:39], v[70:71]
    v_pk_fma_f32 v[32:33], v[32:33], v[40:41], v[48:49]
    v_pk_fma_f32 v[34:35], v[34:35], v[42:43], v[50:51]
    v_pk_fma_f32 v[36:37], v[36:37], v[44:45], v[52:53]
    v_pk_fma_f32 v[38:39], v[38:39], v[46:47], v[54:55]
    v_cvt_pk_bf16_f32 v192, v32, v33
    v_cvt_pk_bf16_f32 v193, v34, v35
    v_cvt_pk_bf16_f32 v194, v36, v37
    v_cvt_pk_bf16_f32 v195, v38, v39
    s_mov_b32 s3, 0
    buffer_store_dwordx4 v[192:195], v27, s[8:11], s3 offen
    s_waitcnt lgkmcnt(15)
    v_pk_add_f32 v[96:97], v[96:97], v[104:105]
    v_pk_add_f32 v[98:99], v[98:99], v[106:107]
    v_pk_add_f32 v[100:101], v[100:101], v[108:109]
    v_pk_add_f32 v[102:103], v[102:103], v[110:111]
    v_pk_add_f32 v[112:113], v[112:113], v[120:121]
    v_pk_add_f32 v[114:115], v[114:115], v[122:123]
    v_pk_add_f32 v[116:117], v[116:117], v[124:125]
    v_pk_add_f32 v[118:119], v[118:119], v[126:127]
    v_pk_add_f32 v[96:97], v[96:97], v[112:113]
    v_pk_add_f32 v[98:99], v[98:99], v[114:115]
    v_pk_add_f32 v[100:101], v[100:101], v[116:117]
    v_pk_add_f32 v[102:103], v[102:103], v[118:119]
    v_pk_mul_f32 v[32:33], v[96:97], s[58:59]
    v_pk_mul_f32 v[34:35], v[98:99], s[58:59]
    v_pk_mul_f32 v[36:37], v[100:101], s[58:59]
    v_pk_mul_f32 v[38:39], v[102:103], s[58:59]
    v_exp_f32 v32, v32
    v_exp_f32 v33, v33
    v_exp_f32 v34, v34
    v_exp_f32 v35, v35
    v_exp_f32 v36, v36
    v_exp_f32 v37, v37
    v_exp_f32 v38, v38
    v_exp_f32 v39, v39
    s_waitcnt vmcnt(7)
    v_lshlrev_b32 v47, 16, v208
    v_and_b32 v46, s39, v208
    v_lshlrev_b32 v55, 16, v212
    v_and_b32 v54, s39, v212
    v_lshlrev_b32 v45, 16, v209
    v_and_b32 v44, s39, v209
    v_lshlrev_b32 v53, 16, v213
    v_and_b32 v52, s39, v213
    v_lshlrev_b32 v43, 16, v210
    v_and_b32 v42, s39, v210
    v_lshlrev_b32 v51, 16, v214
    v_and_b32 v50, s39, v214
    v_lshlrev_b32 v41, 16, v211
    v_and_b32 v40, s39, v211
    v_lshlrev_b32 v49, 16, v215
    v_and_b32 v48, s39, v215
    v_pk_add_f32 v[32:33], v[32:33], 1.0 op_sel_hi:[1,0]
    v_pk_add_f32 v[34:35], v[34:35], 1.0 op_sel_hi:[1,0]
    v_pk_add_f32 v[36:37], v[36:37], 1.0 op_sel_hi:[1,0]
    v_pk_add_f32 v[38:39], v[38:39], 1.0 op_sel_hi:[1,0]
    v_rcp_f32 v32, v32
    v_rcp_f32 v33, v33
    v_rcp_f32 v34, v34
    v_rcp_f32 v35, v35
    v_rcp_f32 v36, v36
    v_rcp_f32 v37, v37
    v_rcp_f32 v38, v38
    v_rcp_f32 v39, v39
    v_pk_fma_f32 v[40:41], v[48:49], s[56:57], v[40:41]
    v_pk_fma_f32 v[42:43], v[50:51], s[56:57], v[42:43]
    v_pk_fma_f32 v[44:45], v[52:53], s[56:57], v[44:45]
    v_pk_fma_f32 v[46:47], v[54:55], s[56:57], v[46:47]
    v_lshlrev_b32 v48, 16, v204
    v_and_b32 v49, s39, v204
    v_lshlrev_b32 v50, 16, v205
    v_and_b32 v51, s39, v205
    v_lshlrev_b32 v52, 16, v206
    v_and_b32 v53, s39, v206
    v_lshlrev_b32 v54, 16, v207
    v_and_b32 v55, s39, v207
    v_pk_mul_f32 v[32:33], v[32:33], v[96:97]
    v_pk_mul_f32 v[34:35], v[34:35], v[98:99]
    v_pk_mul_f32 v[36:37], v[36:37], v[100:101]
    v_pk_mul_f32 v[38:39], v[38:39], v[102:103]
    v_pk_fma_f32 v[32:33], v[32:33], v[40:41], v[48:49]
    v_pk_fma_f32 v[34:35], v[34:35], v[42:43], v[50:51]
    v_pk_fma_f32 v[36:37], v[36:37], v[44:45], v[52:53]
    v_pk_fma_f32 v[38:39], v[38:39], v[46:47], v[54:55]
    v_cvt_pk_bf16_f32 v204, v32, v33
    v_cvt_pk_bf16_f32 v205, v34, v35
    v_cvt_pk_bf16_f32 v206, v36, v37
    v_cvt_pk_bf16_f32 v207, v38, v39
    s_mov_b32 s3, 16384
    buffer_store_dwordx4 v[204:207], v27, s[8:11], s3 offen
    s_waitcnt lgkmcnt(8)
    v_pk_add_f32 v[128:129], v[128:129], v[136:137]
    v_pk_add_f32 v[130:131], v[130:131], v[138:139]
    v_pk_add_f32 v[132:133], v[132:133], v[140:141]
    v_pk_add_f32 v[134:135], v[134:135], v[142:143]
    v_pk_add_f32 v[144:145], v[144:145], v[152:153]
    v_pk_add_f32 v[146:147], v[146:147], v[154:155]
    v_pk_add_f32 v[148:149], v[148:149], v[156:157]
    v_pk_add_f32 v[150:151], v[150:151], v[158:159]
    v_pk_add_f32 v[128:129], v[128:129], v[144:145]
    v_pk_add_f32 v[130:131], v[130:131], v[146:147]
    v_pk_add_f32 v[132:133], v[132:133], v[148:149]
    v_pk_add_f32 v[134:135], v[134:135], v[150:151]
    v_pk_mul_f32 v[32:33], v[128:129], s[58:59]
    v_pk_mul_f32 v[34:35], v[130:131], s[58:59]
    v_pk_mul_f32 v[36:37], v[132:133], s[58:59]
    v_pk_mul_f32 v[38:39], v[134:135], s[58:59]
    v_exp_f32 v32, v32
    v_exp_f32 v33, v33
    v_exp_f32 v34, v34
    v_exp_f32 v35, v35
    v_exp_f32 v36, v36
    v_exp_f32 v37, v37
    v_exp_f32 v38, v38
    v_exp_f32 v39, v39
    s_waitcnt vmcnt(5)
    v_lshlrev_b32 v47, 16, v220
    v_and_b32 v46, s39, v220
    v_lshlrev_b32 v55, 16, v224
    v_and_b32 v54, s39, v224
    v_lshlrev_b32 v45, 16, v221
    v_and_b32 v44, s39, v221
    v_lshlrev_b32 v53, 16, v225
    v_and_b32 v52, s39, v225
    v_lshlrev_b32 v43, 16, v222
    v_and_b32 v42, s39, v222
    v_lshlrev_b32 v51, 16, v226
    v_and_b32 v50, s39, v226
    v_lshlrev_b32 v41, 16, v223
    v_and_b32 v40, s39, v223
    v_lshlrev_b32 v49, 16, v227
    v_and_b32 v48, s39, v227
    v_pk_add_f32 v[32:33], v[32:33], 1.0 op_sel_hi:[1,0]
    v_pk_add_f32 v[34:35], v[34:35], 1.0 op_sel_hi:[1,0]
    v_pk_add_f32 v[36:37], v[36:37], 1.0 op_sel_hi:[1,0]
    v_pk_add_f32 v[38:39], v[38:39], 1.0 op_sel_hi:[1,0]
    v_rcp_f32 v32, v32
    v_rcp_f32 v33, v33
    v_rcp_f32 v34, v34
    v_rcp_f32 v35, v35
    v_rcp_f32 v36, v36
    v_rcp_f32 v37, v37
    v_rcp_f32 v38, v38
    v_rcp_f32 v39, v39
    v_pk_fma_f32 v[40:41], v[48:49], s[56:57], v[40:41]
    v_pk_fma_f32 v[42:43], v[50:51], s[56:57], v[42:43]
    v_pk_fma_f32 v[44:45], v[52:53], s[56:57], v[44:45]
    v_pk_fma_f32 v[46:47], v[54:55], s[56:57], v[46:47]
    v_lshlrev_b32 v48, 16, v216
    v_and_b32 v49, s39, v216
    v_lshlrev_b32 v50, 16, v217
    v_and_b32 v51, s39, v217
    v_lshlrev_b32 v52, 16, v218
    v_and_b32 v53, s39, v218
    v_lshlrev_b32 v54, 16, v219
    v_and_b32 v55, s39, v219
    v_pk_mul_f32 v[32:33], v[32:33], v[128:129]
    v_pk_mul_f32 v[34:35], v[34:35], v[130:131]
    v_pk_mul_f32 v[36:37], v[36:37], v[132:133]
    v_pk_mul_f32 v[38:39], v[38:39], v[134:135]
    v_pk_fma_f32 v[32:33], v[32:33], v[40:41], v[48:49]
    v_pk_fma_f32 v[34:35], v[34:35], v[42:43], v[50:51]
    v_pk_fma_f32 v[36:37], v[36:37], v[44:45], v[52:53]
    v_pk_fma_f32 v[38:39], v[38:39], v[46:47], v[54:55]
    v_cvt_pk_bf16_f32 v216, v32, v33
    v_cvt_pk_bf16_f32 v217, v34, v35
    v_cvt_pk_bf16_f32 v218, v36, v37
    v_cvt_pk_bf16_f32 v219, v38, v39
    s_mov_b32 s3, 32768
    buffer_store_dwordx4 v[216:219], v27, s[8:11], s3 offen
    s_waitcnt lgkmcnt(0)
    v_pk_add_f32 v[160:161], v[160:161], v[168:169]
    v_pk_add_f32 v[162:163], v[162:163], v[170:171]
    v_pk_add_f32 v[164:165], v[164:165], v[172:173]
    v_pk_add_f32 v[166:167], v[166:167], v[174:175]
    v_pk_add_f32 v[176:177], v[176:177], v[184:185]
    v_pk_add_f32 v[178:179], v[178:179], v[186:187]
    v_pk_add_f32 v[180:181], v[180:181], v[188:189]
    v_pk_add_f32 v[182:183], v[182:183], v[190:191]
    v_pk_add_f32 v[160:161], v[160:161], v[176:177]
    v_pk_add_f32 v[162:163], v[162:163], v[178:179]
    v_pk_add_f32 v[164:165], v[164:165], v[180:181]
    v_pk_add_f32 v[166:167], v[166:167], v[182:183]
    v_pk_mul_f32 v[32:33], v[160:161], s[58:59]
    v_pk_mul_f32 v[34:35], v[162:163], s[58:59]
    v_pk_mul_f32 v[36:37], v[164:165], s[58:59]
    v_pk_mul_f32 v[38:39], v[166:167], s[58:59]
    v_exp_f32 v32, v32
    v_exp_f32 v33, v33
    v_exp_f32 v34, v34
    v_exp_f32 v35, v35
    v_exp_f32 v36, v36
    v_exp_f32 v37, v37
    v_exp_f32 v38, v38
    v_exp_f32 v39, v39
    s_waitcnt vmcnt(3)
    v_lshlrev_b32 v47, 16, v232
    v_and_b32 v46, s39, v232
    v_lshlrev_b32 v55, 16, v236
    v_and_b32 v54, s39, v236
    v_lshlrev_b32 v45, 16, v233
    v_and_b32 v44, s39, v233
    v_lshlrev_b32 v53, 16, v237
    v_and_b32 v52, s39, v237
    v_lshlrev_b32 v43, 16, v234
    v_and_b32 v42, s39, v234
    v_lshlrev_b32 v51, 16, v238
    v_and_b32 v50, s39, v238
    v_lshlrev_b32 v41, 16, v235
    v_and_b32 v40, s39, v235
    v_lshlrev_b32 v49, 16, v239
    v_and_b32 v48, s39, v239
    v_pk_add_f32 v[32:33], v[32:33], 1.0 op_sel_hi:[1,0]
    v_pk_add_f32 v[34:35], v[34:35], 1.0 op_sel_hi:[1,0]
    v_pk_add_f32 v[36:37], v[36:37], 1.0 op_sel_hi:[1,0]
    v_pk_add_f32 v[38:39], v[38:39], 1.0 op_sel_hi:[1,0]
    v_rcp_f32 v32, v32
    v_rcp_f32 v33, v33
    v_rcp_f32 v34, v34
    v_rcp_f32 v35, v35
    v_rcp_f32 v36, v36
    v_rcp_f32 v37, v37
    v_rcp_f32 v38, v38
    v_rcp_f32 v39, v39
    v_pk_fma_f32 v[40:41], v[48:49], s[56:57], v[40:41]
    v_pk_fma_f32 v[42:43], v[50:51], s[56:57], v[42:43]
    v_pk_fma_f32 v[44:45], v[52:53], s[56:57], v[44:45]
    v_pk_fma_f32 v[46:47], v[54:55], s[56:57], v[46:47]
    v_lshlrev_b32 v48, 16, v228
    v_and_b32 v49, s39, v228
    v_lshlrev_b32 v50, 16, v229
    v_and_b32 v51, s39, v229
    v_lshlrev_b32 v52, 16, v230
    v_and_b32 v53, s39, v230
    v_lshlrev_b32 v54, 16, v231
    v_and_b32 v55, s39, v231
    v_pk_mul_f32 v[32:33], v[32:33], v[160:161]
    v_pk_mul_f32 v[34:35], v[34:35], v[162:163]
    v_pk_mul_f32 v[36:37], v[36:37], v[164:165]
    v_pk_mul_f32 v[38:39], v[38:39], v[166:167]
    v_pk_fma_f32 v[32:33], v[32:33], v[40:41], v[48:49]
    v_pk_fma_f32 v[34:35], v[34:35], v[42:43], v[50:51]
    v_pk_fma_f32 v[36:37], v[36:37], v[44:45], v[52:53]
    v_pk_fma_f32 v[38:39], v[38:39], v[46:47], v[54:55]
    v_cvt_pk_bf16_f32 v228, v32, v33
    v_cvt_pk_bf16_f32 v229, v34, v35
    v_cvt_pk_bf16_f32 v230, v36, v37
    v_cvt_pk_bf16_f32 v231, v38, v39
    s_mov_b32 s3, 49152
    buffer_store_dwordx4 v[228:231], v27, s[8:11], s3 offen
L_fin:
    s_endpgm
L_dft:
    s_add_u32 s79, s79, L_dft-L_pc0
    buffer_load_dword v37, v36, s[80:83], s79 offen
    s_mov_b32 s12, s4
    s_mov_b32 s13, s5
    s_mov_b32 s14, 4194304
    s_mov_b32 s15, 0x00020000
    s_add_u32 s20, s4, 27262976
    s_addc_u32 s21, s5, 0
    s_mov_b32 s22, 2506752
    s_mov_b32 s23, 0x00020000
    s_mov_b32 s63, 0xffff0000
    v_lshrrev_b32 v5, 3, v1
    v_lshlrev_b32 v5, 15, v5
    v_and_b32 v6, 7, v1
    s_lshl_b32 s28, s24, 11
    s_add_u32 s28, s28, 0
    s_mov_b32 s34, s28
    s_mov_b32 s29, s28
    s_cmp_lg_u32 s76, 0
    s_cbranch_scc1 L_d_slots
    s_lshl_b32 s28, s24, 12
    s_add_u32 s29, s28, 2048
    s_cmp_lt_u32 s24, 2
    s_cbranch_scc1 L_d_slots
    s_lshl_b32 s28, s24, 11
    s_add_u32 s28, s28, 12288
    s_add_u32 s29, s28, 4096
L_d_slots:
    s_waitcnt vmcnt(1)
    v_lshlrev_b32 v100, 16, v64
    v_and_b32 v101, s63, v64
    v_lshlrev_b32 v102, 16, v65
    v_and_b32 v103, s63, v65
    v_lshlrev_b32 v104, 16, v66
    v_and_b32 v105, s63, v66
    v_lshlrev_b32 v106, 16, v67
    v_and_b32 v107, s63, v67
    v_lshlrev_b32 v108, 16, v68
    v_and_b32 v109, s63, v68
    v_lshlrev_b32 v110, 16, v69
    v_and_b32 v111, s63, v69
    v_lshlrev_b32 v112, 16, v70
    v_and_b32 v113, s63, v70
    v_lshlrev_b32 v114, 16, v71
    v_and_b32 v115, s63, v71
    v_lshlrev_b32 v116, 16, v72
    v_and_b32 v117, s63, v72
    v_lshlrev_b32 v118, 16, v73
    v_and_b32 v119, s63, v73
    v_lshlrev_b32 v120, 16, v74
    v_and_b32 v121, s63, v74
    v_lshlrev_b32 v122, 16, v75
    v_and_b32 v123, s63, v75
    v_lshlrev_b32 v124, 16, v76
    v_and_b32 v125, s63, v76
    v_lshlrev_b32 v126, 16, v77
    v_and_b32 v127, s63, v77
    v_lshlrev_b32 v128, 16, v78
    v_and_b32 v129, s63, v78
    v_lshlrev_b32 v130, 16, v79
    v_and_b32 v131, s63, v79
    v_pk_add_f32 v[132:133], v[100:101], v[108:109]
    v_pk_add_f32 v[134:135], v[102:103], v[110:111]
    v_pk_add_f32 v[136:137], v[104:105], v[112:113]
    v_pk_add_f32 v[138:139], v[106:107], v[114:115]
    v_pk_add_f32 v[148:149], v[116:117], v[124:125]
    v_pk_add_f32 v[150:151], v[118:119], v[126:127]
    v_pk_add_f32 v[152:153], v[120:121], v[128:129]
    v_pk_add_f32 v[154:155], v[122:123], v[130:131]
    v_pk_add_f32 v[132:133], v[132:133], v[136:137]
    v_pk_add_f32 v[134:135], v[134:135], v[138:139]
    v_pk_add_f32 v[148:149], v[148:149], v[152:153]
    v_pk_add_f32 v[150:151], v[150:151], v[154:155]
    v_pk_add_f32 v[132:133], v[132:133], v[134:135]
    v_pk_add_f32 v[148:149], v[148:149], v[150:151]
    v_add_f32 v164, v132, v133
    v_add_f32 v165, v148, v149
    s_nop 0
    v_add_f32_dpp v164, v164, v164 row_ror:1 row_mask:0xf bank_mask:0xf
    v_add_f32_dpp v165, v165, v165 row_ror:1 row_mask:0xf bank_mask:0xf
    s_nop 0
    v_add_f32_dpp v164, v164, v164 row_ror:2 row_mask:0xf bank_mask:0xf
    v_add_f32_dpp v165, v165, v165 row_ror:2 row_mask:0xf bank_mask:0xf
    s_nop 0
    v_add_f32_dpp v164, v164, v164 row_ror:4 row_mask:0xf bank_mask:0xf
    v_add_f32_dpp v165, v165, v165 row_ror:4 row_mask:0xf bank_mask:0xf
    s_nop 0
    v_add_f32_dpp v164, v164, v164 row_ror:8 row_mask:0xf bank_mask:0xf
    v_add_f32_dpp v165, v165, v165 row_ror:8 row_mask:0xf bank_mask:0xf
    s_nop 0
    v_mov_b32 v170, v164
    v_mov_b32 v171, v165
    s_nop 1
    v_permlane16_swap_b32 v164, v170
    v_permlane16_swap_b32 v165, v171
    v_add_f32 v164, v164, v170
    v_add_f32 v165, v165, v171
    v_mov_b32 v170, v164
    v_mov_b32 v171, v165
    s_nop 1
    v_permlane32_swap_b32 v164, v170
    v_permlane32_swap_b32 v165, v171
    v_add_f32 v164, v164, v170
    v_add_f32 v165, v165, v171
    v_mul_f32 v164, 0x3a800000, v164
    v_mul_f32 v165, 0x3a800000, v165
    v_sub_f32 v132, v100, v164
    v_sub_f32 v133, v101, v164
    v_sub_f32 v134, v102, v164
    v_sub_f32 v135, v103, v164
    v_sub_f32 v136, v104, v164
    v_sub_f32 v137, v105, v164
    v_sub_f32 v138, v106, v164
    v_sub_f32 v139, v107, v164
    v_sub_f32 v140, v108, v164
    v_sub_f32 v141, v109, v164
    v_sub_f32 v142, v110, v164
    v_sub_f32 v143, v111, v164
    v_sub_f32 v144, v112, v164
    v_sub_f32 v145, v113, v164
    v_sub_f32 v146, v114, v164
    v_sub_f32 v147, v115, v164
    v_sub_f32 v148, v116, v165
    v_sub_f32 v149, v117, v165
    v_sub_f32 v150, v118, v165
    v_sub_f32 v151, v119, v165
    v_sub_f32 v152, v120, v165
    v_sub_f32 v153, v121, v165
    v_sub_f32 v154, v122, v165
    v_sub_f32 v155, v123, v165
    v_sub_f32 v156, v124, v165
    v_sub_f32 v157, v125, v165
    v_sub_f32 v158, v126, v165
    v_sub_f32 v159, v127, v165
    v_sub_f32 v160, v128, v165
    v_sub_f32 v161, v129, v165
    v_sub_f32 v162, v130, v165
    v_sub_f32 v163, v131, v165
    v_pk_mul_f32 v[132:133], v[132:133], v[132:133]
    v_pk_mul_f32 v[134:135], v[134:135], v[134:135]
    v_pk_mul_f32 v[136:137], v[136:137], v[136:137]
    v_pk_mul_f32 v[138:139], v[138:139], v[138:139]
    v_pk_mul_f32 v[140:141], v[140:141], v[140:141]
    v_pk_mul_f32 v[142:143], v[142:143], v[142:143]
    v_pk_mul_f32 v[144:145], v[144:145], v[144:145]
    v_pk_mul_f32 v[146:147], v[146:147], v[146:147]
    v_pk_mul_f32 v[148:149], v[148:149], v[148:149]
    v_pk_mul_f32 v[150:151], v[150:151], v[150:151]
    v_pk_mul_f32 v[152:153], v[152:153], v[152:153]
    v_pk_mul_f32 v[154:155], v[154:155], v[154:155]
    v_pk_mul_f32 v[156:157], v[156:157], v[156:157]
    v_pk_mul_f32 v[158:159], v[158:159], v[158:159]
    v_pk_mul_f32 v[160:161], v[160:161], v[160:161]
    v_pk_mul_f32 v[162:163], v[162:163], v[162:163]
    v_pk_add_f32 v[132:133], v[132:133], v[140:141]
    v_pk_add_f32 v[134:135], v[134:135], v[142:143]
    v_pk_add_f32 v[136:137], v[136:137], v[144:145]
    v_pk_add_f32 v[138:139], v[138:139], v[146:147]
    v_pk_add_f32 v[148:149], v[148:149], v[156:157]
    v_pk_add_f32 v[150:151], v[150:151], v[158:159]
    v_pk_add_f32 v[152:153], v[152:153], v[160:161]
    v_pk_add_f32 v[154:155], v[154:155], v[162:163]
    v_pk_add_f32 v[132:133], v[132:133], v[136:137]
    v_pk_add_f32 v[134:135], v[134:135], v[138:139]
    v_pk_add_f32 v[148:149], v[148:149], v[152:153]
    v_pk_add_f32 v[150:151], v[150:151], v[154:155]
    v_pk_add_f32 v[132:133], v[132:133], v[134:135]
    v_pk_add_f32 v[148:149], v[148:149], v[150:151]
    v_add_f32 v166, v132, v133
    v_add_f32 v167, v148, v149
    s_nop 0
    v_add_f32_dpp v166, v166, v166 row_ror:1 row_mask:0xf bank_mask:0xf
    v_add_f32_dpp v167, v167, v167 row_ror:1 row_mask:0xf bank_mask:0xf
    s_nop 0
    v_add_f32_dpp v166, v166, v166 row_ror:2 row_mask:0xf bank_mask:0xf
    v_add_f32_dpp v167, v167, v167 row_ror:2 row_mask:0xf bank_mask:0xf
    s_nop 0
    v_add_f32_dpp v166, v166, v166 row_ror:4 row_mask:0xf bank_mask:0xf
    v_add_f32_dpp v167, v167, v167 row_ror:4 row_mask:0xf bank_mask:0xf
    s_nop 0
    v_add_f32_dpp v166, v166, v166 row_ror:8 row_mask:0xf bank_mask:0xf
    v_add_f32_dpp v167, v167, v167 row_ror:8 row_mask:0xf bank_mask:0xf
    s_nop 0
    v_mov_b32 v170, v166
    v_mov_b32 v171, v167
    s_nop 1
    v_permlane16_swap_b32 v166, v170
    v_permlane16_swap_b32 v167, v171
    v_add_f32 v166, v166, v170
    v_add_f32 v167, v167, v171
    v_mov_b32 v170, v166
    v_mov_b32 v171, v167
    s_nop 1
    v_permlane32_swap_b32 v166, v170
    v_permlane32_swap_b32 v167, v171
    v_add_f32 v166, v166, v170
    v_add_f32 v167, v167, v171
    v_mul_f32 v166, 0x3a800000, v166
    v_mul_f32 v167, 0x3a800000, v167
    v_cvt_pk_bf16_f32 v170, v164, v166
    v_cvt_pk_bf16_f32 v171, v165, v167
    v_lshlrev_b32 v164, 16, v170
    v_lshlrev_b32 v165, 16, v171
    v_and_b32 v166, s63, v170
    v_and_b32 v167, s63, v171
    v_add_f32 v166, 0x3727c5ac, v166
    v_add_f32 v167, 0x3727c5ac, v167
    v_cvt_pk_bf16_f32 v166, v166, v166
    v_cvt_pk_bf16_f32 v167, v167, v167
    v_and_b32 v166, s63, v166
    v_and_b32 v167, s63, v167
    v_sqrt_f32 v166, v166
    v_sqrt_f32 v167, v167
    v_sub_f32 v132, v100, v164
    v_sub_f32 v133, v101, v164
    v_sub_f32 v134, v102, v164
    v_sub_f32 v135, v103, v164
    v_sub_f32 v136, v104, v164
    v_sub_f32 v137, v105, v164
    v_sub_f32 v138, v106, v164
    v_sub_f32 v139, v107, v164
    v_sub_f32 v140, v108, v164
    v_sub_f32 v141, v109, v164
    v_sub_f32 v142, v110, v164
    v_sub_f32 v143, v111, v164
    v_sub_f32 v144, v112, v164
    v_sub_f32 v145, v113, v164
    v_sub_f32 v146, v114, v164
    v_sub_f32 v147, v115, v164
    v_sub_f32 v148, v116, v165
    v_sub_f32 v149, v117, v165
    v_sub_f32 v150, v118, v165
    v_sub_f32 v151, v119, v165
    v_sub_f32 v152, v120, v165
    v_sub_f32 v153, v121, v165
    v_sub_f32 v154, v122, v165
    v_sub_f32 v155, v123, v165
    v_sub_f32 v156, v124, v165
    v_sub_f32 v157, v125, v165
    v_sub_f32 v158, v126, v165
    v_sub_f32 v159, v127, v165
    v_sub_f32 v160, v128, v165
    v_sub_f32 v161, v129, v165
    v_sub_f32 v162, v130, v165
    v_sub_f32 v163, v131, v165
    v_cvt_pk_bf16_f32 v166, v166, v166
    v_cvt_pk_bf16_f32 v167, v167, v167
    v_and_b32 v166, s63, v166
    v_and_b32 v167, s63, v167
    v_rcp_f32 v168, v166
    v_rcp_f32 v169, v167
    v_cvt_pk_bf16_f32 v64, v132, v133
    v_cvt_pk_bf16_f32 v65, v134, v135
    v_cvt_pk_bf16_f32 v66, v136, v137
    v_cvt_pk_bf16_f32 v67, v138, v139
    v_cvt_pk_bf16_f32 v68, v140, v141
    v_cvt_pk_bf16_f32 v69, v142, v143
    v_cvt_pk_bf16_f32 v70, v144, v145
    v_cvt_pk_bf16_f32 v71, v146, v147
    v_cvt_pk_bf16_f32 v72, v148, v149
    v_cvt_pk_bf16_f32 v73, v150, v151
    v_cvt_pk_bf16_f32 v74, v152, v153
    v_cvt_pk_bf16_f32 v75, v154, v155
    v_cvt_pk_bf16_f32 v76, v156, v157
    v_cvt_pk_bf16_f32 v77, v158, v159
    v_cvt_pk_bf16_f32 v78, v160, v161
    v_cvt_pk_bf16_f32 v79, v162, v163
    v_fma_f32 v170, -v166, v168, 1.0
    v_fma_f32 v171, -v167, v169, 1.0
    v_fmac_f32 v168, v170, v168
    v_fmac_f32 v169, v171, v169
    v_lshlrev_b32 v100, 16, v64
    v_and_b32 v101, s63, v64
    v_lshlrev_b32 v102, 16, v65
    v_and_b32 v103, s63, v65
    v_lshlrev_b32 v104, 16, v66
    v_and_b32 v105, s63, v66
    v_lshlrev_b32 v106, 16, v67
    v_and_b32 v107, s63, v67
    v_lshlrev_b32 v108, 16, v68
    v_and_b32 v109, s63, v68
    v_lshlrev_b32 v110, 16, v69
    v_and_b32 v111, s63, v69
    v_lshlrev_b32 v112, 16, v70
    v_and_b32 v113, s63, v70
    v_lshlrev_b32 v114, 16, v71
    v_and_b32 v115, s63, v71
    v_lshlrev_b32 v116, 16, v72
    v_and_b32 v117, s63, v72
    v_lshlrev_b32 v118, 16, v73
    v_and_b32 v119, s63, v73
    v_lshlrev_b32 v120, 16, v74
    v_and_b32 v121, s63, v74
    v_lshlrev_b32 v122, 16, v75
    v_and_b32 v123, s63, v75
    v_lshlrev_b32 v124, 16, v76
    v_and_b32 v125, s63, v76
    v_lshlrev_b32 v126, 16, v77
    v_and_b32 v127, s63, v77
    v_lshlrev_b32 v128, 16, v78
    v_and_b32 v129, s63, v78
    v_lshlrev_b32 v130, 16, v79
    v_and_b32 v131, s63, v79
    v_mul_f32 v132, v100, v168
    v_mul_f32 v133, v101, v168
    v_mul_f32 v134, v102, v168
    v_mul_f32 v135, v103, v168
    v_mul_f32 v136, v104, v168
    v_mul_f32 v137, v105, v168
    v_mul_f32 v138, v106, v168
    v_mul_f32 v139, v107, v168
    v_mul_f32 v140, v108, v168
    v_mul_f32 v141, v109, v168
    v_mul_f32 v142, v110, v168
    v_mul_f32 v143, v111, v168
    v_mul_f32 v144, v112, v168
    v_mul_f32 v145, v113, v168
    v_mul_f32 v146, v114, v168
    v_mul_f32 v147, v115, v168
    v_mul_f32 v148, v116, v169
    v_mul_f32 v149, v117, v169
    v_mul_f32 v150, v118, v169
    v_mul_f32 v151, v119, v169
    v_mul_f32 v152, v120, v169
    v_mul_f32 v153, v121, v169
    v_mul_f32 v154, v122, v169
    v_mul_f32 v155, v123, v169
    v_mul_f32 v156, v124, v169
    v_mul_f32 v157, v125, v169
    v_mul_f32 v158, v126, v169
    v_mul_f32 v159, v127, v169
    v_mul_f32 v160, v128, v169
    v_mul_f32 v161, v129, v169
    v_mul_f32 v162, v130, v169
    v_mul_f32 v163, v131, v169
    v_cvt_pk_bf16_f32 v64, v132, v133
    v_cvt_pk_bf16_f32 v65, v134, v135
    v_cvt_pk_bf16_f32 v66, v136, v137
    v_cvt_pk_bf16_f32 v67, v138, v139
    v_cvt_pk_bf16_f32 v68, v140, v141
    v_cvt_pk_bf16_f32 v69, v142, v143
    v_cvt_pk_bf16_f32 v70, v144, v145
    v_cvt_pk_bf16_f32 v71, v146, v147
    v_cvt_pk_bf16_f32 v72, v148, v149
    v_cvt_pk_bf16_f32 v73, v150, v151
    v_cvt_pk_bf16_f32 v74, v152, v153
    v_cvt_pk_bf16_f32 v75, v154, v155
    v_cvt_pk_bf16_f32 v76, v156, v157
    v_cvt_pk_bf16_f32 v77, v158, v159
    v_cvt_pk_bf16_f32 v78, v160, v161
    v_cvt_pk_bf16_f32 v79, v162, v163
    v_mov_b32 v4, 0
    buffer_load_dword v62, v4, s[92:95], 0 offen sc1
    s_lshr_b32 s30, s36, 19
    s_lshl_b32 s30, s30, 19
    s_bfe_u32 s3, s36, 0x8000b
    s_lshl_b32 s31, s3, 7
    s_add_u32 s30, s30, s31
    s_bfe_u32 s3, s3, 0x30001
    v_xor_b32 v7, s3, v6
    v_lshl_add_u32 v7, v7, 4, v5
    s_add_u32 s31, s30, 262144
    buffer_store_dwordx4 v[64:67], v7, s[12:15], s30 offen sc1
    buffer_store_dwordx4 v[68:71], v7, s[12:15], s31 offen sc1
    s_lshr_b32 s30, s37, 19
    s_lshl_b32 s30, s30, 19
    s_bfe_u32 s3, s37, 0x8000b
    s_lshl_b32 s31, s3, 7
    s_add_u32 s30, s30, s31
    s_bfe_u32 s3, s3, 0x30001
    v_xor_b32 v7, s3, v6
    v_lshl_add_u32 v7, v7, 4, v5
    s_add_u32 s31, s30, 262144
    buffer_store_dwordx4 v[72:75], v7, s[12:15], s30 offen sc1
    buffer_store_dwordx4 v[76:79], v7, s[12:15], s31 offen sc1
    v_add_u32 v2, s28, v44
    v_add_u32 v3, s29, v44
    v_add_u32 v4, s34, v44
    ds_write_b128 v2, v[64:67]
    ds_write_b128 v2, v[68:71] offset:1024
    ds_write_b128 v3, v[64:67]
    ds_write_b128 v3, v[68:71] offset:1024
    ds_write_b128 v4, v[72:75] offset:8192
    ds_write_b128 v4, v[76:79] offset:9216
    s_waitcnt vmcnt(0) lgkmcnt(0)
    s_mov_b32 s33, 0
L_d_nonce:
    v_readfirstlane_b32 s62, v62
    s_add_u32 s33, s33, 1
    s_cmp_lg_u32 s62, 0
    s_cbranch_scc1 L_d_nonced
    v_mov_b32 v4, 0
    buffer_load_dword v62, v4, s[92:95], 0 offen sc1
    s_waitcnt vmcnt(0)
    s_cmp_lt_u32 s33, 0x40000
    s_cbranch_scc1 L_d_nonce
L_d_nonced:
    s_barrier
    s_cmp_lg_u32 s24, 0
    s_cbranch_scc1 L_d_fa
    s_lshl_b32 s3, s2, 2
    v_mov_b32 v2, s62
    v_mov_b32 v3, s3
    s_mov_b64 exec, 1
    buffer_store_dword v2, v3, s[48:51], 0 offen offset:2048 sc1
    s_mov_b64 exec, -1
L_d_fa:
    s_mov_b32 s28, 0
    v_mov_b32 v100, v0
    v_mov_b32 v136, 0
    v_mov_b32 v137, 24576
    s_cmp_eq_u32 s76, 0
    s_cselect_b32 s30, 0.5, 1.0
    v_mov_b32 v138, s30
L_d_fold:
    v_lshlrev_b32 v101, 1, v100
    v_sub_u32 v102, 2048, v101
    v_and_b32 v102, 2047, v102
    v_add_u32 v128, v136, v101
    v_add_u32 v129, v136, v102
    v_sub_u32 v130, v136, v101
    ds_read_u16_d16_hi v108, v128 offset:0
    ds_read_u16_d16_hi v109, v128 offset:2048
    ds_read_u16_d16_hi v110, v128 offset:4096
    ds_read_u16_d16_hi v111, v128 offset:6144
    ds_read_u16_d16_hi v112, v129 offset:0
    ds_read_u16_d16_hi v113, v129 offset:2048
    ds_read_u16_d16_hi v114, v129 offset:4096
    ds_read_u16_d16_hi v115, v129 offset:6144
    ds_read_u16_d16_hi v116, v130 offset:1024
    ds_read_u16_d16_hi v117, v130 offset:3072
    ds_read_u16_d16_hi v118, v130 offset:5120
    ds_read_u16_d16_hi v119, v130 offset:7168
    ds_read_u16_d16_hi v120, v128 offset:1024
    ds_read_u16_d16_hi v121, v128 offset:3072
    ds_read_u16_d16_hi v122, v128 offset:5120
    ds_read_u16_d16_hi v123, v128 offset:7168
    v_add_u32 v107, v137, v101
    v_and_b32 v105, 255, v100
    v_cmp_eq_u32 vcc, 0, v105
    v_mul_f32 v106, 0.5, v138
    s_nop 0
    v_cndmask_b32 v105, v138, v106, vcc
    v_cmp_ge_u32 vcc, 256, v100
    s_waitcnt lgkmcnt(12)
    v_and_b32 v108, s63, v108
    v_and_b32 v109, s63, v109
    v_and_b32 v110, s63, v110
    v_and_b32 v111, s63, v111
    v_add_f32 v124, v108, v109
    v_sub_f32 v125, v108, v109
    v_add_f32 v126, v110, v111
    v_sub_f32 v127, v110, v111
    v_add_f32 v108, v124, v126
    v_sub_f32 v109, v124, v126
    v_sub_f32 v110, v125, v127
    v_add_f32 v111, v125, v127
    s_waitcnt lgkmcnt(8)
    v_and_b32 v112, s63, v112
    v_and_b32 v113, s63, v113
    v_and_b32 v114, s63, v114
    v_and_b32 v115, s63, v115
    v_add_f32 v124, v112, v113
    v_sub_f32 v125, v112, v113
    v_add_f32 v126, v114, v115
    v_sub_f32 v127, v114, v115
    v_add_f32 v112, v124, v126
    v_sub_f32 v113, v124, v126
    v_sub_f32 v114, v125, v127
    v_add_f32 v115, v125, v127
    s_waitcnt lgkmcnt(4)
    v_and_b32 v116, s63, v116
    v_and_b32 v117, s63, v117
    v_and_b32 v118, s63, v118
    v_and_b32 v119, s63, v119
    v_add_f32 v124, v116, v117
    v_sub_f32 v125, v116, v117
    v_add_f32 v126, v118, v119
    v_sub_f32 v127, v118, v119
    v_add_f32 v116, v124, v126
    v_sub_f32 v117, v124, v126
    v_sub_f32 v118, v125, v127
    v_add_f32 v119, v125, v127
    s_waitcnt lgkmcnt(0)
    v_and_b32 v120, s63, v120
    v_and_b32 v121, s63, v121
    v_and_b32 v122, s63, v122
    v_and_b32 v123, s63, v123
    v_add_f32 v124, v120, v121
    v_sub_f32 v125, v120, v121
    v_add_f32 v126, v122, v123
    v_sub_f32 v127, v122, v123
    v_add_f32 v120, v124, v126
    v_sub_f32 v121, v124, v126
    v_sub_f32 v122, v125, v127
    v_add_f32 v123, v125, v127
    v_add_f32 v124, v108, v112
    v_add_f32 v125, v116, v120
    v_add_f32 v126, v124, v125
    v_sub_f32 v127, v124, v125
    v_mul_f32 v126, v126, v105
    v_mul_f32 v127, v127, v105
    v_cvt_pk_bf16_f32 v132, v126, v127
    v_cndmask_b32 v132, 0, v132, vcc
    ds_write_b16 v107, v132 offset:0
    ds_write_b16_d16_hi v107, v132 offset:576
    v_add_f32 v124, v109, v113
    v_add_f32 v125, v117, v121
    v_add_f32 v126, v124, v125
    v_sub_f32 v127, v124, v125
    v_mul_f32 v126, v126, v105
    v_mul_f32 v127, v127, v105
    v_cvt_pk_bf16_f32 v133, v126, v127
    v_cndmask_b32 v133, 0, v133, vcc
    ds_write_b16 v107, v133 offset:1152
    ds_write_b16_d16_hi v107, v133 offset:1728
    v_sub_f32 v124, v110, v114
    v_sub_f32 v125, v118, v122
    v_sub_f32 v126, v124, v125
    v_add_f32 v127, v124, v125
    v_mul_f32 v126, v126, v105
    v_mul_f32 v127, v127, v105
    v_cvt_pk_bf16_f32 v134, v126, v127
    v_cndmask_b32 v134, 0, v134, vcc
    ds_write_b16 v107, v134 offset:2304
    ds_write_b16_d16_hi v107, v134 offset:2880
    v_sub_f32 v124, v111, v115
    v_sub_f32 v125, v119, v123
    v_sub_f32 v126, v124, v125
    v_add_f32 v127, v124, v125
    v_mul_f32 v126, v126, v105
    v_mul_f32 v127, v127, v105
    v_cvt_pk_bf16_f32 v135, v126, v127
    v_cndmask_b32 v135, 0, v135, vcc
    ds_write_b16 v107, v135 offset:3456
    ds_write_b16_d16_hi v107, v135 offset:4032
    s_add_u32 s28, s28, 1
    s_cmp_lg_u32 s28, 1
    s_cbranch_scc1 L_d_j2
    v_add_u32 v136, 8192, v136
    v_add_u32 v137, 4608, v137
    v_mov_b32 v138, 1.0
    s_branch L_d_fold
L_d_j2:
    s_cmp_lg_u32 s28, 2
    s_cbranch_scc1 L_d_j3
    s_cmp_lg_u32 s24, 3
    s_cbranch_scc1 L_d_j3s
    v_and_b32 v100, 31, v1
    v_add_u32 v100, 256, v100
    v_lshrrev_b32 v101, 5, v1
    v_lshlrev_b32 v136, 13, v101
    v_add_u32 v136, 0, v136
    v_mul_u32_u24 v137, 4608, v101
    v_add_u32 v137, 24576, v137
    v_mov_b32 v138, s30
    s_mov_b32 exec_lo, 0
    v_mov_b32 v138, 1.0
    s_mov_b64 exec, -1
    s_branch L_d_fold
L_d_j3s:
    s_add_u32 s28, s28, 1
L_d_j3:
    s_cmp_lg_u32 s76, 0
    s_cbranch_scc1 L_d_foldd
    s_cmp_eq_u32 s28, 5
    s_cbranch_scc1 L_d_foldd
    v_mov_b32 v136, 16384
    v_mov_b32 v137, 33792
    v_mov_b32 v138, 0.5
    v_mov_b32 v100, v0
    s_cmp_eq_u32 s28, 3
    s_cbranch_scc1 L_d_fold
    v_and_b32 v100, 31, v1
    v_add_u32 v100, 256, v100
    s_branch L_d_fold
L_d_foldd:
    s_waitcnt lgkmcnt(0)
    s_barrier
    v_mov_b32 v100, v0
    s_mul_i32 s34, s76, 1152
    s_mov_b32 s30, 626688
    s_mov_b32 s29, 294912
    s_cmp_eq_u32 s76, 0
    s_cselect_b32 s31, 3, 2
    v_lshlrev_b32 v101, 4, v100
    v_add_u32 v101, 24576, v101
    ds_read_b128 v[108:111], v101
    v_mul_u32_u24 v102, 911, v100
    v_lshrrev_b32 v102, 16, v102
    v_mul_u32_u24 v103, 72, v102
    v_sub_u32 v103, v100, v103
    v_and_b32 v104, 3, v102
    v_lshrrev_b32 v102, 2, v102
    v_mul_lo_u32 v104, v104, s30
    v_lshl_add_u32 v103, v103, 4, v104
    v_mul_lo_u32 v104, v102, s29
    v_add_u32 v112, v103, v104
    v_cmp_gt_u32 vcc, s31, v102
    v_add_u32 v100, 256, v100
    v_mov_b32 v104, 0x7ff00000
    v_cndmask_b32 v112, v104, v112, vcc
    v_lshlrev_b32 v101, 4, v100
    v_add_u32 v101, 24576, v101
    ds_read_b128 v[116:119], v101
    v_mul_u32_u24 v102, 911, v100
    v_lshrrev_b32 v102, 16, v102
    v_mul_u32_u24 v103, 72, v102
    v_sub_u32 v103, v100, v103
    v_and_b32 v104, 3, v102
    v_lshrrev_b32 v102, 2, v102
    v_mul_lo_u32 v104, v104, s30
    v_lshl_add_u32 v103, v103, 4, v104
    v_mul_lo_u32 v104, v102, s29
    v_add_u32 v120, v103, v104
    v_cmp_gt_u32 vcc, s31, v102
    v_add_u32 v100, 256, v100
    v_mov_b32 v104, 0x7ff00000
    v_cndmask_b32 v120, v104, v120, vcc
    v_lshlrev_b32 v101, 4, v100
    v_add_u32 v101, 24576, v101
    ds_read_b128 v[124:127], v101
    v_mul_u32_u24 v102, 911, v100
    v_lshrrev_b32 v102, 16, v102
    v_mul_u32_u24 v103, 72, v102
    v_sub_u32 v103, v100, v103
    v_and_b32 v104, 3, v102
    v_lshrrev_b32 v102, 2, v102
    v_mul_lo_u32 v104, v104, s30
    v_lshl_add_u32 v103, v103, 4, v104
    v_mul_lo_u32 v104, v102, s29
    v_add_u32 v128, v103, v104
    v_cmp_gt_u32 vcc, s31, v102
    v_add_u32 v100, 256, v100
    v_mov_b32 v104, 0x7ff00000
    v_cndmask_b32 v128, v104, v128, vcc
    v_lshlrev_b32 v101, 4, v100
    v_add_u32 v101, 24576, v101
    ds_read_b128 v[132:135], v101
    v_mul_u32_u24 v102, 911, v100
    v_lshrrev_b32 v102, 16, v102
    v_mul_u32_u24 v103, 72, v102
    v_sub_u32 v103, v100, v103
    v_and_b32 v104, 3, v102
    v_lshrrev_b32 v102, 2, v102
    v_mul_lo_u32 v104, v104, s30
    v_lshl_add_u32 v103, v103, 4, v104
    v_mul_lo_u32 v104, v102, s29
    v_add_u32 v136, v103, v104
    v_cmp_gt_u32 vcc, s31, v102
    v_add_u32 v100, 256, v100
    v_mov_b32 v104, 0x7ff00000
    v_cndmask_b32 v136, v104, v136, vcc
    s_waitcnt lgkmcnt(0)
    buffer_store_dwordx4 v[108:111], v112, s[20:23], s34 offen sc1
    buffer_store_dwordx4 v[116:119], v120, s[20:23], s34 offen sc1
    buffer_store_dwordx4 v[124:127], v128, s[20:23], s34 offen sc1
    buffer_store_dwordx4 v[132:135], v136, s[20:23], s34 offen sc1
    s_lshr_b32 s3, s2, 3
    s_and_b32 s52, s27, 3
    s_lshl_b32 s52, s52, 2
    s_and_b32 s53, s3, 3
    s_add_u32 s52, s52, s53
    s_lshr_b32 s53, s27, 2
    s_lshl_b32 s53, s53, 3
    s_lshr_b32 s3, s3, 2
    s_add_u32 s53, s53, s3
    s_lshl_b32 s3, s53, 7
    s_add_u32 s40, s44, s3
    s_addc_u32 s41, s45, 0
    s_sub_u32 s42, 7340032, s3
    s_mov_b32 s43, 0x00020000
    s_mov_b32 s46, 7340032
    s_mov_b32 s47, 0x00020000
    v_lshrrev_b32 v2, 3, v1
    v_lshlrev_b32 v2, 11, v2
    v_lshrrev_b32 v3, 4, v1
    v_lshlrev_b32 v3, 1, v3
    v_and_b32 v4, 7, v1
    v_xor_b32 v4, v4, v3
    v_lshl_add_u32 v40, v4, 4, v2
    v_add_u32 v41, 15360, v40
    v_add_u32 v42, 30720, v40
    v_add_u32 v43, 46080, v40
    s_lshl_b32 s70, s24, 14
    s_add_u32 s68, s70, 98304
    s_add_u32 s70, s70, 32768
    s_lshl_b32 s69, s24, 13
    v_lshrrev_b32 v2, 2, v1
    v_lshlrev_b32 v2, 7, v2
    v_and_b32 v4, 3, v1
    v_lshl_add_u32 v2, v4, 3, v2
    v_bfe_u32 v3, v1, 3, 2
    v_xor_b32 v4, 0, v3
    v_lshl_add_u32 v4, v4, 5, v2
    v_add_u32 v48, s68, v4
    v_add_u32 v52, s69, v4
    v_add_u32 v56, s70, v4
    v_xor_b32 v4, 1, v3
    v_lshl_add_u32 v4, v4, 5, v2
    v_add_u32 v49, s68, v4
    v_add_u32 v53, s69, v4
    v_add_u32 v57, s70, v4
    v_xor_b32 v4, 2, v3
    v_lshl_add_u32 v4, v4, 5, v2
    v_add_u32 v50, s68, v4
    v_add_u32 v54, s69, v4
    v_add_u32 v58, s70, v4
    v_xor_b32 v4, 3, v3
    v_lshl_add_u32 v4, v4, 5, v2
    v_add_u32 v51, s68, v4
    v_add_u32 v55, s69, v4
    v_add_u32 v59, s70, v4
    s_and_b32 s3, s52, 3
    s_lshl_b32 s3, s3, 1
    s_and_b32 s71, s53, 7
    s_add_u32 s71, s71, s3
    s_cmp_ge_u32 s71, 7
    s_cselect_b32 s3, 7, 0
    s_sub_u32 s71, s71, s3
    s_min_u32 s71, s71, 0
    s_mul_i32 s100, s24, 1835008
    s_add_u32 s101, s100, 1835008
    s_lshl_b32 s54, s71, 18
    s_add_u32 s54, s54, s100
    s_add_u32 s55, s54, 65536
    s_lshr_b32 s3, s2, 3
    s_lshr_b32 s25, s27, 1
    s_and_b32 s26, s27, 1
    s_lshl_b32 s26, s26, 2
    s_add_u32 s26, s26, s3
    s_sub_u32 s26, s26, 28
    s_cmp_ge_u32 s26, 7
    s_cbranch_scc1 L_spare
    s_and_b32 s28, s25, 1
    s_lshr_b32 s29, s25, 1
    s_and_b32 s30, s24, 1
    s_lshr_b32 s31, s24, 1
    s_waitcnt vmcnt(0)
    s_barrier
    s_cmp_lg_u32 s24, 0
    s_cbranch_scc1 L_d_fx
    s_lshl_b32 s3, s2, 2
    v_mov_b32 v2, s62
    v_mov_b32 v3, s3
    s_mov_b64 exec, 1
    buffer_store_dword v2, v3, s[48:51], 0 offen offset:3072 sc1
    s_mov_b64 exec, -1
L_d_fx:
    s_cmp_eq_u32 s29, 0
    s_cselect_b32 s20, s84, s86
    s_cselect_b32 s21, s85, s87
    s_mov_b32 s22, 8388608
    v_and_b32 v2, 15, v1
    v_lshrrev_b32 v4, 4, v1
    v_lshlrev_b32 v3, 13, v2
    v_lshl_add_u32 v20, v4, 4, v3
    s_mul_i32 s34, s26, 160
    s_add_u32 s34, s34, s28
    s_lshl_b32 s34, s34, 12
    s_lshl_b32 s3, s24, 6
    s_add_u32 s34, s34, s3
    s_mul_i32 s35, s24, 5120
    s_add_u32 s35, s35, 76800
    s_add_u32 m0, s35, 0
    s_add_u32 s3, s34, 0
    buffer_load_dwordx4 v20, s[20:23], s3 offen lds
    s_add_u32 m0, s35, 1024
    s_add_u32 s3, s34, 131072
    buffer_load_dwordx4 v20, s[20:23], s3 offen lds
    s_add_u32 m0, s35, 2048
    s_add_u32 s3, s34, 262144
    buffer_load_dwordx4 v20, s[20:23], s3 offen lds
    s_add_u32 m0, s35, 3072
    s_add_u32 s3, s34, 393216
    buffer_load_dwordx4 v20, s[20:23], s3 offen lds
    s_add_u32 m0, s35, 4096
    s_add_u32 s3, s34, 524288
    buffer_load_dwordx4 v20, s[20:23], s3 offen lds
    s_add_u32 m0, s35, 20480
    s_add_u32 s3, s34, 256
    buffer_load_dwordx4 v20, s[20:23], s3 offen lds
    s_add_u32 m0, s35, 21504
    s_add_u32 s3, s34, 131328
    buffer_load_dwordx4 v20, s[20:23], s3 offen lds
    s_add_u32 m0, s35, 22528
    s_add_u32 s3, s34, 262400
    buffer_load_dwordx4 v20, s[20:23], s3 offen lds
    s_add_u32 m0, s35, 23552
    s_add_u32 s3, s34, 393472
    buffer_load_dwordx4 v20, s[20:23], s3 offen lds
    s_add_u32 m0, s35, 24576
    s_add_u32 s3, s34, 524544
    buffer_load_dwordx4 v20, s[20:23], s3 offen lds
    s_add_u32 m0, s35, 40960
    s_add_u32 s3, s34, 512
    buffer_load_dwordx4 v20, s[20:23], s3 offen lds
    s_add_u32 m0, s35, 41984
    s_add_u32 s3, s34, 131584
    buffer_load_dwordx4 v20, s[20:23], s3 offen lds
    s_add_u32 m0, s35, 43008
    s_add_u32 s3, s34, 262656
    buffer_load_dwordx4 v20, s[20:23], s3 offen lds
    s_add_u32 m0, s35, 44032
    s_add_u32 s3, s34, 393728
    buffer_load_dwordx4 v20, s[20:23], s3 offen lds
    s_add_u32 m0, s35, 45056
    s_add_u32 s3, s34, 524800
    buffer_load_dwordx4 v20, s[20:23], s3 offen lds
    s_add_u32 m0, s35, 61440
    s_add_u32 s3, s34, 768
    buffer_load_dwordx4 v20, s[20:23], s3 offen lds
    s_add_u32 m0, s35, 62464
    s_add_u32 s3, s34, 131840
    buffer_load_dwordx4 v20, s[20:23], s3 offen lds
    s_add_u32 m0, s35, 63488
    s_add_u32 s3, s34, 262912
    buffer_load_dwordx4 v20, s[20:23], s3 offen lds
    s_add_u32 m0, s35, 64512
    s_add_u32 s3, s34, 393984
    buffer_load_dwordx4 v20, s[20:23], s3 offen lds
    s_add_u32 m0, s35, 65536
    s_add_u32 s3, s34, 525056
    buffer_load_dwordx4 v20, s[20:23], s3 offen lds
    s_cmp_lg_u32 s24, 0
    s_cbranch_scc1 L_msd
    s_add_u32 m0, s35, 81920
    s_add_u32 s3, s34, 1024
    buffer_load_dwordx4 v20, s[20:23], s3 offen lds
    s_add_u32 m0, s35, 82944
    s_add_u32 s3, s34, 132096
    buffer_load_dwordx4 v20, s[20:23], s3 offen lds
    s_add_u32 m0, s35, 83968
    s_add_u32 s3, s34, 263168
    buffer_load_dwordx4 v20, s[20:23], s3 offen lds
    s_add_u32 m0, s35, 84992
    s_add_u32 s3, s34, 394240
    buffer_load_dwordx4 v20, s[20:23], s3 offen lds
    s_add_u32 m0, s35, 86016
    s_add_u32 s3, s34, 525312
    buffer_load_dwordx4 v20, s[20:23], s3 offen lds
L_msd:
    s_add_u32 s79, s79, 16384
    buffer_load_dword v37, v36, s[80:83], s79 offen
    s_mul_i32 s34, s24, 288
    v_add_u32 v7, 0, v1
    v_mul_u32_u24 v3, 3641, v7
    v_lshrrev_b32 v3, 16, v3
    v_mul_u32_u24 v5, 18, v3
    v_sub_u32 v7, v7, v5
    v_and_b32 v5, 19, v3
    v_bfe_u32 v6, v3, 2, 1
    v_lshl_add_u32 v5, v6, 3, v5
    v_bfe_u32 v6, v3, 3, 1
    v_lshl_add_u32 v5, v6, 2, v5
    v_mul_u32_u24 v5, 1152, v5
    v_lshl_add_u32 v5, v7, 4, v5
    v_add_u32 v5, s34, v5
    v_add_u32 v8, 4096, v5
    v_add_u32 v7, 64, v1
    v_mul_u32_u24 v3, 3641, v7
    v_lshrrev_b32 v3, 16, v3
    v_mul_u32_u24 v5, 18, v3
    v_sub_u32 v7, v7, v5
    v_and_b32 v5, 19, v3
    v_bfe_u32 v6, v3, 2, 1
    v_lshl_add_u32 v5, v6, 3, v5
    v_bfe_u32 v6, v3, 3, 1
    v_lshl_add_u32 v5, v6, 2, v5
    v_mul_u32_u24 v5, 1152, v5
    v_lshl_add_u32 v5, v7, 4, v5
    v_add_u32 v5, s34, v5
    v_add_u32 v9, 3072, v5
    v_add_u32 v7, 128, v1
    v_mul_u32_u24 v3, 3641, v7
    v_lshrrev_b32 v3, 16, v3
    v_mul_u32_u24 v5, 18, v3
    v_sub_u32 v7, v7, v5
    v_and_b32 v5, 19, v3
    v_bfe_u32 v6, v3, 2, 1
    v_lshl_add_u32 v5, v6, 3, v5
    v_bfe_u32 v6, v3, 3, 1
    v_lshl_add_u32 v5, v6, 2, v5
    v_mul_u32_u24 v5, 1152, v5
    v_lshl_add_u32 v5, v7, 4, v5
    v_add_u32 v5, s34, v5
    v_add_u32 v10, 2048, v5
    v_add_u32 v7, 192, v1
    v_mul_u32_u24 v3, 3641, v7
    v_lshrrev_b32 v3, 16, v3
    v_mul_u32_u24 v5, 18, v3
    v_sub_u32 v7, v7, v5
    v_and_b32 v5, 19, v3
    v_bfe_u32 v6, v3, 2, 1
    v_lshl_add_u32 v5, v6, 3, v5
    v_bfe_u32 v6, v3, 3, 1
    v_lshl_add_u32 v5, v6, 2, v5
    v_mul_u32_u24 v5, 1152, v5
    v_lshl_add_u32 v5, v7, 4, v5
    v_add_u32 v5, s34, v5
    v_add_u32 v11, 1024, v5
    v_add_u32 v7, 256, v1
    v_mul_u32_u24 v3, 3641, v7
    v_lshrrev_b32 v3, 16, v3
    v_mul_u32_u24 v5, 18, v3
    v_sub_u32 v7, v7, v5
    v_and_b32 v5, 19, v3
    v_bfe_u32 v6, v3, 2, 1
    v_lshl_add_u32 v5, v6, 3, v5
    v_bfe_u32 v6, v3, 3, 1
    v_lshl_add_u32 v5, v6, 2, v5
    v_mul_u32_u24 v5, 1152, v5
    v_lshl_add_u32 v5, v7, 4, v5
    v_add_u32 v5, s34, v5
    v_add_u32 v12, 4096, v5
    v_add_u32 v7, 320, v1
    v_mul_u32_u24 v3, 3641, v7
    v_lshrrev_b32 v3, 16, v3
    v_mul_u32_u24 v5, 18, v3
    v_sub_u32 v7, v7, v5
    v_and_b32 v5, 19, v3
    v_bfe_u32 v6, v3, 2, 1
    v_lshl_add_u32 v5, v6, 3, v5
    v_bfe_u32 v6, v3, 3, 1
    v_lshl_add_u32 v5, v6, 2, v5
    v_mul_u32_u24 v5, 1152, v5
    v_lshl_add_u32 v5, v7, 4, v5
    v_add_u32 v5, s34, v5
    v_add_u32 v13, 3072, v5
    v_add_u32 v7, 384, v1
    v_mul_u32_u24 v3, 3641, v7
    v_lshrrev_b32 v3, 16, v3
    v_mul_u32_u24 v5, 18, v3
    v_sub_u32 v7, v7, v5
    v_and_b32 v5, 19, v3
    v_bfe_u32 v6, v3, 2, 1
    v_lshl_add_u32 v5, v6, 3, v5
    v_bfe_u32 v6, v3, 3, 1
    v_lshl_add_u32 v5, v6, 2, v5
    v_mul_u32_u24 v5, 1152, v5
    v_lshl_add_u32 v5, v7, 4, v5
    v_add_u32 v5, s34, v5
    v_add_u32 v14, 2048, v5
    v_add_u32 v7, 448, v1
    v_mul_u32_u24 v3, 3641, v7
    v_lshrrev_b32 v3, 16, v3
    v_mul_u32_u24 v5, 18, v3
    v_sub_u32 v7, v7, v5
    v_and_b32 v5, 19, v3
    v_bfe_u32 v6, v3, 2, 1
    v_lshl_add_u32 v5, v6, 3, v5
    v_bfe_u32 v6, v3, 3, 1
    v_lshl_add_u32 v5, v6, 2, v5
    v_mul_u32_u24 v5, 1152, v5
    v_lshl_add_u32 v5, v7, 4, v5
    v_add_u32 v5, s34, v5
    v_add_u32 v15, 1024, v5
    v_add_u32 v7, 512, v1
    v_mul_u32_u24 v3, 3641, v7
    v_lshrrev_b32 v3, 16, v3
    v_mul_u32_u24 v5, 18, v3
    v_sub_u32 v7, v7, v5
    v_and_b32 v5, 19, v3
    v_bfe_u32 v6, v3, 2, 1
    v_lshl_add_u32 v5, v6, 3, v5
    v_bfe_u32 v6, v3, 3, 1
    v_lshl_add_u32 v5, v6, 2, v5
    v_mul_u32_u24 v5, 1152, v5
    v_lshl_add_u32 v5, v7, 4, v5
    v_add_u32 v5, s34, v5
    v_add_u32 v16, 4096, v5
    v_add_u32 v21, 4096, v44
    v_add_u32 v19, 8192, v44
    v_bfe_u32 v3, v1, 2, 3
    v_lshrrev_b32 v5, 5, v1
    v_lshl_add_u32 v3, v5, 4, v3
    v_mul_u32_u24 v3, 288, v3
    v_and_b32 v5, 3, v1
    v_lshl_add_u32 v3, v5, 3, v3
    s_mul_i32 s35, s24, 19200
    v_add_u32 v22, s35, v3
    v_mul_u32_u24 v3, 592, v2
    v_lshl_add_u32 v26, v4, 4, v3
    v_add_u32 v27, 47360, v26
    s_mul_i32 s34, s31, 47360
    v_add_u32 v3, s34, v3
    v_lshl_add_u32 v23, v4, 3, v3
    s_mul_i32 s34, s30, 288
    v_add_u32 v23, s34, v23
    s_mul_i32 s34, s25, 626688
    s_add_u32 s34, s34, 27258880
    s_add_u32 s16, s4, s34
    s_addc_u32 s17, s5, 0
    s_mov_b32 s18, 630784
    s_mov_b32 s19, 0x00020000
    s_lshl_b32 s34, s29, 2
    s_add_u32 s34, s34, s24
    s_mul_i32 s34, s34, 92160
    s_add_u32 s34, s34, 34603008
    s_add_u32 s8, s4, s34
    s_addc_u32 s9, s5, 0
    s_mov_b32 s10, 92160
    s_mov_b32 s11, 0x00020000
    s_and_b32 s3, s26, 3
    s_mul_i32 s36, s3, 147456
    s_mul_i32 s37, s3, 20480
    s_mul_i32 s38, s3, 20480
    s_mul_i32 s39, s3, 128
    s_waitcnt vmcnt(0)
    s_cmp_lg_u32 s24, 0
    s_cbranch_scc1 L_d_paxd
    s_mov_b32 s32, 0
L_d_pax:
    buffer_load_dwordx4 v[32:35], v44, s[48:51], 0 offen offset:3072 sc1
L_d_paxe:
    s_waitcnt vmcnt(0)
    v_xor_b32 v32, s62, v32
    v_xor_b32 v33, s62, v33
    v_xor_b32 v34, s62, v34
    v_xor_b32 v35, s62, v35
    v_or3_b32 v32, v32, v33, v34
    v_or_b32 v32, v32, v35
    v_cmp_ne_u32 vcc, 0, v32
    s_add_u32 s32, s32, 1
    s_nop 2
    s_cbranch_vccz L_d_paxd
    s_cmp_lt_u32 s32, 0x40000
    s_cbranch_scc1 L_d_pax
L_d_paxd:
    s_barrier
    s_add_u32 s37, s37, 65536
    s_add_u32 m0, s35, 0
    s_nop 0
    buffer_load_dwordx4 v8, s[16:19], s36 offen offset:0 sc1 lds
    buffer_load_dwordx4 v9, s[16:19], s36 offen offset:1024 sc1 lds
    buffer_load_dwordx4 v10, s[16:19], s36 offen offset:2048 sc1 lds
    buffer_load_dwordx4 v11, s[16:19], s36 offen offset:3072 sc1 lds
    s_add_u32 m0, s35, 4096
    s_nop 0
    buffer_load_dwordx4 v12, s[16:19], s36 offen offset:0 sc1 lds
    buffer_load_dwordx4 v13, s[16:19], s36 offen offset:1024 sc1 lds
    buffer_load_dwordx4 v14, s[16:19], s36 offen offset:2048 sc1 lds
    buffer_load_dwordx4 v15, s[16:19], s36 offen offset:3072 sc1 lds
    s_add_u32 m0, s35, 8192
    s_nop 0
    buffer_load_dwordx4 v16, s[16:19], s36 offen offset:0 sc1 lds
    s_add_u32 s36, s36, 36864
    s_cmp_eq_u32 s36, 626688
    s_cselect_b32 s36, 0, s36
    s_add_u32 m0, s35, 9216
    s_nop 0
    buffer_load_dwordx4 v8, s[16:19], s36 offen offset:0 sc1 lds
    buffer_load_dwordx4 v9, s[16:19], s36 offen offset:1024 sc1 lds
    buffer_load_dwordx4 v10, s[16:19], s36 offen offset:2048 sc1 lds
    buffer_load_dwordx4 v11, s[16:19], s36 offen offset:3072 sc1 lds
    s_add_u32 m0, s35, 13312
    s_nop 0
    buffer_load_dwordx4 v12, s[16:19], s36 offen offset:0 sc1 lds
    buffer_load_dwordx4 v13, s[16:19], s36 offen offset:1024 sc1 lds
    buffer_load_dwordx4 v14, s[16:19], s36 offen offset:2048 sc1 lds
    buffer_load_dwordx4 v15, s[16:19], s36 offen offset:3072 sc1 lds
    s_add_u32 m0, s35, 17408
    s_nop 0
    buffer_load_dwordx4 v16, s[16:19], s36 offen offset:0 sc1 lds
    s_add_u32 s36, s36, 36864
    s_cmp_eq_u32 s36, 626688
    s_cselect_b32 s36, 0, s36
    s_waitcnt vmcnt(9)
    v_add_u32 v24, s37, v44
    ds_read_b64_tr_b16 v[64:65], v22 offset:0
    ds_read_b64_tr_b16 v[66:67], v22 offset:2304
    ds_read_b128 v[136:139], v24 offset:11264
    ds_read_b128 v[140:143], v24 offset:12288
    ds_read_b128 v[144:147], v24 offset:13312
    ds_read_b128 v[148:151], v24 offset:14336
    ds_read_b128 v[152:155], v24 offset:15360
    ds_read_b64_tr_b16 v[68:69], v22 offset:32
    ds_read_b64_tr_b16 v[70:71], v22 offset:2336
    ds_read_b64_tr_b16 v[72:73], v22 offset:64
    ds_read_b64_tr_b16 v[74:75], v22 offset:2368
    ds_read_b64_tr_b16 v[76:77], v22 offset:96
    ds_read_b64_tr_b16 v[78:79], v22 offset:2400
    ds_read_b64_tr_b16 v[80:81], v22 offset:128
    ds_read_b64_tr_b16 v[82:83], v22 offset:2432
    ds_read_b64_tr_b16 v[84:85], v22 offset:160
    ds_read_b64_tr_b16 v[86:87], v22 offset:2464
    ds_read_b64_tr_b16 v[88:89], v22 offset:192
    ds_read_b64_tr_b16 v[90:91], v22 offset:2496
    ds_read_b64_tr_b16 v[92:93], v22 offset:224
    ds_read_b64_tr_b16 v[94:95], v22 offset:2528
    ds_read_b64_tr_b16 v[96:97], v22 offset:256
    ds_read_b64_tr_b16 v[98:99], v22 offset:2560
    s_add_u32 s37, s37, 5120
    s_cmp_eq_u32 s37, 152576
    s_cselect_b32 s37, 0x10000, s37
    s_waitcnt lgkmcnt(0)
    s_add_u32 m0, s35, 0
    s_nop 0
    buffer_load_dwordx4 v8, s[16:19], s36 offen offset:0 sc1 lds
    buffer_load_dwordx4 v9, s[16:19], s36 offen offset:1024 sc1 lds
    buffer_load_dwordx4 v10, s[16:19], s36 offen offset:2048 sc1 lds
    buffer_load_dwordx4 v11, s[16:19], s36 offen offset:3072 sc1 lds
    s_add_u32 m0, s35, 4096
    s_nop 0
    buffer_load_dwordx4 v12, s[16:19], s36 offen offset:0 sc1 lds
    buffer_load_dwordx4 v13, s[16:19], s36 offen offset:1024 sc1 lds
    buffer_load_dwordx4 v14, s[16:19], s36 offen offset:2048 sc1 lds
    buffer_load_dwordx4 v15, s[16:19], s36 offen offset:3072 sc1 lds
    s_add_u32 m0, s35, 8192
    s_nop 0
    buffer_load_dwordx4 v16, s[16:19], s36 offen offset:0 sc1 lds
    s_add_u32 s36, s36, 36864
    s_cmp_eq_u32 s36, 626688
    s_cselect_b32 s36, 0, s36
    s_waitcnt vmcnt(9)
    v_mfma_f32_16x16x32_bf16 a[0:3], v[64:67], v[136:139], 0
    v_add_u32 v24, s37, v44
    ds_read_b64_tr_b16 v[100:101], v22 offset:9216
    v_mfma_f32_16x16x32_bf16 a[4:7], v[64:67], v[140:143], 0
    ds_read_b64_tr_b16 v[102:103], v22 offset:11520
    v_mfma_f32_16x16x32_bf16 a[8:11], v[64:67], v[144:147], 0
    ds_read_b128 v[156:159], v24 offset:11264
    v_mfma_f32_16x16x32_bf16 a[12:15], v[64:67], v[148:151], 0
    ds_read_b128 v[160:163], v24 offset:12288
    ds_read_b128 v[164:167], v24 offset:13312
    v_mfma_f32_16x16x32_bf16 a[16:19], v[64:67], v[152:155], 0
    ds_read_b128 v[168:171], v24 offset:14336
    v_mfma_f32_16x16x32_bf16 a[20:23], v[68:71], v[136:139], 0
    ds_read_b128 v[172:175], v24 offset:15360
    v_mfma_f32_16x16x32_bf16 a[24:27], v[68:71], v[140:143], 0
    ds_read_b64_tr_b16 v[104:105], v22 offset:9248
    ds_read_b64_tr_b16 v[106:107], v22 offset:11552
    v_mfma_f32_16x16x32_bf16 a[28:31], v[68:71], v[144:147], 0
    ds_read_b64_tr_b16 v[108:109], v22 offset:9280
    v_mfma_f32_16x16x32_bf16 a[32:35], v[68:71], v[148:151], 0
    ds_read_b64_tr_b16 v[110:111], v22 offset:11584
    v_mfma_f32_16x16x32_bf16 a[36:39], v[68:71], v[152:155], 0
    ds_read_b64_tr_b16 v[112:113], v22 offset:9312
    ds_read_b64_tr_b16 v[114:115], v22 offset:11616
    v_mfma_f32_16x16x32_bf16 a[40:43], v[72:75], v[136:139], 0
    ds_read_b64_tr_b16 v[116:117], v22 offset:9344
    v_mfma_f32_16x16x32_bf16 a[44:47], v[72:75], v[140:143], 0
    ds_read_b64_tr_b16 v[118:119], v22 offset:11648
    v_mfma_f32_16x16x32_bf16 a[48:51], v[72:75], v[144:147], 0
    ds_read_b64_tr_b16 v[120:121], v22 offset:9376
    ds_read_b64_tr_b16 v[122:123], v22 offset:11680
    v_mfma_f32_16x16x32_bf16 a[52:55], v[72:75], v[148:151], 0
    ds_read_b64_tr_b16 v[124:125], v22 offset:9408
    v_mfma_f32_16x16x32_bf16 a[56:59], v[72:75], v[152:155], 0
    ds_read_b64_tr_b16 v[126:127], v22 offset:11712
    v_mfma_f32_16x16x32_bf16 a[60:63], v[76:79], v[136:139], 0
    ds_read_b64_tr_b16 v[128:129], v22 offset:9440
    ds_read_b64_tr_b16 v[130:131], v22 offset:11744
    v_mfma_f32_16x16x32_bf16 a[64:67], v[76:79], v[140:143], 0
    ds_read_b64_tr_b16 v[132:133], v22 offset:9472
    v_mfma_f32_16x16x32_bf16 a[68:71], v[76:79], v[144:147], 0
    ds_read_b64_tr_b16 v[134:135], v22 offset:11776
    v_mfma_f32_16x16x32_bf16 a[72:75], v[76:79], v[148:151], 0
    s_add_u32 s37, s37, 5120
    s_cmp_eq_u32 s37, 152576
    v_mfma_f32_16x16x32_bf16 a[76:79], v[76:79], v[152:155], 0
    s_cselect_b32 s37, 0x10000, s37
    v_mfma_f32_16x16x32_bf16 a[80:83], v[80:83], v[136:139], 0
    v_mfma_f32_16x16x32_bf16 a[84:87], v[80:83], v[140:143], 0
    v_mfma_f32_16x16x32_bf16 a[88:91], v[80:83], v[144:147], 0
    v_mfma_f32_16x16x32_bf16 a[92:95], v[80:83], v[148:151], 0
    v_mfma_f32_16x16x32_bf16 a[96:99], v[80:83], v[152:155], 0
    s_waitcnt lgkmcnt(0)
    s_add_u32 m0, s35, 9216
    v_mfma_f32_16x16x32_bf16 a[100:103], v[84:87], v[136:139], 0
    buffer_load_dwordx4 v8, s[16:19], s36 offen offset:0 sc1 lds
    v_mfma_f32_16x16x32_bf16 a[104:107], v[84:87], v[140:143], 0
    v_mfma_f32_16x16x32_bf16 a[108:111], v[84:87], v[144:147], 0
    buffer_load_dwordx4 v9, s[16:19], s36 offen offset:1024 sc1 lds
    v_mfma_f32_16x16x32_bf16 a[112:115], v[84:87], v[148:151], 0
    v_mfma_f32_16x16x32_bf16 a[116:119], v[84:87], v[152:155], 0
    buffer_load_dwordx4 v10, s[16:19], s36 offen offset:2048 sc1 lds
    v_mfma_f32_16x16x32_bf16 a[120:123], v[88:91], v[136:139], 0
    v_mfma_f32_16x16x32_bf16 a[124:127], v[88:91], v[140:143], 0
    buffer_load_dwordx4 v11, s[16:19], s36 offen offset:3072 sc1 lds
    v_mfma_f32_16x16x32_bf16 a[128:131], v[88:91], v[144:147], 0
    s_add_u32 m0, s35, 13312
    v_mfma_f32_16x16x32_bf16 a[132:135], v[88:91], v[148:151], 0
    buffer_load_dwordx4 v12, s[16:19], s36 offen offset:0 sc1 lds
    v_mfma_f32_16x16x32_bf16 a[136:139], v[88:91], v[152:155], 0
    v_mfma_f32_16x16x32_bf16 a[140:143], v[92:95], v[136:139], 0
    buffer_load_dwordx4 v13, s[16:19], s36 offen offset:1024 sc1 lds
    v_mfma_f32_16x16x32_bf16 a[144:147], v[92:95], v[140:143], 0
    v_mfma_f32_16x16x32_bf16 a[148:151], v[92:95], v[144:147], 0
    buffer_load_dwordx4 v14, s[16:19], s36 offen offset:2048 sc1 lds
    v_mfma_f32_16x16x32_bf16 a[152:155], v[92:95], v[148:151], 0
    v_mfma_f32_16x16x32_bf16 a[156:159], v[92:95], v[152:155], 0
    buffer_load_dwordx4 v15, s[16:19], s36 offen offset:3072 sc1 lds
    v_mfma_f32_16x16x32_bf16 a[160:163], v[96:99], v[136:139], 0
    s_add_u32 m0, s35, 17408
    v_mfma_f32_16x16x32_bf16 a[164:167], v[96:99], v[140:143], 0
    buffer_load_dwordx4 v16, s[16:19], s36 offen offset:0 sc1 lds
    v_mfma_f32_16x16x32_bf16 a[168:171], v[96:99], v[144:147], 0
    v_mfma_f32_16x16x32_bf16 a[172:175], v[96:99], v[148:151], 0
    s_add_u32 s36, s36, 36864
    s_cmp_eq_u32 s36, 626688
    s_cselect_b32 s36, 0, s36
    v_mfma_f32_16x16x32_bf16 a[176:179], v[96:99], v[152:155], 0
    s_waitcnt vmcnt(9)
    v_mfma_f32_16x16x32_bf16 a[0:3], v[100:103], v[156:159], a[0:3]
    v_add_u32 v24, s37, v44
    ds_read_b64_tr_b16 v[64:65], v22 offset:0
    v_mfma_f32_16x16x32_bf16 a[4:7], v[100:103], v[160:163], a[4:7]
    ds_read_b64_tr_b16 v[66:67], v22 offset:2304
    v_mfma_f32_16x16x32_bf16 a[8:11], v[100:103], v[164:167], a[8:11]
    ds_read_b128 v[136:139], v24 offset:11264
    v_mfma_f32_16x16x32_bf16 a[12:15], v[100:103], v[168:171], a[12:15]
    ds_read_b128 v[140:143], v24 offset:12288
    ds_read_b128 v[144:147], v24 offset:13312
    v_mfma_f32_16x16x32_bf16 a[16:19], v[100:103], v[172:175], a[16:19]
    ds_read_b128 v[148:151], v24 offset:14336
    v_mfma_f32_16x16x32_bf16 a[20:23], v[104:107], v[156:159], a[20:23]
    ds_read_b128 v[152:155], v24 offset:15360
    v_mfma_f32_16x16x32_bf16 a[24:27], v[104:107], v[160:163], a[24:27]
    ds_read_b64_tr_b16 v[68:69], v22 offset:32
    ds_read_b64_tr_b16 v[70:71], v22 offset:2336
    v_mfma_f32_16x16x32_bf16 a[28:31], v[104:107], v[164:167], a[28:31]
    ds_read_b64_tr_b16 v[72:73], v22 offset:64
    v_mfma_f32_16x16x32_bf16 a[32:35], v[104:107], v[168:171], a[32:35]
    ds_read_b64_tr_b16 v[74:75], v22 offset:2368
    v_mfma_f32_16x16x32_bf16 a[36:39], v[104:107], v[172:175], a[36:39]
    ds_read_b64_tr_b16 v[76:77], v22 offset:96
    ds_read_b64_tr_b16 v[78:79], v22 offset:2400
    v_mfma_f32_16x16x32_bf16 a[40:43], v[108:111], v[156:159], a[40:43]
    ds_read_b64_tr_b16 v[80:81], v22 offset:128
    v_mfma_f32_16x16x32_bf16 a[44:47], v[108:111], v[160:163], a[44:47]
    ds_read_b64_tr_b16 v[82:83], v22 offset:2432
    v_mfma_f32_16x16x32_bf16 a[48:51], v[108:111], v[164:167], a[48:51]
    ds_read_b64_tr_b16 v[84:85], v22 offset:160
    ds_read_b64_tr_b16 v[86:87], v22 offset:2464
    v_mfma_f32_16x16x32_bf16 a[52:55], v[108:111], v[168:171], a[52:55]
    ds_read_b64_tr_b16 v[88:89], v22 offset:192
    v_mfma_f32_16x16x32_bf16 a[56:59], v[108:111], v[172:175], a[56:59]
    ds_read_b64_tr_b16 v[90:91], v22 offset:2496
    v_mfma_f32_16x16x32_bf16 a[60:63], v[112:115], v[156:159], a[60:63]
    ds_read_b64_tr_b16 v[92:93], v22 offset:224
    ds_read_b64_tr_b16 v[94:95], v22 offset:2528
    v_mfma_f32_16x16x32_bf16 a[64:67], v[112:115], v[160:163], a[64:67]
    ds_read_b64_tr_b16 v[96:97], v22 offset:256
    v_mfma_f32_16x16x32_bf16 a[68:71], v[112:115], v[164:167], a[68:71]
    ds_read_b64_tr_b16 v[98:99], v22 offset:2560
    v_mfma_f32_16x16x32_bf16 a[72:75], v[112:115], v[168:171], a[72:75]
    s_add_u32 s37, s37, 5120
    s_cmp_eq_u32 s37, 152576
    v_mfma_f32_16x16x32_bf16 a[76:79], v[112:115], v[172:175], a[76:79]
    s_cselect_b32 s37, 0x10000, s37
    v_mfma_f32_16x16x32_bf16 a[80:83], v[116:119], v[156:159], a[80:83]
    v_mfma_f32_16x16x32_bf16 a[84:87], v[116:119], v[160:163], a[84:87]
    v_mfma_f32_16x16x32_bf16 a[88:91], v[116:119], v[164:167], a[88:91]
    v_mfma_f32_16x16x32_bf16 a[92:95], v[116:119], v[168:171], a[92:95]
    v_mfma_f32_16x16x32_bf16 a[96:99], v[116:119], v[172:175], a[96:99]
    s_waitcnt lgkmcnt(0)
    s_add_u32 m0, s35, 0
    v_mfma_f32_16x16x32_bf16 a[100:103], v[120:123], v[156:159], a[100:103]
    buffer_load_dwordx4 v8, s[16:19], s36 offen offset:0 sc1 lds
    v_mfma_f32_16x16x32_bf16 a[104:107], v[120:123], v[160:163], a[104:107]
    v_mfma_f32_16x16x32_bf16 a[108:111], v[120:123], v[164:167], a[108:111]
    buffer_load_dwordx4 v9, s[16:19], s36 offen offset:1024 sc1 lds
    v_mfma_f32_16x16x32_bf16 a[112:115], v[120:123], v[168:171], a[112:115]
    v_mfma_f32_16x16x32_bf16 a[116:119], v[120:123], v[172:175], a[116:119]
    buffer_load_dwordx4 v10, s[16:19], s36 offen offset:2048 sc1 lds
    v_mfma_f32_16x16x32_bf16 a[120:123], v[124:127], v[156:159], a[120:123]
    v_mfma_f32_16x16x32_bf16 a[124:127], v[124:127], v[160:163], a[124:127]
    buffer_load_dwordx4 v11, s[16:19], s36 offen offset:3072 sc1 lds
    v_mfma_f32_16x16x32_bf16 a[128:131], v[124:127], v[164:167], a[128:131]
    s_add_u32 m0, s35, 4096
    v_mfma_f32_16x16x32_bf16 a[132:135], v[124:127], v[168:171], a[132:135]
    buffer_load_dwordx4 v12, s[16:19], s36 offen offset:0 sc1 lds
    v_mfma_f32_16x16x32_bf16 a[136:139], v[124:127], v[172:175], a[136:139]
    v_mfma_f32_16x16x32_bf16 a[140:143], v[128:131], v[156:159], a[140:143]
    buffer_load_dwordx4 v13, s[16:19], s36 offen offset:1024 sc1 lds
    v_mfma_f32_16x16x32_bf16 a[144:147], v[128:131], v[160:163], a[144:147]
    v_mfma_f32_16x16x32_bf16 a[148:151], v[128:131], v[164:167], a[148:151]
    buffer_load_dwordx4 v14, s[16:19], s36 offen offset:2048 sc1 lds
    v_mfma_f32_16x16x32_bf16 a[152:155], v[128:131], v[168:171], a[152:155]
    v_mfma_f32_16x16x32_bf16 a[156:159], v[128:131], v[172:175], a[156:159]
    buffer_load_dwordx4 v15, s[16:19], s36 offen offset:3072 sc1 lds
    v_mfma_f32_16x16x32_bf16 a[160:163], v[132:135], v[156:159], a[160:163]
    s_add_u32 m0, s35, 8192
    v_mfma_f32_16x16x32_bf16 a[164:167], v[132:135], v[160:163], a[164:167]
    buffer_load_dwordx4 v16, s[16:19], s36 offen offset:0 sc1 lds
    v_mfma_f32_16x16x32_bf16 a[168:171], v[132:135], v[164:167], a[168:171]
    v_mfma_f32_16x16x32_bf16 a[172:175], v[132:135], v[168:171], a[172:175]
    s_add_u32 s36, s36, 36864
    s_cmp_eq_u32 s36, 626688
    s_cselect_b32 s36, 0, s36
    v_mfma_f32_16x16x32_bf16 a[176:179], v[132:135], v[172:175], a[176:179]
    s_waitcnt vmcnt(9)
    v_mfma_f32_16x16x32_bf16 a[0:3], v[64:67], v[136:139], a[0:3]
    v_add_u32 v24, s37, v44
    ds_read_b64_tr_b16 v[100:101], v22 offset:9216
    v_mfma_f32_16x16x32_bf16 a[4:7], v[64:67], v[140:143], a[4:7]
    ds_read_b64_tr_b16 v[102:103], v22 offset:11520
    v_mfma_f32_16x16x32_bf16 a[8:11], v[64:67], v[144:147], a[8:11]
    ds_read_b128 v[156:159], v24 offset:11264
    v_mfma_f32_16x16x32_bf16 a[12:15], v[64:67], v[148:151], a[12:15]
    ds_read_b128 v[160:163], v24 offset:12288
    ds_read_b128 v[164:167], v24 offset:13312
    v_mfma_f32_16x16x32_bf16 a[16:19], v[64:67], v[152:155], a[16:19]
    ds_read_b128 v[168:171], v24 offset:14336
    v_mfma_f32_16x16x32_bf16 a[20:23], v[68:71], v[136:139], a[20:23]
    ds_read_b128 v[172:175], v24 offset:15360
    v_mfma_f32_16x16x32_bf16 a[24:27], v[68:71], v[140:143], a[24:27]
    ds_read_b64_tr_b16 v[104:105], v22 offset:9248
    ds_read_b64_tr_b16 v[106:107], v22 offset:11552
    v_mfma_f32_16x16x32_bf16 a[28:31], v[68:71], v[144:147], a[28:31]
    ds_read_b64_tr_b16 v[108:109], v22 offset:9280
    v_mfma_f32_16x16x32_bf16 a[32:35], v[68:71], v[148:151], a[32:35]
    ds_read_b64_tr_b16 v[110:111], v22 offset:11584
    v_mfma_f32_16x16x32_bf16 a[36:39], v[68:71], v[152:155], a[36:39]
    ds_read_b64_tr_b16 v[112:113], v22 offset:9312
    ds_read_b64_tr_b16 v[114:115], v22 offset:11616
    v_mfma_f32_16x16x32_bf16 a[40:43], v[72:75], v[136:139], a[40:43]
    ds_read_b64_tr_b16 v[116:117], v22 offset:9344
    v_mfma_f32_16x16x32_bf16 a[44:47], v[72:75], v[140:143], a[44:47]
    ds_read_b64_tr_b16 v[118:119], v22 offset:11648
    v_mfma_f32_16x16x32_bf16 a[48:51], v[72:75], v[144:147], a[48:51]
    ds_read_b64_tr_b16 v[120:121], v22 offset:9376
    ds_read_b64_tr_b16 v[122:123], v22 offset:11680
    v_mfma_f32_16x16x32_bf16 a[52:55], v[72:75], v[148:151], a[52:55]
    ds_read_b64_tr_b16 v[124:125], v22 offset:9408
    v_mfma_f32_16x16x32_bf16 a[56:59], v[72:75], v[152:155], a[56:59]
    ds_read_b64_tr_b16 v[126:127], v22 offset:11712
    v_mfma_f32_16x16x32_bf16 a[60:63], v[76:79], v[136:139], a[60:63]
    ds_read_b64_tr_b16 v[128:129], v22 offset:9440
    ds_read_b64_tr_b16 v[130:131], v22 offset:11744
    v_mfma_f32_16x16x32_bf16 a[64:67], v[76:79], v[140:143], a[64:67]
    ds_read_b64_tr_b16 v[132:133], v22 offset:9472
    v_mfma_f32_16x16x32_bf16 a[68:71], v[76:79], v[144:147], a[68:71]
    ds_read_b64_tr_b16 v[134:135], v22 offset:11776
    v_mfma_f32_16x16x32_bf16 a[72:75], v[76:79], v[148:151], a[72:75]
    s_add_u32 s37, s37, 5120
    s_cmp_eq_u32 s37, 152576
    v_mfma_f32_16x16x32_bf16 a[76:79], v[76:79], v[152:155], a[76:79]
    s_cselect_b32 s37, 0x10000, s37
    v_mfma_f32_16x16x32_bf16 a[80:83], v[80:83], v[136:139], a[80:83]
    v_mfma_f32_16x16x32_bf16 a[84:87], v[80:83], v[140:143], a[84:87]
    v_mfma_f32_16x16x32_bf16 a[88:91], v[80:83], v[144:147], a[88:91]
    v_mfma_f32_16x16x32_bf16 a[92:95], v[80:83], v[148:151], a[92:95]
    v_mfma_f32_16x16x32_bf16 a[96:99], v[80:83], v[152:155], a[96:99]
    s_waitcnt lgkmcnt(0)
    s_add_u32 m0, s35, 9216
    v_mfma_f32_16x16x32_bf16 a[100:103], v[84:87], v[136:139], a[100:103]
    buffer_load_dwordx4 v8, s[16:19], s36 offen offset:0 sc1 lds
    v_mfma_f32_16x16x32_bf16 a[104:107], v[84:87], v[140:143], a[104:107]
    v_mfma_f32_16x16x32_bf16 a[108:111], v[84:87], v[144:147], a[108:111]
    buffer_load_dwordx4 v9, s[16:19], s36 offen offset:1024 sc1 lds
    v_mfma_f32_16x16x32_bf16 a[112:115], v[84:87], v[148:151], a[112:115]
    v_mfma_f32_16x16x32_bf16 a[116:119], v[84:87], v[152:155], a[116:119]
    buffer_load_dwordx4 v10, s[16:19], s36 offen offset:2048 sc1 lds
    v_mfma_f32_16x16x32_bf16 a[120:123], v[88:91], v[136:139], a[120:123]
    v_mfma_f32_16x16x32_bf16 a[124:127], v[88:91], v[140:143], a[124:127]
    buffer_load_dwordx4 v11, s[16:19], s36 offen offset:3072 sc1 lds
    v_mfma_f32_16x16x32_bf16 a[128:131], v[88:91], v[144:147], a[128:131]
    s_add_u32 m0, s35, 13312
    v_mfma_f32_16x16x32_bf16 a[132:135], v[88:91], v[148:151], a[132:135]
    buffer_load_dwordx4 v12, s[16:19], s36 offen offset:0 sc1 lds
    v_mfma_f32_16x16x32_bf16 a[136:139], v[88:91], v[152:155], a[136:139]
    v_mfma_f32_16x16x32_bf16 a[140:143], v[92:95], v[136:139], a[140:143]
    buffer_load_dwordx4 v13, s[16:19], s36 offen offset:1024 sc1 lds
    v_mfma_f32_16x16x32_bf16 a[144:147], v[92:95], v[140:143], a[144:147]
    v_mfma_f32_16x16x32_bf16 a[148:151], v[92:95], v[144:147], a[148:151]
    buffer_load_dwordx4 v14, s[16:19], s36 offen offset:2048 sc1 lds
    v_mfma_f32_16x16x32_bf16 a[152:155], v[92:95], v[148:151], a[152:155]
    v_mfma_f32_16x16x32_bf16 a[156:159], v[92:95], v[152:155], a[156:159]
    buffer_load_dwordx4 v15, s[16:19], s36 offen offset:3072 sc1 lds
    v_mfma_f32_16x16x32_bf16 a[160:163], v[96:99], v[136:139], a[160:163]
    s_add_u32 m0, s35, 17408
    v_mfma_f32_16x16x32_bf16 a[164:167], v[96:99], v[140:143], a[164:167]
    buffer_load_dwordx4 v16, s[16:19], s36 offen offset:0 sc1 lds
    v_mfma_f32_16x16x32_bf16 a[168:171], v[96:99], v[144:147], a[168:171]
    v_mfma_f32_16x16x32_bf16 a[172:175], v[96:99], v[148:151], a[172:175]
    s_add_u32 s36, s36, 36864
    s_cmp_eq_u32 s36, 626688
    s_cselect_b32 s36, 0, s36
    v_mfma_f32_16x16x32_bf16 a[176:179], v[96:99], v[152:155], a[176:179]
    s_waitcnt vmcnt(9)
    v_mfma_f32_16x16x32_bf16 a[0:3], v[100:103], v[156:159], a[0:3]
    v_add_u32 v24, s37, v44
    ds_read_b64_tr_b16 v[64:65], v22 offset:0
    v_mfma_f32_16x16x32_bf16 a[4:7], v[100:103], v[160:163], a[4:7]
    ds_read_b64_tr_b16 v[66:67], v22 offset:2304
    v_mfma_f32_16x16x32_bf16 a[8:11], v[100:103], v[164:167], a[8:11]
    ds_read_b128 v[136:139], v24 offset:11264
    v_mfma_f32_16x16x32_bf16 a[12:15], v[100:103], v[168:171], a[12:15]
    ds_read_b128 v[140:143], v24 offset:12288
    ds_read_b128 v[144:147], v24 offset:13312
    v_mfma_f32_16x16x32_bf16 a[16:19], v[100:103], v[172:175], a[16:19]
    ds_read_b128 v[148:151], v24 offset:14336
    v_mfma_f32_16x16x32_bf16 a[20:23], v[104:107], v[156:159], a[20:23]
    ds_read_b128 v[152:155], v24 offset:15360
    v_mfma_f32_16x16x32_bf16 a[24:27], v[104:107], v[160:163], a[24:27]
    ds_read_b64_tr_b16 v[68:69], v22 offset:32
    ds_read_b64_tr_b16 v[70:71], v22 offset:2336
    v_mfma_f32_16x16x32_bf16 a[28:31], v[104:107], v[164:167], a[28:31]
    ds_read_b64_tr_b16 v[72:73], v22 offset:64
    v_mfma_f32_16x16x32_bf16 a[32:35], v[104:107], v[168:171], a[32:35]
    ds_read_b64_tr_b16 v[74:75], v22 offset:2368
    v_mfma_f32_16x16x32_bf16 a[36:39], v[104:107], v[172:175], a[36:39]
    ds_read_b64_tr_b16 v[76:77], v22 offset:96
    ds_read_b64_tr_b16 v[78:79], v22 offset:2400
    v_mfma_f32_16x16x32_bf16 a[40:43], v[108:111], v[156:159], a[40:43]
    ds_read_b64_tr_b16 v[80:81], v22 offset:128
    v_mfma_f32_16x16x32_bf16 a[44:47], v[108:111], v[160:163], a[44:47]
    ds_read_b64_tr_b16 v[82:83], v22 offset:2432
    v_mfma_f32_16x16x32_bf16 a[48:51], v[108:111], v[164:167], a[48:51]
    ds_read_b64_tr_b16 v[84:85], v22 offset:160
    ds_read_b64_tr_b16 v[86:87], v22 offset:2464
    v_mfma_f32_16x16x32_bf16 a[52:55], v[108:111], v[168:171], a[52:55]
    ds_read_b64_tr_b16 v[88:89], v22 offset:192
    v_mfma_f32_16x16x32_bf16 a[56:59], v[108:111], v[172:175], a[56:59]
    ds_read_b64_tr_b16 v[90:91], v22 offset:2496
    v_mfma_f32_16x16x32_bf16 a[60:63], v[112:115], v[156:159], a[60:63]
    ds_read_b64_tr_b16 v[92:93], v22 offset:224
    ds_read_b64_tr_b16 v[94:95], v22 offset:2528
    v_mfma_f32_16x16x32_bf16 a[64:67], v[112:115], v[160:163], a[64:67]
    ds_read_b64_tr_b16 v[96:97], v22 offset:256
    v_mfma_f32_16x16x32_bf16 a[68:71], v[112:115], v[164:167], a[68:71]
    ds_read_b64_tr_b16 v[98:99], v22 offset:2560
    v_mfma_f32_16x16x32_bf16 a[72:75], v[112:115], v[168:171], a[72:75]
    s_add_u32 s37, s37, 5120
    s_cmp_eq_u32 s37, 152576
    v_mfma_f32_16x16x32_bf16 a[76:79], v[112:115], v[172:175], a[76:79]
    s_cselect_b32 s37, 0x10000, s37
    v_mfma_f32_16x16x32_bf16 a[80:83], v[116:119], v[156:159], a[80:83]
    v_mfma_f32_16x16x32_bf16 a[84:87], v[116:119], v[160:163], a[84:87]
    v_mfma_f32_16x16x32_bf16 a[88:91], v[116:119], v[164:167], a[88:91]
    v_mfma_f32_16x16x32_bf16 a[92:95], v[116:119], v[168:171], a[92:95]
    v_mfma_f32_16x16x32_bf16 a[96:99], v[116:119], v[172:175], a[96:99]
    s_waitcnt lgkmcnt(0)
    s_add_u32 m0, s35, 0
    v_mfma_f32_16x16x32_bf16 a[100:103], v[120:123], v[156:159], a[100:103]
    buffer_load_dwordx4 v8, s[16:19], s36 offen offset:0 sc1 lds
    v_mfma_f32_16x16x32_bf16 a[104:107], v[120:123], v[160:163], a[104:107]
    v_mfma_f32_16x16x32_bf16 a[108:111], v[120:123], v[164:167], a[108:111]
    buffer_load_dwordx4 v9, s[16:19], s36 offen offset:1024 sc1 lds
    v_mfma_f32_16x16x32_bf16 a[112:115], v[120:123], v[168:171], a[112:115]
    v_mfma_f32_16x16x32_bf16 a[116:119], v[120:123], v[172:175], a[116:119]
    buffer_load_dwordx4 v10, s[16:19], s36 offen offset:2048 sc1 lds
    v_mfma_f32_16x16x32_bf16 a[120:123], v[124:127], v[156:159], a[120:123]
    v_mfma_f32_16x16x32_bf16 a[124:127], v[124:127], v[160:163], a[124:127]
    buffer_load_dwordx4 v11, s[16:19], s36 offen offset:3072 sc1 lds
    v_mfma_f32_16x16x32_bf16 a[128:131], v[124:127], v[164:167], a[128:131]
    s_add_u32 m0, s35, 4096
    v_mfma_f32_16x16x32_bf16 a[132:135], v[124:127], v[168:171], a[132:135]
    buffer_load_dwordx4 v12, s[16:19], s36 offen offset:0 sc1 lds
    v_mfma_f32_16x16x32_bf16 a[136:139], v[124:127], v[172:175], a[136:139]
    v_mfma_f32_16x16x32_bf16 a[140:143], v[128:131], v[156:159], a[140:143]
    buffer_load_dwordx4 v13, s[16:19], s36 offen offset:1024 sc1 lds
    v_mfma_f32_16x16x32_bf16 a[144:147], v[128:131], v[160:163], a[144:147]
    v_mfma_f32_16x16x32_bf16 a[148:151], v[128:131], v[164:167], a[148:151]
    buffer_load_dwordx4 v14, s[16:19], s36 offen offset:2048 sc1 lds
    v_mfma_f32_16x16x32_bf16 a[152:155], v[128:131], v[168:171], a[152:155]
    v_mfma_f32_16x16x32_bf16 a[156:159], v[128:131], v[172:175], a[156:159]
    buffer_load_dwordx4 v15, s[16:19], s36 offen offset:3072 sc1 lds
    v_mfma_f32_16x16x32_bf16 a[160:163], v[132:135], v[156:159], a[160:163]
    s_add_u32 m0, s35, 8192
    v_mfma_f32_16x16x32_bf16 a[164:167], v[132:135], v[160:163], a[164:167]
    buffer_load_dwordx4 v16, s[16:19], s36 offen offset:0 sc1 lds
    v_mfma_f32_16x16x32_bf16 a[168:171], v[132:135], v[164:167], a[168:171]
    v_mfma_f32_16x16x32_bf16 a[172:175], v[132:135], v[168:171], a[172:175]
    s_add_u32 s36, s36, 36864
    s_cmp_eq_u32 s36, 626688
    s_cselect_b32 s36, 0, s36
    v_mfma_f32_16x16x32_bf16 a[176:179], v[132:135], v[172:175], a[176:179]
    s_waitcnt vmcnt(9)
    v_mfma_f32_16x16x32_bf16 a[0:3], v[64:67], v[136:139], a[0:3]
    v_add_u32 v24, s37, v44
    ds_read_b64_tr_b16 v[100:101], v22 offset:9216
    v_mfma_f32_16x16x32_bf16 a[4:7], v[64:67], v[140:143], a[4:7]
    ds_read_b64_tr_b16 v[102:103], v22 offset:11520
    v_mfma_f32_16x16x32_bf16 a[8:11], v[64:67], v[144:147], a[8:11]
    ds_read_b128 v[156:159], v24 offset:11264
    v_mfma_f32_16x16x32_bf16 a[12:15], v[64:67], v[148:151], a[12:15]
    ds_read_b128 v[160:163], v24 offset:12288
    ds_read_b128 v[164:167], v24 offset:13312
    v_mfma_f32_16x16x32_bf16 a[16:19], v[64:67], v[152:155], a[16:19]
    ds_read_b128 v[168:171], v24 offset:14336
    v_mfma_f32_16x16x32_bf16 a[20:23], v[68:71], v[136:139], a[20:23]
    ds_read_b128 v[172:175], v24 offset:15360
    v_mfma_f32_16x16x32_bf16 a[24:27], v[68:71], v[140:143], a[24:27]
    ds_read_b64_tr_b16 v[104:105], v22 offset:9248
    ds_read_b64_tr_b16 v[106:107], v22 offset:11552
    v_mfma_f32_16x16x32_bf16 a[28:31], v[68:71], v[144:147], a[28:31]
    ds_read_b64_tr_b16 v[108:109], v22 offset:9280
    v_mfma_f32_16x16x32_bf16 a[32:35], v[68:71], v[148:151], a[32:35]
    ds_read_b64_tr_b16 v[110:111], v22 offset:11584
    v_mfma_f32_16x16x32_bf16 a[36:39], v[68:71], v[152:155], a[36:39]
    ds_read_b64_tr_b16 v[112:113], v22 offset:9312
    ds_read_b64_tr_b16 v[114:115], v22 offset:11616
    v_mfma_f32_16x16x32_bf16 a[40:43], v[72:75], v[136:139], a[40:43]
    ds_read_b64_tr_b16 v[116:117], v22 offset:9344
    v_mfma_f32_16x16x32_bf16 a[44:47], v[72:75], v[140:143], a[44:47]
    ds_read_b64_tr_b16 v[118:119], v22 offset:11648
    v_mfma_f32_16x16x32_bf16 a[48:51], v[72:75], v[144:147], a[48:51]
    ds_read_b64_tr_b16 v[120:121], v22 offset:9376
    ds_read_b64_tr_b16 v[122:123], v22 offset:11680
    v_mfma_f32_16x16x32_bf16 a[52:55], v[72:75], v[148:151], a[52:55]
    ds_read_b64_tr_b16 v[124:125], v22 offset:9408
    v_mfma_f32_16x16x32_bf16 a[56:59], v[72:75], v[152:155], a[56:59]
    ds_read_b64_tr_b16 v[126:127], v22 offset:11712
    v_mfma_f32_16x16x32_bf16 a[60:63], v[76:79], v[136:139], a[60:63]
    ds_read_b64_tr_b16 v[128:129], v22 offset:9440
    ds_read_b64_tr_b16 v[130:131], v22 offset:11744
    v_mfma_f32_16x16x32_bf16 a[64:67], v[76:79], v[140:143], a[64:67]
    ds_read_b64_tr_b16 v[132:133], v22 offset:9472
    v_mfma_f32_16x16x32_bf16 a[68:71], v[76:79], v[144:147], a[68:71]
    ds_read_b64_tr_b16 v[134:135], v22 offset:11776
    v_mfma_f32_16x16x32_bf16 a[72:75], v[76:79], v[148:151], a[72:75]
    s_add_u32 s37, s37, 5120
    s_cmp_eq_u32 s37, 152576
    v_mfma_f32_16x16x32_bf16 a[76:79], v[76:79], v[152:155], a[76:79]
    s_cselect_b32 s37, 0x10000, s37
    v_mfma_f32_16x16x32_bf16 a[80:83], v[80:83], v[136:139], a[80:83]
    v_mfma_f32_16x16x32_bf16 a[84:87], v[80:83], v[140:143], a[84:87]
    v_mfma_f32_16x16x32_bf16 a[88:91], v[80:83], v[144:147], a[88:91]
    v_mfma_f32_16x16x32_bf16 a[92:95], v[80:83], v[148:151], a[92:95]
    v_mfma_f32_16x16x32_bf16 a[96:99], v[80:83], v[152:155], a[96:99]
    s_waitcnt lgkmcnt(0)
    s_add_u32 m0, s35, 9216
    v_mfma_f32_16x16x32_bf16 a[100:103], v[84:87], v[136:139], a[100:103]
    buffer_load_dwordx4 v8, s[16:19], s36 offen offset:0 sc1 lds
    v_mfma_f32_16x16x32_bf16 a[104:107], v[84:87], v[140:143], a[104:107]
    v_mfma_f32_16x16x32_bf16 a[108:111], v[84:87], v[144:147], a[108:111]
    buffer_load_dwordx4 v9, s[16:19], s36 offen offset:1024 sc1 lds
    v_mfma_f32_16x16x32_bf16 a[112:115], v[84:87], v[148:151], a[112:115]
    v_mfma_f32_16x16x32_bf16 a[116:119], v[84:87], v[152:155], a[116:119]
    buffer_load_dwordx4 v10, s[16:19], s36 offen offset:2048 sc1 lds
    v_mfma_f32_16x16x32_bf16 a[120:123], v[88:91], v[136:139], a[120:123]
    v_mfma_f32_16x16x32_bf16 a[124:127], v[88:91], v[140:143], a[124:127]
    buffer_load_dwordx4 v11, s[16:19], s36 offen offset:3072 sc1 lds
    v_mfma_f32_16x16x32_bf16 a[128:131], v[88:91], v[144:147], a[128:131]
    s_add_u32 m0, s35, 13312
    v_mfma_f32_16x16x32_bf16 a[132:135], v[88:91], v[148:151], a[132:135]
    buffer_load_dwordx4 v12, s[16:19], s36 offen offset:0 sc1 lds
    v_mfma_f32_16x16x32_bf16 a[136:139], v[88:91], v[152:155], a[136:139]
    v_mfma_f32_16x16x32_bf16 a[140:143], v[92:95], v[136:139], a[140:143]
    buffer_load_dwordx4 v13, s[16:19], s36 offen offset:1024 sc1 lds
    v_mfma_f32_16x16x32_bf16 a[144:147], v[92:95], v[140:143], a[144:147]
    v_mfma_f32_16x16x32_bf16 a[148:151], v[92:95], v[144:147], a[148:151]
    buffer_load_dwordx4 v14, s[16:19], s36 offen offset:2048 sc1 lds
    v_mfma_f32_16x16x32_bf16 a[152:155], v[92:95], v[148:151], a[152:155]
    v_mfma_f32_16x16x32_bf16 a[156:159], v[92:95], v[152:155], a[156:159]
    buffer_load_dwordx4 v15, s[16:19], s36 offen offset:3072 sc1 lds
    v_mfma_f32_16x16x32_bf16 a[160:163], v[96:99], v[136:139], a[160:163]
    s_add_u32 m0, s35, 17408
    v_mfma_f32_16x16x32_bf16 a[164:167], v[96:99], v[140:143], a[164:167]
    buffer_load_dwordx4 v16, s[16:19], s36 offen offset:0 sc1 lds
    v_mfma_f32_16x16x32_bf16 a[168:171], v[96:99], v[144:147], a[168:171]
    v_mfma_f32_16x16x32_bf16 a[172:175], v[96:99], v[148:151], a[172:175]
    s_add_u32 s36, s36, 36864
    s_cmp_eq_u32 s36, 626688
    s_cselect_b32 s36, 0, s36
    v_mfma_f32_16x16x32_bf16 a[176:179], v[96:99], v[152:155], a[176:179]
    s_waitcnt vmcnt(9)
    v_mfma_f32_16x16x32_bf16 a[0:3], v[100:103], v[156:159], a[0:3]
    v_add_u32 v24, s37, v44
    ds_read_b64_tr_b16 v[64:65], v22 offset:0
    v_mfma_f32_16x16x32_bf16 a[4:7], v[100:103], v[160:163], a[4:7]
    ds_read_b64_tr_b16 v[66:67], v22 offset:2304
    v_mfma_f32_16x16x32_bf16 a[8:11], v[100:103], v[164:167], a[8:11]
    ds_read_b128 v[136:139], v24 offset:11264
    v_mfma_f32_16x16x32_bf16 a[12:15], v[100:103], v[168:171], a[12:15]
    ds_read_b128 v[140:143], v24 offset:12288
    ds_read_b128 v[144:147], v24 offset:13312
    v_mfma_f32_16x16x32_bf16 a[16:19], v[100:103], v[172:175], a[16:19]
    ds_read_b128 v[148:151], v24 offset:14336
    v_mfma_f32_16x16x32_bf16 a[20:23], v[104:107], v[156:159], a[20:23]
    ds_read_b128 v[152:155], v24 offset:15360
    v_mfma_f32_16x16x32_bf16 a[24:27], v[104:107], v[160:163], a[24:27]
    ds_read_b64_tr_b16 v[68:69], v22 offset:32
    ds_read_b64_tr_b16 v[70:71], v22 offset:2336
    v_mfma_f32_16x16x32_bf16 a[28:31], v[104:107], v[164:167], a[28:31]
    ds_read_b64_tr_b16 v[72:73], v22 offset:64
    v_mfma_f32_16x16x32_bf16 a[32:35], v[104:107], v[168:171], a[32:35]
    ds_read_b64_tr_b16 v[74:75], v22 offset:2368
    v_mfma_f32_16x16x32_bf16 a[36:39], v[104:107], v[172:175], a[36:39]
    ds_read_b64_tr_b16 v[76:77], v22 offset:96
    ds_read_b64_tr_b16 v[78:79], v22 offset:2400
    v_mfma_f32_16x16x32_bf16 a[40:43], v[108:111], v[156:159], a[40:43]
    ds_read_b64_tr_b16 v[80:81], v22 offset:128
    v_mfma_f32_16x16x32_bf16 a[44:47], v[108:111], v[160:163], a[44:47]
    ds_read_b64_tr_b16 v[82:83], v22 offset:2432
    v_mfma_f32_16x16x32_bf16 a[48:51], v[108:111], v[164:167], a[48:51]
    ds_read_b64_tr_b16 v[84:85], v22 offset:160
    ds_read_b64_tr_b16 v[86:87], v22 offset:2464
    v_mfma_f32_16x16x32_bf16 a[52:55], v[108:111], v[168:171], a[52:55]
    ds_read_b64_tr_b16 v[88:89], v22 offset:192
    v_mfma_f32_16x16x32_bf16 a[56:59], v[108:111], v[172:175], a[56:59]
    ds_read_b64_tr_b16 v[90:91], v22 offset:2496
    v_mfma_f32_16x16x32_bf16 a[60:63], v[112:115], v[156:159], a[60:63]
    ds_read_b64_tr_b16 v[92:93], v22 offset:224
    ds_read_b64_tr_b16 v[94:95], v22 offset:2528
    v_mfma_f32_16x16x32_bf16 a[64:67], v[112:115], v[160:163], a[64:67]
    ds_read_b64_tr_b16 v[96:97], v22 offset:256
    v_mfma_f32_16x16x32_bf16 a[68:71], v[112:115], v[164:167], a[68:71]
    ds_read_b64_tr_b16 v[98:99], v22 offset:2560
    v_mfma_f32_16x16x32_bf16 a[72:75], v[112:115], v[168:171], a[72:75]
    s_add_u32 s37, s37, 5120
    s_cmp_eq_u32 s37, 152576
    v_mfma_f32_16x16x32_bf16 a[76:79], v[112:115], v[172:175], a[76:79]
    s_cselect_b32 s37, 0x10000, s37
    v_mfma_f32_16x16x32_bf16 a[80:83], v[116:119], v[156:159], a[80:83]
    v_mfma_f32_16x16x32_bf16 a[84:87], v[116:119], v[160:163], a[84:87]
    v_mfma_f32_16x16x32_bf16 a[88:91], v[116:119], v[164:167], a[88:91]
    v_mfma_f32_16x16x32_bf16 a[92:95], v[116:119], v[168:171], a[92:95]
    v_mfma_f32_16x16x32_bf16 a[96:99], v[116:119], v[172:175], a[96:99]
    s_waitcnt lgkmcnt(0)
    s_add_u32 m0, s35, 0
    v_mfma_f32_16x16x32_bf16 a[100:103], v[120:123], v[156:159], a[100:103]
    buffer_load_dwordx4 v8, s[16:19], s36 offen offset:0 sc1 lds
    v_mfma_f32_16x16x32_bf16 a[104:107], v[120:123], v[160:163], a[104:107]
    v_mfma_f32_16x16x32_bf16 a[108:111], v[120:123], v[164:167], a[108:111]
    buffer_load_dwordx4 v9, s[16:19], s36 offen offset:1024 sc1 lds
    v_mfma_f32_16x16x32_bf16 a[112:115], v[120:123], v[168:171], a[112:115]
    v_mfma_f32_16x16x32_bf16 a[116:119], v[120:123], v[172:175], a[116:119]
    buffer_load_dwordx4 v10, s[16:19], s36 offen offset:2048 sc1 lds
    v_mfma_f32_16x16x32_bf16 a[120:123], v[124:127], v[156:159], a[120:123]
    v_mfma_f32_16x16x32_bf16 a[124:127], v[124:127], v[160:163], a[124:127]
    buffer_load_dwordx4 v11, s[16:19], s36 offen offset:3072 sc1 lds
    v_mfma_f32_16x16x32_bf16 a[128:131], v[124:127], v[164:167], a[128:131]
    s_add_u32 m0, s35, 4096
    v_mfma_f32_16x16x32_bf16 a[132:135], v[124:127], v[168:171], a[132:135]
    buffer_load_dwordx4 v12, s[16:19], s36 offen offset:0 sc1 lds
    v_mfma_f32_16x16x32_bf16 a[136:139], v[124:127], v[172:175], a[136:139]
    v_mfma_f32_16x16x32_bf16 a[140:143], v[128:131], v[156:159], a[140:143]
    buffer_load_dwordx4 v13, s[16:19], s36 offen offset:1024 sc1 lds
    v_mfma_f32_16x16x32_bf16 a[144:147], v[128:131], v[160:163], a[144:147]
    v_mfma_f32_16x16x32_bf16 a[148:151], v[128:131], v[164:167], a[148:151]
    buffer_load_dwordx4 v14, s[16:19], s36 offen offset:2048 sc1 lds
    v_mfma_f32_16x16x32_bf16 a[152:155], v[128:131], v[168:171], a[152:155]
    v_mfma_f32_16x16x32_bf16 a[156:159], v[128:131], v[172:175], a[156:159]
    buffer_load_dwordx4 v15, s[16:19], s36 offen offset:3072 sc1 lds
    v_mfma_f32_16x16x32_bf16 a[160:163], v[132:135], v[156:159], a[160:163]
    s_add_u32 m0, s35, 8192
    v_mfma_f32_16x16x32_bf16 a[164:167], v[132:135], v[160:163], a[164:167]
    buffer_load_dwordx4 v16, s[16:19], s36 offen offset:0 sc1 lds
    v_mfma_f32_16x16x32_bf16 a[168:171], v[132:135], v[164:167], a[168:171]
    v_mfma_f32_16x16x32_bf16 a[172:175], v[132:135], v[168:171], a[172:175]
    s_add_u32 s36, s36, 36864
    s_cmp_eq_u32 s36, 626688
    s_cselect_b32 s36, 0, s36
    v_mfma_f32_16x16x32_bf16 a[176:179], v[132:135], v[172:175], a[176:179]
    s_waitcnt vmcnt(9)
    v_mfma_f32_16x16x32_bf16 a[0:3], v[64:67], v[136:139], a[0:3]
    v_add_u32 v24, s37, v44
    ds_read_b64_tr_b16 v[100:101], v22 offset:9216
    v_mfma_f32_16x16x32_bf16 a[4:7], v[64:67], v[140:143], a[4:7]
    ds_read_b64_tr_b16 v[102:103], v22 offset:11520
    v_mfma_f32_16x16x32_bf16 a[8:11], v[64:67], v[144:147], a[8:11]
    ds_read_b128 v[156:159], v24 offset:11264
    v_mfma_f32_16x16x32_bf16 a[12:15], v[64:67], v[148:151], a[12:15]
    ds_read_b128 v[160:163], v24 offset:12288
    ds_read_b128 v[164:167], v24 offset:13312
    v_mfma_f32_16x16x32_bf16 a[16:19], v[64:67], v[152:155], a[16:19]
    ds_read_b128 v[168:171], v24 offset:14336
    v_mfma_f32_16x16x32_bf16 a[20:23], v[68:71], v[136:139], a[20:23]
    ds_read_b128 v[172:175], v24 offset:15360
    v_mfma_f32_16x16x32_bf16 a[24:27], v[68:71], v[140:143], a[24:27]
    ds_read_b64_tr_b16 v[104:105], v22 offset:9248
    ds_read_b64_tr_b16 v[106:107], v22 offset:11552
    v_mfma_f32_16x16x32_bf16 a[28:31], v[68:71], v[144:147], a[28:31]
    ds_read_b64_tr_b16 v[108:109], v22 offset:9280
    v_mfma_f32_16x16x32_bf16 a[32:35], v[68:71], v[148:151], a[32:35]
    ds_read_b64_tr_b16 v[110:111], v22 offset:11584
    v_mfma_f32_16x16x32_bf16 a[36:39], v[68:71], v[152:155], a[36:39]
    ds_read_b64_tr_b16 v[112:113], v22 offset:9312
    ds_read_b64_tr_b16 v[114:115], v22 offset:11616
    v_mfma_f32_16x16x32_bf16 a[40:43], v[72:75], v[136:139], a[40:43]
    ds_read_b64_tr_b16 v[116:117], v22 offset:9344
    v_mfma_f32_16x16x32_bf16 a[44:47], v[72:75], v[140:143], a[44:47]
    ds_read_b64_tr_b16 v[118:119], v22 offset:11648
    v_mfma_f32_16x16x32_bf16 a[48:51], v[72:75], v[144:147], a[48:51]
    ds_read_b64_tr_b16 v[120:121], v22 offset:9376
    ds_read_b64_tr_b16 v[122:123], v22 offset:11680
    v_mfma_f32_16x16x32_bf16 a[52:55], v[72:75], v[148:151], a[52:55]
    ds_read_b64_tr_b16 v[124:125], v22 offset:9408
    v_mfma_f32_16x16x32_bf16 a[56:59], v[72:75], v[152:155], a[56:59]
    ds_read_b64_tr_b16 v[126:127], v22 offset:11712
    v_mfma_f32_16x16x32_bf16 a[60:63], v[76:79], v[136:139], a[60:63]
    ds_read_b64_tr_b16 v[128:129], v22 offset:9440
    ds_read_b64_tr_b16 v[130:131], v22 offset:11744
    v_mfma_f32_16x16x32_bf16 a[64:67], v[76:79], v[140:143], a[64:67]
    ds_read_b64_tr_b16 v[132:133], v22 offset:9472
    v_mfma_f32_16x16x32_bf16 a[68:71], v[76:79], v[144:147], a[68:71]
    ds_read_b64_tr_b16 v[134:135], v22 offset:11776
    v_mfma_f32_16x16x32_bf16 a[72:75], v[76:79], v[148:151], a[72:75]
    s_add_u32 s37, s37, 5120
    s_cmp_eq_u32 s37, 152576
    v_mfma_f32_16x16x32_bf16 a[76:79], v[76:79], v[152:155], a[76:79]
    s_cselect_b32 s37, 0x10000, s37
    v_mfma_f32_16x16x32_bf16 a[80:83], v[80:83], v[136:139], a[80:83]
    v_mfma_f32_16x16x32_bf16 a[84:87], v[80:83], v[140:143], a[84:87]
    v_mfma_f32_16x16x32_bf16 a[88:91], v[80:83], v[144:147], a[88:91]
    v_mfma_f32_16x16x32_bf16 a[92:95], v[80:83], v[148:151], a[92:95]
    v_mfma_f32_16x16x32_bf16 a[96:99], v[80:83], v[152:155], a[96:99]
    s_waitcnt lgkmcnt(0)
    s_add_u32 m0, s35, 9216
    v_mfma_f32_16x16x32_bf16 a[100:103], v[84:87], v[136:139], a[100:103]
    buffer_load_dwordx4 v8, s[16:19], s36 offen offset:0 sc1 lds
    v_mfma_f32_16x16x32_bf16 a[104:107], v[84:87], v[140:143], a[104:107]
    v_mfma_f32_16x16x32_bf16 a[108:111], v[84:87], v[144:147], a[108:111]
    buffer_load_dwordx4 v9, s[16:19], s36 offen offset:1024 sc1 lds
    v_mfma_f32_16x16x32_bf16 a[112:115], v[84:87], v[148:151], a[112:115]
    v_mfma_f32_16x16x32_bf16 a[116:119], v[84:87], v[152:155], a[116:119]
    buffer_load_dwordx4 v10, s[16:19], s36 offen offset:2048 sc1 lds
    v_mfma_f32_16x16x32_bf16 a[120:123], v[88:91], v[136:139], a[120:123]
    v_mfma_f32_16x16x32_bf16 a[124:127], v[88:91], v[140:143], a[124:127]
    buffer_load_dwordx4 v11, s[16:19], s36 offen offset:3072 sc1 lds
    v_mfma_f32_16x16x32_bf16 a[128:131], v[88:91], v[144:147], a[128:131]
    s_add_u32 m0, s35, 13312
    v_mfma_f32_16x16x32_bf16 a[132:135], v[88:91], v[148:151], a[132:135]
    buffer_load_dwordx4 v12, s[16:19], s36 offen offset:0 sc1 lds
    v_mfma_f32_16x16x32_bf16 a[136:139], v[88:91], v[152:155], a[136:139]
    v_mfma_f32_16x16x32_bf16 a[140:143], v[92:95], v[136:139], a[140:143]
    buffer_load_dwordx4 v13, s[16:19], s36 offen offset:1024 sc1 lds
    v_mfma_f32_16x16x32_bf16 a[144:147], v[92:95], v[140:143], a[144:147]
    v_mfma_f32_16x16x32_bf16 a[148:151], v[92:95], v[144:147], a[148:151]
    buffer_load_dwordx4 v14, s[16:19], s36 offen offset:2048 sc1 lds
    v_mfma_f32_16x16x32_bf16 a[152:155], v[92:95], v[148:151], a[152:155]
    v_mfma_f32_16x16x32_bf16 a[156:159], v[92:95], v[152:155], a[156:159]
    buffer_load_dwordx4 v15, s[16:19], s36 offen offset:3072 sc1 lds
    v_mfma_f32_16x16x32_bf16 a[160:163], v[96:99], v[136:139], a[160:163]
    s_add_u32 m0, s35, 17408
    v_mfma_f32_16x16x32_bf16 a[164:167], v[96:99], v[140:143], a[164:167]
    buffer_load_dwordx4 v16, s[16:19], s36 offen offset:0 sc1 lds
    v_mfma_f32_16x16x32_bf16 a[168:171], v[96:99], v[144:147], a[168:171]
    v_mfma_f32_16x16x32_bf16 a[172:175], v[96:99], v[148:151], a[172:175]
    s_add_u32 s36, s36, 36864
    s_cmp_eq_u32 s36, 626688
    s_cselect_b32 s36, 0, s36
    v_mfma_f32_16x16x32_bf16 a[176:179], v[96:99], v[152:155], a[176:179]
    s_waitcnt vmcnt(9)
    v_mfma_f32_16x16x32_bf16 a[0:3], v[100:103], v[156:159], a[0:3]
    v_add_u32 v24, s37, v44
    ds_read_b64_tr_b16 v[64:65], v22 offset:0
    v_mfma_f32_16x16x32_bf16 a[4:7], v[100:103], v[160:163], a[4:7]
    ds_read_b64_tr_b16 v[66:67], v22 offset:2304
    v_mfma_f32_16x16x32_bf16 a[8:11], v[100:103], v[164:167], a[8:11]
    ds_read_b128 v[136:139], v24 offset:11264
    v_mfma_f32_16x16x32_bf16 a[12:15], v[100:103], v[168:171], a[12:15]
    ds_read_b128 v[140:143], v24 offset:12288
    ds_read_b128 v[144:147], v24 offset:13312
    v_mfma_f32_16x16x32_bf16 a[16:19], v[100:103], v[172:175], a[16:19]
    ds_read_b128 v[148:151], v24 offset:14336
    v_mfma_f32_16x16x32_bf16 a[20:23], v[104:107], v[156:159], a[20:23]
    ds_read_b128 v[152:155], v24 offset:15360
    v_mfma_f32_16x16x32_bf16 a[24:27], v[104:107], v[160:163], a[24:27]
    ds_read_b64_tr_b16 v[68:69], v22 offset:32
    ds_read_b64_tr_b16 v[70:71], v22 offset:2336
    v_mfma_f32_16x16x32_bf16 a[28:31], v[104:107], v[164:167], a[28:31]
    ds_read_b64_tr_b16 v[72:73], v22 offset:64
    v_mfma_f32_16x16x32_bf16 a[32:35], v[104:107], v[168:171], a[32:35]
    ds_read_b64_tr_b16 v[74:75], v22 offset:2368
    v_mfma_f32_16x16x32_bf16 a[36:39], v[104:107], v[172:175], a[36:39]
    ds_read_b64_tr_b16 v[76:77], v22 offset:96
    ds_read_b64_tr_b16 v[78:79], v22 offset:2400
    v_mfma_f32_16x16x32_bf16 a[40:43], v[108:111], v[156:159], a[40:43]
    ds_read_b64_tr_b16 v[80:81], v22 offset:128
    v_mfma_f32_16x16x32_bf16 a[44:47], v[108:111], v[160:163], a[44:47]
    ds_read_b64_tr_b16 v[82:83], v22 offset:2432
    v_mfma_f32_16x16x32_bf16 a[48:51], v[108:111], v[164:167], a[48:51]
    ds_read_b64_tr_b16 v[84:85], v22 offset:160
    ds_read_b64_tr_b16 v[86:87], v22 offset:2464
    v_mfma_f32_16x16x32_bf16 a[52:55], v[108:111], v[168:171], a[52:55]
    ds_read_b64_tr_b16 v[88:89], v22 offset:192
    v_mfma_f32_16x16x32_bf16 a[56:59], v[108:111], v[172:175], a[56:59]
    ds_read_b64_tr_b16 v[90:91], v22 offset:2496
    v_mfma_f32_16x16x32_bf16 a[60:63], v[112:115], v[156:159], a[60:63]
    ds_read_b64_tr_b16 v[92:93], v22 offset:224
    ds_read_b64_tr_b16 v[94:95], v22 offset:2528
    v_mfma_f32_16x16x32_bf16 a[64:67], v[112:115], v[160:163], a[64:67]
    ds_read_b64_tr_b16 v[96:97], v22 offset:256
    v_mfma_f32_16x16x32_bf16 a[68:71], v[112:115], v[164:167], a[68:71]
    ds_read_b64_tr_b16 v[98:99], v22 offset:2560
    v_mfma_f32_16x16x32_bf16 a[72:75], v[112:115], v[168:171], a[72:75]
    s_add_u32 s37, s37, 5120
    s_cmp_eq_u32 s37, 152576
    v_mfma_f32_16x16x32_bf16 a[76:79], v[112:115], v[172:175], a[76:79]
    s_cselect_b32 s37, 0x10000, s37
    v_mfma_f32_16x16x32_bf16 a[80:83], v[116:119], v[156:159], a[80:83]
    v_mfma_f32_16x16x32_bf16 a[84:87], v[116:119], v[160:163], a[84:87]
    v_mfma_f32_16x16x32_bf16 a[88:91], v[116:119], v[164:167], a[88:91]
    v_mfma_f32_16x16x32_bf16 a[92:95], v[116:119], v[168:171], a[92:95]
    v_mfma_f32_16x16x32_bf16 a[96:99], v[116:119], v[172:175], a[96:99]
    s_waitcnt lgkmcnt(0)
    s_add_u32 m0, s35, 0
    v_mfma_f32_16x16x32_bf16 a[100:103], v[120:123], v[156:159], a[100:103]
    buffer_load_dwordx4 v8, s[16:19], s36 offen offset:0 sc1 lds
    v_mfma_f32_16x16x32_bf16 a[104:107], v[120:123], v[160:163], a[104:107]
    v_mfma_f32_16x16x32_bf16 a[108:111], v[120:123], v[164:167], a[108:111]
    buffer_load_dwordx4 v9, s[16:19], s36 offen offset:1024 sc1 lds
    v_mfma_f32_16x16x32_bf16 a[112:115], v[120:123], v[168:171], a[112:115]
    v_mfma_f32_16x16x32_bf16 a[116:119], v[120:123], v[172:175], a[116:119]
    buffer_load_dwordx4 v10, s[16:19], s36 offen offset:2048 sc1 lds
    v_mfma_f32_16x16x32_bf16 a[120:123], v[124:127], v[156:159], a[120:123]
    v_mfma_f32_16x16x32_bf16 a[124:127], v[124:127], v[160:163], a[124:127]
    buffer_load_dwordx4 v11, s[16:19], s36 offen offset:3072 sc1 lds
    v_mfma_f32_16x16x32_bf16 a[128:131], v[124:127], v[164:167], a[128:131]
    s_add_u32 m0, s35, 4096
    v_mfma_f32_16x16x32_bf16 a[132:135], v[124:127], v[168:171], a[132:135]
    buffer_load_dwordx4 v12, s[16:19], s36 offen offset:0 sc1 lds
    v_mfma_f32_16x16x32_bf16 a[136:139], v[124:127], v[172:175], a[136:139]
    v_mfma_f32_16x16x32_bf16 a[140:143], v[128:131], v[156:159], a[140:143]
    buffer_load_dwordx4 v13, s[16:19], s36 offen offset:1024 sc1 lds
    v_mfma_f32_16x16x32_bf16 a[144:147], v[128:131], v[160:163], a[144:147]
    v_mfma_f32_16x16x32_bf16 a[148:151], v[128:131], v[164:167], a[148:151]
    buffer_load_dwordx4 v14, s[16:19], s36 offen offset:2048 sc1 lds
    v_mfma_f32_16x16x32_bf16 a[152:155], v[128:131], v[168:171], a[152:155]
    v_mfma_f32_16x16x32_bf16 a[156:159], v[128:131], v[172:175], a[156:159]
    buffer_load_dwordx4 v15, s[16:19], s36 offen offset:3072 sc1 lds
    v_mfma_f32_16x16x32_bf16 a[160:163], v[132:135], v[156:159], a[160:163]
    s_add_u32 m0, s35, 8192
    v_mfma_f32_16x16x32_bf16 a[164:167], v[132:135], v[160:163], a[164:167]
    buffer_load_dwordx4 v16, s[16:19], s36 offen offset:0 sc1 lds
    v_mfma_f32_16x16x32_bf16 a[168:171], v[132:135], v[164:167], a[168:171]
    v_mfma_f32_16x16x32_bf16 a[172:175], v[132:135], v[168:171], a[172:175]
    s_add_u32 s36, s36, 36864
    s_cmp_eq_u32 s36, 626688
    s_cselect_b32 s36, 0, s36
    v_mfma_f32_16x16x32_bf16 a[176:179], v[132:135], v[172:175], a[176:179]
    s_waitcnt vmcnt(9)
    v_mfma_f32_16x16x32_bf16 a[0:3], v[64:67], v[136:139], a[0:3]
    v_add_u32 v24, s37, v44
    ds_read_b64_tr_b16 v[100:101], v22 offset:9216
    v_mfma_f32_16x16x32_bf16 a[4:7], v[64:67], v[140:143], a[4:7]
    ds_read_b64_tr_b16 v[102:103], v22 offset:11520
    v_mfma_f32_16x16x32_bf16 a[8:11], v[64:67], v[144:147], a[8:11]
    ds_read_b128 v[156:159], v24 offset:11264
    v_mfma_f32_16x16x32_bf16 a[12:15], v[64:67], v[148:151], a[12:15]
    ds_read_b128 v[160:163], v24 offset:12288
    ds_read_b128 v[164:167], v24 offset:13312
    v_mfma_f32_16x16x32_bf16 a[16:19], v[64:67], v[152:155], a[16:19]
    ds_read_b128 v[168:171], v24 offset:14336
    v_mfma_f32_16x16x32_bf16 a[20:23], v[68:71], v[136:139], a[20:23]
    ds_read_b128 v[172:175], v24 offset:15360
    v_mfma_f32_16x16x32_bf16 a[24:27], v[68:71], v[140:143], a[24:27]
    ds_read_b64_tr_b16 v[104:105], v22 offset:9248
    ds_read_b64_tr_b16 v[106:107], v22 offset:11552
    v_mfma_f32_16x16x32_bf16 a[28:31], v[68:71], v[144:147], a[28:31]
    ds_read_b64_tr_b16 v[108:109], v22 offset:9280
    v_mfma_f32_16x16x32_bf16 a[32:35], v[68:71], v[148:151], a[32:35]
    ds_read_b64_tr_b16 v[110:111], v22 offset:11584
    v_mfma_f32_16x16x32_bf16 a[36:39], v[68:71], v[152:155], a[36:39]
    ds_read_b64_tr_b16 v[112:113], v22 offset:9312
    ds_read_b64_tr_b16 v[114:115], v22 offset:11616
    v_mfma_f32_16x16x32_bf16 a[40:43], v[72:75], v[136:139], a[40:43]
    ds_read_b64_tr_b16 v[116:117], v22 offset:9344
    v_mfma_f32_16x16x32_bf16 a[44:47], v[72:75], v[140:143], a[44:47]
    ds_read_b64_tr_b16 v[118:119], v22 offset:11648
    v_mfma_f32_16x16x32_bf16 a[48:51], v[72:75], v[144:147], a[48:51]
    ds_read_b64_tr_b16 v[120:121], v22 offset:9376
    ds_read_b64_tr_b16 v[122:123], v22 offset:11680
    v_mfma_f32_16x16x32_bf16 a[52:55], v[72:75], v[148:151], a[52:55]
    ds_read_b64_tr_b16 v[124:125], v22 offset:9408
    v_mfma_f32_16x16x32_bf16 a[56:59], v[72:75], v[152:155], a[56:59]
    ds_read_b64_tr_b16 v[126:127], v22 offset:11712
    v_mfma_f32_16x16x32_bf16 a[60:63], v[76:79], v[136:139], a[60:63]
    ds_read_b64_tr_b16 v[128:129], v22 offset:9440
    ds_read_b64_tr_b16 v[130:131], v22 offset:11744
    v_mfma_f32_16x16x32_bf16 a[64:67], v[76:79], v[140:143], a[64:67]
    ds_read_b64_tr_b16 v[132:133], v22 offset:9472
    v_mfma_f32_16x16x32_bf16 a[68:71], v[76:79], v[144:147], a[68:71]
    ds_read_b64_tr_b16 v[134:135], v22 offset:11776
    v_mfma_f32_16x16x32_bf16 a[72:75], v[76:79], v[148:151], a[72:75]
    s_add_u32 s37, s37, 5120
    s_cmp_eq_u32 s37, 152576
    v_mfma_f32_16x16x32_bf16 a[76:79], v[76:79], v[152:155], a[76:79]
    s_cselect_b32 s37, 0x10000, s37
    v_mfma_f32_16x16x32_bf16 a[80:83], v[80:83], v[136:139], a[80:83]
    v_mfma_f32_16x16x32_bf16 a[84:87], v[80:83], v[140:143], a[84:87]
    v_mfma_f32_16x16x32_bf16 a[88:91], v[80:83], v[144:147], a[88:91]
    v_mfma_f32_16x16x32_bf16 a[92:95], v[80:83], v[148:151], a[92:95]
    v_mfma_f32_16x16x32_bf16 a[96:99], v[80:83], v[152:155], a[96:99]
    s_waitcnt lgkmcnt(0)
    s_add_u32 m0, s35, 9216
    v_mfma_f32_16x16x32_bf16 a[100:103], v[84:87], v[136:139], a[100:103]
    buffer_load_dwordx4 v8, s[16:19], s36 offen offset:0 sc1 lds
    v_mfma_f32_16x16x32_bf16 a[104:107], v[84:87], v[140:143], a[104:107]
    v_mfma_f32_16x16x32_bf16 a[108:111], v[84:87], v[144:147], a[108:111]
    buffer_load_dwordx4 v9, s[16:19], s36 offen offset:1024 sc1 lds
    v_mfma_f32_16x16x32_bf16 a[112:115], v[84:87], v[148:151], a[112:115]
    v_mfma_f32_16x16x32_bf16 a[116:119], v[84:87], v[152:155], a[116:119]
    buffer_load_dwordx4 v10, s[16:19], s36 offen offset:2048 sc1 lds
    v_mfma_f32_16x16x32_bf16 a[120:123], v[88:91], v[136:139], a[120:123]
    v_mfma_f32_16x16x32_bf16 a[124:127], v[88:91], v[140:143], a[124:127]
    buffer_load_dwordx4 v11, s[16:19], s36 offen offset:3072 sc1 lds
    v_mfma_f32_16x16x32_bf16 a[128:131], v[88:91], v[144:147], a[128:131]
    s_add_u32 m0, s35, 13312
    v_mfma_f32_16x16x32_bf16 a[132:135], v[88:91], v[148:151], a[132:135]
    buffer_load_dwordx4 v12, s[16:19], s36 offen offset:0 sc1 lds
    v_mfma_f32_16x16x32_bf16 a[136:139], v[88:91], v[152:155], a[136:139]
    v_mfma_f32_16x16x32_bf16 a[140:143], v[92:95], v[136:139], a[140:143]
    buffer_load_dwordx4 v13, s[16:19], s36 offen offset:1024 sc1 lds
    v_mfma_f32_16x16x32_bf16 a[144:147], v[92:95], v[140:143], a[144:147]
    v_mfma_f32_16x16x32_bf16 a[148:151], v[92:95], v[144:147], a[148:151]
    buffer_load_dwordx4 v14, s[16:19], s36 offen offset:2048 sc1 lds
    v_mfma_f32_16x16x32_bf16 a[152:155], v[92:95], v[148:151], a[152:155]
    v_mfma_f32_16x16x32_bf16 a[156:159], v[92:95], v[152:155], a[156:159]
    buffer_load_dwordx4 v15, s[16:19], s36 offen offset:3072 sc1 lds
    v_mfma_f32_16x16x32_bf16 a[160:163], v[96:99], v[136:139], a[160:163]
    s_add_u32 m0, s35, 17408
    v_mfma_f32_16x16x32_bf16 a[164:167], v[96:99], v[140:143], a[164:167]
    buffer_load_dwordx4 v16, s[16:19], s36 offen offset:0 sc1 lds
    v_mfma_f32_16x16x32_bf16 a[168:171], v[96:99], v[144:147], a[168:171]
    v_mfma_f32_16x16x32_bf16 a[172:175], v[96:99], v[148:151], a[172:175]
    s_add_u32 s36, s36, 36864
    s_cmp_eq_u32 s36, 626688
    s_cselect_b32 s36, 0, s36
    v_mfma_f32_16x16x32_bf16 a[176:179], v[96:99], v[152:155], a[176:179]
    s_waitcnt vmcnt(9)
    v_mfma_f32_16x16x32_bf16 a[0:3], v[100:103], v[156:159], a[0:3]
    v_add_u32 v24, s37, v44
    ds_read_b64_tr_b16 v[64:65], v22 offset:0
    v_mfma_f32_16x16x32_bf16 a[4:7], v[100:103], v[160:163], a[4:7]
    ds_read_b64_tr_b16 v[66:67], v22 offset:2304
    v_mfma_f32_16x16x32_bf16 a[8:11], v[100:103], v[164:167], a[8:11]
    ds_read_b128 v[136:139], v24 offset:11264
    v_mfma_f32_16x16x32_bf16 a[12:15], v[100:103], v[168:171], a[12:15]
    ds_read_b128 v[140:143], v24 offset:12288
    ds_read_b128 v[144:147], v24 offset:13312
    v_mfma_f32_16x16x32_bf16 a[16:19], v[100:103], v[172:175], a[16:19]
    ds_read_b128 v[148:151], v24 offset:14336
    v_mfma_f32_16x16x32_bf16 a[20:23], v[104:107], v[156:159], a[20:23]
    ds_read_b128 v[152:155], v24 offset:15360
    v_mfma_f32_16x16x32_bf16 a[24:27], v[104:107], v[160:163], a[24:27]
    ds_read_b64_tr_b16 v[68:69], v22 offset:32
    ds_read_b64_tr_b16 v[70:71], v22 offset:2336
    v_mfma_f32_16x16x32_bf16 a[28:31], v[104:107], v[164:167], a[28:31]
    ds_read_b64_tr_b16 v[72:73], v22 offset:64
    v_mfma_f32_16x16x32_bf16 a[32:35], v[104:107], v[168:171], a[32:35]
    ds_read_b64_tr_b16 v[74:75], v22 offset:2368
    v_mfma_f32_16x16x32_bf16 a[36:39], v[104:107], v[172:175], a[36:39]
    ds_read_b64_tr_b16 v[76:77], v22 offset:96
    ds_read_b64_tr_b16 v[78:79], v22 offset:2400
    v_mfma_f32_16x16x32_bf16 a[40:43], v[108:111], v[156:159], a[40:43]
    ds_read_b64_tr_b16 v[80:81], v22 offset:128
    v_mfma_f32_16x16x32_bf16 a[44:47], v[108:111], v[160:163], a[44:47]
    ds_read_b64_tr_b16 v[82:83], v22 offset:2432
    v_mfma_f32_16x16x32_bf16 a[48:51], v[108:111], v[164:167], a[48:51]
    ds_read_b64_tr_b16 v[84:85], v22 offset:160
    ds_read_b64_tr_b16 v[86:87], v22 offset:2464
    v_mfma_f32_16x16x32_bf16 a[52:55], v[108:111], v[168:171], a[52:55]
    ds_read_b64_tr_b16 v[88:89], v22 offset:192
    v_mfma_f32_16x16x32_bf16 a[56:59], v[108:111], v[172:175], a[56:59]
    ds_read_b64_tr_b16 v[90:91], v22 offset:2496
    v_mfma_f32_16x16x32_bf16 a[60:63], v[112:115], v[156:159], a[60:63]
    ds_read_b64_tr_b16 v[92:93], v22 offset:224
    ds_read_b64_tr_b16 v[94:95], v22 offset:2528
    v_mfma_f32_16x16x32_bf16 a[64:67], v[112:115], v[160:163], a[64:67]
    ds_read_b64_tr_b16 v[96:97], v22 offset:256
    v_mfma_f32_16x16x32_bf16 a[68:71], v[112:115], v[164:167], a[68:71]
    ds_read_b64_tr_b16 v[98:99], v22 offset:2560
    v_mfma_f32_16x16x32_bf16 a[72:75], v[112:115], v[168:171], a[72:75]
    s_add_u32 s37, s37, 5120
    s_cmp_eq_u32 s37, 152576
    v_mfma_f32_16x16x32_bf16 a[76:79], v[112:115], v[172:175], a[76:79]
    s_cselect_b32 s37, 0x10000, s37
    v_mfma_f32_16x16x32_bf16 a[80:83], v[116:119], v[156:159], a[80:83]
    v_mfma_f32_16x16x32_bf16 a[84:87], v[116:119], v[160:163], a[84:87]
    v_mfma_f32_16x16x32_bf16 a[88:91], v[116:119], v[164:167], a[88:91]
    v_mfma_f32_16x16x32_bf16 a[92:95], v[116:119], v[168:171], a[92:95]
    v_mfma_f32_16x16x32_bf16 a[96:99], v[116:119], v[172:175], a[96:99]
    s_waitcnt lgkmcnt(0)
    s_add_u32 m0, s35, 0
    v_mfma_f32_16x16x32_bf16 a[100:103], v[120:123], v[156:159], a[100:103]
    buffer_load_dwordx4 v8, s[16:19], s36 offen offset:0 sc1 lds
    v_mfma_f32_16x16x32_bf16 a[104:107], v[120:123], v[160:163], a[104:107]
    v_mfma_f32_16x16x32_bf16 a[108:111], v[120:123], v[164:167], a[108:111]
    buffer_load_dwordx4 v9, s[16:19], s36 offen offset:1024 sc1 lds
    v_mfma_f32_16x16x32_bf16 a[112:115], v[120:123], v[168:171], a[112:115]
    v_mfma_f32_16x16x32_bf16 a[116:119], v[120:123], v[172:175], a[116:119]
    buffer_load_dwordx4 v10, s[16:19], s36 offen offset:2048 sc1 lds
    v_mfma_f32_16x16x32_bf16 a[120:123], v[124:127], v[156:159], a[120:123]
    v_mfma_f32_16x16x32_bf16 a[124:127], v[124:127], v[160:163], a[124:127]
    buffer_load_dwordx4 v11, s[16:19], s36 offen offset:3072 sc1 lds
    v_mfma_f32_16x16x32_bf16 a[128:131], v[124:127], v[164:167], a[128:131]
    s_add_u32 m0, s35, 4096
    v_mfma_f32_16x16x32_bf16 a[132:135], v[124:127], v[168:171], a[132:135]
    buffer_load_dwordx4 v12, s[16:19], s36 offen offset:0 sc1 lds
    v_mfma_f32_16x16x32_bf16 a[136:139], v[124:127], v[172:175], a[136:139]
    v_mfma_f32_16x16x32_bf16 a[140:143], v[128:131], v[156:159], a[140:143]
    buffer_load_dwordx4 v13, s[16:19], s36 offen offset:1024 sc1 lds
    v_mfma_f32_16x16x32_bf16 a[144:147], v[128:131], v[160:163], a[144:147]
    v_mfma_f32_16x16x32_bf16 a[148:151], v[128:131], v[164:167], a[148:151]
    buffer_load_dwordx4 v14, s[16:19], s36 offen offset:2048 sc1 lds
    v_mfma_f32_16x16x32_bf16 a[152:155], v[128:131], v[168:171], a[152:155]
    v_mfma_f32_16x16x32_bf16 a[156:159], v[128:131], v[172:175], a[156:159]
    buffer_load_dwordx4 v15, s[16:19], s36 offen offset:3072 sc1 lds
    v_mfma_f32_16x16x32_bf16 a[160:163], v[132:135], v[156:159], a[160:163]
    s_add_u32 m0, s35, 8192
    v_mfma_f32_16x16x32_bf16 a[164:167], v[132:135], v[160:163], a[164:167]
    buffer_load_dwordx4 v16, s[16:19], s36 offen offset:0 sc1 lds
    v_mfma_f32_16x16x32_bf16 a[168:171], v[132:135], v[164:167], a[168:171]
    v_mfma_f32_16x16x32_bf16 a[172:175], v[132:135], v[168:171], a[172:175]
    s_add_u32 s36, s36, 36864
    s_cmp_eq_u32 s36, 626688
    s_cselect_b32 s36, 0, s36
    v_mfma_f32_16x16x32_bf16 a[176:179], v[132:135], v[172:175], a[176:179]
    s_waitcnt vmcnt(9)
    v_mfma_f32_16x16x32_bf16 a[0:3], v[64:67], v[136:139], a[0:3]
    v_add_u32 v24, s37, v44
    ds_read_b64_tr_b16 v[100:101], v22 offset:9216
    v_mfma_f32_16x16x32_bf16 a[4:7], v[64:67], v[140:143], a[4:7]
    ds_read_b64_tr_b16 v[102:103], v22 offset:11520
    v_mfma_f32_16x16x32_bf16 a[8:11], v[64:67], v[144:147], a[8:11]
    ds_read_b128 v[156:159], v24 offset:11264
    v_mfma_f32_16x16x32_bf16 a[12:15], v[64:67], v[148:151], a[12:15]
    ds_read_b128 v[160:163], v24 offset:12288
    ds_read_b128 v[164:167], v24 offset:13312
    v_mfma_f32_16x16x32_bf16 a[16:19], v[64:67], v[152:155], a[16:19]
    ds_read_b128 v[168:171], v24 offset:14336
    v_mfma_f32_16x16x32_bf16 a[20:23], v[68:71], v[136:139], a[20:23]
    ds_read_b128 v[172:175], v24 offset:15360
    v_mfma_f32_16x16x32_bf16 a[24:27], v[68:71], v[140:143], a[24:27]
    ds_read_b64_tr_b16 v[104:105], v22 offset:9248
    ds_read_b64_tr_b16 v[106:107], v22 offset:11552
    v_mfma_f32_16x16x32_bf16 a[28:31], v[68:71], v[144:147], a[28:31]
    ds_read_b64_tr_b16 v[108:109], v22 offset:9280
    v_mfma_f32_16x16x32_bf16 a[32:35], v[68:71], v[148:151], a[32:35]
    ds_read_b64_tr_b16 v[110:111], v22 offset:11584
    v_mfma_f32_16x16x32_bf16 a[36:39], v[68:71], v[152:155], a[36:39]
    ds_read_b64_tr_b16 v[112:113], v22 offset:9312
    ds_read_b64_tr_b16 v[114:115], v22 offset:11616
    v_mfma_f32_16x16x32_bf16 a[40:43], v[72:75], v[136:139], a[40:43]
    ds_read_b64_tr_b16 v[116:117], v22 offset:9344
    v_mfma_f32_16x16x32_bf16 a[44:47], v[72:75], v[140:143], a[44:47]
    ds_read_b64_tr_b16 v[118:119], v22 offset:11648
    v_mfma_f32_16x16x32_bf16 a[48:51], v[72:75], v[144:147], a[48:51]
    ds_read_b64_tr_b16 v[120:121], v22 offset:9376
    ds_read_b64_tr_b16 v[122:123], v22 offset:11680
    v_mfma_f32_16x16x32_bf16 a[52:55], v[72:75], v[148:151], a[52:55]
    ds_read_b64_tr_b16 v[124:125], v22 offset:9408
    v_mfma_f32_16x16x32_bf16 a[56:59], v[72:75], v[152:155], a[56:59]
    ds_read_b64_tr_b16 v[126:127], v22 offset:11712
    v_mfma_f32_16x16x32_bf16 a[60:63], v[76:79], v[136:139], a[60:63]
    ds_read_b64_tr_b16 v[128:129], v22 offset:9440
    ds_read_b64_tr_b16 v[130:131], v22 offset:11744
    v_mfma_f32_16x16x32_bf16 a[64:67], v[76:79], v[140:143], a[64:67]
    ds_read_b64_tr_b16 v[132:133], v22 offset:9472
    v_mfma_f32_16x16x32_bf16 a[68:71], v[76:79], v[144:147], a[68:71]
    ds_read_b64_tr_b16 v[134:135], v22 offset:11776
    v_mfma_f32_16x16x32_bf16 a[72:75], v[76:79], v[148:151], a[72:75]
    s_add_u32 s37, s37, 5120
    s_cmp_eq_u32 s37, 152576
    v_mfma_f32_16x16x32_bf16 a[76:79], v[76:79], v[152:155], a[76:79]
    s_cselect_b32 s37, 0x10000, s37
    v_mfma_f32_16x16x32_bf16 a[80:83], v[80:83], v[136:139], a[80:83]
    v_mfma_f32_16x16x32_bf16 a[84:87], v[80:83], v[140:143], a[84:87]
    v_mfma_f32_16x16x32_bf16 a[88:91], v[80:83], v[144:147], a[88:91]
    v_mfma_f32_16x16x32_bf16 a[92:95], v[80:83], v[148:151], a[92:95]
    v_mfma_f32_16x16x32_bf16 a[96:99], v[80:83], v[152:155], a[96:99]
    s_waitcnt lgkmcnt(0)
    s_add_u32 m0, s35, 9216
    v_mfma_f32_16x16x32_bf16 a[100:103], v[84:87], v[136:139], a[100:103]
    buffer_load_dwordx4 v8, s[16:19], s36 offen offset:0 sc1 lds
    v_mfma_f32_16x16x32_bf16 a[104:107], v[84:87], v[140:143], a[104:107]
    v_mfma_f32_16x16x32_bf16 a[108:111], v[84:87], v[144:147], a[108:111]
    buffer_load_dwordx4 v9, s[16:19], s36 offen offset:1024 sc1 lds
    v_mfma_f32_16x16x32_bf16 a[112:115], v[84:87], v[148:151], a[112:115]
    v_mfma_f32_16x16x32_bf16 a[116:119], v[84:87], v[152:155], a[116:119]
    buffer_load_dwordx4 v10, s[16:19], s36 offen offset:2048 sc1 lds
    v_mfma_f32_16x16x32_bf16 a[120:123], v[88:91], v[136:139], a[120:123]
    v_mfma_f32_16x16x32_bf16 a[124:127], v[88:91], v[140:143], a[124:127]
    buffer_load_dwordx4 v11, s[16:19], s36 offen offset:3072 sc1 lds
    v_mfma_f32_16x16x32_bf16 a[128:131], v[88:91], v[144:147], a[128:131]
    s_add_u32 m0, s35, 13312
    v_mfma_f32_16x16x32_bf16 a[132:135], v[88:91], v[148:151], a[132:135]
    buffer_load_dwordx4 v12, s[16:19], s36 offen offset:0 sc1 lds
    v_mfma_f32_16x16x32_bf16 a[136:139], v[88:91], v[152:155], a[136:139]
    v_mfma_f32_16x16x32_bf16 a[140:143], v[92:95], v[136:139], a[140:143]
    buffer_load_dwordx4 v13, s[16:19], s36 offen offset:1024 sc1 lds
    v_mfma_f32_16x16x32_bf16 a[144:147], v[92:95], v[140:143], a[144:147]
    v_mfma_f32_16x16x32_bf16 a[148:151], v[92:95], v[144:147], a[148:151]
    buffer_load_dwordx4 v14, s[16:19], s36 offen offset:2048 sc1 lds
    v_mfma_f32_16x16x32_bf16 a[152:155], v[92:95], v[148:151], a[152:155]
    v_mfma_f32_16x16x32_bf16 a[156:159], v[92:95], v[152:155], a[156:159]
    buffer_load_dwordx4 v15, s[16:19], s36 offen offset:3072 sc1 lds
    v_mfma_f32_16x16x32_bf16 a[160:163], v[96:99], v[136:139], a[160:163]
    s_add_u32 m0, s35, 17408
    v_mfma_f32_16x16x32_bf16 a[164:167], v[96:99], v[140:143], a[164:167]
    buffer_load_dwordx4 v16, s[16:19], s36 offen offset:0 sc1 lds
    v_mfma_f32_16x16x32_bf16 a[168:171], v[96:99], v[144:147], a[168:171]
    v_mfma_f32_16x16x32_bf16 a[172:175], v[96:99], v[148:151], a[172:175]
    s_add_u32 s36, s36, 36864
    s_cmp_eq_u32 s36, 626688
    s_cselect_b32 s36, 0, s36
    v_mfma_f32_16x16x32_bf16 a[176:179], v[96:99], v[152:155], a[176:179]
    s_waitcnt vmcnt(9)
    v_mfma_f32_16x16x32_bf16 a[0:3], v[100:103], v[156:159], a[0:3]
    v_add_u32 v24, s37, v44
    ds_read_b64_tr_b16 v[64:65], v22 offset:0
    v_mfma_f32_16x16x32_bf16 a[4:7], v[100:103], v[160:163], a[4:7]
    ds_read_b64_tr_b16 v[66:67], v22 offset:2304
    v_mfma_f32_16x16x32_bf16 a[8:11], v[100:103], v[164:167], a[8:11]
    ds_read_b128 v[136:139], v24 offset:11264
    v_mfma_f32_16x16x32_bf16 a[12:15], v[100:103], v[168:171], a[12:15]
    ds_read_b128 v[140:143], v24 offset:12288
    ds_read_b128 v[144:147], v24 offset:13312
    v_mfma_f32_16x16x32_bf16 a[16:19], v[100:103], v[172:175], a[16:19]
    ds_read_b128 v[148:151], v24 offset:14336
    v_mfma_f32_16x16x32_bf16 a[20:23], v[104:107], v[156:159], a[20:23]
    ds_read_b128 v[152:155], v24 offset:15360
    v_mfma_f32_16x16x32_bf16 a[24:27], v[104:107], v[160:163], a[24:27]
    ds_read_b64_tr_b16 v[68:69], v22 offset:32
    ds_read_b64_tr_b16 v[70:71], v22 offset:2336
    v_mfma_f32_16x16x32_bf16 a[28:31], v[104:107], v[164:167], a[28:31]
    ds_read_b64_tr_b16 v[72:73], v22 offset:64
    v_mfma_f32_16x16x32_bf16 a[32:35], v[104:107], v[168:171], a[32:35]
    ds_read_b64_tr_b16 v[74:75], v22 offset:2368
    v_mfma_f32_16x16x32_bf16 a[36:39], v[104:107], v[172:175], a[36:39]
    ds_read_b64_tr_b16 v[76:77], v22 offset:96
    ds_read_b64_tr_b16 v[78:79], v22 offset:2400
    v_mfma_f32_16x16x32_bf16 a[40:43], v[108:111], v[156:159], a[40:43]
    ds_read_b64_tr_b16 v[80:81], v22 offset:128
    v_mfma_f32_16x16x32_bf16 a[44:47], v[108:111], v[160:163], a[44:47]
    ds_read_b64_tr_b16 v[82:83], v22 offset:2432
    v_mfma_f32_16x16x32_bf16 a[48:51], v[108:111], v[164:167], a[48:51]
    ds_read_b64_tr_b16 v[84:85], v22 offset:160
    ds_read_b64_tr_b16 v[86:87], v22 offset:2464
    v_mfma_f32_16x16x32_bf16 a[52:55], v[108:111], v[168:171], a[52:55]
    ds_read_b64_tr_b16 v[88:89], v22 offset:192
    v_mfma_f32_16x16x32_bf16 a[56:59], v[108:111], v[172:175], a[56:59]
    ds_read_b64_tr_b16 v[90:91], v22 offset:2496
    v_mfma_f32_16x16x32_bf16 a[60:63], v[112:115], v[156:159], a[60:63]
    ds_read_b64_tr_b16 v[92:93], v22 offset:224
    ds_read_b64_tr_b16 v[94:95], v22 offset:2528
    v_mfma_f32_16x16x32_bf16 a[64:67], v[112:115], v[160:163], a[64:67]
    ds_read_b64_tr_b16 v[96:97], v22 offset:256
    v_mfma_f32_16x16x32_bf16 a[68:71], v[112:115], v[164:167], a[68:71]
    ds_read_b64_tr_b16 v[98:99], v22 offset:2560
    v_mfma_f32_16x16x32_bf16 a[72:75], v[112:115], v[168:171], a[72:75]
    s_add_u32 s37, s37, 5120
    s_cmp_eq_u32 s37, 152576
    v_mfma_f32_16x16x32_bf16 a[76:79], v[112:115], v[172:175], a[76:79]
    s_cselect_b32 s37, 0x10000, s37
    v_mfma_f32_16x16x32_bf16 a[80:83], v[116:119], v[156:159], a[80:83]
    v_mfma_f32_16x16x32_bf16 a[84:87], v[116:119], v[160:163], a[84:87]
    v_mfma_f32_16x16x32_bf16 a[88:91], v[116:119], v[164:167], a[88:91]
    v_mfma_f32_16x16x32_bf16 a[92:95], v[116:119], v[168:171], a[92:95]
    v_mfma_f32_16x16x32_bf16 a[96:99], v[116:119], v[172:175], a[96:99]
    s_waitcnt lgkmcnt(0)
    s_add_u32 m0, s35, 0
    v_mfma_f32_16x16x32_bf16 a[100:103], v[120:123], v[156:159], a[100:103]
    buffer_load_dwordx4 v8, s[16:19], s36 offen offset:0 sc1 lds
    v_mfma_f32_16x16x32_bf16 a[104:107], v[120:123], v[160:163], a[104:107]
    v_mfma_f32_16x16x32_bf16 a[108:111], v[120:123], v[164:167], a[108:111]
    buffer_load_dwordx4 v9, s[16:19], s36 offen offset:1024 sc1 lds
    v_mfma_f32_16x16x32_bf16 a[112:115], v[120:123], v[168:171], a[112:115]
    v_mfma_f32_16x16x32_bf16 a[116:119], v[120:123], v[172:175], a[116:119]
    buffer_load_dwordx4 v10, s[16:19], s36 offen offset:2048 sc1 lds
    v_mfma_f32_16x16x32_bf16 a[120:123], v[124:127], v[156:159], a[120:123]
    v_mfma_f32_16x16x32_bf16 a[124:127], v[124:127], v[160:163], a[124:127]
    buffer_load_dwordx4 v11, s[16:19], s36 offen offset:3072 sc1 lds
    v_mfma_f32_16x16x32_bf16 a[128:131], v[124:127], v[164:167], a[128:131]
    s_add_u32 m0, s35, 4096
    v_mfma_f32_16x16x32_bf16 a[132:135], v[124:127], v[168:171], a[132:135]
    buffer_load_dwordx4 v12, s[16:19], s36 offen offset:0 sc1 lds
    v_mfma_f32_16x16x32_bf16 a[136:139], v[124:127], v[172:175], a[136:139]
    v_mfma_f32_16x16x32_bf16 a[140:143], v[128:131], v[156:159], a[140:143]
    buffer_load_dwordx4 v13, s[16:19], s36 offen offset:1024 sc1 lds
    v_mfma_f32_16x16x32_bf16 a[144:147], v[128:131], v[160:163], a[144:147]
    v_mfma_f32_16x16x32_bf16 a[148:151], v[128:131], v[164:167], a[148:151]
    buffer_load_dwordx4 v14, s[16:19], s36 offen offset:2048 sc1 lds
    v_mfma_f32_16x16x32_bf16 a[152:155], v[128:131], v[168:171], a[152:155]
    v_mfma_f32_16x16x32_bf16 a[156:159], v[128:131], v[172:175], a[156:159]
    buffer_load_dwordx4 v15, s[16:19], s36 offen offset:3072 sc1 lds
    v_mfma_f32_16x16x32_bf16 a[160:163], v[132:135], v[156:159], a[160:163]
    s_add_u32 m0, s35, 8192
    v_mfma_f32_16x16x32_bf16 a[164:167], v[132:135], v[160:163], a[164:167]
    buffer_load_dwordx4 v16, s[16:19], s36 offen offset:0 sc1 lds
    v_mfma_f32_16x16x32_bf16 a[168:171], v[132:135], v[164:167], a[168:171]
    v_mfma_f32_16x16x32_bf16 a[172:175], v[132:135], v[168:171], a[172:175]
    s_add_u32 s36, s36, 36864
    s_cmp_eq_u32 s36, 626688
    s_cselect_b32 s36, 0, s36
    v_mfma_f32_16x16x32_bf16 a[176:179], v[132:135], v[172:175], a[176:179]
    s_waitcnt vmcnt(9)
    v_mfma_f32_16x16x32_bf16 a[0:3], v[64:67], v[136:139], a[0:3]
    v_add_u32 v24, s37, v44
    ds_read_b64_tr_b16 v[100:101], v22 offset:9216
    v_mfma_f32_16x16x32_bf16 a[4:7], v[64:67], v[140:143], a[4:7]
    ds_read_b64_tr_b16 v[102:103], v22 offset:11520
    v_mfma_f32_16x16x32_bf16 a[8:11], v[64:67], v[144:147], a[8:11]
    ds_read_b128 v[156:159], v24 offset:11264
    v_mfma_f32_16x16x32_bf16 a[12:15], v[64:67], v[148:151], a[12:15]
    ds_read_b128 v[160:163], v24 offset:12288
    ds_read_b128 v[164:167], v24 offset:13312
    v_mfma_f32_16x16x32_bf16 a[16:19], v[64:67], v[152:155], a[16:19]
    ds_read_b128 v[168:171], v24 offset:14336
    v_mfma_f32_16x16x32_bf16 a[20:23], v[68:71], v[136:139], a[20:23]
    ds_read_b128 v[172:175], v24 offset:15360
    v_mfma_f32_16x16x32_bf16 a[24:27], v[68:71], v[140:143], a[24:27]
    ds_read_b64_tr_b16 v[104:105], v22 offset:9248
    ds_read_b64_tr_b16 v[106:107], v22 offset:11552
    v_mfma_f32_16x16x32_bf16 a[28:31], v[68:71], v[144:147], a[28:31]
    ds_read_b64_tr_b16 v[108:109], v22 offset:9280
    v_mfma_f32_16x16x32_bf16 a[32:35], v[68:71], v[148:151], a[32:35]
    ds_read_b64_tr_b16 v[110:111], v22 offset:11584
    v_mfma_f32_16x16x32_bf16 a[36:39], v[68:71], v[152:155], a[36:39]
    ds_read_b64_tr_b16 v[112:113], v22 offset:9312
    ds_read_b64_tr_b16 v[114:115], v22 offset:11616
    v_mfma_f32_16x16x32_bf16 a[40:43], v[72:75], v[136:139], a[40:43]
    ds_read_b64_tr_b16 v[116:117], v22 offset:9344
    v_mfma_f32_16x16x32_bf16 a[44:47], v[72:75], v[140:143], a[44:47]
    ds_read_b64_tr_b16 v[118:119], v22 offset:11648
    v_mfma_f32_16x16x32_bf16 a[48:51], v[72:75], v[144:147], a[48:51]
    ds_read_b64_tr_b16 v[120:121], v22 offset:9376
    ds_read_b64_tr_b16 v[122:123], v22 offset:11680
    v_mfma_f32_16x16x32_bf16 a[52:55], v[72:75], v[148:151], a[52:55]
    ds_read_b64_tr_b16 v[124:125], v22 offset:9408
    v_mfma_f32_16x16x32_bf16 a[56:59], v[72:75], v[152:155], a[56:59]
    ds_read_b64_tr_b16 v[126:127], v22 offset:11712
    v_mfma_f32_16x16x32_bf16 a[60:63], v[76:79], v[136:139], a[60:63]
    ds_read_b64_tr_b16 v[128:129], v22 offset:9440
    ds_read_b64_tr_b16 v[130:131], v22 offset:11744
    v_mfma_f32_16x16x32_bf16 a[64:67], v[76:79], v[140:143], a[64:67]
    ds_read_b64_tr_b16 v[132:133], v22 offset:9472
    v_mfma_f32_16x16x32_bf16 a[68:71], v[76:79], v[144:147], a[68:71]
    ds_read_b64_tr_b16 v[134:135], v22 offset:11776
    v_mfma_f32_16x16x32_bf16 a[72:75], v[76:79], v[148:151], a[72:75]
    s_add_u32 s37, s37, 5120
    s_cmp_eq_u32 s37, 152576
    v_mfma_f32_16x16x32_bf16 a[76:79], v[76:79], v[152:155], a[76:79]
    s_cselect_b32 s37, 0x10000, s37
    v_mfma_f32_16x16x32_bf16 a[80:83], v[80:83], v[136:139], a[80:83]
    v_mfma_f32_16x16x32_bf16 a[84:87], v[80:83], v[140:143], a[84:87]
    v_mfma_f32_16x16x32_bf16 a[88:91], v[80:83], v[144:147], a[88:91]
    v_mfma_f32_16x16x32_bf16 a[92:95], v[80:83], v[148:151], a[92:95]
    v_mfma_f32_16x16x32_bf16 a[96:99], v[80:83], v[152:155], a[96:99]
    s_waitcnt lgkmcnt(0)
    s_add_u32 m0, s35, 9216
    v_mfma_f32_16x16x32_bf16 a[100:103], v[84:87], v[136:139], a[100:103]
    buffer_load_dwordx4 v8, s[16:19], s36 offen offset:0 sc1 lds
    v_mfma_f32_16x16x32_bf16 a[104:107], v[84:87], v[140:143], a[104:107]
    v_mfma_f32_16x16x32_bf16 a[108:111], v[84:87], v[144:147], a[108:111]
    buffer_load_dwordx4 v9, s[16:19], s36 offen offset:1024 sc1 lds
    v_mfma_f32_16x16x32_bf16 a[112:115], v[84:87], v[148:151], a[112:115]
    v_mfma_f32_16x16x32_bf16 a[116:119], v[84:87], v[152:155], a[116:119]
    buffer_load_dwordx4 v10, s[16:19], s36 offen offset:2048 sc1 lds
    v_mfma_f32_16x16x32_bf16 a[120:123], v[88:91], v[136:139], a[120:123]
    v_mfma_f32_16x16x32_bf16 a[124:127], v[88:91], v[140:143], a[124:127]
    buffer_load_dwordx4 v11, s[16:19], s36 offen offset:3072 sc1 lds
    v_mfma_f32_16x16x32_bf16 a[128:131], v[88:91], v[144:147], a[128:131]
    s_add_u32 m0, s35, 13312
    v_mfma_f32_16x16x32_bf16 a[132:135], v[88:91], v[148:151], a[132:135]
    buffer_load_dwordx4 v12, s[16:19], s36 offen offset:0 sc1 lds
    v_mfma_f32_16x16x32_bf16 a[136:139], v[88:91], v[152:155], a[136:139]
    v_mfma_f32_16x16x32_bf16 a[140:143], v[92:95], v[136:139], a[140:143]
    buffer_load_dwordx4 v13, s[16:19], s36 offen offset:1024 sc1 lds
    v_mfma_f32_16x16x32_bf16 a[144:147], v[92:95], v[140:143], a[144:147]
    v_mfma_f32_16x16x32_bf16 a[148:151], v[92:95], v[144:147], a[148:151]
    buffer_load_dwordx4 v14, s[16:19], s36 offen offset:2048 sc1 lds
    v_mfma_f32_16x16x32_bf16 a[152:155], v[92:95], v[148:151], a[152:155]
    v_mfma_f32_16x16x32_bf16 a[156:159], v[92:95], v[152:155], a[156:159]
    buffer_load_dwordx4 v15, s[16:19], s36 offen offset:3072 sc1 lds
    v_mfma_f32_16x16x32_bf16 a[160:163], v[96:99], v[136:139], a[160:163]
    s_add_u32 m0, s35, 17408
    v_mfma_f32_16x16x32_bf16 a[164:167], v[96:99], v[140:143], a[164:167]
    buffer_load_dwordx4 v16, s[16:19], s36 offen offset:0 sc1 lds
    v_mfma_f32_16x16x32_bf16 a[168:171], v[96:99], v[144:147], a[168:171]
    v_mfma_f32_16x16x32_bf16 a[172:175], v[96:99], v[148:151], a[172:175]
    s_add_u32 s36, s36, 36864
    s_cmp_eq_u32 s36, 626688
    s_cselect_b32 s36, 0, s36
    v_mfma_f32_16x16x32_bf16 a[176:179], v[96:99], v[152:155], a[176:179]
    s_waitcnt vmcnt(9)
    v_mfma_f32_16x16x32_bf16 a[0:3], v[100:103], v[156:159], a[0:3]
    v_add_u32 v24, s37, v44
    ds_read_b64_tr_b16 v[64:65], v22 offset:0
    v_mfma_f32_16x16x32_bf16 a[4:7], v[100:103], v[160:163], a[4:7]
    ds_read_b64_tr_b16 v[66:67], v22 offset:2304
    v_mfma_f32_16x16x32_bf16 a[8:11], v[100:103], v[164:167], a[8:11]
    ds_read_b128 v[136:139], v24 offset:11264
    v_mfma_f32_16x16x32_bf16 a[12:15], v[100:103], v[168:171], a[12:15]
    ds_read_b128 v[140:143], v24 offset:12288
    ds_read_b128 v[144:147], v24 offset:13312
    v_mfma_f32_16x16x32_bf16 a[16:19], v[100:103], v[172:175], a[16:19]
    ds_read_b128 v[148:151], v24 offset:14336
    v_mfma_f32_16x16x32_bf16 a[20:23], v[104:107], v[156:159], a[20:23]
    ds_read_b128 v[152:155], v24 offset:15360
    v_mfma_f32_16x16x32_bf16 a[24:27], v[104:107], v[160:163], a[24:27]
    ds_read_b64_tr_b16 v[68:69], v22 offset:32
    ds_read_b64_tr_b16 v[70:71], v22 offset:2336
    v_mfma_f32_16x16x32_bf16 a[28:31], v[104:107], v[164:167], a[28:31]
    ds_read_b64_tr_b16 v[72:73], v22 offset:64
    v_mfma_f32_16x16x32_bf16 a[32:35], v[104:107], v[168:171], a[32:35]
    ds_read_b64_tr_b16 v[74:75], v22 offset:2368
    v_mfma_f32_16x16x32_bf16 a[36:39], v[104:107], v[172:175], a[36:39]
    ds_read_b64_tr_b16 v[76:77], v22 offset:96
    ds_read_b64_tr_b16 v[78:79], v22 offset:2400
    v_mfma_f32_16x16x32_bf16 a[40:43], v[108:111], v[156:159], a[40:43]
    ds_read_b64_tr_b16 v[80:81], v22 offset:128
    v_mfma_f32_16x16x32_bf16 a[44:47], v[108:111], v[160:163], a[44:47]
    ds_read_b64_tr_b16 v[82:83], v22 offset:2432
    v_mfma_f32_16x16x32_bf16 a[48:51], v[108:111], v[164:167], a[48:51]
    ds_read_b64_tr_b16 v[84:85], v22 offset:160
    ds_read_b64_tr_b16 v[86:87], v22 offset:2464
    v_mfma_f32_16x16x32_bf16 a[52:55], v[108:111], v[168:171], a[52:55]
    ds_read_b64_tr_b16 v[88:89], v22 offset:192
    v_mfma_f32_16x16x32_bf16 a[56:59], v[108:111], v[172:175], a[56:59]
    ds_read_b64_tr_b16 v[90:91], v22 offset:2496
    v_mfma_f32_16x16x32_bf16 a[60:63], v[112:115], v[156:159], a[60:63]
    ds_read_b64_tr_b16 v[92:93], v22 offset:224
    ds_read_b64_tr_b16 v[94:95], v22 offset:2528
    v_mfma_f32_16x16x32_bf16 a[64:67], v[112:115], v[160:163], a[64:67]
    ds_read_b64_tr_b16 v[96:97], v22 offset:256
    v_mfma_f32_16x16x32_bf16 a[68:71], v[112:115], v[164:167], a[68:71]
    ds_read_b64_tr_b16 v[98:99], v22 offset:2560
    v_mfma_f32_16x16x32_bf16 a[72:75], v[112:115], v[168:171], a[72:75]
    s_add_u32 s37, s37, 5120
    s_cmp_eq_u32 s37, 152576
    v_mfma_f32_16x16x32_bf16 a[76:79], v[112:115], v[172:175], a[76:79]
    s_cselect_b32 s37, 0x10000, s37
    v_mfma_f32_16x16x32_bf16 a[80:83], v[116:119], v[156:159], a[80:83]
    v_mfma_f32_16x16x32_bf16 a[84:87], v[116:119], v[160:163], a[84:87]
    v_mfma_f32_16x16x32_bf16 a[88:91], v[116:119], v[164:167], a[88:91]
    v_mfma_f32_16x16x32_bf16 a[92:95], v[116:119], v[168:171], a[92:95]
    v_mfma_f32_16x16x32_bf16 a[96:99], v[116:119], v[172:175], a[96:99]
    s_waitcnt lgkmcnt(0)
    s_add_u32 m0, s35, 0
    v_mfma_f32_16x16x32_bf16 a[100:103], v[120:123], v[156:159], a[100:103]
    buffer_load_dwordx4 v8, s[16:19], s36 offen offset:0 sc1 lds
    v_mfma_f32_16x16x32_bf16 a[104:107], v[120:123], v[160:163], a[104:107]
    v_mfma_f32_16x16x32_bf16 a[108:111], v[120:123], v[164:167], a[108:111]
    buffer_load_dwordx4 v9, s[16:19], s36 offen offset:1024 sc1 lds
    v_mfma_f32_16x16x32_bf16 a[112:115], v[120:123], v[168:171], a[112:115]
    v_mfma_f32_16x16x32_bf16 a[116:119], v[120:123], v[172:175], a[116:119]
    buffer_load_dwordx4 v10, s[16:19], s36 offen offset:2048 sc1 lds
    v_mfma_f32_16x16x32_bf16 a[120:123], v[124:127], v[156:159], a[120:123]
    v_mfma_f32_16x16x32_bf16 a[124:127], v[124:127], v[160:163], a[124:127]
    buffer_load_dwordx4 v11, s[16:19], s36 offen offset:3072 sc1 lds
    v_mfma_f32_16x16x32_bf16 a[128:131], v[124:127], v[164:167], a[128:131]
    s_add_u32 m0, s35, 4096
    v_mfma_f32_16x16x32_bf16 a[132:135], v[124:127], v[168:171], a[132:135]
    buffer_load_dwordx4 v12, s[16:19], s36 offen offset:0 sc1 lds
    v_mfma_f32_16x16x32_bf16 a[136:139], v[124:127], v[172:175], a[136:139]
    v_mfma_f32_16x16x32_bf16 a[140:143], v[128:131], v[156:159], a[140:143]
    buffer_load_dwordx4 v13, s[16:19], s36 offen offset:1024 sc1 lds
    v_mfma_f32_16x16x32_bf16 a[144:147], v[128:131], v[160:163], a[144:147]
    v_mfma_f32_16x16x32_bf16 a[148:151], v[128:131], v[164:167], a[148:151]
    buffer_load_dwordx4 v14, s[16:19], s36 offen offset:2048 sc1 lds
    v_mfma_f32_16x16x32_bf16 a[152:155], v[128:131], v[168:171], a[152:155]
    v_mfma_f32_16x16x32_bf16 a[156:159], v[128:131], v[172:175], a[156:159]
    buffer_load_dwordx4 v15, s[16:19], s36 offen offset:3072 sc1 lds
    v_mfma_f32_16x16x32_bf16 a[160:163], v[132:135], v[156:159], a[160:163]
    s_add_u32 m0, s35, 8192
    v_mfma_f32_16x16x32_bf16 a[164:167], v[132:135], v[160:163], a[164:167]
    buffer_load_dwordx4 v16, s[16:19], s36 offen offset:0 sc1 lds
    v_mfma_f32_16x16x32_bf16 a[168:171], v[132:135], v[164:167], a[168:171]
    v_mfma_f32_16x16x32_bf16 a[172:175], v[132:135], v[168:171], a[172:175]
    s_add_u32 s36, s36, 36864
    s_cmp_eq_u32 s36, 626688
    s_cselect_b32 s36, 0, s36
    v_mfma_f32_16x16x32_bf16 a[176:179], v[132:135], v[172:175], a[176:179]
    s_waitcnt vmcnt(9)
    v_mfma_f32_16x16x32_bf16 a[0:3], v[64:67], v[136:139], a[0:3]
    v_add_u32 v24, s37, v44
    ds_read_b64_tr_b16 v[100:101], v22 offset:9216
    v_mfma_f32_16x16x32_bf16 a[4:7], v[64:67], v[140:143], a[4:7]
    ds_read_b64_tr_b16 v[102:103], v22 offset:11520
    v_mfma_f32_16x16x32_bf16 a[8:11], v[64:67], v[144:147], a[8:11]
    ds_read_b128 v[156:159], v24 offset:11264
    v_mfma_f32_16x16x32_bf16 a[12:15], v[64:67], v[148:151], a[12:15]
    ds_read_b128 v[160:163], v24 offset:12288
    ds_read_b128 v[164:167], v24 offset:13312
    v_mfma_f32_16x16x32_bf16 a[16:19], v[64:67], v[152:155], a[16:19]
    ds_read_b128 v[168:171], v24 offset:14336
    v_mfma_f32_16x16x32_bf16 a[20:23], v[68:71], v[136:139], a[20:23]
    ds_read_b128 v[172:175], v24 offset:15360
    v_mfma_f32_16x16x32_bf16 a[24:27], v[68:71], v[140:143], a[24:27]
    ds_read_b64_tr_b16 v[104:105], v22 offset:9248
    ds_read_b64_tr_b16 v[106:107], v22 offset:11552
    v_mfma_f32_16x16x32_bf16 a[28:31], v[68:71], v[144:147], a[28:31]
    ds_read_b64_tr_b16 v[108:109], v22 offset:9280
    v_mfma_f32_16x16x32_bf16 a[32:35], v[68:71], v[148:151], a[32:35]
    ds_read_b64_tr_b16 v[110:111], v22 offset:11584
    v_mfma_f32_16x16x32_bf16 a[36:39], v[68:71], v[152:155], a[36:39]
    ds_read_b64_tr_b16 v[112:113], v22 offset:9312
    ds_read_b64_tr_b16 v[114:115], v22 offset:11616
    v_mfma_f32_16x16x32_bf16 a[40:43], v[72:75], v[136:139], a[40:43]
    ds_read_b64_tr_b16 v[116:117], v22 offset:9344
    v_mfma_f32_16x16x32_bf16 a[44:47], v[72:75], v[140:143], a[44:47]
    ds_read_b64_tr_b16 v[118:119], v22 offset:11648
    v_mfma_f32_16x16x32_bf16 a[48:51], v[72:75], v[144:147], a[48:51]
    ds_read_b64_tr_b16 v[120:121], v22 offset:9376
    ds_read_b64_tr_b16 v[122:123], v22 offset:11680
    v_mfma_f32_16x16x32_bf16 a[52:55], v[72:75], v[148:151], a[52:55]
    ds_read_b64_tr_b16 v[124:125], v22 offset:9408
    v_mfma_f32_16x16x32_bf16 a[56:59], v[72:75], v[152:155], a[56:59]
    ds_read_b64_tr_b16 v[126:127], v22 offset:11712
    v_mfma_f32_16x16x32_bf16 a[60:63], v[76:79], v[136:139], a[60:63]
    ds_read_b64_tr_b16 v[128:129], v22 offset:9440
    ds_read_b64_tr_b16 v[130:131], v22 offset:11744
    v_mfma_f32_16x16x32_bf16 a[64:67], v[76:79], v[140:143], a[64:67]
    ds_read_b64_tr_b16 v[132:133], v22 offset:9472
    v_mfma_f32_16x16x32_bf16 a[68:71], v[76:79], v[144:147], a[68:71]
    ds_read_b64_tr_b16 v[134:135], v22 offset:11776
    v_mfma_f32_16x16x32_bf16 a[72:75], v[76:79], v[148:151], a[72:75]
    s_add_u32 s37, s37, 5120
    s_cmp_eq_u32 s37, 152576
    v_mfma_f32_16x16x32_bf16 a[76:79], v[76:79], v[152:155], a[76:79]
    s_cselect_b32 s37, 0x10000, s37
    v_mfma_f32_16x16x32_bf16 a[80:83], v[80:83], v[136:139], a[80:83]
    v_mfma_f32_16x16x32_bf16 a[84:87], v[80:83], v[140:143], a[84:87]
    v_mfma_f32_16x16x32_bf16 a[88:91], v[80:83], v[144:147], a[88:91]
    v_mfma_f32_16x16x32_bf16 a[92:95], v[80:83], v[148:151], a[92:95]
    v_mfma_f32_16x16x32_bf16 a[96:99], v[80:83], v[152:155], a[96:99]
    s_waitcnt lgkmcnt(0)
    v_mfma_f32_16x16x32_bf16 a[100:103], v[84:87], v[136:139], a[100:103]
    v_mfma_f32_16x16x32_bf16 a[104:107], v[84:87], v[140:143], a[104:107]
    v_mfma_f32_16x16x32_bf16 a[108:111], v[84:87], v[144:147], a[108:111]
    v_mfma_f32_16x16x32_bf16 a[112:115], v[84:87], v[148:151], a[112:115]
    v_mfma_f32_16x16x32_bf16 a[116:119], v[84:87], v[152:155], a[116:119]
    v_mfma_f32_16x16x32_bf16 a[120:123], v[88:91], v[136:139], a[120:123]
    v_mfma_f32_16x16x32_bf16 a[124:127], v[88:91], v[140:143], a[124:127]
    v_mfma_f32_16x16x32_bf16 a[128:131], v[88:91], v[144:147], a[128:131]
    v_mfma_f32_16x16x32_bf16 a[132:135], v[88:91], v[148:151], a[132:135]
    v_mfma_f32_16x16x32_bf16 a[136:139], v[88:91], v[152:155], a[136:139]
    v_mfma_f32_16x16x32_bf16 a[140:143], v[92:95], v[136:139], a[140:143]
    v_mfma_f32_16x16x32_bf16 a[144:147], v[92:95], v[140:143], a[144:147]
    v_mfma_f32_16x16x32_bf16 a[148:151], v[92:95], v[144:147], a[148:151]
    v_mfma_f32_16x16x32_bf16 a[152:155], v[92:95], v[148:151], a[152:155]
    v_mfma_f32_16x16x32_bf16 a[156:159], v[92:95], v[152:155], a[156:159]
    v_mfma_f32_16x16x32_bf16 a[160:163], v[96:99], v[136:139], a[160:163]
    v_mfma_f32_16x16x32_bf16 a[164:167], v[96:99], v[140:143], a[164:167]
    v_mfma_f32_16x16x32_bf16 a[168:171], v[96:99], v[144:147], a[168:171]
    v_mfma_f32_16x16x32_bf16 a[172:175], v[96:99], v[148:151], a[172:175]
    v_mfma_f32_16x16x32_bf16 a[176:179], v[96:99], v[152:155], a[176:179]
    s_waitcnt vmcnt(0)
    v_mfma_f32_16x16x32_bf16 a[0:3], v[100:103], v[156:159], a[0:3]
    v_add_u32 v24, s37, v44
    ds_read_b64_tr_b16 v[64:65], v22 offset:0
    v_mfma_f32_16x16x32_bf16 a[4:7], v[100:103], v[160:163], a[4:7]
    ds_read_b64_tr_b16 v[66:67], v22 offset:2304
    v_mfma_f32_16x16x32_bf16 a[8:11], v[100:103], v[164:167], a[8:11]
    ds_read_b128 v[136:139], v24 offset:11264
    v_mfma_f32_16x16x32_bf16 a[12:15], v[100:103], v[168:171], a[12:15]
    ds_read_b128 v[140:143], v24 offset:12288
    ds_read_b128 v[144:147], v24 offset:13312
    v_mfma_f32_16x16x32_bf16 a[16:19], v[100:103], v[172:175], a[16:19]
    ds_read_b128 v[148:151], v24 offset:14336
    v_mfma_f32_16x16x32_bf16 a[20:23], v[104:107], v[156:159], a[20:23]
    ds_read_b128 v[152:155], v24 offset:15360
    v_mfma_f32_16x16x32_bf16 a[24:27], v[104:107], v[160:163], a[24:27]
    ds_read_b64_tr_b16 v[68:69], v22 offset:32
    ds_read_b64_tr_b16 v[70:71], v22 offset:2336
    v_mfma_f32_16x16x32_bf16 a[28:31], v[104:107], v[164:167], a[28:31]
    ds_read_b64_tr_b16 v[72:73], v22 offset:64
    v_mfma_f32_16x16x32_bf16 a[32:35], v[104:107], v[168:171], a[32:35]
    ds_read_b64_tr_b16 v[74:75], v22 offset:2368
    v_mfma_f32_16x16x32_bf16 a[36:39], v[104:107], v[172:175], a[36:39]
    ds_read_b64_tr_b16 v[76:77], v22 offset:96
    ds_read_b64_tr_b16 v[78:79], v22 offset:2400
    v_mfma_f32_16x16x32_bf16 a[40:43], v[108:111], v[156:159], a[40:43]
    ds_read_b64_tr_b16 v[80:81], v22 offset:128
    v_mfma_f32_16x16x32_bf16 a[44:47], v[108:111], v[160:163], a[44:47]
    ds_read_b64_tr_b16 v[82:83], v22 offset:2432
    v_mfma_f32_16x16x32_bf16 a[48:51], v[108:111], v[164:167], a[48:51]
    ds_read_b64_tr_b16 v[84:85], v22 offset:160
    ds_read_b64_tr_b16 v[86:87], v22 offset:2464
    v_mfma_f32_16x16x32_bf16 a[52:55], v[108:111], v[168:171], a[52:55]
    ds_read_b64_tr_b16 v[88:89], v22 offset:192
    v_mfma_f32_16x16x32_bf16 a[56:59], v[108:111], v[172:175], a[56:59]
    ds_read_b64_tr_b16 v[90:91], v22 offset:2496
    v_mfma_f32_16x16x32_bf16 a[60:63], v[112:115], v[156:159], a[60:63]
    ds_read_b64_tr_b16 v[92:93], v22 offset:224
    ds_read_b64_tr_b16 v[94:95], v22 offset:2528
    v_mfma_f32_16x16x32_bf16 a[64:67], v[112:115], v[160:163], a[64:67]
    ds_read_b64_tr_b16 v[96:97], v22 offset:256
    v_mfma_f32_16x16x32_bf16 a[68:71], v[112:115], v[164:167], a[68:71]
    ds_read_b64_tr_b16 v[98:99], v22 offset:2560
    v_mfma_f32_16x16x32_bf16 a[72:75], v[112:115], v[168:171], a[72:75]
    s_add_u32 s37, s37, 5120
    s_cmp_eq_u32 s37, 152576
    v_mfma_f32_16x16x32_bf16 a[76:79], v[112:115], v[172:175], a[76:79]
    s_cselect_b32 s37, 0x10000, s37
    v_mfma_f32_16x16x32_bf16 a[80:83], v[116:119], v[156:159], a[80:83]
    s_lshl_b32 s79, s24, 12
    s_add_u32 s79, s79, L_dftb-L_pc0
    v_mfma_f32_16x16x32_bf16 a[84:87], v[116:119], v[160:163], a[84:87]
    buffer_load_dword v37, v36, s[80:83], s79 offen
    v_mfma_f32_16x16x32_bf16 a[88:91], v[116:119], v[164:167], a[88:91]
    v_mfma_f32_16x16x32_bf16 a[92:95], v[116:119], v[168:171], a[92:95]
    v_mfma_f32_16x16x32_bf16 a[96:99], v[116:119], v[172:175], a[96:99]
    s_waitcnt lgkmcnt(0)
    v_mfma_f32_16x16x32_bf16 a[100:103], v[120:123], v[156:159], a[100:103]
    v_mfma_f32_16x16x32_bf16 a[104:107], v[120:123], v[160:163], a[104:107]
    v_mfma_f32_16x16x32_bf16 a[108:111], v[120:123], v[164:167], a[108:111]
    v_mfma_f32_16x16x32_bf16 a[112:115], v[120:123], v[168:171], a[112:115]
    v_mfma_f32_16x16x32_bf16 a[116:119], v[120:123], v[172:175], a[116:119]
    v_mfma_f32_16x16x32_bf16 a[120:123], v[124:127], v[156:159], a[120:123]
    s_lshl_b32 s79, s24, 12
    s_add_u32 s79, s79, L_g4-L_pc0
    v_mfma_f32_16x16x32_bf16 a[124:127], v[124:127], v[160:163], a[124:127]
    buffer_load_dword v38, v36, s[80:83], s79 offen
    v_mfma_f32_16x16x32_bf16 a[128:131], v[124:127], v[164:167], a[128:131]
    v_mfma_f32_16x16x32_bf16 a[132:135], v[124:127], v[168:171], a[132:135]
    v_mfma_f32_16x16x32_bf16 a[136:139], v[124:127], v[172:175], a[136:139]
    v_mfma_f32_16x16x32_bf16 a[140:143], v[128:131], v[156:159], a[140:143]
    v_mfma_f32_16x16x32_bf16 a[144:147], v[128:131], v[160:163], a[144:147]
    v_mfma_f32_16x16x32_bf16 a[148:151], v[128:131], v[164:167], a[148:151]
    v_mfma_f32_16x16x32_bf16 a[152:155], v[128:131], v[168:171], a[152:155]
    v_mfma_f32_16x16x32_bf16 a[156:159], v[128:131], v[172:175], a[156:159]
    v_mfma_f32_16x16x32_bf16 a[160:163], v[132:135], v[156:159], a[160:163]
    v_mfma_f32_16x16x32_bf16 a[164:167], v[132:135], v[160:163], a[164:167]
    v_mfma_f32_16x16x32_bf16 a[168:171], v[132:135], v[164:167], a[168:171]
    v_mfma_f32_16x16x32_bf16 a[172:175], v[132:135], v[168:171], a[172:175]
    v_mfma_f32_16x16x32_bf16 a[176:179], v[132:135], v[172:175], a[176:179]
    v_mfma_f32_16x16x32_bf16 a[0:3], v[64:67], v[136:139], a[0:3]
    v_mfma_f32_16x16x32_bf16 a[4:7], v[64:67], v[140:143], a[4:7]
    v_mfma_f32_16x16x32_bf16 a[8:11], v[64:67], v[144:147], a[8:11]
    v_mfma_f32_16x16x32_bf16 a[12:15], v[64:67], v[148:151], a[12:15]
    v_mfma_f32_16x16x32_bf16 a[16:19], v[64:67], v[152:155], a[16:19]
    v_mfma_f32_16x16x32_bf16 a[20:23], v[68:71], v[136:139], a[20:23]
    v_mfma_f32_16x16x32_bf16 a[24:27], v[68:71], v[140:143], a[24:27]
    v_mfma_f32_16x16x32_bf16 a[28:31], v[68:71], v[144:147], a[28:31]
    v_mfma_f32_16x16x32_bf16 a[32:35], v[68:71], v[148:151], a[32:35]
    v_mfma_f32_16x16x32_bf16 a[36:39], v[68:71], v[152:155], a[36:39]
    v_mfma_f32_16x16x32_bf16 a[40:43], v[72:75], v[136:139], a[40:43]
    v_mfma_f32_16x16x32_bf16 a[44:47], v[72:75], v[140:143], a[44:47]
    v_mfma_f32_16x16x32_bf16 a[48:51], v[72:75], v[144:147], a[48:51]
    v_mfma_f32_16x16x32_bf16 a[52:55], v[72:75], v[148:151], a[52:55]
    v_mfma_f32_16x16x32_bf16 a[56:59], v[72:75], v[152:155], a[56:59]
    v_mfma_f32_16x16x32_bf16 a[60:63], v[76:79], v[136:139], a[60:63]
    v_mfma_f32_16x16x32_bf16 a[64:67], v[76:79], v[140:143], a[64:67]
    v_mfma_f32_16x16x32_bf16 a[68:71], v[76:79], v[144:147], a[68:71]
    v_mfma_f32_16x16x32_bf16 a[72:75], v[76:79], v[148:151], a[72:75]
    v_mfma_f32_16x16x32_bf16 a[76:79], v[76:79], v[152:155], a[76:79]
    v_mfma_f32_16x16x32_bf16 a[80:83], v[80:83], v[136:139], a[80:83]
    v_mfma_f32_16x16x32_bf16 a[84:87], v[80:83], v[140:143], a[84:87]
    v_mfma_f32_16x16x32_bf16 a[88:91], v[80:83], v[144:147], a[88:91]
    v_mfma_f32_16x16x32_bf16 a[92:95], v[80:83], v[148:151], a[92:95]
    v_mfma_f32_16x16x32_bf16 a[96:99], v[80:83], v[152:155], a[96:99]
    v_mfma_f32_16x16x32_bf16 a[100:103], v[84:87], v[136:139], a[100:103]
    v_mfma_f32_16x16x32_bf16 a[104:107], v[84:87], v[140:143], a[104:107]
    v_mfma_f32_16x16x32_bf16 a[108:111], v[84:87], v[144:147], a[108:111]
    v_mfma_f32_16x16x32_bf16 a[112:115], v[84:87], v[148:151], a[112:115]
    v_mfma_f32_16x16x32_bf16 a[116:119], v[84:87], v[152:155], a[116:119]
    v_mfma_f32_16x16x32_bf16 a[120:123], v[88:91], v[136:139], a[120:123]
    v_mfma_f32_16x16x32_bf16 a[124:127], v[88:91], v[140:143], a[124:127]
    v_mfma_f32_16x16x32_bf16 a[128:131], v[88:91], v[144:147], a[128:131]
    v_mfma_f32_16x16x32_bf16 a[132:135], v[88:91], v[148:151], a[132:135]
    v_mfma_f32_16x16x32_bf16 a[136:139], v[88:91], v[152:155], a[136:139]
    v_mfma_f32_16x16x32_bf16 a[140:143], v[92:95], v[136:139], a[140:143]
    v_mfma_f32_16x16x32_bf16 a[144:147], v[92:95], v[140:143], a[144:147]
    v_mfma_f32_16x16x32_bf16 a[148:151], v[92:95], v[144:147], a[148:151]
    v_mfma_f32_16x16x32_bf16 a[152:155], v[92:95], v[148:151], a[152:155]
    v_mfma_f32_16x16x32_bf16 a[156:159], v[92:95], v[152:155], a[156:159]
    v_mfma_f32_16x16x32_bf16 a[160:163], v[96:99], v[136:139], a[160:163]
    v_mfma_f32_16x16x32_bf16 a[164:167], v[96:99], v[140:143], a[164:167]
    v_mfma_f32_16x16x32_bf16 a[168:171], v[96:99], v[144:147], a[168:171]
    v_mfma_f32_16x16x32_bf16 a[172:175], v[96:99], v[148:151], a[172:175]
    v_mfma_f32_16x16x32_bf16 a[176:179], v[96:99], v[152:155], a[176:179]
L_dftb:
    v_lshlrev_b32 v9, 2, v1
    s_mov_b32 s32, 0
L_pmd:
    buffer_load_dword v10, v9, s[48:51], 0 offen offset:1024 sc1
    s_waitcnt vmcnt(0)
    v_cmp_eq_u32 vcc, s62, v10
    s_add_u32 s32, s32, 1
    s_nop 2
    s_lshr_b32 s3, vcc_lo, 28
    s_cmp_eq_u32 s3, 15
    s_cbranch_scc1 L_pmdd
    s_sleep 2
    s_cmp_lt_u32 s32, 0x40000
    s_cbranch_scc1 L_pmd
L_pmdd:
    s_barrier
    buffer_load_dwordx4 v[64:67], v44, s[8:11], s38 offen offset:0 sc1
    buffer_load_dwordx4 v[68:71], v44, s[8:11], s38 offen offset:1024 sc1
    buffer_load_dwordx4 v[72:75], v44, s[8:11], s38 offen offset:2048 sc1
    buffer_load_dwordx4 v[76:79], v44, s[8:11], s38 offen offset:3072 sc1
    buffer_load_dwordx4 v[80:83], v21, s[8:11], s38 offen offset:0 sc1
    buffer_load_dwordx4 v[84:87], v21, s[8:11], s38 offen offset:1024 sc1
    buffer_load_dwordx4 v[88:91], v21, s[8:11], s38 offen offset:2048 sc1
    buffer_load_dwordx4 v[92:95], v21, s[8:11], s38 offen offset:3072 sc1
    buffer_load_dwordx4 v[96:99], v19, s[8:11], s38 offen offset:0 sc1
    buffer_load_dwordx4 v[100:103], v19, s[8:11], s38 offen offset:1024 sc1
    s_add_u32 s38, s38, 10240
    s_cmp_eq_u32 s38, 92160
    s_cselect_b32 s38, 0, s38
    buffer_load_dwordx4 v[104:107], v44, s[8:11], s38 offen offset:0 sc1
    buffer_load_dwordx4 v[108:111], v44, s[8:11], s38 offen offset:1024 sc1
    buffer_load_dwordx4 v[112:115], v44, s[8:11], s38 offen offset:2048 sc1
    buffer_load_dwordx4 v[116:119], v44, s[8:11], s38 offen offset:3072 sc1
    buffer_load_dwordx4 v[120:123], v21, s[8:11], s38 offen offset:0 sc1
    buffer_load_dwordx4 v[124:127], v21, s[8:11], s38 offen offset:1024 sc1
    buffer_load_dwordx4 v[128:131], v21, s[8:11], s38 offen offset:2048 sc1
    buffer_load_dwordx4 v[132:135], v21, s[8:11], s38 offen offset:3072 sc1
    buffer_load_dwordx4 v[136:139], v19, s[8:11], s38 offen offset:0 sc1
    buffer_load_dwordx4 v[140:143], v19, s[8:11], s38 offen offset:1024 sc1
    s_add_u32 s38, s38, 10240
    s_cmp_eq_u32 s38, 92160
    s_cselect_b32 s38, 0, s38
    v_accvgpr_read_b32 v184, a0
    v_accvgpr_read_b32 v185, a1
    v_accvgpr_read_b32 v186, a2
    v_accvgpr_read_b32 v187, a3
    v_cvt_pk_bf16_f32 v188, v184, v185
    v_cvt_pk_bf16_f32 v189, v186, v187
    ds_write_b64 v23, v[188:189] offset:0
    v_accvgpr_read_b32 v192, a4
    v_accvgpr_read_b32 v193, a5
    v_accvgpr_read_b32 v194, a6
    v_accvgpr_read_b32 v195, a7
    v_cvt_pk_bf16_f32 v196, v192, v193
    v_cvt_pk_bf16_f32 v197, v194, v195
    ds_write_b64 v23, v[196:197] offset:9472
    v_accvgpr_read_b32 v200, a8
    v_accvgpr_read_b32 v201, a9
    v_accvgpr_read_b32 v202, a10
    v_accvgpr_read_b32 v203, a11
    v_cvt_pk_bf16_f32 v204, v200, v201
    v_cvt_pk_bf16_f32 v205, v202, v203
    ds_write_b64 v23, v[204:205] offset:18944
    v_accvgpr_read_b32 v208, a12
    v_accvgpr_read_b32 v209, a13
    v_accvgpr_read_b32 v210, a14
    v_accvgpr_read_b32 v211, a15
    v_cvt_pk_bf16_f32 v212, v208, v209
    v_cvt_pk_bf16_f32 v213, v210, v211
    ds_write_b64 v23, v[212:213] offset:28416
    v_accvgpr_read_b32 v184, a16
    v_accvgpr_read_b32 v185, a17
    v_accvgpr_read_b32 v186, a18
    v_accvgpr_read_b32 v187, a19
    v_cvt_pk_bf16_f32 v188, v184, v185
    v_cvt_pk_bf16_f32 v189, v186, v187
    ds_write_b64 v23, v[188:189] offset:37888
    v_accvgpr_read_b32 v192, a20
    v_accvgpr_read_b32 v193, a21
    v_accvgpr_read_b32 v194, a22
    v_accvgpr_read_b32 v195, a23
    v_cvt_pk_bf16_f32 v196, v192, v193
    v_cvt_pk_bf16_f32 v197, v194, v195
    ds_write_b64 v23, v[196:197] offset:32
    v_accvgpr_read_b32 v200, a24
    v_accvgpr_read_b32 v201, a25
    v_accvgpr_read_b32 v202, a26
    v_accvgpr_read_b32 v203, a27
    v_cvt_pk_bf16_f32 v204, v200, v201
    v_cvt_pk_bf16_f32 v205, v202, v203
    ds_write_b64 v23, v[204:205] offset:9504
    v_accvgpr_read_b32 v208, a28
    v_accvgpr_read_b32 v209, a29
    v_accvgpr_read_b32 v210, a30
    v_accvgpr_read_b32 v211, a31
    v_cvt_pk_bf16_f32 v212, v208, v209
    v_cvt_pk_bf16_f32 v213, v210, v211
    ds_write_b64 v23, v[212:213] offset:18976
    v_accvgpr_read_b32 v184, a32
    v_accvgpr_read_b32 v185, a33
    v_accvgpr_read_b32 v186, a34
    v_accvgpr_read_b32 v187, a35
    v_cvt_pk_bf16_f32 v188, v184, v185
    v_cvt_pk_bf16_f32 v189, v186, v187
    ds_write_b64 v23, v[188:189] offset:28448
    v_accvgpr_read_b32 v192, a36
    v_accvgpr_read_b32 v193, a37
    v_accvgpr_read_b32 v194, a38
    v_accvgpr_read_b32 v195, a39
    v_cvt_pk_bf16_f32 v196, v192, v193
    v_cvt_pk_bf16_f32 v197, v194, v195
    ds_write_b64 v23, v[196:197] offset:37920
    v_accvgpr_read_b32 v200, a40
    v_accvgpr_read_b32 v201, a41
    v_accvgpr_read_b32 v202, a42
    v_accvgpr_read_b32 v203, a43
    v_cvt_pk_bf16_f32 v204, v200, v201
    v_cvt_pk_bf16_f32 v205, v202, v203
    ds_write_b64 v23, v[204:205] offset:64
    v_accvgpr_read_b32 v208, a44
    v_accvgpr_read_b32 v209, a45
    v_accvgpr_read_b32 v210, a46
    v_accvgpr_read_b32 v211, a47
    v_cvt_pk_bf16_f32 v212, v208, v209
    v_cvt_pk_bf16_f32 v213, v210, v211
    ds_write_b64 v23, v[212:213] offset:9536
    v_accvgpr_read_b32 v184, a48
    v_accvgpr_read_b32 v185, a49
    v_accvgpr_read_b32 v186, a50
    v_accvgpr_read_b32 v187, a51
    v_cvt_pk_bf16_f32 v188, v184, v185
    v_cvt_pk_bf16_f32 v189, v186, v187
    ds_write_b64 v23, v[188:189] offset:19008
    v_accvgpr_read_b32 v192, a52
    v_accvgpr_read_b32 v193, a53
    v_accvgpr_read_b32 v194, a54
    v_accvgpr_read_b32 v195, a55
    v_cvt_pk_bf16_f32 v196, v192, v193
    v_cvt_pk_bf16_f32 v197, v194, v195
    ds_write_b64 v23, v[196:197] offset:28480
    v_accvgpr_read_b32 v200, a56
    v_accvgpr_read_b32 v201, a57
    v_accvgpr_read_b32 v202, a58
    v_accvgpr_read_b32 v203, a59
    v_cvt_pk_bf16_f32 v204, v200, v201
    v_cvt_pk_bf16_f32 v205, v202, v203
    ds_write_b64 v23, v[204:205] offset:37952
    v_accvgpr_read_b32 v208, a60
    v_accvgpr_read_b32 v209, a61
    v_accvgpr_read_b32 v210, a62
    v_accvgpr_read_b32 v211, a63
    v_cvt_pk_bf16_f32 v212, v208, v209
    v_cvt_pk_bf16_f32 v213, v210, v211
    ds_write_b64 v23, v[212:213] offset:96
    v_accvgpr_read_b32 v184, a64
    v_accvgpr_read_b32 v185, a65
    v_accvgpr_read_b32 v186, a66
    v_accvgpr_read_b32 v187, a67
    v_cvt_pk_bf16_f32 v188, v184, v185
    v_cvt_pk_bf16_f32 v189, v186, v187
    ds_write_b64 v23, v[188:189] offset:9568
    v_accvgpr_read_b32 v192, a68
    v_accvgpr_read_b32 v193, a69
    v_accvgpr_read_b32 v194, a70
    v_accvgpr_read_b32 v195, a71
    v_cvt_pk_bf16_f32 v196, v192, v193
    v_cvt_pk_bf16_f32 v197, v194, v195
    ds_write_b64 v23, v[196:197] offset:19040
    v_accvgpr_read_b32 v200, a72
    v_accvgpr_read_b32 v201, a73
    v_accvgpr_read_b32 v202, a74
    v_accvgpr_read_b32 v203, a75
    v_cvt_pk_bf16_f32 v204, v200, v201
    v_cvt_pk_bf16_f32 v205, v202, v203
    ds_write_b64 v23, v[204:205] offset:28512
    v_accvgpr_read_b32 v208, a76
    v_accvgpr_read_b32 v209, a77
    v_accvgpr_read_b32 v210, a78
    v_accvgpr_read_b32 v211, a79
    v_cvt_pk_bf16_f32 v212, v208, v209
    v_cvt_pk_bf16_f32 v213, v210, v211
    ds_write_b64 v23, v[212:213] offset:37984
    v_accvgpr_read_b32 v184, a80
    v_accvgpr_read_b32 v185, a81
    v_accvgpr_read_b32 v186, a82
    v_accvgpr_read_b32 v187, a83
    v_cvt_pk_bf16_f32 v188, v184, v185
    v_cvt_pk_bf16_f32 v189, v186, v187
    ds_write_b64 v23, v[188:189] offset:128
    v_accvgpr_read_b32 v192, a84
    v_accvgpr_read_b32 v193, a85
    v_accvgpr_read_b32 v194, a86
    v_accvgpr_read_b32 v195, a87
    v_cvt_pk_bf16_f32 v196, v192, v193
    v_cvt_pk_bf16_f32 v197, v194, v195
    ds_write_b64 v23, v[196:197] offset:9600
    v_accvgpr_read_b32 v200, a88
    v_accvgpr_read_b32 v201, a89
    v_accvgpr_read_b32 v202, a90
    v_accvgpr_read_b32 v203, a91
    v_cvt_pk_bf16_f32 v204, v200, v201
    v_cvt_pk_bf16_f32 v205, v202, v203
    ds_write_b64 v23, v[204:205] offset:19072
    v_accvgpr_read_b32 v208, a92
    v_accvgpr_read_b32 v209, a93
    v_accvgpr_read_b32 v210, a94
    v_accvgpr_read_b32 v211, a95
    v_cvt_pk_bf16_f32 v212, v208, v209
    v_cvt_pk_bf16_f32 v213, v210, v211
    ds_write_b64 v23, v[212:213] offset:28544
    v_accvgpr_read_b32 v184, a96
    v_accvgpr_read_b32 v185, a97
    v_accvgpr_read_b32 v186, a98
    v_accvgpr_read_b32 v187, a99
    v_cvt_pk_bf16_f32 v188, v184, v185
    v_cvt_pk_bf16_f32 v189, v186, v187
    ds_write_b64 v23, v[188:189] offset:38016
    v_accvgpr_read_b32 v192, a100
    v_accvgpr_read_b32 v193, a101
    v_accvgpr_read_b32 v194, a102
    v_accvgpr_read_b32 v195, a103
    v_cvt_pk_bf16_f32 v196, v192, v193
    v_cvt_pk_bf16_f32 v197, v194, v195
    ds_write_b64 v23, v[196:197] offset:160
    v_accvgpr_read_b32 v200, a104
    v_accvgpr_read_b32 v201, a105
    v_accvgpr_read_b32 v202, a106
    v_accvgpr_read_b32 v203, a107
    v_cvt_pk_bf16_f32 v204, v200, v201
    v_cvt_pk_bf16_f32 v205, v202, v203
    ds_write_b64 v23, v[204:205] offset:9632
    v_accvgpr_read_b32 v208, a108
    v_accvgpr_read_b32 v209, a109
    v_accvgpr_read_b32 v210, a110
    v_accvgpr_read_b32 v211, a111
    v_cvt_pk_bf16_f32 v212, v208, v209
    v_cvt_pk_bf16_f32 v213, v210, v211
    ds_write_b64 v23, v[212:213] offset:19104
    v_accvgpr_read_b32 v184, a112
    v_accvgpr_read_b32 v185, a113
    v_accvgpr_read_b32 v186, a114
    v_accvgpr_read_b32 v187, a115
    v_cvt_pk_bf16_f32 v188, v184, v185
    v_cvt_pk_bf16_f32 v189, v186, v187
    ds_write_b64 v23, v[188:189] offset:28576
    v_accvgpr_read_b32 v192, a116
    v_accvgpr_read_b32 v193, a117
    v_accvgpr_read_b32 v194, a118
    v_accvgpr_read_b32 v195, a119
    v_cvt_pk_bf16_f32 v196, v192, v193
    v_cvt_pk_bf16_f32 v197, v194, v195
    ds_write_b64 v23, v[196:197] offset:38048
    v_accvgpr_read_b32 v200, a120
    v_accvgpr_read_b32 v201, a121
    v_accvgpr_read_b32 v202, a122
    v_accvgpr_read_b32 v203, a123
    v_cvt_pk_bf16_f32 v204, v200, v201
    v_cvt_pk_bf16_f32 v205, v202, v203
    ds_write_b64 v23, v[204:205] offset:192
    v_accvgpr_read_b32 v208, a124
    v_accvgpr_read_b32 v209, a125
    v_accvgpr_read_b32 v210, a126
    v_accvgpr_read_b32 v211, a127
    v_cvt_pk_bf16_f32 v212, v208, v209
    v_cvt_pk_bf16_f32 v213, v210, v211
    ds_write_b64 v23, v[212:213] offset:9664
    v_accvgpr_read_b32 v184, a128
    v_accvgpr_read_b32 v185, a129
    v_accvgpr_read_b32 v186, a130
    v_accvgpr_read_b32 v187, a131
    v_cvt_pk_bf16_f32 v188, v184, v185
    v_cvt_pk_bf16_f32 v189, v186, v187
    ds_write_b64 v23, v[188:189] offset:19136
    v_accvgpr_read_b32 v192, a132
    v_accvgpr_read_b32 v193, a133
    v_accvgpr_read_b32 v194, a134
    v_accvgpr_read_b32 v195, a135
    v_cvt_pk_bf16_f32 v196, v192, v193
    v_cvt_pk_bf16_f32 v197, v194, v195
    ds_write_b64 v23, v[196:197] offset:28608
    v_accvgpr_read_b32 v200, a136
    v_accvgpr_read_b32 v201, a137
    v_accvgpr_read_b32 v202, a138
    v_accvgpr_read_b32 v203, a139
    v_cvt_pk_bf16_f32 v204, v200, v201
    v_cvt_pk_bf16_f32 v205, v202, v203
    ds_write_b64 v23, v[204:205] offset:38080
    v_accvgpr_read_b32 v208, a140
    v_accvgpr_read_b32 v209, a141
    v_accvgpr_read_b32 v210, a142
    v_accvgpr_read_b32 v211, a143
    v_cvt_pk_bf16_f32 v212, v208, v209
    v_cvt_pk_bf16_f32 v213, v210, v211
    ds_write_b64 v23, v[212:213] offset:224
    v_accvgpr_read_b32 v184, a144
    v_accvgpr_read_b32 v185, a145
    v_accvgpr_read_b32 v186, a146
    v_accvgpr_read_b32 v187, a147
    v_cvt_pk_bf16_f32 v188, v184, v185
    v_cvt_pk_bf16_f32 v189, v186, v187
    ds_write_b64 v23, v[188:189] offset:9696
    v_accvgpr_read_b32 v192, a148
    v_accvgpr_read_b32 v193, a149
    v_accvgpr_read_b32 v194, a150
    v_accvgpr_read_b32 v195, a151
    v_cvt_pk_bf16_f32 v196, v192, v193
    v_cvt_pk_bf16_f32 v197, v194, v195
    ds_write_b64 v23, v[196:197] offset:19168
    v_accvgpr_read_b32 v200, a152
    v_accvgpr_read_b32 v201, a153
    v_accvgpr_read_b32 v202, a154
    v_accvgpr_read_b32 v203, a155
    v_cvt_pk_bf16_f32 v204, v200, v201
    v_cvt_pk_bf16_f32 v205, v202, v203
    ds_write_b64 v23, v[204:205] offset:28640
    v_accvgpr_read_b32 v208, a156
    v_accvgpr_read_b32 v209, a157
    v_accvgpr_read_b32 v210, a158
    v_accvgpr_read_b32 v211, a159
    v_cvt_pk_bf16_f32 v212, v208, v209
    v_cvt_pk_bf16_f32 v213, v210, v211
    ds_write_b64 v23, v[212:213] offset:38112
    v_accvgpr_read_b32 v184, a160
    v_accvgpr_read_b32 v185, a161
    v_accvgpr_read_b32 v186, a162
    v_accvgpr_read_b32 v187, a163
    v_cvt_pk_bf16_f32 v188, v184, v185
    v_cvt_pk_bf16_f32 v189, v186, v187
    ds_write_b64 v23, v[188:189] offset:256
    v_accvgpr_read_b32 v192, a164
    v_accvgpr_read_b32 v193, a165
    v_accvgpr_read_b32 v194, a166
    v_accvgpr_read_b32 v195, a167
    v_cvt_pk_bf16_f32 v196, v192, v193
    v_cvt_pk_bf16_f32 v197, v194, v195
    ds_write_b64 v23, v[196:197] offset:9728
    v_accvgpr_read_b32 v200, a168
    v_accvgpr_read_b32 v201, a169
    v_accvgpr_read_b32 v202, a170
    v_accvgpr_read_b32 v203, a171
    v_cvt_pk_bf16_f32 v204, v200, v201
    v_cvt_pk_bf16_f32 v205, v202, v203
    ds_write_b64 v23, v[204:205] offset:19200
    v_accvgpr_read_b32 v208, a172
    v_accvgpr_read_b32 v209, a173
    v_accvgpr_read_b32 v210, a174
    v_accvgpr_read_b32 v211, a175
    v_cvt_pk_bf16_f32 v212, v208, v209
    v_cvt_pk_bf16_f32 v213, v210, v211
    ds_write_b64 v23, v[212:213] offset:28672
    v_accvgpr_read_b32 v184, a176
    v_accvgpr_read_b32 v185, a177
    v_accvgpr_read_b32 v186, a178
    v_accvgpr_read_b32 v187, a179
    v_cvt_pk_bf16_f32 v188, v184, v185
    v_cvt_pk_bf16_f32 v189, v186, v187
    ds_write_b64 v23, v[188:189] offset:38144
    s_waitcnt lgkmcnt(0)
    s_barrier
    v_add_u32 v24, s39, v26
    v_add_u32 v25, s39, v27
    ds_read_b128 v[184:187], v24 offset:0
    ds_read_b128 v[188:191], v24 offset:9472
    ds_read_b128 v[192:195], v24 offset:18944
    ds_read_b128 v[196:199], v24 offset:28416
    ds_read_b128 v[200:203], v24 offset:37888
    ds_read_b128 v[204:207], v25 offset:0
    ds_read_b128 v[208:211], v25 offset:9472
    ds_read_b128 v[212:215], v25 offset:18944
    ds_read_b128 v[216:219], v25 offset:28416
    ds_read_b128 v[220:223], v25 offset:37888
    s_add_u32 s39, s39, 64
    s_cmp_eq_u32 s39, 576
    s_cselect_b32 s39, 0, s39
    s_waitcnt lgkmcnt(0) vmcnt(10)
    v_mfma_f32_16x16x32_bf16 a[0:3], v[64:67], v[184:187], 0
    v_add_u32 v24, s39, v26
    v_mfma_f32_16x16x32_bf16 a[4:7], v[64:67], v[188:191], 0
    v_add_u32 v25, s39, v27
    buffer_load_dwordx4 v[144:147], v44, s[8:11], s38 offen offset:0 sc1
    v_mfma_f32_16x16x32_bf16 a[8:11], v[64:67], v[192:195], 0
    ds_read_b128 v[224:227], v24 offset:0
    v_mfma_f32_16x16x32_bf16 a[12:15], v[64:67], v[196:199], 0
    ds_read_b128 v[228:231], v24 offset:9472
    v_mfma_f32_16x16x32_bf16 a[16:19], v[64:67], v[200:203], 0
    ds_read_b128 v[232:235], v24 offset:18944
    buffer_load_dwordx4 v[148:151], v44, s[8:11], s38 offen offset:1024 sc1
    v_mfma_f32_16x16x32_bf16 a[20:23], v[68:71], v[204:207], 0
    ds_read_b128 v[236:239], v24 offset:28416
    v_mfma_f32_16x16x32_bf16 a[24:27], v[68:71], v[208:211], 0
    ds_read_b128 v[240:243], v24 offset:37888
    v_mfma_f32_16x16x32_bf16 a[28:31], v[68:71], v[212:215], 0
    ds_read_b128 v[244:247], v25 offset:0
    buffer_load_dwordx4 v[152:155], v44, s[8:11], s38 offen offset:2048 sc1
    v_mfma_f32_16x16x32_bf16 a[32:35], v[68:71], v[216:219], 0
    ds_read_b128 v[248:251], v25 offset:9472
    v_mfma_f32_16x16x32_bf16 a[36:39], v[68:71], v[220:223], 0
    ds_read_b128 v[252:255], v25 offset:18944
    v_mfma_f32_16x16x32_bf16 a[40:43], v[72:75], v[184:187], 0
    ds_read_b128 v[32:35], v25 offset:28416
    buffer_load_dwordx4 v[156:159], v44, s[8:11], s38 offen offset:3072 sc1
    v_mfma_f32_16x16x32_bf16 a[44:47], v[72:75], v[188:191], 0
    ds_read_b128 v[36:39], v25 offset:37888
    v_mfma_f32_16x16x32_bf16 a[48:51], v[72:75], v[192:195], 0
    s_add_u32 s39, s39, 64
    v_mfma_f32_16x16x32_bf16 a[52:55], v[72:75], v[196:199], 0
    s_cmp_eq_u32 s39, 576
    buffer_load_dwordx4 v[160:163], v21, s[8:11], s38 offen offset:0 sc1
    v_mfma_f32_16x16x32_bf16 a[56:59], v[72:75], v[200:203], 0
    s_cselect_b32 s39, 0, s39
    v_mfma_f32_16x16x32_bf16 a[60:63], v[76:79], v[204:207], 0
    v_mfma_f32_16x16x32_bf16 a[64:67], v[76:79], v[208:211], 0
    buffer_load_dwordx4 v[164:167], v21, s[8:11], s38 offen offset:1024 sc1
    v_mfma_f32_16x16x32_bf16 a[68:71], v[76:79], v[212:215], 0
    v_mfma_f32_16x16x32_bf16 a[72:75], v[76:79], v[216:219], 0
    v_mfma_f32_16x16x32_bf16 a[76:79], v[76:79], v[220:223], 0
    buffer_load_dwordx4 v[168:171], v21, s[8:11], s38 offen offset:2048 sc1
    v_mfma_f32_16x16x32_bf16 a[80:83], v[80:83], v[184:187], 0
    v_mfma_f32_16x16x32_bf16 a[84:87], v[80:83], v[188:191], 0
    v_mfma_f32_16x16x32_bf16 a[88:91], v[80:83], v[192:195], 0
    buffer_load_dwordx4 v[172:175], v21, s[8:11], s38 offen offset:3072 sc1
    v_mfma_f32_16x16x32_bf16 a[92:95], v[80:83], v[196:199], 0
    v_mfma_f32_16x16x32_bf16 a[96:99], v[80:83], v[200:203], 0
    v_mfma_f32_16x16x32_bf16 a[100:103], v[84:87], v[204:207], 0
    buffer_load_dwordx4 v[176:179], v19, s[8:11], s38 offen offset:0 sc1
    v_mfma_f32_16x16x32_bf16 a[104:107], v[84:87], v[208:211], 0
    v_mfma_f32_16x16x32_bf16 a[108:111], v[84:87], v[212:215], 0
    v_mfma_f32_16x16x32_bf16 a[112:115], v[84:87], v[216:219], 0
    buffer_load_dwordx4 v[180:183], v19, s[8:11], s38 offen offset:1024 sc1
    v_mfma_f32_16x16x32_bf16 a[116:119], v[84:87], v[220:223], 0
    v_mfma_f32_16x16x32_bf16 a[120:123], v[88:91], v[184:187], 0
    v_mfma_f32_16x16x32_bf16 a[124:127], v[88:91], v[188:191], 0
    s_add_u32 s38, s38, 10240
    v_mfma_f32_16x16x32_bf16 a[128:131], v[88:91], v[192:195], 0
    s_cmp_eq_u32 s38, 92160
    s_cselect_b32 s38, 0, s38
    v_mfma_f32_16x16x32_bf16 a[132:135], v[88:91], v[196:199], 0
    v_mfma_f32_16x16x32_bf16 a[136:139], v[88:91], v[200:203], 0
    v_mfma_f32_16x16x32_bf16 a[140:143], v[92:95], v[204:207], 0
    v_mfma_f32_16x16x32_bf16 a[144:147], v[92:95], v[208:211], 0
    v_mfma_f32_16x16x32_bf16 a[148:151], v[92:95], v[212:215], 0
    v_mfma_f32_16x16x32_bf16 a[152:155], v[92:95], v[216:219], 0
    v_mfma_f32_16x16x32_bf16 a[156:159], v[92:95], v[220:223], 0
    v_mfma_f32_16x16x32_bf16 a[160:163], v[96:99], v[184:187], 0
    v_mfma_f32_16x16x32_bf16 a[164:167], v[96:99], v[188:191], 0
    v_mfma_f32_16x16x32_bf16 a[168:171], v[96:99], v[192:195], 0
    v_mfma_f32_16x16x32_bf16 a[172:175], v[96:99], v[196:199], 0
    v_mfma_f32_16x16x32_bf16 a[176:179], v[96:99], v[200:203], 0
    v_mfma_f32_16x16x32_bf16 a[180:183], v[100:103], v[204:207], 0
    v_mfma_f32_16x16x32_bf16 a[184:187], v[100:103], v[208:211], 0
    v_mfma_f32_16x16x32_bf16 a[188:191], v[100:103], v[212:215], 0
    v_mfma_f32_16x16x32_bf16 a[192:195], v[100:103], v[216:219], 0
    v_mfma_f32_16x16x32_bf16 a[196:199], v[100:103], v[220:223], 0
    s_waitcnt lgkmcnt(0) vmcnt(10)
    v_mfma_f32_16x16x32_bf16 a[0:3], v[104:107], v[224:227], a[0:3]
    v_add_u32 v24, s39, v26
    v_mfma_f32_16x16x32_bf16 a[4:7], v[104:107], v[228:231], a[4:7]
    v_add_u32 v25, s39, v27
    buffer_load_dwordx4 v[64:67], v44, s[8:11], s38 offen offset:0 sc1
    v_mfma_f32_16x16x32_bf16 a[8:11], v[104:107], v[232:235], a[8:11]
    ds_read_b128 v[184:187], v24 offset:0
    v_mfma_f32_16x16x32_bf16 a[12:15], v[104:107], v[236:239], a[12:15]
    ds_read_b128 v[188:191], v24 offset:9472
    v_mfma_f32_16x16x32_bf16 a[16:19], v[104:107], v[240:243], a[16:19]
    ds_read_b128 v[192:195], v24 offset:18944
    buffer_load_dwordx4 v[68:71], v44, s[8:11], s38 offen offset:1024 sc1
    v_mfma_f32_16x16x32_bf16 a[20:23], v[108:111], v[244:247], a[20:23]
    ds_read_b128 v[196:199], v24 offset:28416
    v_mfma_f32_16x16x32_bf16 a[24:27], v[108:111], v[248:251], a[24:27]
    ds_read_b128 v[200:203], v24 offset:37888
    v_mfma_f32_16x16x32_bf16 a[28:31], v[108:111], v[252:255], a[28:31]
    ds_read_b128 v[204:207], v25 offset:0
    buffer_load_dwordx4 v[72:75], v44, s[8:11], s38 offen offset:2048 sc1
    v_mfma_f32_16x16x32_bf16 a[32:35], v[108:111], v[32:35], a[32:35]
    ds_read_b128 v[208:211], v25 offset:9472
    v_mfma_f32_16x16x32_bf16 a[36:39], v[108:111], v[36:39], a[36:39]
    ds_read_b128 v[212:215], v25 offset:18944
    v_mfma_f32_16x16x32_bf16 a[40:43], v[112:115], v[224:227], a[40:43]
    ds_read_b128 v[216:219], v25 offset:28416
    buffer_load_dwordx4 v[76:79], v44, s[8:11], s38 offen offset:3072 sc1
    v_mfma_f32_16x16x32_bf16 a[44:47], v[112:115], v[228:231], a[44:47]
    ds_read_b128 v[220:223], v25 offset:37888
    v_mfma_f32_16x16x32_bf16 a[48:51], v[112:115], v[232:235], a[48:51]
    s_add_u32 s39, s39, 64
    v_mfma_f32_16x16x32_bf16 a[52:55], v[112:115], v[236:239], a[52:55]
    s_cmp_eq_u32 s39, 576
    buffer_load_dwordx4 v[80:83], v21, s[8:11], s38 offen offset:0 sc1
    v_mfma_f32_16x16x32_bf16 a[56:59], v[112:115], v[240:243], a[56:59]
    s_cselect_b32 s39, 0, s39
    v_mfma_f32_16x16x32_bf16 a[60:63], v[116:119], v[244:247], a[60:63]
    v_mfma_f32_16x16x32_bf16 a[64:67], v[116:119], v[248:251], a[64:67]
    buffer_load_dwordx4 v[84:87], v21, s[8:11], s38 offen offset:1024 sc1
    v_mfma_f32_16x16x32_bf16 a[68:71], v[116:119], v[252:255], a[68:71]
    v_mfma_f32_16x16x32_bf16 a[72:75], v[116:119], v[32:35], a[72:75]
    v_mfma_f32_16x16x32_bf16 a[76:79], v[116:119], v[36:39], a[76:79]
    buffer_load_dwordx4 v[88:91], v21, s[8:11], s38 offen offset:2048 sc1
    v_mfma_f32_16x16x32_bf16 a[80:83], v[120:123], v[224:227], a[80:83]
    v_mfma_f32_16x16x32_bf16 a[84:87], v[120:123], v[228:231], a[84:87]
    v_mfma_f32_16x16x32_bf16 a[88:91], v[120:123], v[232:235], a[88:91]
    buffer_load_dwordx4 v[92:95], v21, s[8:11], s38 offen offset:3072 sc1
    v_mfma_f32_16x16x32_bf16 a[92:95], v[120:123], v[236:239], a[92:95]
    v_mfma_f32_16x16x32_bf16 a[96:99], v[120:123], v[240:243], a[96:99]
    v_mfma_f32_16x16x32_bf16 a[100:103], v[124:127], v[244:247], a[100:103]
    buffer_load_dwordx4 v[96:99], v19, s[8:11], s38 offen offset:0 sc1
    v_mfma_f32_16x16x32_bf16 a[104:107], v[124:127], v[248:251], a[104:107]
    v_mfma_f32_16x16x32_bf16 a[108:111], v[124:127], v[252:255], a[108:111]
    v_mfma_f32_16x16x32_bf16 a[112:115], v[124:127], v[32:35], a[112:115]
    buffer_load_dwordx4 v[100:103], v19, s[8:11], s38 offen offset:1024 sc1
    v_mfma_f32_16x16x32_bf16 a[116:119], v[124:127], v[36:39], a[116:119]
    v_mfma_f32_16x16x32_bf16 a[120:123], v[128:131], v[224:227], a[120:123]
    v_mfma_f32_16x16x32_bf16 a[124:127], v[128:131], v[228:231], a[124:127]
    s_add_u32 s38, s38, 10240
    v_mfma_f32_16x16x32_bf16 a[128:131], v[128:131], v[232:235], a[128:131]
    s_cmp_eq_u32 s38, 92160
    s_cselect_b32 s38, 0, s38
    v_mfma_f32_16x16x32_bf16 a[132:135], v[128:131], v[236:239], a[132:135]
    v_mfma_f32_16x16x32_bf16 a[136:139], v[128:131], v[240:243], a[136:139]
    v_mfma_f32_16x16x32_bf16 a[140:143], v[132:135], v[244:247], a[140:143]
    v_mfma_f32_16x16x32_bf16 a[144:147], v[132:135], v[248:251], a[144:147]
    v_mfma_f32_16x16x32_bf16 a[148:151], v[132:135], v[252:255], a[148:151]
    v_mfma_f32_16x16x32_bf16 a[152:155], v[132:135], v[32:35], a[152:155]
    v_mfma_f32_16x16x32_bf16 a[156:159], v[132:135], v[36:39], a[156:159]
    v_mfma_f32_16x16x32_bf16 a[160:163], v[136:139], v[224:227], a[160:163]
    v_mfma_f32_16x16x32_bf16 a[164:167], v[136:139], v[228:231], a[164:167]
    v_mfma_f32_16x16x32_bf16 a[168:171], v[136:139], v[232:235], a[168:171]
    v_mfma_f32_16x16x32_bf16 a[172:175], v[136:139], v[236:239], a[172:175]
    v_mfma_f32_16x16x32_bf16 a[176:179], v[136:139], v[240:243], a[176:179]
    v_mfma_f32_16x16x32_bf16 a[180:183], v[140:143], v[244:247], a[180:183]
    v_mfma_f32_16x16x32_bf16 a[184:187], v[140:143], v[248:251], a[184:187]
    v_mfma_f32_16x16x32_bf16 a[188:191], v[140:143], v[252:255], a[188:191]
    v_mfma_f32_16x16x32_bf16 a[192:195], v[140:143], v[32:35], a[192:195]
    v_mfma_f32_16x16x32_bf16 a[196:199], v[140:143], v[36:39], a[196:199]
    s_waitcnt lgkmcnt(0) vmcnt(10)
    v_mfma_f32_16x16x32_bf16 a[0:3], v[144:147], v[184:187], a[0:3]
    v_add_u32 v24, s39, v26
    v_mfma_f32_16x16x32_bf16 a[4:7], v[144:147], v[188:191], a[4:7]
    v_add_u32 v25, s39, v27
    buffer_load_dwordx4 v[104:107], v44, s[8:11], s38 offen offset:0 sc1
    v_mfma_f32_16x16x32_bf16 a[8:11], v[144:147], v[192:195], a[8:11]
    ds_read_b128 v[224:227], v24 offset:0
    v_mfma_f32_16x16x32_bf16 a[12:15], v[144:147], v[196:199], a[12:15]
    ds_read_b128 v[228:231], v24 offset:9472
    v_mfma_f32_16x16x32_bf16 a[16:19], v[144:147], v[200:203], a[16:19]
    ds_read_b128 v[232:235], v24 offset:18944
    buffer_load_dwordx4 v[108:111], v44, s[8:11], s38 offen offset:1024 sc1
    v_mfma_f32_16x16x32_bf16 a[20:23], v[148:151], v[204:207], a[20:23]
    ds_read_b128 v[236:239], v24 offset:28416
    v_mfma_f32_16x16x32_bf16 a[24:27], v[148:151], v[208:211], a[24:27]
    ds_read_b128 v[240:243], v24 offset:37888
    v_mfma_f32_16x16x32_bf16 a[28:31], v[148:151], v[212:215], a[28:31]
    ds_read_b128 v[244:247], v25 offset:0
    buffer_load_dwordx4 v[112:115], v44, s[8:11], s38 offen offset:2048 sc1
    v_mfma_f32_16x16x32_bf16 a[32:35], v[148:151], v[216:219], a[32:35]
    ds_read_b128 v[248:251], v25 offset:9472
    v_mfma_f32_16x16x32_bf16 a[36:39], v[148:151], v[220:223], a[36:39]
    ds_read_b128 v[252:255], v25 offset:18944
    v_mfma_f32_16x16x32_bf16 a[40:43], v[152:155], v[184:187], a[40:43]
    ds_read_b128 v[32:35], v25 offset:28416
    buffer_load_dwordx4 v[116:119], v44, s[8:11], s38 offen offset:3072 sc1
    v_mfma_f32_16x16x32_bf16 a[44:47], v[152:155], v[188:191], a[44:47]
    ds_read_b128 v[36:39], v25 offset:37888
    v_mfma_f32_16x16x32_bf16 a[48:51], v[152:155], v[192:195], a[48:51]
    s_add_u32 s39, s39, 64
    v_mfma_f32_16x16x32_bf16 a[52:55], v[152:155], v[196:199], a[52:55]
    s_cmp_eq_u32 s39, 576
    buffer_load_dwordx4 v[120:123], v21, s[8:11], s38 offen offset:0 sc1
    v_mfma_f32_16x16x32_bf16 a[56:59], v[152:155], v[200:203], a[56:59]
    s_cselect_b32 s39, 0, s39
    v_mfma_f32_16x16x32_bf16 a[60:63], v[156:159], v[204:207], a[60:63]
    v_mfma_f32_16x16x32_bf16 a[64:67], v[156:159], v[208:211], a[64:67]
    buffer_load_dwordx4 v[124:127], v21, s[8:11], s38 offen offset:1024 sc1
    v_mfma_f32_16x16x32_bf16 a[68:71], v[156:159], v[212:215], a[68:71]
    v_mfma_f32_16x16x32_bf16 a[72:75], v[156:159], v[216:219], a[72:75]
    v_mfma_f32_16x16x32_bf16 a[76:79], v[156:159], v[220:223], a[76:79]
    buffer_load_dwordx4 v[128:131], v21, s[8:11], s38 offen offset:2048 sc1
    v_mfma_f32_16x16x32_bf16 a[80:83], v[160:163], v[184:187], a[80:83]
    v_mfma_f32_16x16x32_bf16 a[84:87], v[160:163], v[188:191], a[84:87]
    v_mfma_f32_16x16x32_bf16 a[88:91], v[160:163], v[192:195], a[88:91]
    buffer_load_dwordx4 v[132:135], v21, s[8:11], s38 offen offset:3072 sc1
    v_mfma_f32_16x16x32_bf16 a[92:95], v[160:163], v[196:199], a[92:95]
    v_mfma_f32_16x16x32_bf16 a[96:99], v[160:163], v[200:203], a[96:99]
    v_mfma_f32_16x16x32_bf16 a[100:103], v[164:167], v[204:207], a[100:103]
    buffer_load_dwordx4 v[136:139], v19, s[8:11], s38 offen offset:0 sc1
    v_mfma_f32_16x16x32_bf16 a[104:107], v[164:167], v[208:211], a[104:107]
    v_mfma_f32_16x16x32_bf16 a[108:111], v[164:167], v[212:215], a[108:111]
    v_mfma_f32_16x16x32_bf16 a[112:115], v[164:167], v[216:219], a[112:115]
    buffer_load_dwordx4 v[140:143], v19, s[8:11], s38 offen offset:1024 sc1
    v_mfma_f32_16x16x32_bf16 a[116:119], v[164:167], v[220:223], a[116:119]
    v_mfma_f32_16x16x32_bf16 a[120:123], v[168:171], v[184:187], a[120:123]
    v_mfma_f32_16x16x32_bf16 a[124:127], v[168:171], v[188:191], a[124:127]
    s_add_u32 s38, s38, 10240
    v_mfma_f32_16x16x32_bf16 a[128:131], v[168:171], v[192:195], a[128:131]
    s_cmp_eq_u32 s38, 92160
    s_cselect_b32 s38, 0, s38
    v_mfma_f32_16x16x32_bf16 a[132:135], v[168:171], v[196:199], a[132:135]
    v_mfma_f32_16x16x32_bf16 a[136:139], v[168:171], v[200:203], a[136:139]
    v_mfma_f32_16x16x32_bf16 a[140:143], v[172:175], v[204:207], a[140:143]
    v_mfma_f32_16x16x32_bf16 a[144:147], v[172:175], v[208:211], a[144:147]
    v_mfma_f32_16x16x32_bf16 a[148:151], v[172:175], v[212:215], a[148:151]
    v_mfma_f32_16x16x32_bf16 a[152:155], v[172:175], v[216:219], a[152:155]
    v_mfma_f32_16x16x32_bf16 a[156:159], v[172:175], v[220:223], a[156:159]
    v_mfma_f32_16x16x32_bf16 a[160:163], v[176:179], v[184:187], a[160:163]
    v_mfma_f32_16x16x32_bf16 a[164:167], v[176:179], v[188:191], a[164:167]
    v_mfma_f32_16x16x32_bf16 a[168:171], v[176:179], v[192:195], a[168:171]
    v_mfma_f32_16x16x32_bf16 a[172:175], v[176:179], v[196:199], a[172:175]
    v_mfma_f32_16x16x32_bf16 a[176:179], v[176:179], v[200:203], a[176:179]
    v_mfma_f32_16x16x32_bf16 a[180:183], v[180:183], v[204:207], a[180:183]
    v_mfma_f32_16x16x32_bf16 a[184:187], v[180:183], v[208:211], a[184:187]
    v_mfma_f32_16x16x32_bf16 a[188:191], v[180:183], v[212:215], a[188:191]
    v_mfma_f32_16x16x32_bf16 a[192:195], v[180:183], v[216:219], a[192:195]
    v_mfma_f32_16x16x32_bf16 a[196:199], v[180:183], v[220:223], a[196:199]
    s_waitcnt lgkmcnt(0) vmcnt(10)
    v_mfma_f32_16x16x32_bf16 a[0:3], v[64:67], v[224:227], a[0:3]
    v_add_u32 v24, s39, v26
    v_mfma_f32_16x16x32_bf16 a[4:7], v[64:67], v[228:231], a[4:7]
    v_add_u32 v25, s39, v27
    buffer_load_dwordx4 v[144:147], v44, s[8:11], s38 offen offset:0 sc1
    v_mfma_f32_16x16x32_bf16 a[8:11], v[64:67], v[232:235], a[8:11]
    ds_read_b128 v[184:187], v24 offset:0
    v_mfma_f32_16x16x32_bf16 a[12:15], v[64:67], v[236:239], a[12:15]
    ds_read_b128 v[188:191], v24 offset:9472
    v_mfma_f32_16x16x32_bf16 a[16:19], v[64:67], v[240:243], a[16:19]
    ds_read_b128 v[192:195], v24 offset:18944
    buffer_load_dwordx4 v[148:151], v44, s[8:11], s38 offen offset:1024 sc1
    v_mfma_f32_16x16x32_bf16 a[20:23], v[68:71], v[244:247], a[20:23]
    ds_read_b128 v[196:199], v24 offset:28416
    v_mfma_f32_16x16x32_bf16 a[24:27], v[68:71], v[248:251], a[24:27]
    ds_read_b128 v[200:203], v24 offset:37888
    v_mfma_f32_16x16x32_bf16 a[28:31], v[68:71], v[252:255], a[28:31]
    ds_read_b128 v[204:207], v25 offset:0
    buffer_load_dwordx4 v[152:155], v44, s[8:11], s38 offen offset:2048 sc1
    v_mfma_f32_16x16x32_bf16 a[32:35], v[68:71], v[32:35], a[32:35]
    ds_read_b128 v[208:211], v25 offset:9472
    v_mfma_f32_16x16x32_bf16 a[36:39], v[68:71], v[36:39], a[36:39]
    ds_read_b128 v[212:215], v25 offset:18944
    v_mfma_f32_16x16x32_bf16 a[40:43], v[72:75], v[224:227], a[40:43]
    ds_read_b128 v[216:219], v25 offset:28416
    buffer_load_dwordx4 v[156:159], v44, s[8:11], s38 offen offset:3072 sc1
    v_mfma_f32_16x16x32_bf16 a[44:47], v[72:75], v[228:231], a[44:47]
    ds_read_b128 v[220:223], v25 offset:37888
    v_mfma_f32_16x16x32_bf16 a[48:51], v[72:75], v[232:235], a[48:51]
    s_add_u32 s39, s39, 64
    v_mfma_f32_16x16x32_bf16 a[52:55], v[72:75], v[236:239], a[52:55]
    s_cmp_eq_u32 s39, 576
    buffer_load_dwordx4 v[160:163], v21, s[8:11], s38 offen offset:0 sc1
    v_mfma_f32_16x16x32_bf16 a[56:59], v[72:75], v[240:243], a[56:59]
    s_cselect_b32 s39, 0, s39
    v_mfma_f32_16x16x32_bf16 a[60:63], v[76:79], v[244:247], a[60:63]
    v_mfma_f32_16x16x32_bf16 a[64:67], v[76:79], v[248:251], a[64:67]
    buffer_load_dwordx4 v[164:167], v21, s[8:11], s38 offen offset:1024 sc1
    v_mfma_f32_16x16x32_bf16 a[68:71], v[76:79], v[252:255], a[68:71]
    v_mfma_f32_16x16x32_bf16 a[72:75], v[76:79], v[32:35], a[72:75]
    v_mfma_f32_16x16x32_bf16 a[76:79], v[76:79], v[36:39], a[76:79]
    buffer_load_dwordx4 v[168:171], v21, s[8:11], s38 offen offset:2048 sc1
    v_mfma_f32_16x16x32_bf16 a[80:83], v[80:83], v[224:227], a[80:83]
    v_mfma_f32_16x16x32_bf16 a[84:87], v[80:83], v[228:231], a[84:87]
    v_mfma_f32_16x16x32_bf16 a[88:91], v[80:83], v[232:235], a[88:91]
    buffer_load_dwordx4 v[172:175], v21, s[8:11], s38 offen offset:3072 sc1
    v_mfma_f32_16x16x32_bf16 a[92:95], v[80:83], v[236:239], a[92:95]
    v_mfma_f32_16x16x32_bf16 a[96:99], v[80:83], v[240:243], a[96:99]
    v_mfma_f32_16x16x32_bf16 a[100:103], v[84:87], v[244:247], a[100:103]
    buffer_load_dwordx4 v[176:179], v19, s[8:11], s38 offen offset:0 sc1
    v_mfma_f32_16x16x32_bf16 a[104:107], v[84:87], v[248:251], a[104:107]
    v_mfma_f32_16x16x32_bf16 a[108:111], v[84:87], v[252:255], a[108:111]
    v_mfma_f32_16x16x32_bf16 a[112:115], v[84:87], v[32:35], a[112:115]
    buffer_load_dwordx4 v[180:183], v19, s[8:11], s38 offen offset:1024 sc1
    v_mfma_f32_16x16x32_bf16 a[116:119], v[84:87], v[36:39], a[116:119]
    v_mfma_f32_16x16x32_bf16 a[120:123], v[88:91], v[224:227], a[120:123]
    v_mfma_f32_16x16x32_bf16 a[124:127], v[88:91], v[228:231], a[124:127]
    s_add_u32 s38, s38, 10240
    v_mfma_f32_16x16x32_bf16 a[128:131], v[88:91], v[232:235], a[128:131]
    s_cmp_eq_u32 s38, 92160
    s_cselect_b32 s38, 0, s38
    v_mfma_f32_16x16x32_bf16 a[132:135], v[88:91], v[236:239], a[132:135]
    v_mfma_f32_16x16x32_bf16 a[136:139], v[88:91], v[240:243], a[136:139]
    v_mfma_f32_16x16x32_bf16 a[140:143], v[92:95], v[244:247], a[140:143]
    v_mfma_f32_16x16x32_bf16 a[144:147], v[92:95], v[248:251], a[144:147]
    v_mfma_f32_16x16x32_bf16 a[148:151], v[92:95], v[252:255], a[148:151]
    v_mfma_f32_16x16x32_bf16 a[152:155], v[92:95], v[32:35], a[152:155]
    v_mfma_f32_16x16x32_bf16 a[156:159], v[92:95], v[36:39], a[156:159]
    v_mfma_f32_16x16x32_bf16 a[160:163], v[96:99], v[224:227], a[160:163]
    v_mfma_f32_16x16x32_bf16 a[164:167], v[96:99], v[228:231], a[164:167]
    v_mfma_f32_16x16x32_bf16 a[168:171], v[96:99], v[232:235], a[168:171]
    v_mfma_f32_16x16x32_bf16 a[172:175], v[96:99], v[236:239], a[172:175]
    v_mfma_f32_16x16x32_bf16 a[176:179], v[96:99], v[240:243], a[176:179]
    v_mfma_f32_16x16x32_bf16 a[180:183], v[100:103], v[244:247], a[180:183]
    v_mfma_f32_16x16x32_bf16 a[184:187], v[100:103], v[248:251], a[184:187]
    v_mfma_f32_16x16x32_bf16 a[188:191], v[100:103], v[252:255], a[188:191]
    v_mfma_f32_16x16x32_bf16 a[192:195], v[100:103], v[32:35], a[192:195]
    v_mfma_f32_16x16x32_bf16 a[196:199], v[100:103], v[36:39], a[196:199]
    s_waitcnt lgkmcnt(0) vmcnt(10)
    v_mfma_f32_16x16x32_bf16 a[0:3], v[104:107], v[184:187], a[0:3]
    v_add_u32 v24, s39, v26
    v_mfma_f32_16x16x32_bf16 a[4:7], v[104:107], v[188:191], a[4:7]
    v_add_u32 v25, s39, v27
    buffer_load_dwordx4 v[64:67], v44, s[8:11], s38 offen offset:0 sc1
    v_mfma_f32_16x16x32_bf16 a[8:11], v[104:107], v[192:195], a[8:11]
    ds_read_b128 v[224:227], v24 offset:0
    v_mfma_f32_16x16x32_bf16 a[12:15], v[104:107], v[196:199], a[12:15]
    ds_read_b128 v[228:231], v24 offset:9472
    v_mfma_f32_16x16x32_bf16 a[16:19], v[104:107], v[200:203], a[16:19]
    ds_read_b128 v[232:235], v24 offset:18944
    buffer_load_dwordx4 v[68:71], v44, s[8:11], s38 offen offset:1024 sc1
    v_mfma_f32_16x16x32_bf16 a[20:23], v[108:111], v[204:207], a[20:23]
    ds_read_b128 v[236:239], v24 offset:28416
    v_mfma_f32_16x16x32_bf16 a[24:27], v[108:111], v[208:211], a[24:27]
    ds_read_b128 v[240:243], v24 offset:37888
    v_mfma_f32_16x16x32_bf16 a[28:31], v[108:111], v[212:215], a[28:31]
    ds_read_b128 v[244:247], v25 offset:0
    buffer_load_dwordx4 v[72:75], v44, s[8:11], s38 offen offset:2048 sc1
    v_mfma_f32_16x16x32_bf16 a[32:35], v[108:111], v[216:219], a[32:35]
    ds_read_b128 v[248:251], v25 offset:9472
    v_mfma_f32_16x16x32_bf16 a[36:39], v[108:111], v[220:223], a[36:39]
    ds_read_b128 v[252:255], v25 offset:18944
    v_mfma_f32_16x16x32_bf16 a[40:43], v[112:115], v[184:187], a[40:43]
    ds_read_b128 v[32:35], v25 offset:28416
    buffer_load_dwordx4 v[76:79], v44, s[8:11], s38 offen offset:3072 sc1
    v_mfma_f32_16x16x32_bf16 a[44:47], v[112:115], v[188:191], a[44:47]
    ds_read_b128 v[36:39], v25 offset:37888
    v_mfma_f32_16x16x32_bf16 a[48:51], v[112:115], v[192:195], a[48:51]
    s_add_u32 s39, s39, 64
    v_mfma_f32_16x16x32_bf16 a[52:55], v[112:115], v[196:199], a[52:55]
    s_cmp_eq_u32 s39, 576
    buffer_load_dwordx4 v[80:83], v21, s[8:11], s38 offen offset:0 sc1
    v_mfma_f32_16x16x32_bf16 a[56:59], v[112:115], v[200:203], a[56:59]
    s_cselect_b32 s39, 0, s39
    v_mfma_f32_16x16x32_bf16 a[60:63], v[116:119], v[204:207], a[60:63]
    v_mfma_f32_16x16x32_bf16 a[64:67], v[116:119], v[208:211], a[64:67]
    buffer_load_dwordx4 v[84:87], v21, s[8:11], s38 offen offset:1024 sc1
    v_mfma_f32_16x16x32_bf16 a[68:71], v[116:119], v[212:215], a[68:71]
    v_mfma_f32_16x16x32_bf16 a[72:75], v[116:119], v[216:219], a[72:75]
    v_mfma_f32_16x16x32_bf16 a[76:79], v[116:119], v[220:223], a[76:79]
    buffer_load_dwordx4 v[88:91], v21, s[8:11], s38 offen offset:2048 sc1
    v_mfma_f32_16x16x32_bf16 a[80:83], v[120:123], v[184:187], a[80:83]
    v_mfma_f32_16x16x32_bf16 a[84:87], v[120:123], v[188:191], a[84:87]
    v_mfma_f32_16x16x32_bf16 a[88:91], v[120:123], v[192:195], a[88:91]
    buffer_load_dwordx4 v[92:95], v21, s[8:11], s38 offen offset:3072 sc1
    v_mfma_f32_16x16x32_bf16 a[92:95], v[120:123], v[196:199], a[92:95]
    v_mfma_f32_16x16x32_bf16 a[96:99], v[120:123], v[200:203], a[96:99]
    v_mfma_f32_16x16x32_bf16 a[100:103], v[124:127], v[204:207], a[100:103]
    buffer_load_dwordx4 v[96:99], v19, s[8:11], s38 offen offset:0 sc1
    v_mfma_f32_16x16x32_bf16 a[104:107], v[124:127], v[208:211], a[104:107]
    v_mfma_f32_16x16x32_bf16 a[108:111], v[124:127], v[212:215], a[108:111]
    v_mfma_f32_16x16x32_bf16 a[112:115], v[124:127], v[216:219], a[112:115]
    buffer_load_dwordx4 v[100:103], v19, s[8:11], s38 offen offset:1024 sc1
    v_mfma_f32_16x16x32_bf16 a[116:119], v[124:127], v[220:223], a[116:119]
    v_mfma_f32_16x16x32_bf16 a[120:123], v[128:131], v[184:187], a[120:123]
    v_mfma_f32_16x16x32_bf16 a[124:127], v[128:131], v[188:191], a[124:127]
    s_add_u32 s38, s38, 10240
    v_mfma_f32_16x16x32_bf16 a[128:131], v[128:131], v[192:195], a[128:131]
    s_cmp_eq_u32 s38, 92160
    s_cselect_b32 s38, 0, s38
    v_mfma_f32_16x16x32_bf16 a[132:135], v[128:131], v[196:199], a[132:135]
    v_mfma_f32_16x16x32_bf16 a[136:139], v[128:131], v[200:203], a[136:139]
    v_mfma_f32_16x16x32_bf16 a[140:143], v[132:135], v[204:207], a[140:143]
    v_mfma_f32_16x16x32_bf16 a[144:147], v[132:135], v[208:211], a[144:147]
    v_mfma_f32_16x16x32_bf16 a[148:151], v[132:135], v[212:215], a[148:151]
    v_mfma_f32_16x16x32_bf16 a[152:155], v[132:135], v[216:219], a[152:155]
    v_mfma_f32_16x16x32_bf16 a[156:159], v[132:135], v[220:223], a[156:159]
    v_mfma_f32_16x16x32_bf16 a[160:163], v[136:139], v[184:187], a[160:163]
    v_mfma_f32_16x16x32_bf16 a[164:167], v[136:139], v[188:191], a[164:167]
    v_mfma_f32_16x16x32_bf16 a[168:171], v[136:139], v[192:195], a[168:171]
    v_mfma_f32_16x16x32_bf16 a[172:175], v[136:139], v[196:199], a[172:175]
    v_mfma_f32_16x16x32_bf16 a[176:179], v[136:139], v[200:203], a[176:179]
    v_mfma_f32_16x16x32_bf16 a[180:183], v[140:143], v[204:207], a[180:183]
    v_mfma_f32_16x16x32_bf16 a[184:187], v[140:143], v[208:211], a[184:187]
    v_mfma_f32_16x16x32_bf16 a[188:191], v[140:143], v[212:215], a[188:191]
    v_mfma_f32_16x16x32_bf16 a[192:195], v[140:143], v[216:219], a[192:195]
    v_mfma_f32_16x16x32_bf16 a[196:199], v[140:143], v[220:223], a[196:199]
    s_waitcnt lgkmcnt(0) vmcnt(10)
    v_mfma_f32_16x16x32_bf16 a[0:3], v[144:147], v[224:227], a[0:3]
    v_add_u32 v24, s39, v26
    v_mfma_f32_16x16x32_bf16 a[4:7], v[144:147], v[228:231], a[4:7]
    v_add_u32 v25, s39, v27
    buffer_load_dwordx4 v[104:107], v44, s[8:11], s38 offen offset:0 sc1
    v_mfma_f32_16x16x32_bf16 a[8:11], v[144:147], v[232:235], a[8:11]
    ds_read_b128 v[184:187], v24 offset:0
    v_mfma_f32_16x16x32_bf16 a[12:15], v[144:147], v[236:239], a[12:15]
    ds_read_b128 v[188:191], v24 offset:9472
    v_mfma_f32_16x16x32_bf16 a[16:19], v[144:147], v[240:243], a[16:19]
    ds_read_b128 v[192:195], v24 offset:18944
    buffer_load_dwordx4 v[108:111], v44, s[8:11], s38 offen offset:1024 sc1
    v_mfma_f32_16x16x32_bf16 a[20:23], v[148:151], v[244:247], a[20:23]
    ds_read_b128 v[196:199], v24 offset:28416
    v_mfma_f32_16x16x32_bf16 a[24:27], v[148:151], v[248:251], a[24:27]
    ds_read_b128 v[200:203], v24 offset:37888
    v_mfma_f32_16x16x32_bf16 a[28:31], v[148:151], v[252:255], a[28:31]
    ds_read_b128 v[204:207], v25 offset:0
    buffer_load_dwordx4 v[112:115], v44, s[8:11], s38 offen offset:2048 sc1
    v_mfma_f32_16x16x32_bf16 a[32:35], v[148:151], v[32:35], a[32:35]
    ds_read_b128 v[208:211], v25 offset:9472
    v_mfma_f32_16x16x32_bf16 a[36:39], v[148:151], v[36:39], a[36:39]
    ds_read_b128 v[212:215], v25 offset:18944
    v_mfma_f32_16x16x32_bf16 a[40:43], v[152:155], v[224:227], a[40:43]
    ds_read_b128 v[216:219], v25 offset:28416
    buffer_load_dwordx4 v[116:119], v44, s[8:11], s38 offen offset:3072 sc1
    v_mfma_f32_16x16x32_bf16 a[44:47], v[152:155], v[228:231], a[44:47]
    ds_read_b128 v[220:223], v25 offset:37888
    v_mfma_f32_16x16x32_bf16 a[48:51], v[152:155], v[232:235], a[48:51]
    s_add_u32 s39, s39, 64
    v_mfma_f32_16x16x32_bf16 a[52:55], v[152:155], v[236:239], a[52:55]
    s_cmp_eq_u32 s39, 576
    buffer_load_dwordx4 v[120:123], v21, s[8:11], s38 offen offset:0 sc1
    v_mfma_f32_16x16x32_bf16 a[56:59], v[152:155], v[240:243], a[56:59]
    s_cselect_b32 s39, 0, s39
    v_mfma_f32_16x16x32_bf16 a[60:63], v[156:159], v[244:247], a[60:63]
    v_mfma_f32_16x16x32_bf16 a[64:67], v[156:159], v[248:251], a[64:67]
    buffer_load_dwordx4 v[124:127], v21, s[8:11], s38 offen offset:1024 sc1
    v_mfma_f32_16x16x32_bf16 a[68:71], v[156:159], v[252:255], a[68:71]
    v_mfma_f32_16x16x32_bf16 a[72:75], v[156:159], v[32:35], a[72:75]
    v_mfma_f32_16x16x32_bf16 a[76:79], v[156:159], v[36:39], a[76:79]
    buffer_load_dwordx4 v[128:131], v21, s[8:11], s38 offen offset:2048 sc1
    v_mfma_f32_16x16x32_bf16 a[80:83], v[160:163], v[224:227], a[80:83]
    v_mfma_f32_16x16x32_bf16 a[84:87], v[160:163], v[228:231], a[84:87]
    v_mfma_f32_16x16x32_bf16 a[88:91], v[160:163], v[232:235], a[88:91]
    buffer_load_dwordx4 v[132:135], v21, s[8:11], s38 offen offset:3072 sc1
    v_mfma_f32_16x16x32_bf16 a[92:95], v[160:163], v[236:239], a[92:95]
    v_mfma_f32_16x16x32_bf16 a[96:99], v[160:163], v[240:243], a[96:99]
    v_mfma_f32_16x16x32_bf16 a[100:103], v[164:167], v[244:247], a[100:103]
    buffer_load_dwordx4 v[136:139], v19, s[8:11], s38 offen offset:0 sc1
    v_mfma_f32_16x16x32_bf16 a[104:107], v[164:167], v[248:251], a[104:107]
    v_mfma_f32_16x16x32_bf16 a[108:111], v[164:167], v[252:255], a[108:111]
    v_mfma_f32_16x16x32_bf16 a[112:115], v[164:167], v[32:35], a[112:115]
    buffer_load_dwordx4 v[140:143], v19, s[8:11], s38 offen offset:1024 sc1
    v_mfma_f32_16x16x32_bf16 a[116:119], v[164:167], v[36:39], a[116:119]
    v_mfma_f32_16x16x32_bf16 a[120:123], v[168:171], v[224:227], a[120:123]
    v_mfma_f32_16x16x32_bf16 a[124:127], v[168:171], v[228:231], a[124:127]
    s_add_u32 s38, s38, 10240
    v_mfma_f32_16x16x32_bf16 a[128:131], v[168:171], v[232:235], a[128:131]
    s_cmp_eq_u32 s38, 92160
    s_cselect_b32 s38, 0, s38
    v_mfma_f32_16x16x32_bf16 a[132:135], v[168:171], v[236:239], a[132:135]
    v_mfma_f32_16x16x32_bf16 a[136:139], v[168:171], v[240:243], a[136:139]
    s_add_u32 m0, s68, 0
    v_mfma_f32_16x16x32_bf16 a[140:143], v[172:175], v[244:247], a[140:143]
    buffer_load_dwordx4 v40, s[40:43], s54 offen offset:0 lds
    v_mfma_f32_16x16x32_bf16 a[144:147], v[172:175], v[248:251], a[144:147]
    v_mfma_f32_16x16x32_bf16 a[148:151], v[172:175], v[252:255], a[148:151]
    v_mfma_f32_16x16x32_bf16 a[152:155], v[172:175], v[32:35], a[152:155]
    buffer_load_dwordx4 v41, s[40:43], s54 offen offset:1024 lds
    v_mfma_f32_16x16x32_bf16 a[156:159], v[172:175], v[36:39], a[156:159]
    v_mfma_f32_16x16x32_bf16 a[160:163], v[176:179], v[224:227], a[160:163]
    v_mfma_f32_16x16x32_bf16 a[164:167], v[176:179], v[228:231], a[164:167]
    buffer_load_dwordx4 v42, s[40:43], s54 offen offset:2048 lds
    v_mfma_f32_16x16x32_bf16 a[168:171], v[176:179], v[232:235], a[168:171]
    v_mfma_f32_16x16x32_bf16 a[172:175], v[176:179], v[236:239], a[172:175]
    v_mfma_f32_16x16x32_bf16 a[176:179], v[176:179], v[240:243], a[176:179]
    buffer_load_dwordx4 v43, s[40:43], s54 offen offset:3072 lds
    v_mfma_f32_16x16x32_bf16 a[180:183], v[180:183], v[244:247], a[180:183]
    v_mfma_f32_16x16x32_bf16 a[184:187], v[180:183], v[248:251], a[184:187]
    v_mfma_f32_16x16x32_bf16 a[188:191], v[180:183], v[252:255], a[188:191]
    v_mfma_f32_16x16x32_bf16 a[192:195], v[180:183], v[32:35], a[192:195]
    v_mfma_f32_16x16x32_bf16 a[196:199], v[180:183], v[36:39], a[196:199]
    s_waitcnt lgkmcnt(0) vmcnt(14)
    v_mfma_f32_16x16x32_bf16 a[0:3], v[64:67], v[184:187], a[0:3]
    v_add_u32 v24, s39, v26
    v_mfma_f32_16x16x32_bf16 a[4:7], v[64:67], v[188:191], a[4:7]
    v_add_u32 v25, s39, v27
    buffer_load_dwordx4 v[144:147], v44, s[8:11], s38 offen offset:0 sc1
    v_mfma_f32_16x16x32_bf16 a[8:11], v[64:67], v[192:195], a[8:11]
    ds_read_b128 v[224:227], v24 offset:0
    v_mfma_f32_16x16x32_bf16 a[12:15], v[64:67], v[196:199], a[12:15]
    ds_read_b128 v[228:231], v24 offset:9472
    v_mfma_f32_16x16x32_bf16 a[16:19], v[64:67], v[200:203], a[16:19]
    ds_read_b128 v[232:235], v24 offset:18944
    buffer_load_dwordx4 v[148:151], v44, s[8:11], s38 offen offset:1024 sc1
    v_mfma_f32_16x16x32_bf16 a[20:23], v[68:71], v[204:207], a[20:23]
    ds_read_b128 v[236:239], v24 offset:28416
    v_mfma_f32_16x16x32_bf16 a[24:27], v[68:71], v[208:211], a[24:27]
    ds_read_b128 v[240:243], v24 offset:37888
    v_mfma_f32_16x16x32_bf16 a[28:31], v[68:71], v[212:215], a[28:31]
    ds_read_b128 v[244:247], v25 offset:0
    buffer_load_dwordx4 v[152:155], v44, s[8:11], s38 offen offset:2048 sc1
    v_mfma_f32_16x16x32_bf16 a[32:35], v[68:71], v[216:219], a[32:35]
    ds_read_b128 v[248:251], v25 offset:9472
    v_mfma_f32_16x16x32_bf16 a[36:39], v[68:71], v[220:223], a[36:39]
    ds_read_b128 v[252:255], v25 offset:18944
    v_mfma_f32_16x16x32_bf16 a[40:43], v[72:75], v[184:187], a[40:43]
    ds_read_b128 v[32:35], v25 offset:28416
    buffer_load_dwordx4 v[156:159], v44, s[8:11], s38 offen offset:3072 sc1
    v_mfma_f32_16x16x32_bf16 a[44:47], v[72:75], v[188:191], a[44:47]
    ds_read_b128 v[36:39], v25 offset:37888
    v_mfma_f32_16x16x32_bf16 a[48:51], v[72:75], v[192:195], a[48:51]
    s_add_u32 s39, s39, 64
    v_mfma_f32_16x16x32_bf16 a[52:55], v[72:75], v[196:199], a[52:55]
    s_cmp_eq_u32 s39, 576
    buffer_load_dwordx4 v[160:163], v21, s[8:11], s38 offen offset:0 sc1
    v_mfma_f32_16x16x32_bf16 a[56:59], v[72:75], v[200:203], a[56:59]
    s_cselect_b32 s39, 0, s39
    v_mfma_f32_16x16x32_bf16 a[60:63], v[76:79], v[204:207], a[60:63]
    v_mfma_f32_16x16x32_bf16 a[64:67], v[76:79], v[208:211], a[64:67]
    buffer_load_dwordx4 v[164:167], v21, s[8:11], s38 offen offset:1024 sc1
    v_mfma_f32_16x16x32_bf16 a[68:71], v[76:79], v[212:215], a[68:71]
    v_mfma_f32_16x16x32_bf16 a[72:75], v[76:79], v[216:219], a[72:75]
    v_mfma_f32_16x16x32_bf16 a[76:79], v[76:79], v[220:223], a[76:79]
    buffer_load_dwordx4 v[168:171], v21, s[8:11], s38 offen offset:2048 sc1
    v_mfma_f32_16x16x32_bf16 a[80:83], v[80:83], v[184:187], a[80:83]
    v_mfma_f32_16x16x32_bf16 a[84:87], v[80:83], v[188:191], a[84:87]
    v_mfma_f32_16x16x32_bf16 a[88:91], v[80:83], v[192:195], a[88:91]
    buffer_load_dwordx4 v[172:175], v21, s[8:11], s38 offen offset:3072 sc1
    v_mfma_f32_16x16x32_bf16 a[92:95], v[80:83], v[196:199], a[92:95]
    v_mfma_f32_16x16x32_bf16 a[96:99], v[80:83], v[200:203], a[96:99]
    v_mfma_f32_16x16x32_bf16 a[100:103], v[84:87], v[204:207], a[100:103]
    buffer_load_dwordx4 v[176:179], v19, s[8:11], s38 offen offset:0 sc1
    v_mfma_f32_16x16x32_bf16 a[104:107], v[84:87], v[208:211], a[104:107]
    v_mfma_f32_16x16x32_bf16 a[108:111], v[84:87], v[212:215], a[108:111]
    v_mfma_f32_16x16x32_bf16 a[112:115], v[84:87], v[216:219], a[112:115]
    buffer_load_dwordx4 v[180:183], v19, s[8:11], s38 offen offset:1024 sc1
    v_mfma_f32_16x16x32_bf16 a[116:119], v[84:87], v[220:223], a[116:119]
    v_mfma_f32_16x16x32_bf16 a[120:123], v[88:91], v[184:187], a[120:123]
    v_mfma_f32_16x16x32_bf16 a[124:127], v[88:91], v[188:191], a[124:127]
    s_add_u32 s38, s38, 10240
    v_mfma_f32_16x16x32_bf16 a[128:131], v[88:91], v[192:195], a[128:131]
    s_cmp_eq_u32 s38, 92160
    s_cselect_b32 s38, 0, s38
    v_mfma_f32_16x16x32_bf16 a[132:135], v[88:91], v[196:199], a[132:135]
    v_mfma_f32_16x16x32_bf16 a[136:139], v[88:91], v[200:203], a[136:139]
    s_add_u32 m0, s68, 4096
    v_mfma_f32_16x16x32_bf16 a[140:143], v[92:95], v[204:207], a[140:143]
    buffer_load_dwordx4 v40, s[40:43], s55 offen offset:0 lds
    v_mfma_f32_16x16x32_bf16 a[144:147], v[92:95], v[208:211], a[144:147]
    v_mfma_f32_16x16x32_bf16 a[148:151], v[92:95], v[212:215], a[148:151]
    v_mfma_f32_16x16x32_bf16 a[152:155], v[92:95], v[216:219], a[152:155]
    buffer_load_dwordx4 v41, s[40:43], s55 offen offset:1024 lds
    v_mfma_f32_16x16x32_bf16 a[156:159], v[92:95], v[220:223], a[156:159]
    v_mfma_f32_16x16x32_bf16 a[160:163], v[96:99], v[184:187], a[160:163]
    v_mfma_f32_16x16x32_bf16 a[164:167], v[96:99], v[188:191], a[164:167]
    buffer_load_dwordx4 v42, s[40:43], s55 offen offset:2048 lds
    v_mfma_f32_16x16x32_bf16 a[168:171], v[96:99], v[192:195], a[168:171]
    v_mfma_f32_16x16x32_bf16 a[172:175], v[96:99], v[196:199], a[172:175]
    v_mfma_f32_16x16x32_bf16 a[176:179], v[96:99], v[200:203], a[176:179]
    buffer_load_dwordx4 v43, s[40:43], s55 offen offset:3072 lds
    v_mfma_f32_16x16x32_bf16 a[180:183], v[100:103], v[204:207], a[180:183]
    v_mfma_f32_16x16x32_bf16 a[184:187], v[100:103], v[208:211], a[184:187]
    s_add_u32 s54, s54, 131072
    s_cmp_eq_u32 s54, s101
    s_cselect_b32 s54, s100, s54
    s_add_u32 s55, s54, 65536
    v_mfma_f32_16x16x32_bf16 a[188:191], v[100:103], v[212:215], a[188:191]
    v_mfma_f32_16x16x32_bf16 a[192:195], v[100:103], v[216:219], a[192:195]
    v_mfma_f32_16x16x32_bf16 a[196:199], v[100:103], v[220:223], a[196:199]
    s_waitcnt lgkmcnt(0) vmcnt(18)
    v_mfma_f32_16x16x32_bf16 a[0:3], v[104:107], v[224:227], a[0:3]
    v_add_u32 v24, s39, v26
    v_mfma_f32_16x16x32_bf16 a[4:7], v[104:107], v[228:231], a[4:7]
    v_add_u32 v25, s39, v27
    v_mfma_f32_16x16x32_bf16 a[8:11], v[104:107], v[232:235], a[8:11]
    ds_read_b128 v[184:187], v24 offset:0
    v_mfma_f32_16x16x32_bf16 a[12:15], v[104:107], v[236:239], a[12:15]
    ds_read_b128 v[188:191], v24 offset:9472
    v_mfma_f32_16x16x32_bf16 a[16:19], v[104:107], v[240:243], a[16:19]
    ds_read_b128 v[192:195], v24 offset:18944
    v_mfma_f32_16x16x32_bf16 a[20:23], v[108:111], v[244:247], a[20:23]
    ds_read_b128 v[196:199], v24 offset:28416
    v_mfma_f32_16x16x32_bf16 a[24:27], v[108:111], v[248:251], a[24:27]
    ds_read_b128 v[200:203], v24 offset:37888
    v_mfma_f32_16x16x32_bf16 a[28:31], v[108:111], v[252:255], a[28:31]
    ds_read_b128 v[204:207], v25 offset:0
    v_mfma_f32_16x16x32_bf16 a[32:35], v[108:111], v[32:35], a[32:35]
    ds_read_b128 v[208:211], v25 offset:9472
    v_mfma_f32_16x16x32_bf16 a[36:39], v[108:111], v[36:39], a[36:39]
    ds_read_b128 v[212:215], v25 offset:18944
    v_mfma_f32_16x16x32_bf16 a[40:43], v[112:115], v[224:227], a[40:43]
    ds_read_b128 v[216:219], v25 offset:28416
    v_mfma_f32_16x16x32_bf16 a[44:47], v[112:115], v[228:231], a[44:47]
    ds_read_b128 v[220:223], v25 offset:37888
    v_mfma_f32_16x16x32_bf16 a[48:51], v[112:115], v[232:235], a[48:51]
    s_add_u32 s39, s39, 64
    v_mfma_f32_16x16x32_bf16 a[52:55], v[112:115], v[236:239], a[52:55]
    s_cmp_eq_u32 s39, 576
    v_mfma_f32_16x16x32_bf16 a[56:59], v[112:115], v[240:243], a[56:59]
    s_cselect_b32 s39, 0, s39
    v_mfma_f32_16x16x32_bf16 a[60:63], v[116:119], v[244:247], a[60:63]
    v_mfma_f32_16x16x32_bf16 a[64:67], v[116:119], v[248:251], a[64:67]
    v_mfma_f32_16x16x32_bf16 a[68:71], v[116:119], v[252:255], a[68:71]
    v_mfma_f32_16x16x32_bf16 a[72:75], v[116:119], v[32:35], a[72:75]
    v_mfma_f32_16x16x32_bf16 a[76:79], v[116:119], v[36:39], a[76:79]
    v_mfma_f32_16x16x32_bf16 a[80:83], v[120:123], v[224:227], a[80:83]
    v_mfma_f32_16x16x32_bf16 a[84:87], v[120:123], v[228:231], a[84:87]
    v_mfma_f32_16x16x32_bf16 a[88:91], v[120:123], v[232:235], a[88:91]
    v_mfma_f32_16x16x32_bf16 a[92:95], v[120:123], v[236:239], a[92:95]
    v_mfma_f32_16x16x32_bf16 a[96:99], v[120:123], v[240:243], a[96:99]
    v_mfma_f32_16x16x32_bf16 a[100:103], v[124:127], v[244:247], a[100:103]
    v_mfma_f32_16x16x32_bf16 a[104:107], v[124:127], v[248:251], a[104:107]
    v_mfma_f32_16x16x32_bf16 a[108:111], v[124:127], v[252:255], a[108:111]
    v_mfma_f32_16x16x32_bf16 a[112:115], v[124:127], v[32:35], a[112:115]
    v_mfma_f32_16x16x32_bf16 a[116:119], v[124:127], v[36:39], a[116:119]
    v_mfma_f32_16x16x32_bf16 a[120:123], v[128:131], v[224:227], a[120:123]
    v_mfma_f32_16x16x32_bf16 a[124:127], v[128:131], v[228:231], a[124:127]
    v_mfma_f32_16x16x32_bf16 a[128:131], v[128:131], v[232:235], a[128:131]
    v_mfma_f32_16x16x32_bf16 a[132:135], v[128:131], v[236:239], a[132:135]
    v_mfma_f32_16x16x32_bf16 a[136:139], v[128:131], v[240:243], a[136:139]
    s_add_u32 m0, s68, 8192
    v_mfma_f32_16x16x32_bf16 a[140:143], v[132:135], v[244:247], a[140:143]
    buffer_load_dwordx4 v40, s[40:43], s54 offen offset:0 lds
    v_mfma_f32_16x16x32_bf16 a[144:147], v[132:135], v[248:251], a[144:147]
    v_mfma_f32_16x16x32_bf16 a[148:151], v[132:135], v[252:255], a[148:151]
    v_mfma_f32_16x16x32_bf16 a[152:155], v[132:135], v[32:35], a[152:155]
    buffer_load_dwordx4 v41, s[40:43], s54 offen offset:1024 lds
    v_mfma_f32_16x16x32_bf16 a[156:159], v[132:135], v[36:39], a[156:159]
    v_mfma_f32_16x16x32_bf16 a[160:163], v[136:139], v[224:227], a[160:163]
    v_mfma_f32_16x16x32_bf16 a[164:167], v[136:139], v[228:231], a[164:167]
    buffer_load_dwordx4 v42, s[40:43], s54 offen offset:2048 lds
    v_mfma_f32_16x16x32_bf16 a[168:171], v[136:139], v[232:235], a[168:171]
    v_mfma_f32_16x16x32_bf16 a[172:175], v[136:139], v[236:239], a[172:175]
    v_mfma_f32_16x16x32_bf16 a[176:179], v[136:139], v[240:243], a[176:179]
    buffer_load_dwordx4 v43, s[40:43], s54 offen offset:3072 lds
    v_mfma_f32_16x16x32_bf16 a[180:183], v[140:143], v[244:247], a[180:183]
    v_mfma_f32_16x16x32_bf16 a[184:187], v[140:143], v[248:251], a[184:187]
    v_mfma_f32_16x16x32_bf16 a[188:191], v[140:143], v[252:255], a[188:191]
    v_mfma_f32_16x16x32_bf16 a[192:195], v[140:143], v[32:35], a[192:195]
    v_mfma_f32_16x16x32_bf16 a[196:199], v[140:143], v[36:39], a[196:199]
    s_waitcnt lgkmcnt(0) vmcnt(8)
    v_mfma_f32_16x16x32_bf16 a[0:3], v[144:147], v[184:187], a[0:3]
    v_mfma_f32_16x16x32_bf16 a[4:7], v[144:147], v[188:191], a[4:7]
    v_mfma_f32_16x16x32_bf16 a[8:11], v[144:147], v[192:195], a[8:11]
    v_mfma_f32_16x16x32_bf16 a[12:15], v[144:147], v[196:199], a[12:15]
    v_mfma_f32_16x16x32_bf16 a[16:19], v[144:147], v[200:203], a[16:19]
    v_mfma_f32_16x16x32_bf16 a[20:23], v[148:151], v[204:207], a[20:23]
    v_mfma_f32_16x16x32_bf16 a[24:27], v[148:151], v[208:211], a[24:27]
    v_mfma_f32_16x16x32_bf16 a[28:31], v[148:151], v[212:215], a[28:31]
    v_mfma_f32_16x16x32_bf16 a[32:35], v[148:151], v[216:219], a[32:35]
    v_mfma_f32_16x16x32_bf16 a[36:39], v[148:151], v[220:223], a[36:39]
    v_mfma_f32_16x16x32_bf16 a[40:43], v[152:155], v[184:187], a[40:43]
    v_mfma_f32_16x16x32_bf16 a[44:47], v[152:155], v[188:191], a[44:47]
    v_mfma_f32_16x16x32_bf16 a[48:51], v[152:155], v[192:195], a[48:51]
    v_mfma_f32_16x16x32_bf16 a[52:55], v[152:155], v[196:199], a[52:55]
    v_mfma_f32_16x16x32_bf16 a[56:59], v[152:155], v[200:203], a[56:59]
    v_mfma_f32_16x16x32_bf16 a[60:63], v[156:159], v[204:207], a[60:63]
    v_mfma_f32_16x16x32_bf16 a[64:67], v[156:159], v[208:211], a[64:67]
    v_mfma_f32_16x16x32_bf16 a[68:71], v[156:159], v[212:215], a[68:71]
    v_mfma_f32_16x16x32_bf16 a[72:75], v[156:159], v[216:219], a[72:75]
    v_mfma_f32_16x16x32_bf16 a[76:79], v[156:159], v[220:223], a[76:79]
    v_mfma_f32_16x16x32_bf16 a[80:83], v[160:163], v[184:187], a[80:83]
    v_mfma_f32_16x16x32_bf16 a[84:87], v[160:163], v[188:191], a[84:87]
    v_mfma_f32_16x16x32_bf16 a[88:91], v[160:163], v[192:195], a[88:91]
    v_mfma_f32_16x16x32_bf16 a[92:95], v[160:163], v[196:199], a[92:95]
    v_mfma_f32_16x16x32_bf16 a[96:99], v[160:163], v[200:203], a[96:99]
    v_mfma_f32_16x16x32_bf16 a[100:103], v[164:167], v[204:207], a[100:103]
    v_mfma_f32_16x16x32_bf16 a[104:107], v[164:167], v[208:211], a[104:107]
    v_mfma_f32_16x16x32_bf16 a[108:111], v[164:167], v[212:215], a[108:111]
    v_mfma_f32_16x16x32_bf16 a[112:115], v[164:167], v[216:219], a[112:115]
    v_mfma_f32_16x16x32_bf16 a[116:119], v[164:167], v[220:223], a[116:119]
    v_mfma_f32_16x16x32_bf16 a[120:123], v[168:171], v[184:187], a[120:123]
    v_mfma_f32_16x16x32_bf16 a[124:127], v[168:171], v[188:191], a[124:127]
    v_mfma_f32_16x16x32_bf16 a[128:131], v[168:171], v[192:195], a[128:131]
    v_mfma_f32_16x16x32_bf16 a[132:135], v[168:171], v[196:199], a[132:135]
    v_mfma_f32_16x16x32_bf16 a[136:139], v[168:171], v[200:203], a[136:139]
    s_add_u32 m0, s68, 12288
    v_mfma_f32_16x16x32_bf16 a[140:143], v[172:175], v[204:207], a[140:143]
    buffer_load_dwordx4 v40, s[40:43], s55 offen offset:0 lds
    v_mfma_f32_16x16x32_bf16 a[144:147], v[172:175], v[208:211], a[144:147]
    v_mfma_f32_16x16x32_bf16 a[148:151], v[172:175], v[212:215], a[148:151]
    v_mfma_f32_16x16x32_bf16 a[152:155], v[172:175], v[216:219], a[152:155]
    buffer_load_dwordx4 v41, s[40:43], s55 offen offset:1024 lds
    v_mfma_f32_16x16x32_bf16 a[156:159], v[172:175], v[220:223], a[156:159]
    v_mfma_f32_16x16x32_bf16 a[160:163], v[176:179], v[184:187], a[160:163]
    v_mfma_f32_16x16x32_bf16 a[164:167], v[176:179], v[188:191], a[164:167]
    buffer_load_dwordx4 v42, s[40:43], s55 offen offset:2048 lds
    v_mfma_f32_16x16x32_bf16 a[168:171], v[176:179], v[192:195], a[168:171]
    v_mfma_f32_16x16x32_bf16 a[172:175], v[176:179], v[196:199], a[172:175]
    v_mfma_f32_16x16x32_bf16 a[176:179], v[176:179], v[200:203], a[176:179]
    buffer_load_dwordx4 v43, s[40:43], s55 offen offset:3072 lds
    v_mfma_f32_16x16x32_bf16 a[180:183], v[180:183], v[204:207], a[180:183]
    v_mfma_f32_16x16x32_bf16 a[184:187], v[180:183], v[208:211], a[184:187]
    s_add_u32 s54, s54, 131072
    s_cmp_eq_u32 s54, s101
    s_cselect_b32 s54, s100, s54
    s_add_u32 s55, s54, 65536
    v_mfma_f32_16x16x32_bf16 a[188:191], v[180:183], v[212:215], a[188:191]
    v_mfma_f32_16x16x32_bf16 a[192:195], v[180:183], v[216:219], a[192:195]
    v_mfma_f32_16x16x32_bf16 a[196:199], v[180:183], v[220:223], a[196:199]
    s_mul_i32 s34, s29, 3145728
    s_add_u32 s34, s34, 20971520
    s_add_u32 s16, s4, s34
    s_addc_u32 s17, s5, 0
    s_mov_b32 s18, 1312000
    s_mul_i32 s34, s26, 160
    s_add_u32 s34, s34, s28
    s_mul_i32 s34, s34, 1280
    v_and_b32 v2, 15, v1
    v_mul_u32_u24 v2, 1104, v2
    v_lshrrev_b32 v4, 4, v1
    v_lshl_add_u32 v2, v4, 4, v2
    s_mul_i32 s36, s24, 320
    v_add_u32 v2, s36, v2
    v_add_u32 v3, 52992, v2
    s_barrier
    v_accvgpr_read_b32 v68, a0
    v_accvgpr_read_b32 v72, a20
    v_accvgpr_read_b32 v69, a1
    v_accvgpr_read_b32 v73, a21
    v_accvgpr_read_b32 v70, a2
    v_accvgpr_read_b32 v74, a22
    v_accvgpr_read_b32 v71, a3
    v_accvgpr_read_b32 v75, a23
    v_cvt_pk_bf16_f32 v64, v68, v72
    v_cvt_pk_bf16_f32 v65, v69, v73
    v_cvt_pk_bf16_f32 v66, v70, v74
    v_cvt_pk_bf16_f32 v67, v71, v75
    ds_write_b128 v2, v[64:67] offset:0
    v_accvgpr_read_b32 v80, a4
    v_accvgpr_read_b32 v84, a24
    v_accvgpr_read_b32 v81, a5
    v_accvgpr_read_b32 v85, a25
    v_accvgpr_read_b32 v82, a6
    v_accvgpr_read_b32 v86, a26
    v_accvgpr_read_b32 v83, a7
    v_accvgpr_read_b32 v87, a27
    v_cvt_pk_bf16_f32 v76, v80, v84
    v_cvt_pk_bf16_f32 v77, v81, v85
    v_cvt_pk_bf16_f32 v78, v82, v86
    v_cvt_pk_bf16_f32 v79, v83, v87
    ds_write_b128 v2, v[76:79] offset:17664
    v_accvgpr_read_b32 v92, a8
    v_accvgpr_read_b32 v96, a28
    v_accvgpr_read_b32 v93, a9
    v_accvgpr_read_b32 v97, a29
    v_accvgpr_read_b32 v94, a10
    v_accvgpr_read_b32 v98, a30
    v_accvgpr_read_b32 v95, a11
    v_accvgpr_read_b32 v99, a31
    v_cvt_pk_bf16_f32 v88, v92, v96
    v_cvt_pk_bf16_f32 v89, v93, v97
    v_cvt_pk_bf16_f32 v90, v94, v98
    v_cvt_pk_bf16_f32 v91, v95, v99
    ds_write_b128 v2, v[88:91] offset:35328
    v_accvgpr_read_b32 v104, a12
    v_accvgpr_read_b32 v108, a32
    v_accvgpr_read_b32 v105, a13
    v_accvgpr_read_b32 v109, a33
    v_accvgpr_read_b32 v106, a14
    v_accvgpr_read_b32 v110, a34
    v_accvgpr_read_b32 v107, a15
    v_accvgpr_read_b32 v111, a35
    v_cvt_pk_bf16_f32 v100, v104, v108
    v_cvt_pk_bf16_f32 v101, v105, v109
    v_cvt_pk_bf16_f32 v102, v106, v110
    v_cvt_pk_bf16_f32 v103, v107, v111
    ds_write_b128 v3, v[100:103] offset:0
    v_accvgpr_read_b32 v68, a16
    v_accvgpr_read_b32 v72, a36
    v_accvgpr_read_b32 v69, a17
    v_accvgpr_read_b32 v73, a37
    v_accvgpr_read_b32 v70, a18
    v_accvgpr_read_b32 v74, a38
    v_accvgpr_read_b32 v71, a19
    v_accvgpr_read_b32 v75, a39
    v_cvt_pk_bf16_f32 v64, v68, v72
    v_cvt_pk_bf16_f32 v65, v69, v73
    v_cvt_pk_bf16_f32 v66, v70, v74
    v_cvt_pk_bf16_f32 v67, v71, v75
    ds_write_b128 v3, v[64:67] offset:17664
    v_accvgpr_read_b32 v80, a40
    v_accvgpr_read_b32 v84, a60
    v_accvgpr_read_b32 v81, a41
    v_accvgpr_read_b32 v85, a61
    v_accvgpr_read_b32 v82, a42
    v_accvgpr_read_b32 v86, a62
    v_accvgpr_read_b32 v83, a43
    v_accvgpr_read_b32 v87, a63
    v_cvt_pk_bf16_f32 v76, v80, v84
    v_cvt_pk_bf16_f32 v77, v81, v85
    v_cvt_pk_bf16_f32 v78, v82, v86
    v_cvt_pk_bf16_f32 v79, v83, v87
    ds_write_b128 v2, v[76:79] offset:64
    v_accvgpr_read_b32 v92, a44
    v_accvgpr_read_b32 v96, a64
    v_accvgpr_read_b32 v93, a45
    v_accvgpr_read_b32 v97, a65
    v_accvgpr_read_b32 v94, a46
    v_accvgpr_read_b32 v98, a66
    v_accvgpr_read_b32 v95, a47
    v_accvgpr_read_b32 v99, a67
    v_cvt_pk_bf16_f32 v88, v92, v96
    v_cvt_pk_bf16_f32 v89, v93, v97
    v_cvt_pk_bf16_f32 v90, v94, v98
    v_cvt_pk_bf16_f32 v91, v95, v99
    ds_write_b128 v2, v[88:91] offset:17728
    v_accvgpr_read_b32 v104, a48
    v_accvgpr_read_b32 v108, a68
    v_accvgpr_read_b32 v105, a49
    v_accvgpr_read_b32 v109, a69
    v_accvgpr_read_b32 v106, a50
    v_accvgpr_read_b32 v110, a70
    v_accvgpr_read_b32 v107, a51
    v_accvgpr_read_b32 v111, a71
    v_cvt_pk_bf16_f32 v100, v104, v108
    v_cvt_pk_bf16_f32 v101, v105, v109
    v_cvt_pk_bf16_f32 v102, v106, v110
    v_cvt_pk_bf16_f32 v103, v107, v111
    ds_write_b128 v2, v[100:103] offset:35392
    v_accvgpr_read_b32 v68, a52
    v_accvgpr_read_b32 v72, a72
    v_accvgpr_read_b32 v69, a53
    v_accvgpr_read_b32 v73, a73
    v_accvgpr_read_b32 v70, a54
    v_accvgpr_read_b32 v74, a74
    v_accvgpr_read_b32 v71, a55
    v_accvgpr_read_b32 v75, a75
    v_cvt_pk_bf16_f32 v64, v68, v72
    v_cvt_pk_bf16_f32 v65, v69, v73
    v_cvt_pk_bf16_f32 v66, v70, v74
    v_cvt_pk_bf16_f32 v67, v71, v75
    ds_write_b128 v3, v[64:67] offset:64
    v_accvgpr_read_b32 v80, a56
    v_accvgpr_read_b32 v84, a76
    v_accvgpr_read_b32 v81, a57
    v_accvgpr_read_b32 v85, a77
    v_accvgpr_read_b32 v82, a58
    v_accvgpr_read_b32 v86, a78
    v_accvgpr_read_b32 v83, a59
    v_accvgpr_read_b32 v87, a79
    v_cvt_pk_bf16_f32 v76, v80, v84
    v_cvt_pk_bf16_f32 v77, v81, v85
    v_cvt_pk_bf16_f32 v78, v82, v86
    v_cvt_pk_bf16_f32 v79, v83, v87
    ds_write_b128 v3, v[76:79] offset:17728
    s_cmp_eq_u32 s24, 3
    s_cbranch_scc1 L_outd
    v_accvgpr_read_b32 v92, a80
    v_accvgpr_read_b32 v96, a100
    v_accvgpr_read_b32 v93, a81
    v_accvgpr_read_b32 v97, a101
    v_accvgpr_read_b32 v94, a82
    v_accvgpr_read_b32 v98, a102
    v_accvgpr_read_b32 v95, a83
    v_accvgpr_read_b32 v99, a103
    v_cvt_pk_bf16_f32 v88, v92, v96
    v_cvt_pk_bf16_f32 v89, v93, v97
    v_cvt_pk_bf16_f32 v90, v94, v98
    v_cvt_pk_bf16_f32 v91, v95, v99
    ds_write_b128 v2, v[88:91] offset:128
    v_accvgpr_read_b32 v104, a84
    v_accvgpr_read_b32 v108, a104
    v_accvgpr_read_b32 v105, a85
    v_accvgpr_read_b32 v109, a105
    v_accvgpr_read_b32 v106, a86
    v_accvgpr_read_b32 v110, a106
    v_accvgpr_read_b32 v107, a87
    v_accvgpr_read_b32 v111, a107
    v_cvt_pk_bf16_f32 v100, v104, v108
    v_cvt_pk_bf16_f32 v101, v105, v109
    v_cvt_pk_bf16_f32 v102, v106, v110
    v_cvt_pk_bf16_f32 v103, v107, v111
    ds_write_b128 v2, v[100:103] offset:17792
    v_accvgpr_read_b32 v68, a88
    v_accvgpr_read_b32 v72, a108
    v_accvgpr_read_b32 v69, a89
    v_accvgpr_read_b32 v73, a109
    v_accvgpr_read_b32 v70, a90
    v_accvgpr_read_b32 v74, a110
    v_accvgpr_read_b32 v71, a91
    v_accvgpr_read_b32 v75, a111
    v_cvt_pk_bf16_f32 v64, v68, v72
    v_cvt_pk_bf16_f32 v65, v69, v73
    v_cvt_pk_bf16_f32 v66, v70, v74
    v_cvt_pk_bf16_f32 v67, v71, v75
    ds_write_b128 v2, v[64:67] offset:35456
    v_accvgpr_read_b32 v80, a92
    v_accvgpr_read_b32 v84, a112
    v_accvgpr_read_b32 v81, a93
    v_accvgpr_read_b32 v85, a113
    v_accvgpr_read_b32 v82, a94
    v_accvgpr_read_b32 v86, a114
    v_accvgpr_read_b32 v83, a95
    v_accvgpr_read_b32 v87, a115
    v_cvt_pk_bf16_f32 v76, v80, v84
    v_cvt_pk_bf16_f32 v77, v81, v85
    v_cvt_pk_bf16_f32 v78, v82, v86
    v_cvt_pk_bf16_f32 v79, v83, v87
    ds_write_b128 v3, v[76:79] offset:128
    v_accvgpr_read_b32 v92, a96
    v_accvgpr_read_b32 v96, a116
    v_accvgpr_read_b32 v93, a97
    v_accvgpr_read_b32 v97, a117
    v_accvgpr_read_b32 v94, a98
    v_accvgpr_read_b32 v98, a118
    v_accvgpr_read_b32 v95, a99
    v_accvgpr_read_b32 v99, a119
    v_cvt_pk_bf16_f32 v88, v92, v96
    v_cvt_pk_bf16_f32 v89, v93, v97
    v_cvt_pk_bf16_f32 v90, v94, v98
    v_cvt_pk_bf16_f32 v91, v95, v99
    ds_write_b128 v3, v[88:91] offset:17792
    v_accvgpr_read_b32 v104, a120
    v_accvgpr_read_b32 v108, a140
    v_accvgpr_read_b32 v105, a121
    v_accvgpr_read_b32 v109, a141
    v_accvgpr_read_b32 v106, a122
    v_accvgpr_read_b32 v110, a142
    v_accvgpr_read_b32 v107, a123
    v_accvgpr_read_b32 v111, a143
    v_cvt_pk_bf16_f32 v100, v104, v108
    v_cvt_pk_bf16_f32 v101, v105, v109
    v_cvt_pk_bf16_f32 v102, v106, v110
    v_cvt_pk_bf16_f32 v103, v107, v111
    ds_write_b128 v2, v[100:103] offset:192
    v_accvgpr_read_b32 v68, a124
    v_accvgpr_read_b32 v72, a144
    v_accvgpr_read_b32 v69, a125
    v_accvgpr_read_b32 v73, a145
    v_accvgpr_read_b32 v70, a126
    v_accvgpr_read_b32 v74, a146
    v_accvgpr_read_b32 v71, a127
    v_accvgpr_read_b32 v75, a147
    v_cvt_pk_bf16_f32 v64, v68, v72
    v_cvt_pk_bf16_f32 v65, v69, v73
    v_cvt_pk_bf16_f32 v66, v70, v74
    v_cvt_pk_bf16_f32 v67, v71, v75
    ds_write_b128 v2, v[64:67] offset:17856
    v_accvgpr_read_b32 v80, a128
    v_accvgpr_read_b32 v84, a148
    v_accvgpr_read_b32 v81, a129
    v_accvgpr_read_b32 v85, a149
    v_accvgpr_read_b32 v82, a130
    v_accvgpr_read_b32 v86, a150
    v_accvgpr_read_b32 v83, a131
    v_accvgpr_read_b32 v87, a151
    v_cvt_pk_bf16_f32 v76, v80, v84
    v_cvt_pk_bf16_f32 v77, v81, v85
    v_cvt_pk_bf16_f32 v78, v82, v86
    v_cvt_pk_bf16_f32 v79, v83, v87
    ds_write_b128 v2, v[76:79] offset:35520
    v_accvgpr_read_b32 v92, a132
    v_accvgpr_read_b32 v96, a152
    v_accvgpr_read_b32 v93, a133
    v_accvgpr_read_b32 v97, a153
    v_accvgpr_read_b32 v94, a134
    v_accvgpr_read_b32 v98, a154
    v_accvgpr_read_b32 v95, a135
    v_accvgpr_read_b32 v99, a155
    v_cvt_pk_bf16_f32 v88, v92, v96
    v_cvt_pk_bf16_f32 v89, v93, v97
    v_cvt_pk_bf16_f32 v90, v94, v98
    v_cvt_pk_bf16_f32 v91, v95, v99
    ds_write_b128 v3, v[88:91] offset:192
    v_accvgpr_read_b32 v104, a136
    v_accvgpr_read_b32 v108, a156
    v_accvgpr_read_b32 v105, a137
    v_accvgpr_read_b32 v109, a157
    v_accvgpr_read_b32 v106, a138
    v_accvgpr_read_b32 v110, a158
    v_accvgpr_read_b32 v107, a139
    v_accvgpr_read_b32 v111, a159
    v_cvt_pk_bf16_f32 v100, v104, v108
    v_cvt_pk_bf16_f32 v101, v105, v109
    v_cvt_pk_bf16_f32 v102, v106, v110
    v_cvt_pk_bf16_f32 v103, v107, v111
    ds_write_b128 v3, v[100:103] offset:17856
    v_accvgpr_read_b32 v68, a160
    v_accvgpr_read_b32 v72, a180
    v_accvgpr_read_b32 v69, a161
    v_accvgpr_read_b32 v73, a181
    v_accvgpr_read_b32 v70, a162
    v_accvgpr_read_b32 v74, a182
    v_accvgpr_read_b32 v71, a163
    v_accvgpr_read_b32 v75, a183
    v_cvt_pk_bf16_f32 v64, v68, v72
    v_cvt_pk_bf16_f32 v65, v69, v73
    v_cvt_pk_bf16_f32 v66, v70, v74
    v_cvt_pk_bf16_f32 v67, v71, v75
    ds_write_b128 v2, v[64:67] offset:256
    v_accvgpr_read_b32 v80, a164
    v_accvgpr_read_b32 v84, a184
    v_accvgpr_read_b32 v81, a165
    v_accvgpr_read_b32 v85, a185
    v_accvgpr_read_b32 v82, a166
    v_accvgpr_read_b32 v86, a186
    v_accvgpr_read_b32 v83, a167
    v_accvgpr_read_b32 v87, a187
    v_cvt_pk_bf16_f32 v76, v80, v84
    v_cvt_pk_bf16_f32 v77, v81, v85
    v_cvt_pk_bf16_f32 v78, v82, v86
    v_cvt_pk_bf16_f32 v79, v83, v87
    ds_write_b128 v2, v[76:79] offset:17920
    v_accvgpr_read_b32 v92, a168
    v_accvgpr_read_b32 v96, a188
    v_accvgpr_read_b32 v93, a169
    v_accvgpr_read_b32 v97, a189
    v_accvgpr_read_b32 v94, a170
    v_accvgpr_read_b32 v98, a190
    v_accvgpr_read_b32 v95, a171
    v_accvgpr_read_b32 v99, a191
    v_cvt_pk_bf16_f32 v88, v92, v96
    v_cvt_pk_bf16_f32 v89, v93, v97
    v_cvt_pk_bf16_f32 v90, v94, v98
    v_cvt_pk_bf16_f32 v91, v95, v99
    ds_write_b128 v2, v[88:91] offset:35584
    v_accvgpr_read_b32 v104, a172
    v_accvgpr_read_b32 v108, a192
    v_accvgpr_read_b32 v105, a173
    v_accvgpr_read_b32 v109, a193
    v_accvgpr_read_b32 v106, a174
    v_accvgpr_read_b32 v110, a194
    v_accvgpr_read_b32 v107, a175
    v_accvgpr_read_b32 v111, a195
    v_cvt_pk_bf16_f32 v100, v104, v108
    v_cvt_pk_bf16_f32 v101, v105, v109
    v_cvt_pk_bf16_f32 v102, v106, v110
    v_cvt_pk_bf16_f32 v103, v107, v111
    ds_write_b128 v3, v[100:103] offset:256
    v_accvgpr_read_b32 v68, a176
    v_accvgpr_read_b32 v72, a196
    v_accvgpr_read_b32 v69, a177
    v_accvgpr_read_b32 v73, a197
    v_accvgpr_read_b32 v70, a178
    v_accvgpr_read_b32 v74, a198
    v_accvgpr_read_b32 v71, a179
    v_accvgpr_read_b32 v75, a199
    v_cvt_pk_bf16_f32 v64, v68, v72
    v_cvt_pk_bf16_f32 v65, v69, v73
    v_cvt_pk_bf16_f32 v66, v70, v74
    v_cvt_pk_bf16_f32 v67, v71, v75
    ds_write_b128 v3, v[64:67] offset:17920
L_outd:
    s_mul_i32 s36, s24, 1104
    v_add_u32 v2, s36, v44
    v_add_u32 v3, 44160, v2
    s_mul_i32 s36, s24, 2560
    s_add_u32 s36, s36, s34
    v_mul_u32_u24 v4, 1104, v0
    v_mul_u32_u24 v5, 2560, v0
    v_cmp_gt_u32 vcc, 80, v0
    v_mov_b32 v6, 0x7ff00000
    s_waitcnt lgkmcnt(0)
    v_cndmask_b32 v4, 0, v4, vcc
    v_cndmask_b32 v5, v6, v5, vcc
    s_barrier
    ds_read_b128 v[64:67], v2 offset:0
    ds_read_b128 v[68:71], v2 offset:4416
    ds_read_b128 v[72:75], v2 offset:8832
    ds_read_b128 v[76:79], v2 offset:13248
    ds_read_b128 v[80:83], v2 offset:17664
    ds_read_b128 v[84:87], v2 offset:22080
    ds_read_b128 v[88:91], v2 offset:26496
    ds_read_b128 v[92:95], v2 offset:30912
    ds_read_b128 v[96:99], v2 offset:35328
    ds_read_b128 v[100:103], v2 offset:39744
    ds_read_b128 v[104:107], v3 offset:0
    ds_read_b128 v[108:111], v3 offset:4416
    ds_read_b128 v[112:115], v3 offset:8832
    ds_read_b128 v[116:119], v3 offset:13248
    ds_read_b128 v[120:123], v3 offset:17664
    ds_read_b128 v[124:127], v3 offset:22080
    ds_read_b128 v[128:131], v3 offset:26496
    ds_read_b128 v[132:135], v3 offset:30912
    ds_read_b128 v[136:139], v3 offset:35328
    ds_read_b128 v[140:143], v3 offset:39744
    ds_read_b128 v[144:147], v4 offset:1024
    s_waitcnt lgkmcnt(15)
    buffer_store_dwordx4 v[64:67], v44, s[16:19], s36 offen sc1
    s_add_u32 s36, s36, 10240
    s_waitcnt lgkmcnt(15)
    buffer_store_dwordx4 v[68:71], v44, s[16:19], s36 offen sc1
    s_add_u32 s36, s36, 10240
    s_waitcnt lgkmcnt(15)
    buffer_store_dwordx4 v[72:75], v44, s[16:19], s36 offen sc1
    s_add_u32 s36, s36, 10240
    s_waitcnt lgkmcnt(15)
    buffer_store_dwordx4 v[76:79], v44, s[16:19], s36 offen sc1
    s_add_u32 s36, s36, 10240
    s_waitcnt lgkmcnt(15)
    buffer_store_dwordx4 v[80:83], v44, s[16:19], s36 offen sc1
    s_add_u32 s36, s36, 10240
    s_waitcnt lgkmcnt(15)
    buffer_store_dwordx4 v[84:87], v44, s[16:19], s36 offen sc1
    s_add_u32 s36, s36, 10240
    s_waitcnt lgkmcnt(14)
    buffer_store_dwordx4 v[88:91], v44, s[16:19], s36 offen sc1
    s_add_u32 s36, s36, 10240
    s_waitcnt lgkmcnt(13)
    buffer_store_dwordx4 v[92:95], v44, s[16:19], s36 offen sc1
    s_add_u32 s36, s36, 10240
    s_waitcnt lgkmcnt(12)
    buffer_store_dwordx4 v[96:99], v44, s[16:19], s36 offen sc1
    s_add_u32 s36, s36, 10240
    s_waitcnt lgkmcnt(11)
    buffer_store_dwordx4 v[100:103], v44, s[16:19], s36 offen sc1
    s_add_u32 s36, s36, 10240
    s_waitcnt lgkmcnt(10)
    buffer_store_dwordx4 v[104:107], v44, s[16:19], s36 offen sc1
    s_add_u32 s36, s36, 10240
    s_waitcnt lgkmcnt(9)
    buffer_store_dwordx4 v[108:111], v44, s[16:19], s36 offen sc1
    s_add_u32 s36, s36, 10240
    s_waitcnt lgkmcnt(8)
    buffer_store_dwordx4 v[112:115], v44, s[16:19], s36 offen sc1
    s_add_u32 s36, s36, 10240
    s_waitcnt lgkmcnt(7)
    buffer_store_dwordx4 v[116:119], v44, s[16:19], s36 offen sc1
    s_add_u32 s36, s36, 10240
    s_waitcnt lgkmcnt(6)
    buffer_store_dwordx4 v[120:123], v44, s[16:19], s36 offen sc1
    s_add_u32 s36, s36, 10240
    s_waitcnt lgkmcnt(5)
    buffer_store_dwordx4 v[124:127], v44, s[16:19], s36 offen sc1
    s_add_u32 s36, s36, 10240
    s_waitcnt lgkmcnt(4)
    buffer_store_dwordx4 v[128:131], v44, s[16:19], s36 offen sc1
    s_add_u32 s36, s36, 10240
    s_waitcnt lgkmcnt(3)
    buffer_store_dwordx4 v[132:135], v44, s[16:19], s36 offen sc1
    s_add_u32 s36, s36, 10240
    s_waitcnt lgkmcnt(2)
    buffer_store_dwordx4 v[136:139], v44, s[16:19], s36 offen sc1
    s_add_u32 s36, s36, 10240
    s_waitcnt lgkmcnt(1)
    buffer_store_dwordx4 v[140:143], v44, s[16:19], s36 offen sc1
    s_add_u32 s36, s36, 10240
    s_waitcnt lgkmcnt(0)
    s_add_u32 s34, s34, 1024
    buffer_store_dwordx4 v[144:147], v5, s[16:19], s34 offen sc1
    s_barrier
    s_add_u32 m0, s69, 0
    s_nop 0
    buffer_load_dwordx4 v40, s[40:43], s54 offen offset:0 lds
    buffer_load_dwordx4 v41, s[40:43], s54 offen offset:1024 lds
    buffer_load_dwordx4 v42, s[40:43], s54 offen offset:2048 lds
    buffer_load_dwordx4 v43, s[40:43], s54 offen offset:3072 lds
    s_add_u32 m0, s69, 4096
    s_nop 0
    buffer_load_dwordx4 v40, s[40:43], s55 offen offset:0 lds
    buffer_load_dwordx4 v41, s[40:43], s55 offen offset:1024 lds
    buffer_load_dwordx4 v42, s[40:43], s55 offen offset:2048 lds
    buffer_load_dwordx4 v43, s[40:43], s55 offen offset:3072 lds
    s_add_u32 s54, s54, 131072
    s_cmp_eq_u32 s54, s101
    s_cselect_b32 s54, s100, s54
    s_add_u32 s55, s54, 65536
    s_add_u32 m0, s70, 0
    s_nop 0
    buffer_load_dwordx4 v40, s[40:43], s54 offen offset:0 lds
    buffer_load_dwordx4 v41, s[40:43], s54 offen offset:1024 lds
    buffer_load_dwordx4 v42, s[40:43], s54 offen offset:2048 lds
    buffer_load_dwordx4 v43, s[40:43], s54 offen offset:3072 lds
    s_add_u32 m0, s70, 4096
    s_nop 0
    buffer_load_dwordx4 v40, s[40:43], s55 offen offset:0 lds
    buffer_load_dwordx4 v41, s[40:43], s55 offen offset:1024 lds
    buffer_load_dwordx4 v42, s[40:43], s55 offen offset:2048 lds
    buffer_load_dwordx4 v43, s[40:43], s55 offen offset:3072 lds
    s_add_u32 s54, s54, 131072
    s_cmp_eq_u32 s54, s101
    s_cselect_b32 s54, s100, s54
    s_add_u32 s55, s54, 65536
    s_add_u32 m0, s70, 8192
    s_nop 0
    buffer_load_dwordx4 v40, s[40:43], s54 offen offset:0 lds
    buffer_load_dwordx4 v41, s[40:43], s54 offen offset:1024 lds
    buffer_load_dwordx4 v42, s[40:43], s54 offen offset:2048 lds
    buffer_load_dwordx4 v43, s[40:43], s54 offen offset:3072 lds
    s_add_u32 m0, s70, 12288
    s_nop 0
    buffer_load_dwordx4 v40, s[40:43], s55 offen offset:0 lds
    buffer_load_dwordx4 v41, s[40:43], s55 offen offset:1024 lds
    buffer_load_dwordx4 v42, s[40:43], s55 offen offset:2048 lds
    buffer_load_dwordx4 v43, s[40:43], s55 offen offset:3072 lds
    s_add_u32 s54, s54, 131072
    s_cmp_eq_u32 s54, s101
    s_cselect_b32 s54, s100, s54
    s_add_u32 s55, s54, 65536
    s_waitcnt vmcnt(16)
    s_barrier
    s_cmp_lg_u32 s24, 0
    s_cbranch_scc1 L_auxt
    s_mul_i32 s3, s25, 7
    s_add_u32 s3, s3, s26
    s_lshl_b32 s3, s3, 2
    v_mov_b32 v2, s62
    v_mov_b32 v3, s3
    s_mov_b64 exec, 1
    buffer_store_dword v2, v3, s[48:51], 0 offen offset:1024 sc1
    s_mov_b64 exec, -1
    s_branch L_auxt
L_spare:
    v_mov_b32 v64, 0
    v_mov_b32 v65, 0
    v_mov_b32 v66, 0
    v_mov_b32 v67, 0
    s_mul_i32 s3, s25, 626688
    s_add_u32 s3, s3, 590976
    s_lshl_b32 s28, s24, 10
    s_add_u32 s3, s3, s28
    s_mul_i32 s22, s25, 626688
    s_add_u32 s22, s22, 626688
    buffer_store_dwordx4 v[64:67], v44, s[20:23], s3 offen sc1
    s_add_u32 s3, s3, 4096
    buffer_store_dwordx4 v[64:67], v44, s[20:23], s3 offen sc1
    s_add_u32 s3, s3, 4096
    buffer_store_dwordx4 v[64:67], v44, s[20:23], s3 offen sc1
    s_add_u32 s3, s3, 4096
    buffer_store_dwordx4 v[64:67], v44, s[20:23], s3 offen sc1
    s_add_u32 s3, s3, 4096
    buffer_store_dwordx4 v[64:67], v44, s[20:23], s3 offen sc1
    s_add_u32 s3, s3, 4096
    buffer_store_dwordx4 v[64:67], v44, s[20:23], s3 offen sc1
    s_add_u32 s3, s3, 4096
    buffer_store_dwordx4 v[64:67], v44, s[20:23], s3 offen sc1
    s_add_u32 s3, s3, 4096
    buffer_store_dwordx4 v[64:67], v44, s[20:23], s3 offen sc1
    s_add_u32 s3, s3, 4096
    buffer_store_dwordx4 v[64:67], v44, s[20:23], s3 offen sc1
    s_add_u32 s3, s3, 4096
    s_waitcnt vmcnt(0)
    s_barrier
    s_cmp_lg_u32 s24, 0
    s_cbranch_scc1 L_s_fx
    s_lshl_b32 s3, s2, 2
    v_mov_b32 v2, s62
    v_mov_b32 v3, s3
    s_mov_b64 exec, 1
    buffer_store_dword v2, v3, s[48:51], 0 offen offset:3072 sc1
    s_mov_b64 exec, -1
L_s_fx:
    s_lshr_b32 s28, s25, 1
    s_cmp_eq_u32 s28, 0
    s_cselect_b32 s16, s88, s90
    s_cselect_b32 s17, s89, s91
    s_mov_b32 s18, 2097152
    s_mov_b32 s19, 0x00020000
    s_add_u32 s20, s4, 34603008
    s_addc_u32 s21, s5, 0
    s_mov_b32 s22, 737280
    v_and_b32 v4, 15, v1
    v_lshrrev_b32 v5, 4, v1
    v_lshlrev_b32 v6, 12, v4
    v_lshl_add_u32 v6, v5, 4, v6
    s_and_b32 s29, s25, 1
    s_lshl_b32 s29, s29, 1
    s_lshr_b32 s30, s24, 1
    s_add_u32 s29, s29, s30
    s_and_b32 s30, s24, 1
    s_mul_i32 s30, s30, 5
    s_lshl_b32 s31, s28, 2
    s_add_u32 s31, s31, s29
    s_mul_i32 s31, s31, 90
    s_add_u32 s31, s31, s30
    s_lshl_b32 s31, s31, 10
    s_mul_i32 s29, s29, 160
    s_lshr_b32 s3, s30, 1
    s_lshl_b32 s3, s3, 5
    s_add_u32 s3, s3, s29
    s_and_b32 s32, s30, 1
    s_add_u32 s3, s3, s32
    s_lshl_b32 s3, s3, 11
    buffer_load_dwordx4 v[64:67], v6, s[16:19], s3 offen offset:0
    buffer_load_dwordx4 v[68:71], v6, s[16:19], s3 offen offset:64
    buffer_load_dwordx4 v[72:75], v6, s[16:19], s3 offen offset:128
    buffer_load_dwordx4 v[76:79], v6, s[16:19], s3 offen offset:192
    buffer_load_dwordx4 v[80:83], v6, s[16:19], s3 offen offset:256
    buffer_load_dwordx4 v[84:87], v6, s[16:19], s3 offen offset:320
    buffer_load_dwordx4 v[88:91], v6, s[16:19], s3 offen offset:384
    buffer_load_dwordx4 v[92:95], v6, s[16:19], s3 offen offset:448
    buffer_load_dwordx4 v[96:99], v6, s[16:19], s3 offen offset:512
    s_add_u32 s30, s30, 1
    s_lshr_b32 s3, s30, 1
    s_lshl_b32 s3, s3, 5
    s_add_u32 s3, s3, s29
    s_and_b32 s32, s30, 1
    s_add_u32 s3, s3, s32
    s_lshl_b32 s3, s3, 11
    buffer_load_dwordx4 v[100:103], v6, s[16:19], s3 offen offset:0
    buffer_load_dwordx4 v[104:107], v6, s[16:19], s3 offen offset:64
    buffer_load_dwordx4 v[108:111], v6, s[16:19], s3 offen offset:128
    buffer_load_dwordx4 v[112:115], v6, s[16:19], s3 offen offset:192
    buffer_load_dwordx4 v[116:119], v6, s[16:19], s3 offen offset:256
    buffer_load_dwordx4 v[120:123], v6, s[16:19], s3 offen offset:320
    buffer_load_dwordx4 v[124:127], v6, s[16:19], s3 offen offset:384
    buffer_load_dwordx4 v[128:131], v6, s[16:19], s3 offen offset:448
    buffer_load_dwordx4 v[132:135], v6, s[16:19], s3 offen offset:512
    s_add_u32 s30, s30, 1
    s_lshr_b32 s3, s30, 1
    s_lshl_b32 s3, s3, 5
    s_add_u32 s3, s3, s29
    s_and_b32 s32, s30, 1
    s_add_u32 s3, s3, s32
    s_lshl_b32 s3, s3, 11
    buffer_load_dwordx4 v[136:139], v6, s[16:19], s3 offen offset:0
    buffer_load_dwordx4 v[140:143], v6, s[16:19], s3 offen offset:64
    buffer_load_dwordx4 v[144:147], v6, s[16:19], s3 offen offset:128
    buffer_load_dwordx4 v[148:151], v6, s[16:19], s3 offen offset:192
    buffer_load_dwordx4 v[152:155], v6, s[16:19], s3 offen offset:256
    buffer_load_dwordx4 v[156:159], v6, s[16:19], s3 offen offset:320
    buffer_load_dwordx4 v[160:163], v6, s[16:19], s3 offen offset:384
    buffer_load_dwordx4 v[164:167], v6, s[16:19], s3 offen offset:448
    buffer_load_dwordx4 v[168:171], v6, s[16:19], s3 offen offset:512
    s_add_u32 s30, s30, 1
    s_lshr_b32 s3, s30, 1
    s_lshl_b32 s3, s3, 5
    s_add_u32 s3, s3, s29
    s_and_b32 s32, s30, 1
    s_add_u32 s3, s3, s32
    s_lshl_b32 s3, s3, 11
    buffer_load_dwordx4 v[172:175], v6, s[16:19], s3 offen offset:0
    buffer_load_dwordx4 v[176:179], v6, s[16:19], s3 offen offset:64
    buffer_load_dwordx4 v[180:183], v6, s[16:19], s3 offen offset:128
    buffer_load_dwordx4 v[184:187], v6, s[16:19], s3 offen offset:192
    buffer_load_dwordx4 v[188:191], v6, s[16:19], s3 offen offset:256
    buffer_load_dwordx4 v[192:195], v6, s[16:19], s3 offen offset:320
    buffer_load_dwordx4 v[196:199], v6, s[16:19], s3 offen offset:384
    buffer_load_dwordx4 v[200:203], v6, s[16:19], s3 offen offset:448
    buffer_load_dwordx4 v[204:207], v6, s[16:19], s3 offen offset:512
    s_add_u32 s30, s30, 1
    s_lshr_b32 s3, s30, 1
    s_lshl_b32 s3, s3, 5
    s_add_u32 s3, s3, s29
    s_and_b32 s32, s30, 1
    s_add_u32 s3, s3, s32
    s_lshl_b32 s3, s3, 11
    buffer_load_dwordx4 v[208:211], v6, s[16:19], s3 offen offset:0
    buffer_load_dwordx4 v[212:215], v6, s[16:19], s3 offen offset:64
    buffer_load_dwordx4 v[216:219], v6, s[16:19], s3 offen offset:128
    buffer_load_dwordx4 v[220:223], v6, s[16:19], s3 offen offset:192
    buffer_load_dwordx4 v[224:227], v6, s[16:19], s3 offen offset:256
    buffer_load_dwordx4 v[228:231], v6, s[16:19], s3 offen offset:320
    buffer_load_dwordx4 v[232:235], v6, s[16:19], s3 offen offset:384
    buffer_load_dwordx4 v[236:239], v6, s[16:19], s3 offen offset:448
    buffer_load_dwordx4 v[240:243], v6, s[16:19], s3 offen offset:512
    s_add_u32 s30, s30, 1
    s_mov_b32 s3, s31
    s_waitcnt vmcnt(44)
    buffer_store_dwordx4 v[64:67], v44, s[20:23], s3 offen sc1
    s_add_u32 s3, s3, 10240
    s_waitcnt vmcnt(44)
    buffer_store_dwordx4 v[68:71], v44, s[20:23], s3 offen sc1
    s_add_u32 s3, s3, 10240
    s_waitcnt vmcnt(44)
    buffer_store_dwordx4 v[72:75], v44, s[20:23], s3 offen sc1
    s_add_u32 s3, s3, 10240
    s_waitcnt vmcnt(44)
    buffer_store_dwordx4 v[76:79], v44, s[20:23], s3 offen sc1
    s_add_u32 s3, s3, 10240
    s_waitcnt vmcnt(44)
    buffer_store_dwordx4 v[80:83], v44, s[20:23], s3 offen sc1
    s_add_u32 s3, s3, 10240
    s_waitcnt vmcnt(44)
    buffer_store_dwordx4 v[84:87], v44, s[20:23], s3 offen sc1
    s_add_u32 s3, s3, 10240
    s_waitcnt vmcnt(44)
    buffer_store_dwordx4 v[88:91], v44, s[20:23], s3 offen sc1
    s_add_u32 s3, s3, 10240
    s_waitcnt vmcnt(44)
    buffer_store_dwordx4 v[92:95], v44, s[20:23], s3 offen sc1
    s_add_u32 s3, s3, 10240
    s_waitcnt vmcnt(44)
    buffer_store_dwordx4 v[96:99], v44, s[20:23], s3 offen sc1
    s_add_u32 s3, s3, 10240
    s_add_u32 s31, s31, 1024
    s_mov_b32 s3, s31
    s_waitcnt vmcnt(44)
    buffer_store_dwordx4 v[100:103], v44, s[20:23], s3 offen sc1
    s_add_u32 s3, s3, 10240
    s_waitcnt vmcnt(44)
    buffer_store_dwordx4 v[104:107], v44, s[20:23], s3 offen sc1
    s_add_u32 s3, s3, 10240
    s_waitcnt vmcnt(44)
    buffer_store_dwordx4 v[108:111], v44, s[20:23], s3 offen sc1
    s_add_u32 s3, s3, 10240
    s_waitcnt vmcnt(44)
    buffer_store_dwordx4 v[112:115], v44, s[20:23], s3 offen sc1
    s_add_u32 s3, s3, 10240
    s_waitcnt vmcnt(44)
    buffer_store_dwordx4 v[116:119], v44, s[20:23], s3 offen sc1
    s_add_u32 s3, s3, 10240
    s_waitcnt vmcnt(44)
    buffer_store_dwordx4 v[120:123], v44, s[20:23], s3 offen sc1
    s_add_u32 s3, s3, 10240
    s_waitcnt vmcnt(44)
    buffer_store_dwordx4 v[124:127], v44, s[20:23], s3 offen sc1
    s_add_u32 s3, s3, 10240
    s_waitcnt vmcnt(44)
    buffer_store_dwordx4 v[128:131], v44, s[20:23], s3 offen sc1
    s_add_u32 s3, s3, 10240
    s_waitcnt vmcnt(44)
    buffer_store_dwordx4 v[132:135], v44, s[20:23], s3 offen sc1
    s_add_u32 s3, s3, 10240
    s_add_u32 s31, s31, 1024
    s_mov_b32 s3, s31
    s_waitcnt vmcnt(44)
    buffer_store_dwordx4 v[136:139], v44, s[20:23], s3 offen sc1
    s_add_u32 s3, s3, 10240
    s_waitcnt vmcnt(44)
    buffer_store_dwordx4 v[140:143], v44, s[20:23], s3 offen sc1
    s_add_u32 s3, s3, 10240
    s_waitcnt vmcnt(44)
    buffer_store_dwordx4 v[144:147], v44, s[20:23], s3 offen sc1
    s_add_u32 s3, s3, 10240
    s_waitcnt vmcnt(44)
    buffer_store_dwordx4 v[148:151], v44, s[20:23], s3 offen sc1
    s_add_u32 s3, s3, 10240
    s_waitcnt vmcnt(44)
    buffer_store_dwordx4 v[152:155], v44, s[20:23], s3 offen sc1
    s_add_u32 s3, s3, 10240
    s_waitcnt vmcnt(44)
    buffer_store_dwordx4 v[156:159], v44, s[20:23], s3 offen sc1
    s_add_u32 s3, s3, 10240
    s_waitcnt vmcnt(44)
    buffer_store_dwordx4 v[160:163], v44, s[20:23], s3 offen sc1
    s_add_u32 s3, s3, 10240
    s_waitcnt vmcnt(44)
    buffer_store_dwordx4 v[164:167], v44, s[20:23], s3 offen sc1
    s_add_u32 s3, s3, 10240
    s_waitcnt vmcnt(44)
    buffer_store_dwordx4 v[168:171], v44, s[20:23], s3 offen sc1
    s_add_u32 s3, s3, 10240
    s_add_u32 s31, s31, 1024
    s_mov_b32 s3, s31
    s_waitcnt vmcnt(44)
    buffer_store_dwordx4 v[172:175], v44, s[20:23], s3 offen sc1
    s_add_u32 s3, s3, 10240
    s_waitcnt vmcnt(44)
    buffer_store_dwordx4 v[176:179], v44, s[20:23], s3 offen sc1
    s_add_u32 s3, s3, 10240
    s_waitcnt vmcnt(44)
    buffer_store_dwordx4 v[180:183], v44, s[20:23], s3 offen sc1
    s_add_u32 s3, s3, 10240
    s_waitcnt vmcnt(44)
    buffer_store_dwordx4 v[184:187], v44, s[20:23], s3 offen sc1
    s_add_u32 s3, s3, 10240
    s_waitcnt vmcnt(44)
    buffer_store_dwordx4 v[188:191], v44, s[20:23], s3 offen sc1
    s_add_u32 s3, s3, 10240
    s_waitcnt vmcnt(44)
    buffer_store_dwordx4 v[192:195], v44, s[20:23], s3 offen sc1
    s_add_u32 s3, s3, 10240
    s_waitcnt vmcnt(44)
    buffer_store_dwordx4 v[196:199], v44, s[20:23], s3 offen sc1
    s_add_u32 s3, s3, 10240
    s_waitcnt vmcnt(44)
    buffer_store_dwordx4 v[200:203], v44, s[20:23], s3 offen sc1
    s_add_u32 s3, s3, 10240
    s_waitcnt vmcnt(44)
    buffer_store_dwordx4 v[204:207], v44, s[20:23], s3 offen sc1
    s_add_u32 s3, s3, 10240
    s_add_u32 s31, s31, 1024
    s_mov_b32 s3, s31
    s_waitcnt vmcnt(44)
    buffer_store_dwordx4 v[208:211], v44, s[20:23], s3 offen sc1
    s_add_u32 s3, s3, 10240
    s_waitcnt vmcnt(44)
    buffer_store_dwordx4 v[212:215], v44, s[20:23], s3 offen sc1
    s_add_u32 s3, s3, 10240
    s_waitcnt vmcnt(44)
    buffer_store_dwordx4 v[216:219], v44, s[20:23], s3 offen sc1
    s_add_u32 s3, s3, 10240
    s_waitcnt vmcnt(44)
    buffer_store_dwordx4 v[220:223], v44, s[20:23], s3 offen sc1
    s_add_u32 s3, s3, 10240
    s_waitcnt vmcnt(44)
    buffer_store_dwordx4 v[224:227], v44, s[20:23], s3 offen sc1
    s_add_u32 s3, s3, 10240
    s_waitcnt vmcnt(44)
    buffer_store_dwordx4 v[228:231], v44, s[20:23], s3 offen sc1
    s_add_u32 s3, s3, 10240
    s_waitcnt vmcnt(44)
    buffer_store_dwordx4 v[232:235], v44, s[20:23], s3 offen sc1
    s_add_u32 s3, s3, 10240
    s_waitcnt vmcnt(44)
    buffer_store_dwordx4 v[236:239], v44, s[20:23], s3 offen sc1
    s_add_u32 s3, s3, 10240
    s_waitcnt vmcnt(44)
    buffer_store_dwordx4 v[240:243], v44, s[20:23], s3 offen sc1
    s_add_u32 s3, s3, 10240
    s_add_u32 s31, s31, 1024
    s_waitcnt vmcnt(0)
    s_barrier
    s_cmp_lg_u32 s24, 0
    s_cbranch_scc1 L_sfd
    s_lshl_b32 s3, s25, 2
    v_mov_b32 v2, s62
    v_mov_b32 v3, s3
    s_mov_b64 exec, 1
    buffer_store_dword v2, v3, s[48:51], 0 offen offset:1136 sc1
    s_mov_b64 exec, -1
L_sfd:
    s_add_u32 m0, s68, 0
    s_nop 0
    buffer_load_dwordx4 v40, s[40:43], s54 offen offset:0 lds
    buffer_load_dwordx4 v41, s[40:43], s54 offen offset:1024 lds
    buffer_load_dwordx4 v42, s[40:43], s54 offen offset:2048 lds
    buffer_load_dwordx4 v43, s[40:43], s54 offen offset:3072 lds
    s_add_u32 m0, s68, 4096
    s_nop 0
    buffer_load_dwordx4 v40, s[40:43], s55 offen offset:0 lds
    buffer_load_dwordx4 v41, s[40:43], s55 offen offset:1024 lds
    buffer_load_dwordx4 v42, s[40:43], s55 offen offset:2048 lds
    buffer_load_dwordx4 v43, s[40:43], s55 offen offset:3072 lds
    s_add_u32 s54, s54, 131072
    s_cmp_eq_u32 s54, s101
    s_cselect_b32 s54, s100, s54
    s_add_u32 s55, s54, 65536
    s_add_u32 m0, s68, 8192
    s_nop 0
    buffer_load_dwordx4 v40, s[40:43], s54 offen offset:0 lds
    buffer_load_dwordx4 v41, s[40:43], s54 offen offset:1024 lds
    buffer_load_dwordx4 v42, s[40:43], s54 offen offset:2048 lds
    buffer_load_dwordx4 v43, s[40:43], s54 offen offset:3072 lds
    s_add_u32 m0, s68, 12288
    s_nop 0
    buffer_load_dwordx4 v40, s[40:43], s55 offen offset:0 lds
    buffer_load_dwordx4 v41, s[40:43], s55 offen offset:1024 lds
    buffer_load_dwordx4 v42, s[40:43], s55 offen offset:2048 lds
    buffer_load_dwordx4 v43, s[40:43], s55 offen offset:3072 lds
    s_add_u32 s54, s54, 131072
    s_cmp_eq_u32 s54, s101
    s_cselect_b32 s54, s100, s54
    s_add_u32 s55, s54, 65536
    s_add_u32 m0, s69, 0
    s_nop 0
    buffer_load_dwordx4 v40, s[40:43], s54 offen offset:0 lds
    buffer_load_dwordx4 v41, s[40:43], s54 offen offset:1024 lds
    buffer_load_dwordx4 v42, s[40:43], s54 offen offset:2048 lds
    buffer_load_dwordx4 v43, s[40:43], s54 offen offset:3072 lds
    s_add_u32 m0, s69, 4096
    s_nop 0
    buffer_load_dwordx4 v40, s[40:43], s55 offen offset:0 lds
    buffer_load_dwordx4 v41, s[40:43], s55 offen offset:1024 lds
    buffer_load_dwordx4 v42, s[40:43], s55 offen offset:2048 lds
    buffer_load_dwordx4 v43, s[40:43], s55 offen offset:3072 lds
    s_add_u32 s54, s54, 131072
    s_cmp_eq_u32 s54, s101
    s_cselect_b32 s54, s100, s54
    s_add_u32 s55, s54, 65536
    s_add_u32 m0, s70, 0
    s_nop 0
    buffer_load_dwordx4 v40, s[40:43], s54 offen offset:0 lds
    buffer_load_dwordx4 v41, s[40:43], s54 offen offset:1024 lds
    buffer_load_dwordx4 v42, s[40:43], s54 offen offset:2048 lds
    buffer_load_dwordx4 v43, s[40:43], s54 offen offset:3072 lds
    s_add_u32 m0, s70, 4096
    s_nop 0
    buffer_load_dwordx4 v40, s[40:43], s55 offen offset:0 lds
    buffer_load_dwordx4 v41, s[40:43], s55 offen offset:1024 lds
    buffer_load_dwordx4 v42, s[40:43], s55 offen offset:2048 lds
    buffer_load_dwordx4 v43, s[40:43], s55 offen offset:3072 lds
    s_add_u32 s54, s54, 131072
    s_cmp_eq_u32 s54, s101
    s_cselect_b32 s54, s100, s54
    s_add_u32 s55, s54, 65536
    s_add_u32 m0, s70, 8192
    s_nop 0
    buffer_load_dwordx4 v40, s[40:43], s54 offen offset:0 lds
    buffer_load_dwordx4 v41, s[40:43], s54 offen offset:1024 lds
    buffer_load_dwordx4 v42, s[40:43], s54 offen offset:2048 lds
    buffer_load_dwordx4 v43, s[40:43], s54 offen offset:3072 lds
    s_add_u32 m0, s70, 12288
    s_nop 0
    buffer_load_dwordx4 v40, s[40:43], s55 offen offset:0 lds
    buffer_load_dwordx4 v41, s[40:43], s55 offen offset:1024 lds
    buffer_load_dwordx4 v42, s[40:43], s55 offen offset:2048 lds
    buffer_load_dwordx4 v43, s[40:43], s55 offen offset:3072 lds
    s_add_u32 s54, s54, 131072
    s_cmp_eq_u32 s54, s101
    s_cselect_b32 s54, s100, s54
    s_add_u32 s55, s54, 65536
    s_waitcnt vmcnt(16)
L_auxt:
    ds_read_b64_tr_b16 a[128:129], v48 offset:0
    ds_read_b64_tr_b16 a[130:131], v48 offset:2048
    ds_read_b64_tr_b16 a[160:161], v49 offset:0
    ds_read_b64_tr_b16 a[162:163], v49 offset:2048
    ds_read_b64_tr_b16 a[192:193], v50 offset:0
    ds_read_b64_tr_b16 a[194:195], v50 offset:2048
    ds_read_b64_tr_b16 a[224:225], v51 offset:0
    ds_read_b64_tr_b16 a[226:227], v51 offset:2048
    ds_read_b64_tr_b16 a[132:133], v48 offset:4096
    ds_read_b64_tr_b16 a[134:135], v48 offset:6144
    ds_read_b64_tr_b16 a[164:165], v49 offset:4096
    ds_read_b64_tr_b16 a[166:167], v49 offset:6144
    ds_read_b64_tr_b16 a[196:197], v50 offset:4096
    ds_read_b64_tr_b16 a[198:199], v50 offset:6144
    ds_read_b64_tr_b16 a[228:229], v51 offset:4096
    ds_read_b64_tr_b16 a[230:231], v51 offset:6144
    ds_read_b64_tr_b16 a[136:137], v48 offset:8192
    ds_read_b64_tr_b16 a[138:139], v48 offset:10240
    ds_read_b64_tr_b16 a[168:169], v49 offset:8192
    ds_read_b64_tr_b16 a[170:171], v49 offset:10240
    ds_read_b64_tr_b16 a[200:201], v50 offset:8192
    ds_read_b64_tr_b16 a[202:203], v50 offset:10240
    ds_read_b64_tr_b16 a[232:233], v51 offset:8192
    ds_read_b64_tr_b16 a[234:235], v51 offset:10240
    ds_read_b64_tr_b16 a[140:141], v48 offset:12288
    ds_read_b64_tr_b16 a[142:143], v48 offset:14336
    ds_read_b64_tr_b16 a[172:173], v49 offset:12288
    ds_read_b64_tr_b16 a[174:175], v49 offset:14336
    ds_read_b64_tr_b16 a[204:205], v50 offset:12288
    ds_read_b64_tr_b16 a[206:207], v50 offset:14336
    ds_read_b64_tr_b16 a[236:237], v51 offset:12288
    ds_read_b64_tr_b16 a[238:239], v51 offset:14336
    ds_read_b64_tr_b16 a[144:145], v52 offset:0
    ds_read_b64_tr_b16 a[146:147], v52 offset:2048
    ds_read_b64_tr_b16 a[176:177], v53 offset:0
    ds_read_b64_tr_b16 a[178:179], v53 offset:2048
    ds_read_b64_tr_b16 a[208:209], v54 offset:0
    ds_read_b64_tr_b16 a[210:211], v54 offset:2048
    ds_read_b64_tr_b16 a[240:241], v55 offset:0
    ds_read_b64_tr_b16 a[242:243], v55 offset:2048
    ds_read_b64_tr_b16 a[148:149], v52 offset:4096
    ds_read_b64_tr_b16 a[150:151], v52 offset:6144
    ds_read_b64_tr_b16 a[180:181], v53 offset:4096
    ds_read_b64_tr_b16 a[182:183], v53 offset:6144
    ds_read_b64_tr_b16 a[212:213], v54 offset:4096
    ds_read_b64_tr_b16 a[214:215], v54 offset:6144
    ds_read_b64_tr_b16 a[244:245], v55 offset:4096
    ds_read_b64_tr_b16 a[246:247], v55 offset:6144
    s_waitcnt lgkmcnt(0)
    s_branch L_g4
L_done:
    s_endpgm
L_end:
.section .rodata,"a"
.p2align 6
.amdhsa_kernel recurrent_scan__spectral_fnet__glu_gated_bilinear__prompt_kernel
.amdhsa_next_free_vgpr 512
.amdhsa_next_free_sgpr 102
.amdhsa_accum_offset 256
.amdhsa_group_segment_fixed_size 0
.amdhsa_kernarg_size 96
.amdhsa_user_sgpr_count 2
.amdhsa_user_sgpr_kernarg_segment_ptr 1
.amdhsa_system_sgpr_workgroup_id_x 1
.end_amdhsa_kernel
```
